```python
import torch

def _softmax(x, axis=-1):
    return torch.softmax(x, dim=axis)
def _gelu(x):
    return torch.nn.functional.gelu(x, approximate="tanh")
def _silu(x):
    return torch.nn.functional.silu(x)
def _sigmoid(x):
    return torch.sigmoid(x)
def _layernorm(x, axis=-1, eps=1e-5):
    m = x.mean(dim=axis, keepdim=True)
    v = x.var(dim=axis, keepdim=True, unbiased=False)
    return (x - m) / torch.sqrt(v + eps)
def _scatter_add(tgt, idx, src, axis=0):
    return tgt.clone().index_add_(axis, idx, src)
def _segment_sum(src, seg, n):
    out = torch.zeros((n,) + src.shape[1:], dtype=src.dtype)
    return out.index_add_(0, seg, src)
def _pad(x, pw):
    flat = tuple(v for pair in reversed(pw) for v in pair)
    return torch.nn.functional.pad(x, flat)

kernel_name = 'recurrent_scan__gqa_block_cached__dense_activation_gelu__prompt'

def setup_inputs():

    _w = (lambda a: (lambda t: t.to(torch.bfloat16) if t.is_floating_point() else t)(torch.as_tensor(a)))
    def _A_setup():
        B, Sq, D = 1, 2048, 512
        Hq, Hkv, Sk, Dh = 32, 32, 2048, 128
        assert Hq % Hkv == 0, (Hq, Hkv)
        return {
            "x": _w((lambda *s: torch.randn(*s, dtype=torch.bfloat16) * 0.05)(B, Sq, D)),
            "k_cache": _w((lambda *s: torch.randn(*s, dtype=torch.bfloat16) * 3.2)(B, Hkv, Sk, Dh)),
            "v_cache": _w((lambda *s: torch.randn(*s, dtype=torch.bfloat16) * 3.2)(B, Hkv, Sk, Dh)),
            "wq": _w((lambda *s: torch.randn(*s, dtype=torch.bfloat16) * 3.2)(D, Hq * Dh) * (D ** -0.5)),
            "wo": _w((lambda *s: torch.randn(*s, dtype=torch.bfloat16) * 3.2)(Hq * Dh, D) * ((Hq * Dh) ** -0.5)),
        }
    _A_in = _A_setup()

    def _B_setup():
        B, S, D, F = 1, 2048, 512, 1376
        return {
            "x": _w((lambda *s: torch.randn(*s, dtype=torch.bfloat16) * 0.05)(B, S, D)),
            "w1": _w((lambda *s: torch.randn(*s, dtype=torch.bfloat16) * 3.2)(D, F) * (D ** -0.5)),
            "b1": _w((lambda *s: torch.randn(*s, dtype=torch.bfloat16) * 3.2)(F) * 0.01),
            "w2": _w((lambda *s: torch.randn(*s, dtype=torch.bfloat16) * 0.8)(F, D) * (F ** -0.5)),
            "b2": _w((lambda *s: torch.randn(*s, dtype=torch.bfloat16) * 0.8)(D) * 0.01),
        }
    _B_in = _B_setup()

    return {
        "A_x": _A_in["x"],
        "A_k_cache": _A_in["k_cache"],
        "A_v_cache": _A_in["v_cache"],
        "A_wq": _A_in["wq"],
        "A_wo": _A_in["wo"],
        "B_x": _B_in["x"],
        "B_w1": _B_in["w1"],
        "B_b1": _B_in["b1"],
        "B_w2": _B_in["w2"],
        "B_b2": _B_in["b2"],
    }

def reference(A_x, A_k_cache, A_v_cache, A_wq, A_wo, B_x, B_w1, B_b1, B_w2, B_b2):
    def _A_ref(x, k_cache, v_cache, wq, wo):
        B, Sq, D = x.shape
        Hq, Dh = 32, 128
        Hkv = k_cache.shape[1]
        rep = Hq // Hkv
        q = (lambda x, *d: x.permute(*d))((x @ wq).reshape(B, Sq, Hq, Dh), 0, 2, 1, 3)
        k = (lambda x, n, axis: torch.repeat_interleave(x, n, dim=axis))(k_cache, rep, axis=1)
        v = (lambda x, n, axis: torch.repeat_interleave(x, n, dim=axis))(v_cache, rep, axis=1)
        scores = torch.einsum("bhqd,bhkd->bhqk", q, k) * (Dh ** -0.5)
        p = _softmax(scores, axis=-1)
        o = torch.einsum("bhqk,bhkd->bhqd", p, v)
        return (lambda x, *d: x.permute(*d))(o, 0, 2, 1, 3).reshape(B, Sq, Hq * Dh) @ wo

    def _B_ref(x, w1, b1, w2, b2):
        h = torch.einsum("bsd,df->bsf", x, w1) + b1
        h = _gelu(h)
        return torch.einsum("bsf,fd->bsd", h, w2) + b2

    x = A_x
    xn = _layernorm(x, axis=-1)
    s = _A_ref(xn, A_k_cache, A_v_cache, A_wq, A_wo)
    g = _silu(_B_ref(xn, B_w1, B_b1, B_w2, B_b2))
    return x + s * g
```

```asm
; @launch grid=(256,1,1) block=(256,1,1) lds=163840
.amdgcn_target "amdgcn-amd-amdhsa--gfx950"
.text
.globl recurrent_scan__gqa_block_cached__dense_activation_gelu__prompt_kernel
.p2align 8
.type recurrent_scan__gqa_block_cached__dense_activation_gelu__prompt_kernel,@function
recurrent_scan__gqa_block_cached__dense_activation_gelu__prompt_kernel:
    s_cmp_ge_u32 s2, 256
    s_cbranch_scc1 L1_end
    s_mov_b32 s46, 0
L1_top:
    s_load_dwordx8 s[48:55], s[0:1], 0
    s_load_dwordx4 s[56:59], s[0:1], 48
    s_load_dwordx2 s[60:61], s[0:1], 96
    s_load_dwordx2 s[82:83], s[0:1], 32
    s_load_dwordx8 s[88:95], s[0:1], 64
    s_getpc_b64 s[4:5]
L1_pc:
    s_lshr_b32 s3, s2, 3
    s_mul_i32 s3, s3, 3072
    v_lshrrev_b32 v72, 6, v0
    v_and_b32 v73, 7, v0
    v_mad_u32_u24 v72, v72, 6, v73
    v_lshl_add_u32 v72, v72, 7, s3
    v_mov_b32 v75, s5
    v_min_u32 v72, L1_last-L1_pc, v72
    v_add_co_u32 v74, vcc, s4, v72
    s_mov_b64 exec, 63
    s_nop 0
    v_addc_co_u32 v75, vcc, 0, v75, vcc
    global_load_dword v22, v[74:75], off
    s_mov_b64 exec, -1
    v_lshrrev_b32 v67, 6, v0
    v_and_b32 v64, 63, v0
    s_and_b32 s43, s2, 7
    v_readfirstlane_b32 s45, v67
    s_bfe_u32 s3, s2, 131075
    s_lshl_b32 s43, s43, 2
    s_add_u32 s43, s43, s3
    s_bfe_u32 s44, s2, 196613
    v_lshrrev_b32 v65, 4, v64
    v_and_b32 v66, 15, v64
    v_lshlrev_b32 v1, 4, v64
    s_lshl_b32 s41, s45, 12
    s_lshl_b32 s47, s45, 14
    s_lshl_b32 s68, s45, 11
    s_mov_b32 s69, 0
    s_lshl_b32 s4, s44, 3
    s_add_u32 s4, s4, s45
    s_lshl_b32 s65, s4, 2
    s_add_u32 s65, s65, 4
    s_and_b32 s5, s2, 0x19
    s_cmp_eq_u32 s5, 8
    s_cselect_b32 s64, s65, 0x1000
    s_lshl_b32 s42, s2, 0
    s_and_b32 s42, s42, 6
    s_lshl_b32 s78, s42, 7
    s_lshl_b32 s79, s42, 19
    s_lshl_b32 s3, s44, 8
    s_lshl_b32 s4, s45, 6
    s_add_u32 s3, s3, s4
    v_lshrrev_b32 v68, 3, v64
    v_add_u32 v69, s3, v68
    v_lshlrev_b32 v69, 10, v69
    v_and_b32 v70, 7, v64
    v_xor_b32 v71, v70, v65
    v_lshl_add_u32 v34, v71, 4, v69
    v_xor_b32 v71, 4, v71
    v_lshl_add_u32 v35, v71, 4, v69
    v_add_u32 v35, 7168, v35
    v_add_u32 v36, 14336, v34
    v_add_u32 v37, 14336, v35
    s_lshr_b32 s3, s45, 1
    s_lshl_b32 s3, s3, 5
    s_and_b32 s4, s45, 1
    s_lshl_b32 s4, s4, 2
    s_add_u32 s3, s3, s4
    v_add_u32 v69, s3, v65
    v_lshlrev_b32 v69, 13, v69
    v_lshlrev_b32 v71, 1, v65
    v_xor_b32 v71, v71, v66
    v_lshl_add_u32 v38, v71, 4, v69
    v_xor_b32 v71, 8, v71
    v_lshl_add_u32 v39, v71, 4, v69
    v_add_u32 v39, 64512, v39
    v_add_u32 v40, 129024, v38
    v_add_u32 v41, 129024, v39
    s_waitcnt lgkmcnt(0)
    s_mov_b32 s20, s48
    s_mov_b32 s21, s49
    s_mov_b32 s22, 2097152
    s_mov_b32 s23, 0x20000
    s_lshl_b32 s4, s43, 8
    s_add_u32 s24, s54, s4
    s_addc_u32 s25, s55, 0
    s_mov_b32 s26, 0
    s_mov_b32 s27, 0x20000
    s_sub_u32 s26, 4194304, s4
    s_cmp_lt_u32 s64, 256
    s_cbranch_scc1 L1_puba
L1_puba_ret:
    s_add_u32 m0, s47, 0
    s_xor_b32 s40, s78, 0
    buffer_load_dwordx4 v34, s[20:23], s40 offen offset:0 lds
    buffer_load_dwordx4 v35, s[20:23], s40 offen offset:1024 lds
    buffer_load_dwordx4 v36, s[20:23], s40 offen offset:2048 lds
    buffer_load_dwordx4 v37, s[20:23], s40 offen offset:3072 lds
    s_add_u32 m0, s47, 4096
    s_xor_b32 s40, s78, 32768
    buffer_load_dwordx4 v34, s[20:23], s40 offen offset:0 lds
    buffer_load_dwordx4 v35, s[20:23], s40 offen offset:1024 lds
    buffer_load_dwordx4 v36, s[20:23], s40 offen offset:2048 lds
    buffer_load_dwordx4 v37, s[20:23], s40 offen offset:3072 lds
    s_add_u32 m0, s41, 65536
    s_xor_b32 s40, s79, 0
    buffer_load_dwordx4 v38, s[24:27], s40 offen offset:0 lds
    buffer_load_dwordx4 v39, s[24:27], s40 offen offset:1024 lds
    buffer_load_dwordx4 v40, s[24:27], s40 offen offset:2048 lds
    buffer_load_dwordx4 v41, s[24:27], s40 offen offset:3072 lds
    s_mov_b32 s28, s56
    s_mov_b32 s29, s57
    s_mov_b32 s30, 1409024
    s_mov_b32 s31, 0x20000
    s_lshl_b32 s66, s44, 11
    s_lshr_b32 s4, s68, 2
    s_add_u32 s66, s66, s4
    s_add_u32 s66, s66, 13107200
    s_mov_b32 s67, 0x7000000
    s_lshl_b32 s80, s43, 6
    s_bfe_u32 s4, s2, 131073
    s_and_b32 s5, s43, 3
    s_xor_b32 s5, s5, 2
    s_lshl_b32 s5, s5, 2
    s_add_u32 s4, s4, s5
    s_add_u32 s70, s4, 32
    s_bfe_u32 s77, s2, 65536
    s_lshl_b32 s5, s77, 4
    s_add_u32 s70, s70, s5
    s_lshl_b32 s4, s70, 6
    s_cmp_lt_u32 s70, 43
    s_cselect_b32 s81, s4, 0x1000000
    s_cselect_b32 s77, s77, 1
    v_lshrrev_b32 v69, 5, v64
    v_and_b32 v68, 3, v68
    v_lshl_add_u32 v69, v69, 3, v68
    v_add_u32 v69, s3, v69
    v_mul_u32_u24 v69, 2752, v69
    v_lshlrev_b32 v71, 1, v65
    v_xor_b32 v71, v71, v70
    v_cmp_gt_u32 vcc, 4, v71
    v_mov_b32 v68, s80
    v_mov_b32 v70, s81
    v_and_b32 v71, 3, v71
    v_cndmask_b32 v68, v70, v68, vcc
    v_lshl_add_u32 v69, v71, 4, v69
    v_add_u32 v42, v68, v69
    v_add_u32 v43, 43008, v42
    v_lshrrev_b32 v68, 1, v66
    v_xor_b32 v68, v68, v65
    v_lshlrev_b32 v69, 7, v66
    v_add_u32 v69, s47, v69
    v_lshl_add_u32 v32, v68, 4, v69
    v_xor_b32 v33, 64, v32
    v_lshrrev_b32 v68, 2, v64
    v_and_b32 v70, 3, v64
    v_lshlrev_b32 v71, 3, v70
    v_lshl_add_u32 v69, v68, 8, v71
    v_lshl_add_u32 v71, v68, 7, v71
    v_and_b32 v6, 7, v68
    v_bfe_u32 v68, v68, 1, 2
    s_lshl_b32 s4, s45, 6
    s_add_u32 s4, s4, 65536
    v_lshl_add_u32 v6, v6, 5, v69
    v_lshl_add_u32 v71, v68, 5, v71
    v_xor_b32 v6, s4, v6
    v_add_u32 v56, 131072, v71
    s_lshl_b32 s4, s45, 5
    v_lshlrev_b32 v68, 3, v70
    v_xor_b32 v6, v68, v6
    v_lshlrev_b32 v68, 4, v70
    v_xor_b32 v6, v68, v6
    v_xor_b32 v7, 8, v6
    v_xor_b32 v8, 64, v6
    v_xor_b32 v9, 72, v6
    v_xor_b32 v10, 128, v6
    v_xor_b32 v11, 136, v6
    v_xor_b32 v12, 192, v6
    v_xor_b32 v13, 200, v6
    v_xor_b32 v57, 32, v56
    v_xor_b32 v58, 64, v56
    v_xor_b32 v59, 96, v56
    v_xor_b32 v60, s4, v56
    v_mov_b32 v69, 0x3f803f80
    v_cmp_gt_u32 vcc, 2, v70
    v_cmp_eq_u32 s[62:63], 1, v70
    v_mov_b32 v68, 0xeeeeeeee
    v_mov_b32 v20, 0x44444444
    v_cndmask_b32 v24, 0, v69, vcc
    v_cndmask_b32 v25, 0, v69, vcc
    v_cndmask_b32 v26, 0, v69, vcc
    v_cndmask_b32 v27, 0, v69, vcc
    v_cndmask_b32 v20, v20, v68, s[62:63]
    v_accvgpr_write_b32 a232, 0
    v_accvgpr_write_b32 a233, 0
    v_accvgpr_write_b32 a234, 0
    v_accvgpr_write_b32 a235, 0
    v_accvgpr_write_b32 a236, 0
    v_accvgpr_write_b32 a237, 0
    v_accvgpr_write_b32 a238, 0
    v_accvgpr_write_b32 a239, 0
    v_accvgpr_write_b32 a240, 0
    v_accvgpr_write_b32 a241, 0
    v_accvgpr_write_b32 a242, 0
    v_accvgpr_write_b32 a243, 0
    s_add_u32 m0, s68, 131072
    s_xor_b32 s40, s42, 0
    s_mul_i32 s40, s40, 176128
    buffer_load_dwordx4 v42, s[28:31], s40 offen offset:0 lds
    buffer_load_dwordx4 v43, s[28:31], s40 offen offset:1024 lds
    s_cmp_lt_u32 s64, 256
    s_cbranch_scc1 L1_pubb
L1_pubb_ret:
    s_mov_b64 exec, 0
    s_lshl_b32 s3, s77, 2
    s_add_u32 s3, s3, s45
    s_cmp_eq_u32 s3, 7
    s_cbranch_scc1 L1_pb3
    s_cmp_eq_u32 s3, 6
    s_cbranch_scc1 L1_pb2
    s_cmp_eq_u32 s3, 5
    s_cbranch_scc1 L1_pb1
    s_cmp_eq_u32 s3, 4
    s_cbranch_scc1 L1_pb0
    s_cmp_eq_u32 s3, 3
    s_cbranch_scc1 L1_pa3
    s_cmp_eq_u32 s3, 2
    s_cbranch_scc1 L1_pa2
    s_cmp_eq_u32 s3, 1
    s_cbranch_scc1 L1_pa1
    s_branch L1_pa0
L1_pgret:
    s_mov_b64 exec, -1
    s_add_u32 m0, s47, 8192
    s_xor_b32 s40, s78, 256
    buffer_load_dwordx4 v34, s[20:23], s40 offen offset:0 lds
    buffer_load_dwordx4 v35, s[20:23], s40 offen offset:1024 lds
    buffer_load_dwordx4 v36, s[20:23], s40 offen offset:2048 lds
    buffer_load_dwordx4 v37, s[20:23], s40 offen offset:3072 lds
    s_add_u32 m0, s47, 12288
    s_xor_b32 s40, s78, 33024
    buffer_load_dwordx4 v34, s[20:23], s40 offen offset:0 lds
    buffer_load_dwordx4 v35, s[20:23], s40 offen offset:1024 lds
    buffer_load_dwordx4 v36, s[20:23], s40 offen offset:2048 lds
    buffer_load_dwordx4 v37, s[20:23], s40 offen offset:3072 lds
    s_add_u32 m0, s41, 81920
    s_xor_b32 s40, s79, 1048576
    buffer_load_dwordx4 v38, s[24:27], s40 offen offset:0 lds
    buffer_load_dwordx4 v39, s[24:27], s40 offen offset:1024 lds
    buffer_load_dwordx4 v40, s[24:27], s40 offen offset:2048 lds
    buffer_load_dwordx4 v41, s[24:27], s40 offen offset:3072 lds
    s_add_u32 m0, s68, 139264
    s_xor_b32 s40, s42, 2
    s_mul_i32 s40, s40, 176128
    buffer_load_dwordx4 v42, s[28:31], s40 offen offset:0 lds
    buffer_load_dwordx4 v43, s[28:31], s40 offen offset:1024 lds
    s_waitcnt vmcnt(20)
    ds_read_b128 a[128:131], v32 offset:0
    ds_read_b128 a[132:135], v33 offset:0
    ds_read_b128 a[136:139], v32 offset:2048
    ds_read_b128 a[140:143], v33 offset:2048
    ds_read_b128 a[144:147], v32 offset:4096
    ds_read_b128 a[148:151], v33 offset:4096
    ds_read_b128 a[152:155], v32 offset:6144
    ds_read_b128 a[156:159], v33 offset:6144
    s_waitcnt vmcnt(14)
    s_barrier
    s_cmp_lg_u32 s77, 0
    s_cbranch_scc1 L1_bodyb
    s_branch L1_body
L1_ph_spin:
    s_mov_b32 s4, 0x400000
L1_ph_again:
    s_mov_b64 exec, 255
    v_lshlrev_b32 v22, 1, v1
    buffer_load_dword v22, v22, s[52:55], 0 offen offset:0 sc1
    s_mov_b64 exec, -1
    s_waitcnt vmcnt(0)
    v_cmp_ne_u32 vcc, -1, v22
    s_nop 0
    s_and_b32 s3, vcc_lo, 255
    s_cbranch_scc0 L1_ph_ok
    s_sleep 4
    s_sub_u32 s4, s4, 1
    s_cbranch_scc0 L1_ph_again
    s_branch L1_ph_ok
L1_pa_spin:
    s_mov_b32 s4, 0x400000
L1_pa_again:
    s_mov_b64 exec, 255
    buffer_load_dword v22, v29, s[84:87], 0 offen offset:0 sc1
    s_mov_b64 exec, -1
    s_waitcnt vmcnt(0)
    v_cmp_ne_u32 vcc, 0x3f803f80, v22
    s_nop 0
    s_and_b32 s3, vcc_lo, 255
    s_cbranch_scc0 L1_pa_ok
    s_sub_u32 s4, s4, 1
    s_cbranch_scc0 L1_pa_again
    s_branch L1_pa_ok
L1_pb_spin:
    s_mov_b32 s4, 0x400000
L1_pb_again:
    s_mov_b64 exec, 255
    buffer_load_dword v22, v29, s[84:87], 0 offen offset:128 sc1
    s_mov_b64 exec, -1
    s_waitcnt vmcnt(0)
    v_cmp_ne_u32 vcc, 0x3f803f80, v22
    s_nop 0
    s_and_b32 s3, vcc_lo, 255
    s_cbranch_scc0 L1_pb_ok
    s_sub_u32 s4, s4, 1
    s_cbranch_scc0 L1_pb_again
    s_branch L1_pb_ok
L1_pf_spin:
    s_mov_b32 s4, 0x400000
L1_pf_again:
    s_mov_b64 exec, 7
    buffer_load_dword v22, v30, s[84:87], 0 offen offset:256 sc1
    s_mov_b64 exec, -1
    s_waitcnt vmcnt(0)
    v_cmp_ne_u32 vcc, 0x3f803f80, v22
    s_nop 0
    s_and_b32 s3, vcc_lo, 7
    s_cbranch_scc0 L1_pf_ok
    s_sub_u32 s4, s4, 1
    s_cbranch_scc0 L1_pf_again
    s_branch L1_pf_ok
L1_ps_spin:
    s_mov_b32 s4, 0x400000
L1_ps_again:
    s_mov_b64 exec, 7
    buffer_load_dword v22, v30, s[84:87], 0 offen offset:384 sc1
    s_mov_b64 exec, -1
    s_waitcnt vmcnt(0)
    v_cmp_ne_u32 vcc, 0x3f803f80, v22
    s_nop 0
    s_and_b32 s3, vcc_lo, 7
    s_cbranch_scc0 L1_ps_ok
    s_sub_u32 s4, s4, 1
    s_cbranch_scc0 L1_ps_again
    s_branch L1_ps_ok
L1_pta_spin:
    s_mov_b32 s7, 0x400000
L1_pta_again:
    s_mov_b64 exec, 1
    buffer_load_dword v22, off, s[52:55], s65 sc1
    s_mov_b64 exec, -1
    s_waitcnt vmcnt(0)
    v_cmp_ne_u32 vcc, 15, v22
    s_nop 0
    s_and_b32 s6, vcc_lo, 1
    s_cbranch_scc0 L1_pta_ok
    s_sleep 4
    s_sub_u32 s7, s7, 1
    s_cbranch_scc0 L1_pta_again
    s_branch L1_pta_ok
L1_ptb_spin:
    s_mov_b32 s7, 0x400000
L1_ptb_again:
    s_mov_b64 exec, 1
    buffer_load_dword v22, off, s[52:55], s65 sc1
    s_mov_b64 exec, -1
    s_waitcnt vmcnt(0)
    v_cmp_ne_u32 vcc, 15, v22
    s_nop 0
    s_and_b32 s6, vcc_lo, 1
    s_cbranch_scc0 L1_ptb_ok
    s_sleep 4
    s_sub_u32 s7, s7, 1
    s_cbranch_scc0 L1_ptb_again
    s_branch L1_ptb_ok
L1_end:
    s_endpgm
L1_puba:
    s_lshl_b32 s4, s44, 18
    s_lshl_b32 s5, s45, 16
    s_add_u32 s4, s4, s5
    s_bfe_u32 s5, s2, 0x20001
    s_lshl_b32 s5, s5, 14
    s_add_u32 s4, s4, s5
    s_add_u32 m0, s47, 0
    s_add_u32 s40, s4, 0
    v_xor_b32 v76, 0, v1
    buffer_load_dwordx4 v76, s[20:23], s40 offen offset:0 lds
    v_xor_b32 v77, 16, v1
    buffer_load_dwordx4 v77, s[20:23], s40 offen offset:1024 lds
    v_xor_b32 v76, 32, v1
    buffer_load_dwordx4 v76, s[20:23], s40 offen offset:2048 lds
    v_xor_b32 v77, 48, v1
    buffer_load_dwordx4 v77, s[20:23], s40 offen offset:3072 lds
    s_add_u32 m0, s47, 4096
    s_add_u32 s40, s4, 4096
    v_xor_b32 v76, 64, v1
    buffer_load_dwordx4 v76, s[20:23], s40 offen offset:0 lds
    v_xor_b32 v77, 80, v1
    buffer_load_dwordx4 v77, s[20:23], s40 offen offset:1024 lds
    v_xor_b32 v76, 96, v1
    buffer_load_dwordx4 v76, s[20:23], s40 offen offset:2048 lds
    v_xor_b32 v77, 112, v1
    buffer_load_dwordx4 v77, s[20:23], s40 offen offset:3072 lds
    s_add_u32 m0, s47, 8192
    s_add_u32 s40, s4, 8192
    v_xor_b32 v76, 128, v1
    buffer_load_dwordx4 v76, s[20:23], s40 offen offset:0 lds
    v_xor_b32 v77, 144, v1
    buffer_load_dwordx4 v77, s[20:23], s40 offen offset:1024 lds
    v_xor_b32 v76, 160, v1
    buffer_load_dwordx4 v76, s[20:23], s40 offen offset:2048 lds
    v_xor_b32 v77, 176, v1
    buffer_load_dwordx4 v77, s[20:23], s40 offen offset:3072 lds
    s_add_u32 m0, s47, 12288
    s_add_u32 s40, s4, 12288
    v_xor_b32 v76, 192, v1
    buffer_load_dwordx4 v76, s[20:23], s40 offen offset:0 lds
    v_xor_b32 v77, 208, v1
    buffer_load_dwordx4 v77, s[20:23], s40 offen offset:1024 lds
    v_xor_b32 v76, 224, v1
    buffer_load_dwordx4 v76, s[20:23], s40 offen offset:2048 lds
    v_xor_b32 v77, 240, v1
    buffer_load_dwordx4 v77, s[20:23], s40 offen offset:3072 lds
    v_mov_b32 v78, s47
    v_xor_b32 v76, v65, v66
    v_lshl_add_u32 v77, v66, 10, v78
    v_lshl_add_u32 v76, v76, 4, v77
    v_xor_b32 v77, 64, v76
    v_xor_b32 v78, 128, v76
    v_xor_b32 v79, 192, v76
    s_waitcnt vmcnt(0)
    ds_read_b128 a[64:67], v76 offset:0
    ds_read_b128 a[68:71], v77 offset:0
    ds_read_b128 a[72:75], v78 offset:0
    ds_read_b128 a[76:79], v79 offset:0
    ds_read_b128 a[80:83], v76 offset:256
    ds_read_b128 a[84:87], v77 offset:256
    ds_read_b128 a[88:91], v78 offset:256
    ds_read_b128 a[92:95], v79 offset:256
    ds_read_b128 a[96:99], v76 offset:512
    ds_read_b128 a[100:103], v77 offset:512
    ds_read_b128 a[104:107], v78 offset:512
    ds_read_b128 a[108:111], v79 offset:512
    ds_read_b128 a[112:115], v76 offset:768
    ds_read_b128 a[116:119], v77 offset:768
    ds_read_b128 a[120:123], v78 offset:768
    ds_read_b128 a[124:127], v79 offset:768
    s_waitcnt lgkmcnt(0)
    s_branch L1_puba_ret
L1_pubb:
    v_mov_b32 v132, 0
    v_mov_b32 v133, 0
    v_mov_b32 v134, 0
    v_mov_b32 v135, 0
    s_waitcnt lgkmcnt(0)
    s_nop 0
    v_smfmac_f32_16x16x64_bf16 v[132:135], v[24:27], a[64:71], v20
    v_smfmac_f32_16x16x64_bf16 v[132:135], v[24:27], a[72:79], v20
    v_smfmac_f32_16x16x64_bf16 v[132:135], v[24:27], a[80:87], v20
    v_smfmac_f32_16x16x64_bf16 v[132:135], v[24:27], a[88:95], v20
    v_smfmac_f32_16x16x64_bf16 v[132:135], v[24:27], a[96:103], v20
    v_smfmac_f32_16x16x64_bf16 v[132:135], v[24:27], a[104:111], v20
    v_smfmac_f32_16x16x64_bf16 v[132:135], v[24:27], a[112:119], v20
    v_smfmac_f32_16x16x64_bf16 v[132:135], v[24:27], a[120:127], v20
    v_mfma_f32_16x16x32_bf16 v[136:139], a[64:67], a[64:67], 0
    v_mfma_f32_16x16x32_bf16 v[136:139], a[68:71], a[68:71], v[136:139]
    v_mfma_f32_16x16x32_bf16 v[136:139], a[72:75], a[72:75], v[136:139]
    v_mfma_f32_16x16x32_bf16 v[136:139], a[76:79], a[76:79], v[136:139]
    v_mfma_f32_16x16x32_bf16 v[140:143], a[80:83], a[80:83], 0
    v_mfma_f32_16x16x32_bf16 v[140:143], a[84:87], a[84:87], v[140:143]
    v_mfma_f32_16x16x32_bf16 v[140:143], a[88:91], a[88:91], v[140:143]
    v_mfma_f32_16x16x32_bf16 v[140:143], a[92:95], a[92:95], v[140:143]
    v_mfma_f32_16x16x32_bf16 v[144:147], a[96:99], a[96:99], 0
    v_mfma_f32_16x16x32_bf16 v[144:147], a[100:103], a[100:103], v[144:147]
    v_mfma_f32_16x16x32_bf16 v[144:147], a[104:107], a[104:107], v[144:147]
    v_mfma_f32_16x16x32_bf16 v[144:147], a[108:111], a[108:111], v[144:147]
    v_mfma_f32_16x16x32_bf16 v[148:151], a[112:115], a[112:115], 0
    v_mfma_f32_16x16x32_bf16 v[148:151], a[116:119], a[116:119], v[148:151]
    v_mfma_f32_16x16x32_bf16 v[148:151], a[120:123], a[120:123], v[148:151]
    v_mfma_f32_16x16x32_bf16 v[148:151], a[124:127], a[124:127], v[148:151]
    v_and_b32 v76, 3, v66
    v_lshrrev_b32 v77, 2, v66
    v_lshl_add_u32 v77, v77, 4, v66
    v_lshlrev_b32 v77, 2, v77
    v_cmp_eq_u32 vcc, 2, v76
    v_cmp_eq_u32 s[6:7], 3, v76
    v_add_f32 v132, v132, v133
    s_bfe_u32 s5, s2, 0x20001
    v_mul_f32 v28, 0xbb000000, v132
    v_mul_f32 v132, 0x3e800000, v132
    s_lshl_b32 s5, s5, 7
    s_add_u32 s67, s5, s66
    v_cndmask_b32 v136, v136, v137, s[62:63]
    v_cndmask_b32 v140, v140, v141, s[62:63]
    v_cndmask_b32 v144, v144, v145, s[62:63]
    v_cndmask_b32 v148, v148, v149, s[62:63]
    v_cndmask_b32 v136, v136, v138, vcc
    v_cndmask_b32 v140, v140, v142, vcc
    v_cndmask_b32 v144, v144, v146, vcc
    v_cndmask_b32 v148, v148, v150, vcc
    v_cndmask_b32 v136, v136, v139, s[6:7]
    v_cndmask_b32 v140, v140, v143, s[6:7]
    v_cndmask_b32 v144, v144, v147, s[6:7]
    v_cndmask_b32 v148, v148, v151, s[6:7]
    v_fmac_f32 v136, v28, v132
    v_fmac_f32 v140, v28, v132
    v_fmac_f32 v144, v28, v132
    v_fmac_f32 v148, v28, v132
    v_add_f32 v136, v136, v140
    v_add_f32 v144, v144, v148
    v_add_f32 v136, v136, v144
    ds_bpermute_b32 v129, v77, v136
    s_waitcnt lgkmcnt(0)
    v_mul_f32 v129, 0x3b000000, v129
    v_max_f32 v129, 0, v129
    v_add_f32 v129, 0x3727c5ac, v129
    v_rsq_f32 v29, v129
    s_branch L1_pubb_ret
.p2align 12
L1_body:
L1_pa0:
    s_cbranch_execz L1_pa4
    ds_read_b64_tr_b16 a[192:193], v6 offset:0
    ds_read_b64_tr_b16 a[194:195], v6 offset:4096
    ds_read_b64_tr_b16 a[196:197], v6 offset:8192
    ds_read_b64_tr_b16 a[198:199], v6 offset:12288
    ds_read_b64_tr_b16 a[200:201], v58 offset:0
    ds_read_b64_tr_b16 a[202:203], v58 offset:2048
    ds_read_b64_tr_b16 a[204:205], v58 offset:4096
    ds_read_b64_tr_b16 a[206:207], v58 offset:6144
    ds_read_b64_tr_b16 a[208:209], v7 offset:0
    ds_read_b64_tr_b16 a[210:211], v7 offset:4096
    ds_read_b64_tr_b16 a[212:213], v7 offset:8192
    ds_read_b64_tr_b16 a[214:215], v7 offset:12288
    s_waitcnt lgkmcnt(8)
    v_mfma_f32_16x16x32_bf16 v[192:195], a[192:195], a[128:131], 0
    s_add_u32 m0, s47, 0
    s_xor_b32 s40, s78, 512
    v_mfma_f32_16x16x32_bf16 v[192:195], a[196:199], a[132:135], v[192:195]
    buffer_load_dwordx4 v34, s[20:23], s40 offen offset:0 lds
    v_mfma_f32_16x16x32_bf16 v[196:199], a[196:199], a[140:143], 0
    s_add_u32 s84, s60, 25165824
    s_addc_u32 s85, s61, 0
    v_mfma_f32_16x16x32_bf16 v[196:199], a[192:195], a[136:139], v[196:199]
    s_mov_b32 s86, 13123584
    s_mov_b32 s87, 0x20000
    v_mfma_f32_16x16x32_bf16 v[200:203], a[192:195], a[144:147], 0
    v_bfe_u32 v45, v1, 4, 4
    v_lshlrev_b32 v62, 3, v45
    v_mfma_f32_16x16x32_bf16 v[200:203], a[196:199], a[148:151], v[200:203]
    s_lshl_b32 s3, s43, 19
    v_accvgpr_write_b32 a0, 0
    v_mfma_f32_16x16x32_bf16 v[204:207], a[196:199], a[156:159], 0
    ds_read_b64_tr_b16 a[216:217], v8 offset:0
    s_add_u32 s12, s52, s3
    s_addc_u32 s13, s53, 0
    v_mfma_f32_16x16x32_bf16 v[204:207], a[192:195], a[152:155], v[204:207]
    s_waitcnt lgkmcnt(5)
    s_mov_b32 s14, 524288
    v_smfmac_f32_16x16x64_bf16 a[232:235], v[24:27], a[192:199], v20
    ds_read_b64_tr_b16 a[218:219], v8 offset:4096
    v_mfma_f32_16x16x32_bf16 v[160:163], a[200:203], a[128:131], 0
    buffer_load_dwordx4 v35, s[20:23], s40 offen offset:1024 lds
    v_mfma_f32_16x16x32_bf16 v[160:163], a[204:207], a[132:135], v[160:163]
    ds_read_b64_tr_b16 a[220:221], v8 offset:8192
    s_mov_b32 s15, 0x20000
    v_mfma_f32_16x16x32_bf16 v[164:167], a[204:207], a[140:143], 0
    buffer_load_dwordx4 v36, s[20:23], s40 offen offset:2048 lds
    v_mfma_f32_16x16x32_bf16 v[164:167], a[200:203], a[136:139], v[164:167]
    ds_read_b64_tr_b16 a[222:223], v8 offset:12288
    v_accvgpr_write_b32 a1, 0
    v_mfma_f32_16x16x32_bf16 v[168:171], a[200:203], a[144:147], 0
    s_add_u32 s8, s50, s3
    s_addc_u32 s9, s51, 0
    v_mfma_f32_16x16x32_bf16 v[168:171], a[204:207], a[148:151], v[168:171]
    ds_read_b64_tr_b16 a[224:225], v59 offset:0
    s_mov_b32 s10, 524288
    v_mfma_f32_16x16x32_bf16 v[172:175], a[204:207], a[156:159], 0
    s_mov_b32 s11, 0x20000
    s_mov_b32 s52, s94
    v_mfma_f32_16x16x32_bf16 v[172:175], a[200:203], a[152:155], v[172:175]
    ds_read_b64_tr_b16 a[226:227], v59 offset:2048
    s_waitcnt lgkmcnt(6)
    v_mfma_f32_16x16x32_bf16 v[76:79], a[208:211], a[152:155], 0
    buffer_load_dwordx4 v37, s[20:23], s40 offen offset:3072 lds
    v_mfma_f32_16x16x32_bf16 v[76:79], a[212:215], a[156:159], v[76:79]
    ds_read_b64_tr_b16 a[228:229], v59 offset:4096
    s_mov_b32 s53, s95
    v_mfma_f32_16x16x32_bf16 v[72:75], a[212:215], a[148:151], 0
    s_mov_b32 s54, 256
    s_mov_b32 s55, 0x20000
    v_mfma_f32_16x16x32_bf16 v[72:75], a[208:211], a[144:147], v[72:75]
    ds_read_b64_tr_b16 a[230:231], v59 offset:6144
    s_add_u32 m0, s47, 4096
    v_mfma_f32_16x16x32_bf16 v[68:71], a[208:211], a[136:139], 0
    s_xor_b32 s40, s78, 33280
    s_bfe_u32 s4, s2, 0x20001
    v_mfma_f32_16x16x32_bf16 v[68:71], a[212:215], a[140:143], v[68:71]
    ds_read_b64_tr_b16 a[192:193], v9 offset:0
    s_lshl_b32 s4, 1, s4
    v_mfma_f32_16x16x32_bf16 v[64:67], a[212:215], a[132:135], 0
    buffer_load_dwordx4 v34, s[20:23], s40 offen offset:0 lds
    v_mfma_f32_16x16x32_bf16 v[64:67], a[208:211], a[128:131], v[64:67]
    ds_read_b64_tr_b16 a[194:195], v9 offset:4096
    v_mov_b32 v21, s4
    v_smfmac_f32_16x16x64_bf16 a[236:239], v[24:27], a[208:215], v20
    s_waitcnt lgkmcnt(6)
    v_mfma_f32_16x16x32_bf16 v[208:211], a[216:219], a[128:131], 0
    ds_read_b64_tr_b16 a[196:197], v9 offset:8192
    v_accvgpr_write_b32 a2, 0
    v_mfma_f32_16x16x32_bf16 v[208:211], a[220:223], a[132:135], v[208:211]
    buffer_load_dwordx4 v35, s[20:23], s40 offen offset:1024 lds
    v_mfma_f32_16x16x32_bf16 v[212:215], a[220:223], a[140:143], 0
    ds_read_b64_tr_b16 a[198:199], v9 offset:12288
    v_accvgpr_write_b32 a3, 0
    v_mfma_f32_16x16x32_bf16 v[212:215], a[216:219], a[136:139], v[212:215]
    v_accvgpr_write_b32 a4, 0
    v_accvgpr_write_b32 a5, 0
    v_mfma_f32_16x16x32_bf16 v[216:219], a[216:219], a[144:147], 0
    ds_read_b64_tr_b16 a[200:201], v10 offset:0
    v_accvgpr_write_b32 a6, 0
    v_mfma_f32_16x16x32_bf16 v[216:219], a[220:223], a[148:151], v[216:219]
    buffer_load_dwordx4 v36, s[20:23], s40 offen offset:2048 lds
    v_mfma_f32_16x16x32_bf16 v[220:223], a[220:223], a[156:159], 0
    ds_read_b64_tr_b16 a[202:203], v10 offset:4096
    v_accvgpr_write_b32 a7, 0
    v_mfma_f32_16x16x32_bf16 v[220:223], a[216:219], a[152:155], v[220:223]
    s_waitcnt lgkmcnt(6)
    v_accvgpr_write_b32 a8, 0
    v_mfma_f32_16x16x32_bf16 v[188:191], a[224:227], a[152:155], 0
    ds_read_b64_tr_b16 a[204:205], v10 offset:8192
    v_accvgpr_write_b32 a9, 0
    v_mfma_f32_16x16x32_bf16 v[188:191], a[228:231], a[156:159], v[188:191]
    v_accvgpr_write_b32 a10, 0
    v_accvgpr_write_b32 a11, 0
    v_mfma_f32_16x16x32_bf16 v[184:187], a[228:231], a[148:151], 0
    ds_read_b64_tr_b16 a[206:207], v10 offset:12288
    v_accvgpr_write_b32 a12, 0
    v_mfma_f32_16x16x32_bf16 v[184:187], a[224:227], a[144:147], v[184:187]
    buffer_load_dwordx4 v37, s[20:23], s40 offen offset:3072 lds
    v_mfma_f32_16x16x32_bf16 v[180:183], a[224:227], a[136:139], 0
    ds_read_b64_tr_b16 a[208:209], v60 offset:0
    v_accvgpr_write_b32 a13, 0
    v_mfma_f32_16x16x32_bf16 v[180:183], a[228:231], a[140:143], v[180:183]
    v_accvgpr_write_b32 a14, 0
    v_accvgpr_write_b32 a15, 0
    v_mfma_f32_16x16x32_bf16 v[176:179], a[228:231], a[132:135], 0
    ds_read_b64_tr_b16 a[210:211], v60 offset:2048
    s_add_u32 m0, s41, 98304
    v_mfma_f32_16x16x32_bf16 v[176:179], a[224:227], a[128:131], v[176:179]
    s_waitcnt lgkmcnt(6)
    s_xor_b32 s40, s79, 2097152
    v_mfma_f32_16x16x32_bf16 v[92:95], a[192:195], a[152:155], 0
    ds_read_b64_tr_b16 a[212:213], v60 offset:4096
    v_accvgpr_write_b32 a16, 0
    v_mfma_f32_16x16x32_bf16 v[92:95], a[196:199], a[156:159], v[92:95]
    buffer_load_dwordx4 v38, s[24:27], s40 offen offset:0 lds
    v_mfma_f32_16x16x32_bf16 v[88:91], a[196:199], a[148:151], 0
    ds_read_b64_tr_b16 a[214:215], v60 offset:6144
    v_accvgpr_write_b32 a17, 0
    v_mfma_f32_16x16x32_bf16 v[88:91], a[192:195], a[144:147], v[88:91]
    v_accvgpr_write_b32 a18, 0
    v_accvgpr_write_b32 a19, 0
    v_mfma_f32_16x16x32_bf16 v[84:87], a[192:195], a[136:139], 0
    ds_read_b64_tr_b16 a[216:217], v11 offset:0
    v_accvgpr_write_b32 a20, 0
    v_mfma_f32_16x16x32_bf16 v[84:87], a[196:199], a[140:143], v[84:87]
    ds_read_b64_tr_b16 a[218:219], v11 offset:4096
    v_accvgpr_write_b32 a21, 0
    v_mfma_f32_16x16x32_bf16 v[80:83], a[196:199], a[132:135], 0
    ds_read_b64_tr_b16 a[220:221], v11 offset:8192
    v_accvgpr_write_b32 a22, 0
    v_mfma_f32_16x16x32_bf16 v[80:83], a[192:195], a[128:131], v[80:83]
    ds_read_b64_tr_b16 a[222:223], v11 offset:12288
    s_waitcnt lgkmcnt(8)
    v_mfma_f32_16x16x32_bf16 v[224:227], a[200:203], a[128:131], 0
    ds_read_b64_tr_b16 a[224:225], v12 offset:0
    v_accvgpr_write_b32 a23, 0
    v_mfma_f32_16x16x32_bf16 v[224:227], a[204:207], a[132:135], v[224:227]
    buffer_load_dwordx4 v39, s[24:27], s40 offen offset:1024 lds
    v_mfma_f32_16x16x32_bf16 v[228:231], a[204:207], a[140:143], 0
    ds_read_b64_tr_b16 a[226:227], v12 offset:4096
    v_accvgpr_write_b32 a24, 0
    v_mfma_f32_16x16x32_bf16 v[228:231], a[200:203], a[136:139], v[228:231]
    buffer_load_dwordx4 v40, s[24:27], s40 offen offset:2048 lds
    v_mfma_f32_16x16x32_bf16 v[232:235], a[200:203], a[144:147], 0
    ds_read_b64_tr_b16 a[228:229], v12 offset:8192
    v_accvgpr_write_b32 a25, 0
    v_mfma_f32_16x16x32_bf16 v[232:235], a[204:207], a[148:151], v[232:235]
    ds_read_b64_tr_b16 a[230:231], v12 offset:12288
    v_accvgpr_write_b32 a26, 0
    v_mfma_f32_16x16x32_bf16 v[236:239], a[204:207], a[156:159], 0
    ds_read_b64_tr_b16 a[192:193], v13 offset:0
    v_accvgpr_write_b32 a27, 0
    v_mfma_f32_16x16x32_bf16 v[236:239], a[200:203], a[152:155], v[236:239]
    s_waitcnt lgkmcnt(9)
    s_waitcnt lgkmcnt(5)
    v_smfmac_f32_16x16x64_bf16 a[240:243], v[24:27], a[208:215], v20
    ds_read_b64_tr_b16 a[194:195], v13 offset:4096
    v_mfma_f32_16x16x32_bf16 v[108:111], a[216:219], a[152:155], 0
    buffer_load_dwordx4 v41, s[24:27], s40 offen offset:3072 lds
    v_mfma_f32_16x16x32_bf16 v[108:111], a[220:223], a[156:159], v[108:111]
    ds_read_b64_tr_b16 a[196:197], v13 offset:8192
    s_add_u32 m0, s68, 147456
    v_mfma_f32_16x16x32_bf16 v[104:107], a[220:223], a[148:151], 0
    s_xor_b32 s40, s42, 4
    s_mul_i32 s40, s40, 176128
    v_mfma_f32_16x16x32_bf16 v[104:107], a[216:219], a[144:147], v[104:107]
    ds_read_b64_tr_b16 a[198:199], v13 offset:12288
    v_accvgpr_write_b32 a28, 0
    v_mfma_f32_16x16x32_bf16 v[100:103], a[216:219], a[136:139], 0
    ds_read_b64_tr_b16 a[200:201], v56 offset:0
    v_accvgpr_write_b32 a29, 0
    v_mfma_f32_16x16x32_bf16 v[100:103], a[220:223], a[140:143], v[100:103]
    buffer_load_dwordx4 v42, s[28:31], s40 offen offset:0 lds
    v_mfma_f32_16x16x32_bf16 v[96:99], a[220:223], a[132:135], 0
    ds_read_b64_tr_b16 a[202:203], v56 offset:2048
    s_waitcnt vmcnt(19)
    v_mfma_f32_16x16x32_bf16 v[96:99], a[216:219], a[128:131], v[96:99]
    s_waitcnt lgkmcnt(6)
    ds_read_b128 a[160:163], v32 offset:8192
    v_mfma_f32_16x16x32_bf16 v[240:243], a[224:227], a[128:131], 0
    ds_read_b64_tr_b16 a[204:205], v56 offset:4096
    v_accvgpr_write_b32 a30, 0
    v_mfma_f32_16x16x32_bf16 v[240:243], a[228:231], a[132:135], v[240:243]
    ds_read_b128 a[164:167], v33 offset:8192
    v_accvgpr_write_b32 a31, 0
    v_mfma_f32_16x16x32_bf16 v[244:247], a[228:231], a[140:143], 0
    ds_read_b64_tr_b16 a[206:207], v56 offset:6144
    v_accvgpr_write_b32 a32, 0
    v_mfma_f32_16x16x32_bf16 v[244:247], a[224:227], a[136:139], v[244:247]
    ds_read_b128 a[168:171], v32 offset:10240
    v_accvgpr_write_b32 a33, 0
    v_mfma_f32_16x16x32_bf16 v[248:251], a[224:227], a[144:147], 0
    ds_read_b64_tr_b16 a[208:209], v57 offset:0
    v_accvgpr_write_b32 a34, 0
    v_mfma_f32_16x16x32_bf16 v[248:251], a[228:231], a[148:151], v[248:251]
    ds_read_b128 a[172:175], v33 offset:10240
    v_accvgpr_write_b32 a35, 0
    v_mfma_f32_16x16x32_bf16 v[252:255], a[228:231], a[156:159], 0
    ds_read_b64_tr_b16 a[210:211], v57 offset:2048
    v_accvgpr_write_b32 a36, 0
    v_mfma_f32_16x16x32_bf16 v[252:255], a[224:227], a[152:155], v[252:255]
    s_waitcnt lgkmcnt(10)
    ds_read_b128 a[176:179], v32 offset:12288
    v_mfma_f32_16x16x32_bf16 v[124:127], a[192:195], a[152:155], 0
    ds_read_b64_tr_b16 a[212:213], v57 offset:4096
    v_accvgpr_write_b32 a37, 0
    v_mfma_f32_16x16x32_bf16 v[124:127], a[196:199], a[156:159], v[124:127]
    ds_read_b128 a[180:183], v33 offset:12288
    v_accvgpr_write_b32 a38, 0
    v_mfma_f32_16x16x32_bf16 v[120:123], a[196:199], a[148:151], 0
    ds_read_b64_tr_b16 a[214:215], v57 offset:6144
    v_accvgpr_write_b32 a39, 0
    v_mfma_f32_16x16x32_bf16 v[120:123], a[192:195], a[144:147], v[120:123]
    ds_read_b128 a[184:187], v32 offset:14336
    v_accvgpr_write_b32 a40, 0
    v_mfma_f32_16x16x32_bf16 v[116:119], a[192:195], a[136:139], 0
    ds_read_b128 a[188:191], v33 offset:14336
    v_accvgpr_write_b32 a41, 0
    v_mfma_f32_16x16x32_bf16 v[116:119], a[196:199], a[140:143], v[116:119]
    buffer_load_dwordx4 v43, s[28:31], s40 offen offset:1024 lds
    v_mfma_f32_16x16x32_bf16 v[112:115], a[196:199], a[132:135], 0
    v_accvgpr_write_b32 a42, 0
    v_accvgpr_write_b32 a43, 0
    v_mfma_f32_16x16x32_bf16 v[112:115], a[192:195], a[128:131], v[112:115]
    s_waitcnt lgkmcnt(10)
    v_accvgpr_write_b32 a44, 0
    v_mfma_f32_16x16x32_bf16 v[128:131], a[200:203], a[128:131], 0
    v_accvgpr_write_b32 a45, 0
    v_accvgpr_write_b32 a46, 0
    v_mfma_f32_16x16x32_bf16 v[128:131], a[204:207], a[132:135], v[128:131]
    v_accvgpr_write_b32 a47, 0
    v_accvgpr_write_b32 a48, 0
    v_mfma_f32_16x16x32_bf16 v[132:135], a[204:207], a[140:143], 0
    v_accvgpr_write_b32 a49, 0
    v_accvgpr_write_b32 a50, 0
    v_mfma_f32_16x16x32_bf16 v[132:135], a[200:203], a[136:139], v[132:135]
    s_waitcnt vmcnt(14)
    v_accvgpr_write_b32 a51, 0
    v_mfma_f32_16x16x32_bf16 v[136:139], a[200:203], a[144:147], 0
    s_waitcnt lgkmcnt(2)
    s_barrier
    v_mfma_f32_16x16x32_bf16 v[136:139], a[204:207], a[148:151], v[136:139]
    ds_read_b64_tr_b16 a[216:217], v6 offset:16384
    v_accvgpr_write_b32 a52, 0
    v_mfma_f32_16x16x32_bf16 v[140:143], a[204:207], a[156:159], 0
    ds_read_b64_tr_b16 a[218:219], v6 offset:20480
    v_accvgpr_write_b32 a53, 0
    v_mfma_f32_16x16x32_bf16 v[140:143], a[200:203], a[152:155], v[140:143]
    ds_read_b64_tr_b16 a[220:221], v6 offset:24576
    v_accvgpr_write_b32 a54, 0
    v_mfma_f32_16x16x32_bf16 v[156:159], a[208:211], a[152:155], 0
    ds_read_b64_tr_b16 a[222:223], v6 offset:28672
    v_accvgpr_write_b32 a55, 0
    v_mfma_f32_16x16x32_bf16 v[156:159], a[212:215], a[156:159], v[156:159]
    ds_read_b64_tr_b16 a[224:225], v58 offset:8192
    v_accvgpr_write_b32 a56, 0
    v_mfma_f32_16x16x32_bf16 v[152:155], a[212:215], a[148:151], 0
    v_accvgpr_write_b32 a57, 0
    v_accvgpr_write_b32 a58, 0
    v_mfma_f32_16x16x32_bf16 v[152:155], a[208:211], a[144:147], v[152:155]
    ds_read_b64_tr_b16 a[226:227], v58 offset:10240
    v_accvgpr_write_b32 a59, 0
    v_mfma_f32_16x16x32_bf16 v[148:151], a[208:211], a[136:139], 0
    v_accvgpr_write_b32 a60, 0
    v_accvgpr_write_b32 a61, 0
    v_mfma_f32_16x16x32_bf16 v[148:151], a[212:215], a[140:143], v[148:151]
    ds_read_b64_tr_b16 a[228:229], v58 offset:12288
    s_mov_b32 s32, s58
    v_mfma_f32_16x16x32_bf16 v[144:147], a[212:215], a[132:135], 0
    ds_read_b64_tr_b16 a[230:231], v58 offset:14336
    s_waitcnt lgkmcnt(8)
    v_mfma_f32_16x16x32_bf16 v[144:147], a[208:211], a[128:131], v[144:147]
    ds_read_b64_tr_b16 a[192:193], v7 offset:16384
    s_waitcnt lgkmcnt(5)
    v_mfma_f32_16x16x32_bf16 v[192:195], a[216:219], a[160:163], v[192:195]
    s_add_u32 m0, s47, 8192
    s_xor_b32 s40, s78, 768
    v_mfma_f32_16x16x32_bf16 v[192:195], a[220:223], a[164:167], v[192:195]
    ds_read_b64_tr_b16 a[194:195], v7 offset:20480
    s_mov_b32 s33, s59
    v_mfma_f32_16x16x32_bf16 v[196:199], a[220:223], a[172:175], v[196:199]
    buffer_load_dwordx4 v34, s[20:23], s40 offen offset:0 lds
    v_mfma_f32_16x16x32_bf16 v[196:199], a[216:219], a[168:171], v[196:199]
    ds_read_b64_tr_b16 a[196:197], v7 offset:24576
    s_mov_b32 s34, 2752
    v_mfma_f32_16x16x32_bf16 v[200:203], a[216:219], a[176:179], v[200:203]
    s_mov_b32 s35, 0x20000
    v_lshrrev_b32 v44, 8, v1
    v_mfma_f32_16x16x32_bf16 v[200:203], a[220:223], a[180:183], v[200:203]
    ds_read_b64_tr_b16 a[198:199], v7 offset:28672
    v_accvgpr_write_b32 a62, 0
    v_mfma_f32_16x16x32_bf16 v[204:207], a[220:223], a[188:191], v[204:207]
    ds_read_b64_tr_b16 a[200:201], v8 offset:16384
    v_accvgpr_write_b32 a63, 0
    v_mfma_f32_16x16x32_bf16 v[204:207], a[216:219], a[184:187], v[204:207]
    s_waitcnt lgkmcnt(5)
    v_accvgpr_write_b32 a64, 0
    v_smfmac_f32_16x16x64_bf16 a[232:235], v[24:27], a[216:223], v20
    ds_read_b64_tr_b16 a[202:203], v8 offset:20480
    v_mfma_f32_16x16x32_bf16 v[160:163], a[224:227], a[160:163], v[160:163]
    buffer_load_dwordx4 v35, s[20:23], s40 offen offset:1024 lds
    v_mfma_f32_16x16x32_bf16 v[160:163], a[228:231], a[164:167], v[160:163]
    ds_read_b64_tr_b16 a[204:205], v8 offset:24576
    v_accvgpr_write_b32 a65, 0
    v_mfma_f32_16x16x32_bf16 v[164:167], a[228:231], a[172:175], v[164:167]
    buffer_load_dwordx4 v36, s[20:23], s40 offen offset:2048 lds
    v_mfma_f32_16x16x32_bf16 v[164:167], a[224:227], a[168:171], v[164:167]
    ds_read_b64_tr_b16 a[206:207], v8 offset:28672
    v_accvgpr_write_b32 a66, 0
    v_mfma_f32_16x16x32_bf16 v[168:171], a[224:227], a[176:179], v[168:171]
    s_add_u32 s16, s60, 0
    s_addc_u32 s17, s61, 0
    v_mfma_f32_16x16x32_bf16 v[168:171], a[228:231], a[180:183], v[168:171]
    ds_read_b64_tr_b16 a[208:209], v59 offset:8192
    s_mov_b32 s18, 16777216
    v_mfma_f32_16x16x32_bf16 v[172:175], a[228:231], a[188:191], v[172:175]
    s_mov_b32 s19, 0x20000
    v_accvgpr_write_b32 a67, 0
    v_mfma_f32_16x16x32_bf16 v[172:175], a[224:227], a[184:187], v[172:175]
    ds_read_b64_tr_b16 a[210:211], v59 offset:10240
    s_waitcnt lgkmcnt(6)
    v_mfma_f32_16x16x32_bf16 v[76:79], a[192:195], a[184:187], v[76:79]
    buffer_load_dwordx4 v37, s[20:23], s40 offen offset:3072 lds
    v_mfma_f32_16x16x32_bf16 v[76:79], a[196:199], a[188:191], v[76:79]
    ds_read_b64_tr_b16 a[212:213], v59 offset:12288
    v_accvgpr_write_b32 a68, 0
    v_mfma_f32_16x16x32_bf16 v[72:75], a[196:199], a[180:183], v[72:75]
    s_add_u32 s36, s60, 16777216
    s_addc_u32 s37, s61, 0
    v_mfma_f32_16x16x32_bf16 v[72:75], a[192:195], a[176:179], v[72:75]
    ds_read_b64_tr_b16 a[214:215], v59 offset:14336
    s_add_u32 m0, s47, 12288
    v_mfma_f32_16x16x32_bf16 v[68:71], a[192:195], a[168:171], v[68:71]
    s_xor_b32 s40, s78, 33536
    s_mov_b32 s38, 5636096
    v_mfma_f32_16x16x32_bf16 v[68:71], a[196:199], a[172:175], v[68:71]
    ds_read_b64_tr_b16 a[216:217], v9 offset:16384
    s_mov_b32 s39, 0x20000
    v_mfma_f32_16x16x32_bf16 v[64:67], a[196:199], a[164:167], v[64:67]
    buffer_load_dwordx4 v34, s[20:23], s40 offen offset:0 lds
    v_mfma_f32_16x16x32_bf16 v[64:67], a[192:195], a[160:163], v[64:67]
    ds_read_b64_tr_b16 a[218:219], v9 offset:20480
    s_lshl_b32 s5, s44, 14
    v_smfmac_f32_16x16x64_bf16 a[236:239], v[24:27], a[192:199], v20
    s_waitcnt lgkmcnt(6)
    v_mfma_f32_16x16x32_bf16 v[208:211], a[200:203], a[160:163], v[208:211]
    ds_read_b64_tr_b16 a[220:221], v9 offset:24576
    s_add_u32 s5, s5, s41
    v_mfma_f32_16x16x32_bf16 v[208:211], a[204:207], a[164:167], v[208:211]
    buffer_load_dwordx4 v35, s[20:23], s40 offen offset:1024 lds
    v_mfma_f32_16x16x32_bf16 v[212:215], a[204:207], a[172:175], v[212:215]
    ds_read_b64_tr_b16 a[222:223], v9 offset:28672
    s_lshr_b32 s6, s69, 4
    v_mfma_f32_16x16x32_bf16 v[212:215], a[200:203], a[168:171], v[212:215]
    s_add_u32 s5, s5, s6
    s_lshl_b32 s3, s43, 17
    v_mfma_f32_16x16x32_bf16 v[216:219], a[200:203], a[176:179], v[216:219]
    ds_read_b64_tr_b16 a[224:225], v10 offset:16384
    s_add_u32 s72, s3, s5
    v_mfma_f32_16x16x32_bf16 v[216:219], a[204:207], a[180:183], v[216:219]
    buffer_load_dwordx4 v36, s[20:23], s40 offen offset:2048 lds
    v_mfma_f32_16x16x32_bf16 v[220:223], a[204:207], a[188:191], v[220:223]
    ds_read_b64_tr_b16 a[226:227], v10 offset:20480
    s_xor_b32 s73, s72, 2048
    v_mfma_f32_16x16x32_bf16 v[220:223], a[200:203], a[184:187], v[220:223]
    s_waitcnt lgkmcnt(6)
    s_lshl_b32 s3, s70, 17
    v_mfma_f32_16x16x32_bf16 v[188:191], a[208:211], a[184:187], v[188:191]
    ds_read_b64_tr_b16 a[228:229], v10 offset:24576
    s_add_u32 s74, s3, s5
    v_mfma_f32_16x16x32_bf16 v[188:191], a[212:215], a[188:191], v[188:191]
    s_lshl_b32 s70, s2, 11
    s_lshl_b32 s3, s45, 9
    v_mfma_f32_16x16x32_bf16 v[184:187], a[212:215], a[180:183], v[184:187]
    ds_read_b64_tr_b16 a[230:231], v10 offset:28672
    s_add_u32 s70, s70, s3
    v_mfma_f32_16x16x32_bf16 v[184:187], a[208:211], a[176:179], v[184:187]
    buffer_load_dwordx4 v37, s[20:23], s40 offen offset:3072 lds
    v_mfma_f32_16x16x32_bf16 v[180:183], a[208:211], a[168:171], v[180:183]
    ds_read_b64_tr_b16 a[192:193], v60 offset:8192
    s_add_u32 s70, s70, 12582912
    v_mfma_f32_16x16x32_bf16 v[180:183], a[212:215], a[172:175], v[180:183]
    s_lshl_b32 s3, s45, 2
    s_lshl_b32 s5, s44, 21
    v_mfma_f32_16x16x32_bf16 v[176:179], a[212:215], a[164:167], v[176:179]
    ds_read_b64_tr_b16 a[194:195], v60 offset:10240
    s_add_u32 m0, s41, 65536
    v_mfma_f32_16x16x32_bf16 v[176:179], a[208:211], a[160:163], v[176:179]
    s_waitcnt lgkmcnt(6)
    s_xor_b32 s40, s79, 3145728
    v_mfma_f32_16x16x32_bf16 v[92:95], a[216:219], a[184:187], v[92:95]
    ds_read_b64_tr_b16 a[196:197], v60 offset:12288
    s_lshl_b32 s6, s45, 19
    v_mfma_f32_16x16x32_bf16 v[92:95], a[220:223], a[188:191], v[92:95]
    buffer_load_dwordx4 v38, s[24:27], s40 offen offset:0 lds
    v_mfma_f32_16x16x32_bf16 v[88:91], a[220:223], a[180:183], v[88:91]
    ds_read_b64_tr_b16 a[198:199], v60 offset:14336
    s_add_u32 s5, s5, s6
    v_mfma_f32_16x16x32_bf16 v[88:91], a[216:219], a[176:179], v[88:91]
    s_lshl_b32 s6, s43, 12
    s_add_u32 s76, s5, s6
    v_mfma_f32_16x16x32_bf16 v[84:87], a[216:219], a[168:171], v[84:87]
    ds_read_b64_tr_b16 a[200:201], v11 offset:16384
    v_lshrrev_b32 v46, 1, v44
    v_mfma_f32_16x16x32_bf16 v[84:87], a[220:223], a[172:175], v[84:87]
    ds_read_b64_tr_b16 a[202:203], v11 offset:20480
    v_and_b32 v47, 1, v44
    v_mfma_f32_16x16x32_bf16 v[80:83], a[220:223], a[164:167], v[80:83]
    ds_read_b64_tr_b16 a[204:205], v11 offset:24576
    v_lshl_or_b32 v46, v47, 1, v46
    v_mfma_f32_16x16x32_bf16 v[80:83], a[216:219], a[160:163], v[80:83]
    ds_read_b64_tr_b16 a[206:207], v11 offset:28672
    s_waitcnt lgkmcnt(8)
    v_mfma_f32_16x16x32_bf16 v[224:227], a[224:227], a[160:163], v[224:227]
    ds_read_b64_tr_b16 a[208:209], v12 offset:16384
    v_xor_b32 v46, v44, v45
    v_mfma_f32_16x16x32_bf16 v[224:227], a[228:231], a[164:167], v[224:227]
    buffer_load_dwordx4 v39, s[24:27], s40 offen offset:1024 lds
    v_mfma_f32_16x16x32_bf16 v[228:231], a[228:231], a[172:175], v[228:231]
    ds_read_b64_tr_b16 a[210:211], v12 offset:20480
    v_xor_b32 v46, s3, v46
    v_mfma_f32_16x16x32_bf16 v[228:231], a[224:227], a[168:171], v[228:231]
    buffer_load_dwordx4 v40, s[24:27], s40 offen offset:2048 lds
    v_mfma_f32_16x16x32_bf16 v[232:235], a[224:227], a[176:179], v[232:235]
    ds_read_b64_tr_b16 a[212:213], v12 offset:24576
    v_lshlrev_b32 v47, 8, v45
    v_mfma_f32_16x16x32_bf16 v[232:235], a[228:231], a[180:183], v[232:235]
    ds_read_b64_tr_b16 a[214:215], v12 offset:28672
    v_lshl_add_u32 v2, v46, 4, v47
    v_mfma_f32_16x16x32_bf16 v[236:239], a[228:231], a[188:191], v[236:239]
    ds_read_b64_tr_b16 a[216:217], v13 offset:16384
    v_xor_b32 v3, 64, v2
    v_mfma_f32_16x16x32_bf16 v[236:239], a[224:227], a[184:187], v[236:239]
    s_waitcnt lgkmcnt(9)
    s_waitcnt lgkmcnt(5)
    v_smfmac_f32_16x16x64_bf16 a[240:243], v[24:27], a[192:199], v20
    ds_read_b64_tr_b16 a[218:219], v13 offset:20480
    v_mfma_f32_16x16x32_bf16 v[108:111], a[200:203], a[184:187], v[108:111]
    buffer_load_dwordx4 v41, s[24:27], s40 offen offset:3072 lds
    v_mfma_f32_16x16x32_bf16 v[108:111], a[204:207], a[188:191], v[108:111]
    ds_read_b64_tr_b16 a[220:221], v13 offset:24576
    s_add_u32 m0, s68, 131072
    v_mfma_f32_16x16x32_bf16 v[104:107], a[204:207], a[180:183], v[104:107]
    s_xor_b32 s40, s42, 6
    s_mul_i32 s40, s40, 176128
    v_mfma_f32_16x16x32_bf16 v[104:107], a[200:203], a[176:179], v[104:107]
    ds_read_b64_tr_b16 a[222:223], v13 offset:28672
    v_xor_b32 v4, 128, v2
    v_mfma_f32_16x16x32_bf16 v[100:103], a[200:203], a[168:171], v[100:103]
    ds_read_b64_tr_b16 a[224:225], v56 offset:8192
    v_xor_b32 v5, 192, v2
    v_mfma_f32_16x16x32_bf16 v[100:103], a[204:207], a[172:175], v[100:103]
    buffer_load_dwordx4 v42, s[28:31], s40 offen offset:0 lds
    v_mfma_f32_16x16x32_bf16 v[96:99], a[204:207], a[164:167], v[96:99]
    ds_read_b64_tr_b16 a[226:227], v56 offset:10240
    s_waitcnt vmcnt(19)
    v_mfma_f32_16x16x32_bf16 v[96:99], a[200:203], a[160:163], v[96:99]
    s_waitcnt lgkmcnt(6)
    ds_read_b128 a[128:131], v32 offset:0
    v_mfma_f32_16x16x32_bf16 v[240:243], a[208:211], a[160:163], v[240:243]
    ds_read_b64_tr_b16 a[228:229], v56 offset:12288
    v_lshl_add_u32 v46, v44, 8, s41
    v_mfma_f32_16x16x32_bf16 v[240:243], a[212:215], a[164:167], v[240:243]
    ds_read_b128 a[132:135], v33 offset:0
    v_xor_b32 v47, v44, v45
    v_mfma_f32_16x16x32_bf16 v[244:247], a[212:215], a[172:175], v[244:247]
    ds_read_b64_tr_b16 a[230:231], v56 offset:14336
    v_lshl_add_u32 v14, v47, 4, v46
    v_mfma_f32_16x16x32_bf16 v[244:247], a[208:211], a[168:171], v[244:247]
    ds_read_b128 a[136:139], v32 offset:2048
    v_lshlrev_b32 v47, 1, v44
    v_mfma_f32_16x16x32_bf16 v[248:251], a[208:211], a[176:179], v[248:251]
    ds_read_b64_tr_b16 a[192:193], v57 offset:8192
    v_xor_b32 v47, v47, v45
    v_mfma_f32_16x16x32_bf16 v[248:251], a[212:215], a[180:183], v[248:251]
    ds_read_b128 a[140:143], v33 offset:2048
    v_lshl_add_u32 v18, v47, 4, v46
    v_mfma_f32_16x16x32_bf16 v[252:255], a[212:215], a[188:191], v[252:255]
    ds_read_b64_tr_b16 a[194:195], v57 offset:10240
    v_xor_b32 v19, 128, v18
    v_mfma_f32_16x16x32_bf16 v[252:255], a[208:211], a[184:187], v[252:255]
    s_waitcnt lgkmcnt(10)
    ds_read_b128 a[144:147], v32 offset:4096
    v_mfma_f32_16x16x32_bf16 v[124:127], a[216:219], a[184:187], v[124:127]
    ds_read_b64_tr_b16 a[196:197], v57 offset:12288
    v_xor_b32 v15, 64, v14
    v_mfma_f32_16x16x32_bf16 v[124:127], a[220:223], a[188:191], v[124:127]
    ds_read_b128 a[148:151], v33 offset:4096
    v_xor_b32 v16, 128, v14
    v_mfma_f32_16x16x32_bf16 v[120:123], a[220:223], a[180:183], v[120:123]
    ds_read_b64_tr_b16 a[198:199], v57 offset:14336
    v_xor_b32 v17, 192, v14
    v_mfma_f32_16x16x32_bf16 v[120:123], a[216:219], a[176:179], v[120:123]
    ds_read_b128 a[152:155], v32 offset:6144
    v_lshlrev_b32 v61, 3, v44
    v_mfma_f32_16x16x32_bf16 v[116:119], a[216:219], a[168:171], v[116:119]
    ds_read_b128 a[156:159], v33 offset:6144
    v_mov_b32 v44, 0
    v_mfma_f32_16x16x32_bf16 v[116:119], a[220:223], a[172:175], v[116:119]
    buffer_load_dwordx4 v43, s[28:31], s40 offen offset:1024 lds
    v_mfma_f32_16x16x32_bf16 v[112:115], a[220:223], a[164:167], v[112:115]
    v_mov_b32 v45, 0
    v_mov_b32 v46, 0
    v_mfma_f32_16x16x32_bf16 v[112:115], a[216:219], a[160:163], v[112:115]
    s_waitcnt lgkmcnt(10)
    v_mov_b32 v47, 0
    v_mfma_f32_16x16x32_bf16 v[128:131], a[224:227], a[160:163], v[128:131]
    v_accvgpr_write_b32 a69, 0
    v_accvgpr_write_b32 a70, 0
    v_mfma_f32_16x16x32_bf16 v[128:131], a[228:231], a[164:167], v[128:131]
    v_accvgpr_write_b32 a71, 0
    v_accvgpr_write_b32 a72, 0
    v_mfma_f32_16x16x32_bf16 v[132:135], a[228:231], a[172:175], v[132:135]
    v_accvgpr_write_b32 a73, 0
    v_accvgpr_write_b32 a74, 0
    v_mfma_f32_16x16x32_bf16 v[132:135], a[224:227], a[168:171], v[132:135]
    s_waitcnt vmcnt(14)
    v_accvgpr_write_b32 a75, 0
    v_mfma_f32_16x16x32_bf16 v[136:139], a[224:227], a[176:179], v[136:139]
    s_waitcnt lgkmcnt(2)
    s_barrier
    v_mfma_f32_16x16x32_bf16 v[136:139], a[228:231], a[180:183], v[136:139]
    ds_read_b64_tr_b16 a[200:201], v6 offset:32768
    v_accvgpr_write_b32 a76, 0
    v_mfma_f32_16x16x32_bf16 v[140:143], a[228:231], a[188:191], v[140:143]
    ds_read_b64_tr_b16 a[202:203], v6 offset:36864
    v_accvgpr_write_b32 a77, 0
    v_mfma_f32_16x16x32_bf16 v[140:143], a[224:227], a[184:187], v[140:143]
    ds_read_b64_tr_b16 a[204:205], v6 offset:40960
    v_accvgpr_write_b32 a78, 0
    v_mfma_f32_16x16x32_bf16 v[156:159], a[192:195], a[184:187], v[156:159]
    ds_read_b64_tr_b16 a[206:207], v6 offset:45056
    v_accvgpr_write_b32 a79, 0
    v_mfma_f32_16x16x32_bf16 v[156:159], a[196:199], a[188:191], v[156:159]
L1_pa1:
    s_cbranch_execz L1_pa5
    ds_read_b64_tr_b16 a[208:209], v58 offset:16384
    v_accvgpr_write_b32 a80, 0
    v_mfma_f32_16x16x32_bf16 v[152:155], a[196:199], a[180:183], v[152:155]
    v_accvgpr_write_b32 a81, 0
    v_accvgpr_write_b32 a82, 0
    v_mfma_f32_16x16x32_bf16 v[152:155], a[192:195], a[176:179], v[152:155]
    ds_read_b64_tr_b16 a[210:211], v58 offset:18432
    v_accvgpr_write_b32 a83, 0
    v_mfma_f32_16x16x32_bf16 v[148:151], a[192:195], a[168:171], v[148:151]
    v_accvgpr_write_b32 a84, 0
    v_accvgpr_write_b32 a85, 0
    v_mfma_f32_16x16x32_bf16 v[148:151], a[196:199], a[172:175], v[148:151]
    ds_read_b64_tr_b16 a[212:213], v58 offset:20480
    v_accvgpr_write_b32 a86, 0
    v_mfma_f32_16x16x32_bf16 v[144:147], a[196:199], a[164:167], v[144:147]
    ds_read_b64_tr_b16 a[214:215], v58 offset:22528
    s_waitcnt lgkmcnt(8)
    v_mfma_f32_16x16x32_bf16 v[144:147], a[192:195], a[160:163], v[144:147]
    ds_read_b64_tr_b16 a[216:217], v7 offset:32768
    s_waitcnt lgkmcnt(5)
    v_mfma_f32_16x16x32_bf16 v[192:195], a[200:203], a[128:131], v[192:195]
    s_add_u32 m0, s47, 0
    s_xor_b32 s40, s78, 128
    v_mfma_f32_16x16x32_bf16 v[192:195], a[204:207], a[132:135], v[192:195]
    ds_read_b64_tr_b16 a[218:219], v7 offset:36864
    v_accvgpr_write_b32 a87, 0
    v_mfma_f32_16x16x32_bf16 v[196:199], a[204:207], a[140:143], v[196:199]
    buffer_load_dwordx4 v34, s[20:23], s40 offen offset:0 lds
    v_mfma_f32_16x16x32_bf16 v[196:199], a[200:203], a[136:139], v[196:199]
    ds_read_b64_tr_b16 a[220:221], v7 offset:40960
    v_accvgpr_write_b32 a88, 0
    v_mfma_f32_16x16x32_bf16 v[200:203], a[200:203], a[144:147], v[200:203]
    v_accvgpr_write_b32 a89, 0
    v_accvgpr_write_b32 a90, 0
    v_mfma_f32_16x16x32_bf16 v[200:203], a[204:207], a[148:151], v[200:203]
    ds_read_b64_tr_b16 a[222:223], v7 offset:45056
    v_accvgpr_write_b32 a91, 0
    v_mfma_f32_16x16x32_bf16 v[204:207], a[204:207], a[156:159], v[204:207]
    ds_read_b64_tr_b16 a[224:225], v8 offset:32768
    v_accvgpr_write_b32 a92, 0
    v_mfma_f32_16x16x32_bf16 v[204:207], a[200:203], a[152:155], v[204:207]
    s_waitcnt lgkmcnt(5)
    v_accvgpr_write_b32 a93, 0
    v_smfmac_f32_16x16x64_bf16 a[232:235], v[24:27], a[200:207], v20
    ds_read_b64_tr_b16 a[226:227], v8 offset:36864
    v_mfma_f32_16x16x32_bf16 v[160:163], a[208:211], a[128:131], v[160:163]
    buffer_load_dwordx4 v35, s[20:23], s40 offen offset:1024 lds
    v_mfma_f32_16x16x32_bf16 v[160:163], a[212:215], a[132:135], v[160:163]
    ds_read_b64_tr_b16 a[228:229], v8 offset:40960
    v_accvgpr_write_b32 a94, 0
    v_mfma_f32_16x16x32_bf16 v[164:167], a[212:215], a[140:143], v[164:167]
    buffer_load_dwordx4 v36, s[20:23], s40 offen offset:2048 lds
    v_mfma_f32_16x16x32_bf16 v[164:167], a[208:211], a[136:139], v[164:167]
    ds_read_b64_tr_b16 a[230:231], v8 offset:45056
    v_accvgpr_write_b32 a95, 0
    v_mfma_f32_16x16x32_bf16 v[168:171], a[208:211], a[144:147], v[168:171]
    v_accvgpr_write_b32 a96, 0
    v_accvgpr_write_b32 a97, 0
    v_mfma_f32_16x16x32_bf16 v[168:171], a[212:215], a[148:151], v[168:171]
    ds_read_b64_tr_b16 a[192:193], v59 offset:16384
    v_accvgpr_write_b32 a98, 0
    v_mfma_f32_16x16x32_bf16 v[172:175], a[212:215], a[156:159], v[172:175]
    v_accvgpr_write_b32 a99, 0
    v_accvgpr_write_b32 a100, 0
    v_mfma_f32_16x16x32_bf16 v[172:175], a[208:211], a[152:155], v[172:175]
    ds_read_b64_tr_b16 a[194:195], v59 offset:18432
    s_waitcnt lgkmcnt(6)
    v_mfma_f32_16x16x32_bf16 v[76:79], a[216:219], a[152:155], v[76:79]
    buffer_load_dwordx4 v37, s[20:23], s40 offen offset:3072 lds
    v_mfma_f32_16x16x32_bf16 v[76:79], a[220:223], a[156:159], v[76:79]
    ds_read_b64_tr_b16 a[196:197], v59 offset:20480
    v_accvgpr_write_b32 a101, 0
    v_mfma_f32_16x16x32_bf16 v[72:75], a[220:223], a[148:151], v[72:75]
    v_accvgpr_write_b32 a102, 0
    v_accvgpr_write_b32 a103, 0
    v_mfma_f32_16x16x32_bf16 v[72:75], a[216:219], a[144:147], v[72:75]
    ds_read_b64_tr_b16 a[198:199], v59 offset:22528
    s_add_u32 m0, s47, 4096
    v_mfma_f32_16x16x32_bf16 v[68:71], a[216:219], a[136:139], v[68:71]
    s_xor_b32 s40, s78, 32896
    v_accvgpr_write_b32 a104, 0
    v_mfma_f32_16x16x32_bf16 v[68:71], a[220:223], a[140:143], v[68:71]
    ds_read_b64_tr_b16 a[200:201], v9 offset:32768
    v_accvgpr_write_b32 a105, 0
    v_mfma_f32_16x16x32_bf16 v[64:67], a[220:223], a[132:135], v[64:67]
    buffer_load_dwordx4 v34, s[20:23], s40 offen offset:0 lds
    v_mfma_f32_16x16x32_bf16 v[64:67], a[216:219], a[128:131], v[64:67]
    ds_read_b64_tr_b16 a[202:203], v9 offset:36864
    v_accvgpr_write_b32 a106, 0
    v_smfmac_f32_16x16x64_bf16 a[236:239], v[24:27], a[216:223], v20
    s_waitcnt lgkmcnt(6)
    v_mfma_f32_16x16x32_bf16 v[208:211], a[224:227], a[128:131], v[208:211]
    ds_read_b64_tr_b16 a[204:205], v9 offset:40960
    v_accvgpr_write_b32 a107, 0
    v_mfma_f32_16x16x32_bf16 v[208:211], a[228:231], a[132:135], v[208:211]
    buffer_load_dwordx4 v35, s[20:23], s40 offen offset:1024 lds
    v_mfma_f32_16x16x32_bf16 v[212:215], a[228:231], a[140:143], v[212:215]
    ds_read_b64_tr_b16 a[206:207], v9 offset:45056
    v_accvgpr_write_b32 a108, 0
    v_mfma_f32_16x16x32_bf16 v[212:215], a[224:227], a[136:139], v[212:215]
    v_accvgpr_write_b32 a109, 0
    v_accvgpr_write_b32 a110, 0
    v_mfma_f32_16x16x32_bf16 v[216:219], a[224:227], a[144:147], v[216:219]
    ds_read_b64_tr_b16 a[208:209], v10 offset:32768
    v_accvgpr_write_b32 a111, 0
    v_mfma_f32_16x16x32_bf16 v[216:219], a[228:231], a[148:151], v[216:219]
    buffer_load_dwordx4 v36, s[20:23], s40 offen offset:2048 lds
    v_mfma_f32_16x16x32_bf16 v[220:223], a[228:231], a[156:159], v[220:223]
    ds_read_b64_tr_b16 a[210:211], v10 offset:36864
    v_accvgpr_write_b32 a112, 0
    v_mfma_f32_16x16x32_bf16 v[220:223], a[224:227], a[152:155], v[220:223]
    s_waitcnt lgkmcnt(6)
    v_accvgpr_write_b32 a113, 0
    v_mfma_f32_16x16x32_bf16 v[188:191], a[192:195], a[152:155], v[188:191]
    ds_read_b64_tr_b16 a[212:213], v10 offset:40960
    v_accvgpr_write_b32 a114, 0
    v_mfma_f32_16x16x32_bf16 v[188:191], a[196:199], a[156:159], v[188:191]
    v_accvgpr_write_b32 a115, 0
    v_accvgpr_write_b32 a116, 0
    v_mfma_f32_16x16x32_bf16 v[184:187], a[196:199], a[148:151], v[184:187]
    ds_read_b64_tr_b16 a[214:215], v10 offset:45056
    v_accvgpr_write_b32 a117, 0
    v_mfma_f32_16x16x32_bf16 v[184:187], a[192:195], a[144:147], v[184:187]
    buffer_load_dwordx4 v37, s[20:23], s40 offen offset:3072 lds
    v_mfma_f32_16x16x32_bf16 v[180:183], a[192:195], a[136:139], v[180:183]
    ds_read_b64_tr_b16 a[216:217], v60 offset:16384
    v_accvgpr_write_b32 a118, 0
    v_mfma_f32_16x16x32_bf16 v[180:183], a[196:199], a[140:143], v[180:183]
    v_accvgpr_write_b32 a119, 0
    v_accvgpr_write_b32 a120, 0
    v_mfma_f32_16x16x32_bf16 v[176:179], a[196:199], a[132:135], v[176:179]
    ds_read_b64_tr_b16 a[218:219], v60 offset:18432
    s_add_u32 m0, s41, 81920
    v_mfma_f32_16x16x32_bf16 v[176:179], a[192:195], a[128:131], v[176:179]
    s_waitcnt lgkmcnt(6)
    s_xor_b32 s40, s79, 524288
    v_mfma_f32_16x16x32_bf16 v[92:95], a[200:203], a[152:155], v[92:95]
    ds_read_b64_tr_b16 a[220:221], v60 offset:20480
    v_accvgpr_write_b32 a121, 0
    v_mfma_f32_16x16x32_bf16 v[92:95], a[204:207], a[156:159], v[92:95]
    buffer_load_dwordx4 v38, s[24:27], s40 offen offset:0 lds
    v_mfma_f32_16x16x32_bf16 v[88:91], a[204:207], a[148:151], v[88:91]
    ds_read_b64_tr_b16 a[222:223], v60 offset:22528
    v_accvgpr_write_b32 a122, 0
    v_mfma_f32_16x16x32_bf16 v[88:91], a[200:203], a[144:147], v[88:91]
    v_accvgpr_write_b32 a123, 0
    v_accvgpr_write_b32 a124, 0
    v_mfma_f32_16x16x32_bf16 v[84:87], a[200:203], a[136:139], v[84:87]
    ds_read_b64_tr_b16 a[224:225], v11 offset:32768
    v_accvgpr_write_b32 a125, 0
    v_mfma_f32_16x16x32_bf16 v[84:87], a[204:207], a[140:143], v[84:87]
    ds_read_b64_tr_b16 a[226:227], v11 offset:36864
    v_accvgpr_write_b32 a126, 0
    v_mfma_f32_16x16x32_bf16 v[80:83], a[204:207], a[132:135], v[80:83]
    ds_read_b64_tr_b16 a[228:229], v11 offset:40960
    v_accvgpr_write_b32 a127, 0
    v_mfma_f32_16x16x32_bf16 v[80:83], a[200:203], a[128:131], v[80:83]
    ds_read_b64_tr_b16 a[230:231], v11 offset:45056
    s_waitcnt lgkmcnt(8)
    v_mfma_f32_16x16x32_bf16 v[224:227], a[208:211], a[128:131], v[224:227]
    ds_read_b64_tr_b16 a[192:193], v12 offset:32768
    v_mfma_f32_16x16x32_bf16 v[224:227], a[212:215], a[132:135], v[224:227]
    buffer_load_dwordx4 v39, s[24:27], s40 offen offset:1024 lds
    v_mfma_f32_16x16x32_bf16 v[228:231], a[212:215], a[140:143], v[228:231]
    ds_read_b64_tr_b16 a[194:195], v12 offset:36864
    v_mfma_f32_16x16x32_bf16 v[228:231], a[208:211], a[136:139], v[228:231]
    buffer_load_dwordx4 v40, s[24:27], s40 offen offset:2048 lds
    v_mfma_f32_16x16x32_bf16 v[232:235], a[208:211], a[144:147], v[232:235]
    ds_read_b64_tr_b16 a[196:197], v12 offset:40960
    v_mfma_f32_16x16x32_bf16 v[232:235], a[212:215], a[148:151], v[232:235]
    ds_read_b64_tr_b16 a[198:199], v12 offset:45056
    v_mfma_f32_16x16x32_bf16 v[236:239], a[212:215], a[156:159], v[236:239]
    ds_read_b64_tr_b16 a[200:201], v13 offset:32768
    v_mfma_f32_16x16x32_bf16 v[236:239], a[208:211], a[152:155], v[236:239]
    s_waitcnt lgkmcnt(9)
    s_waitcnt lgkmcnt(5)
    v_smfmac_f32_16x16x64_bf16 a[240:243], v[24:27], a[216:223], v20
    ds_read_b64_tr_b16 a[202:203], v13 offset:36864
    v_mfma_f32_16x16x32_bf16 v[108:111], a[224:227], a[152:155], v[108:111]
    buffer_load_dwordx4 v41, s[24:27], s40 offen offset:3072 lds
    v_mfma_f32_16x16x32_bf16 v[108:111], a[228:231], a[156:159], v[108:111]
    ds_read_b64_tr_b16 a[204:205], v13 offset:40960
    s_add_u32 m0, s68, 139264
    v_mfma_f32_16x16x32_bf16 v[104:107], a[228:231], a[148:151], v[104:107]
    s_xor_b32 s40, s42, 1
    s_mul_i32 s40, s40, 176128
    v_mfma_f32_16x16x32_bf16 v[104:107], a[224:227], a[144:147], v[104:107]
    ds_read_b64_tr_b16 a[206:207], v13 offset:45056
    v_mfma_f32_16x16x32_bf16 v[100:103], a[224:227], a[136:139], v[100:103]
    ds_read_b64_tr_b16 a[208:209], v56 offset:16384
    v_mfma_f32_16x16x32_bf16 v[100:103], a[228:231], a[140:143], v[100:103]
    buffer_load_dwordx4 v42, s[28:31], s40 offen offset:0 lds
    v_mfma_f32_16x16x32_bf16 v[96:99], a[228:231], a[132:135], v[96:99]
    ds_read_b64_tr_b16 a[210:211], v56 offset:18432
    s_waitcnt vmcnt(19)
    v_mfma_f32_16x16x32_bf16 v[96:99], a[224:227], a[128:131], v[96:99]
    s_waitcnt lgkmcnt(6)
    ds_read_b128 a[160:163], v32 offset:8192
    v_mfma_f32_16x16x32_bf16 v[240:243], a[192:195], a[128:131], v[240:243]
    ds_read_b64_tr_b16 a[212:213], v56 offset:20480
    v_mfma_f32_16x16x32_bf16 v[240:243], a[196:199], a[132:135], v[240:243]
    ds_read_b128 a[164:167], v33 offset:8192
    v_mfma_f32_16x16x32_bf16 v[244:247], a[196:199], a[140:143], v[244:247]
    ds_read_b64_tr_b16 a[214:215], v56 offset:22528
    v_mfma_f32_16x16x32_bf16 v[244:247], a[192:195], a[136:139], v[244:247]
    ds_read_b128 a[168:171], v32 offset:10240
    v_mfma_f32_16x16x32_bf16 v[248:251], a[192:195], a[144:147], v[248:251]
    ds_read_b64_tr_b16 a[216:217], v57 offset:16384
    v_mfma_f32_16x16x32_bf16 v[248:251], a[196:199], a[148:151], v[248:251]
    ds_read_b128 a[172:175], v33 offset:10240
    v_mfma_f32_16x16x32_bf16 v[252:255], a[196:199], a[156:159], v[252:255]
    ds_read_b64_tr_b16 a[218:219], v57 offset:18432
    v_mfma_f32_16x16x32_bf16 v[252:255], a[192:195], a[152:155], v[252:255]
    s_waitcnt lgkmcnt(10)
    ds_read_b128 a[176:179], v32 offset:12288
    v_mfma_f32_16x16x32_bf16 v[124:127], a[200:203], a[152:155], v[124:127]
    ds_read_b64_tr_b16 a[220:221], v57 offset:20480
    v_mfma_f32_16x16x32_bf16 v[124:127], a[204:207], a[156:159], v[124:127]
    ds_read_b128 a[180:183], v33 offset:12288
    v_mfma_f32_16x16x32_bf16 v[120:123], a[204:207], a[148:151], v[120:123]
    ds_read_b64_tr_b16 a[222:223], v57 offset:22528
    v_mfma_f32_16x16x32_bf16 v[120:123], a[200:203], a[144:147], v[120:123]
    ds_read_b128 a[184:187], v32 offset:14336
    v_mfma_f32_16x16x32_bf16 v[116:119], a[200:203], a[136:139], v[116:119]
    ds_read_b128 a[188:191], v33 offset:14336
    v_mfma_f32_16x16x32_bf16 v[116:119], a[204:207], a[140:143], v[116:119]
    buffer_load_dwordx4 v43, s[28:31], s40 offen offset:1024 lds
    v_mfma_f32_16x16x32_bf16 v[112:115], a[204:207], a[132:135], v[112:115]
    v_mfma_f32_16x16x32_bf16 v[112:115], a[200:203], a[128:131], v[112:115]
    s_waitcnt lgkmcnt(10)
    v_mfma_f32_16x16x32_bf16 v[128:131], a[208:211], a[128:131], v[128:131]
    v_mfma_f32_16x16x32_bf16 v[128:131], a[212:215], a[132:135], v[128:131]
    v_mfma_f32_16x16x32_bf16 v[132:135], a[212:215], a[140:143], v[132:135]
    v_mfma_f32_16x16x32_bf16 v[132:135], a[208:211], a[136:139], v[132:135]
    s_waitcnt vmcnt(14)
    v_mfma_f32_16x16x32_bf16 v[136:139], a[208:211], a[144:147], v[136:139]
    s_waitcnt lgkmcnt(2)
    s_barrier
    v_mfma_f32_16x16x32_bf16 v[136:139], a[212:215], a[148:151], v[136:139]
    ds_read_b64_tr_b16 a[224:225], v6 offset:0
    v_mfma_f32_16x16x32_bf16 v[140:143], a[212:215], a[156:159], v[140:143]
    ds_read_b64_tr_b16 a[226:227], v6 offset:4096
    v_mfma_f32_16x16x32_bf16 v[140:143], a[208:211], a[152:155], v[140:143]
    ds_read_b64_tr_b16 a[228:229], v6 offset:8192
    v_mfma_f32_16x16x32_bf16 v[156:159], a[216:219], a[152:155], v[156:159]
    ds_read_b64_tr_b16 a[230:231], v6 offset:12288
    v_mfma_f32_16x16x32_bf16 v[156:159], a[220:223], a[156:159], v[156:159]
    ds_read_b64_tr_b16 a[192:193], v58 offset:0
    v_mfma_f32_16x16x32_bf16 v[152:155], a[220:223], a[148:151], v[152:155]
    v_mfma_f32_16x16x32_bf16 v[152:155], a[216:219], a[144:147], v[152:155]
    ds_read_b64_tr_b16 a[194:195], v58 offset:2048
    v_mfma_f32_16x16x32_bf16 v[148:151], a[216:219], a[136:139], v[148:151]
    v_mfma_f32_16x16x32_bf16 v[148:151], a[220:223], a[140:143], v[148:151]
    ds_read_b64_tr_b16 a[196:197], v58 offset:4096
    v_mfma_f32_16x16x32_bf16 v[144:147], a[220:223], a[132:135], v[144:147]
    ds_read_b64_tr_b16 a[198:199], v58 offset:6144
    s_waitcnt lgkmcnt(8)
    v_mfma_f32_16x16x32_bf16 v[144:147], a[216:219], a[128:131], v[144:147]
    ds_read_b64_tr_b16 a[200:201], v7 offset:0
    s_waitcnt lgkmcnt(5)
    v_mfma_f32_16x16x32_bf16 v[192:195], a[224:227], a[160:163], v[192:195]
    s_add_u32 m0, s47, 8192
    s_xor_b32 s40, s78, 384
    v_mfma_f32_16x16x32_bf16 v[192:195], a[228:231], a[164:167], v[192:195]
    ds_read_b64_tr_b16 a[202:203], v7 offset:4096
    v_mfma_f32_16x16x32_bf16 v[196:199], a[228:231], a[172:175], v[196:199]
    buffer_load_dwordx4 v34, s[20:23], s40 offen offset:0 lds
    v_mfma_f32_16x16x32_bf16 v[196:199], a[224:227], a[168:171], v[196:199]
    ds_read_b64_tr_b16 a[204:205], v7 offset:8192
    v_mfma_f32_16x16x32_bf16 v[200:203], a[224:227], a[176:179], v[200:203]
    v_mfma_f32_16x16x32_bf16 v[200:203], a[228:231], a[180:183], v[200:203]
    ds_read_b64_tr_b16 a[206:207], v7 offset:12288
    v_mfma_f32_16x16x32_bf16 v[204:207], a[228:231], a[188:191], v[204:207]
    ds_read_b64_tr_b16 a[208:209], v8 offset:0
    v_mfma_f32_16x16x32_bf16 v[204:207], a[224:227], a[184:187], v[204:207]
    s_waitcnt lgkmcnt(5)
    v_smfmac_f32_16x16x64_bf16 a[232:235], v[24:27], a[224:231], v20
    ds_read_b64_tr_b16 a[210:211], v8 offset:4096
    v_mfma_f32_16x16x32_bf16 v[160:163], a[192:195], a[160:163], v[160:163]
    buffer_load_dwordx4 v35, s[20:23], s40 offen offset:1024 lds
    v_mfma_f32_16x16x32_bf16 v[160:163], a[196:199], a[164:167], v[160:163]
    ds_read_b64_tr_b16 a[212:213], v8 offset:8192
    v_mfma_f32_16x16x32_bf16 v[164:167], a[196:199], a[172:175], v[164:167]
    buffer_load_dwordx4 v36, s[20:23], s40 offen offset:2048 lds
    v_mfma_f32_16x16x32_bf16 v[164:167], a[192:195], a[168:171], v[164:167]
    ds_read_b64_tr_b16 a[214:215], v8 offset:12288
    v_mfma_f32_16x16x32_bf16 v[168:171], a[192:195], a[176:179], v[168:171]
    v_mfma_f32_16x16x32_bf16 v[168:171], a[196:199], a[180:183], v[168:171]
    ds_read_b64_tr_b16 a[216:217], v59 offset:0
    v_mfma_f32_16x16x32_bf16 v[172:175], a[196:199], a[188:191], v[172:175]
    v_mfma_f32_16x16x32_bf16 v[172:175], a[192:195], a[184:187], v[172:175]
    ds_read_b64_tr_b16 a[218:219], v59 offset:2048
    s_waitcnt lgkmcnt(6)
    v_mfma_f32_16x16x32_bf16 v[76:79], a[200:203], a[184:187], v[76:79]
    buffer_load_dwordx4 v37, s[20:23], s40 offen offset:3072 lds
    v_mfma_f32_16x16x32_bf16 v[76:79], a[204:207], a[188:191], v[76:79]
    ds_read_b64_tr_b16 a[220:221], v59 offset:4096
    v_mfma_f32_16x16x32_bf16 v[72:75], a[204:207], a[180:183], v[72:75]
    v_mfma_f32_16x16x32_bf16 v[72:75], a[200:203], a[176:179], v[72:75]
    ds_read_b64_tr_b16 a[222:223], v59 offset:6144
    s_add_u32 m0, s47, 12288
    v_mfma_f32_16x16x32_bf16 v[68:71], a[200:203], a[168:171], v[68:71]
    s_xor_b32 s40, s78, 33152
    v_mfma_f32_16x16x32_bf16 v[68:71], a[204:207], a[172:175], v[68:71]
    ds_read_b64_tr_b16 a[224:225], v9 offset:0
    v_mfma_f32_16x16x32_bf16 v[64:67], a[204:207], a[164:167], v[64:67]
    buffer_load_dwordx4 v34, s[20:23], s40 offen offset:0 lds
    v_mfma_f32_16x16x32_bf16 v[64:67], a[200:203], a[160:163], v[64:67]
    ds_read_b64_tr_b16 a[226:227], v9 offset:4096
    v_smfmac_f32_16x16x64_bf16 a[236:239], v[24:27], a[200:207], v20
    s_waitcnt lgkmcnt(6)
    v_mfma_f32_16x16x32_bf16 v[208:211], a[208:211], a[160:163], v[208:211]
    ds_read_b64_tr_b16 a[228:229], v9 offset:8192
    v_mfma_f32_16x16x32_bf16 v[208:211], a[212:215], a[164:167], v[208:211]
    buffer_load_dwordx4 v35, s[20:23], s40 offen offset:1024 lds
    v_mfma_f32_16x16x32_bf16 v[212:215], a[212:215], a[172:175], v[212:215]
    ds_read_b64_tr_b16 a[230:231], v9 offset:12288
    v_mfma_f32_16x16x32_bf16 v[212:215], a[208:211], a[168:171], v[212:215]
    v_mfma_f32_16x16x32_bf16 v[216:219], a[208:211], a[176:179], v[216:219]
    ds_read_b64_tr_b16 a[192:193], v10 offset:0
    v_mfma_f32_16x16x32_bf16 v[216:219], a[212:215], a[180:183], v[216:219]
    buffer_load_dwordx4 v36, s[20:23], s40 offen offset:2048 lds
    v_mfma_f32_16x16x32_bf16 v[220:223], a[212:215], a[188:191], v[220:223]
    ds_read_b64_tr_b16 a[194:195], v10 offset:4096
    v_mfma_f32_16x16x32_bf16 v[220:223], a[208:211], a[184:187], v[220:223]
    s_waitcnt lgkmcnt(6)
    v_mfma_f32_16x16x32_bf16 v[188:191], a[216:219], a[184:187], v[188:191]
    ds_read_b64_tr_b16 a[196:197], v10 offset:8192
    v_mfma_f32_16x16x32_bf16 v[188:191], a[220:223], a[188:191], v[188:191]
    v_mfma_f32_16x16x32_bf16 v[184:187], a[220:223], a[180:183], v[184:187]
    ds_read_b64_tr_b16 a[198:199], v10 offset:12288
    v_mfma_f32_16x16x32_bf16 v[184:187], a[216:219], a[176:179], v[184:187]
    buffer_load_dwordx4 v37, s[20:23], s40 offen offset:3072 lds
    v_mfma_f32_16x16x32_bf16 v[180:183], a[216:219], a[168:171], v[180:183]
    ds_read_b64_tr_b16 a[200:201], v60 offset:0
    v_mfma_f32_16x16x32_bf16 v[180:183], a[220:223], a[172:175], v[180:183]
    v_mfma_f32_16x16x32_bf16 v[176:179], a[220:223], a[164:167], v[176:179]
    ds_read_b64_tr_b16 a[202:203], v60 offset:2048
    s_add_u32 m0, s41, 98304
    v_mfma_f32_16x16x32_bf16 v[176:179], a[216:219], a[160:163], v[176:179]
    s_waitcnt lgkmcnt(6)
    s_xor_b32 s40, s79, 1572864
    v_mfma_f32_16x16x32_bf16 v[92:95], a[224:227], a[184:187], v[92:95]
    ds_read_b64_tr_b16 a[204:205], v60 offset:4096
    v_mfma_f32_16x16x32_bf16 v[92:95], a[228:231], a[188:191], v[92:95]
    buffer_load_dwordx4 v38, s[24:27], s40 offen offset:0 lds
    v_mfma_f32_16x16x32_bf16 v[88:91], a[228:231], a[180:183], v[88:91]
    ds_read_b64_tr_b16 a[206:207], v60 offset:6144
    v_mfma_f32_16x16x32_bf16 v[88:91], a[224:227], a[176:179], v[88:91]
    v_mfma_f32_16x16x32_bf16 v[84:87], a[224:227], a[168:171], v[84:87]
    ds_read_b64_tr_b16 a[208:209], v11 offset:0
    v_mfma_f32_16x16x32_bf16 v[84:87], a[228:231], a[172:175], v[84:87]
    ds_read_b64_tr_b16 a[210:211], v11 offset:4096
    v_mfma_f32_16x16x32_bf16 v[80:83], a[228:231], a[164:167], v[80:83]
    ds_read_b64_tr_b16 a[212:213], v11 offset:8192
    v_mfma_f32_16x16x32_bf16 v[80:83], a[224:227], a[160:163], v[80:83]
    ds_read_b64_tr_b16 a[214:215], v11 offset:12288
    s_waitcnt lgkmcnt(8)
    v_mfma_f32_16x16x32_bf16 v[224:227], a[192:195], a[160:163], v[224:227]
    ds_read_b64_tr_b16 a[216:217], v12 offset:0
    v_mfma_f32_16x16x32_bf16 v[224:227], a[196:199], a[164:167], v[224:227]
    buffer_load_dwordx4 v39, s[24:27], s40 offen offset:1024 lds
    v_mfma_f32_16x16x32_bf16 v[228:231], a[196:199], a[172:175], v[228:231]
    ds_read_b64_tr_b16 a[218:219], v12 offset:4096
    v_mfma_f32_16x16x32_bf16 v[228:231], a[192:195], a[168:171], v[228:231]
    buffer_load_dwordx4 v40, s[24:27], s40 offen offset:2048 lds
    v_mfma_f32_16x16x32_bf16 v[232:235], a[192:195], a[176:179], v[232:235]
    ds_read_b64_tr_b16 a[220:221], v12 offset:8192
    v_mfma_f32_16x16x32_bf16 v[232:235], a[196:199], a[180:183], v[232:235]
    ds_read_b64_tr_b16 a[222:223], v12 offset:12288
    v_mfma_f32_16x16x32_bf16 v[236:239], a[196:199], a[188:191], v[236:239]
    ds_read_b64_tr_b16 a[224:225], v13 offset:0
    v_mfma_f32_16x16x32_bf16 v[236:239], a[192:195], a[184:187], v[236:239]
    s_waitcnt lgkmcnt(9)
    s_waitcnt lgkmcnt(5)
    v_smfmac_f32_16x16x64_bf16 a[240:243], v[24:27], a[200:207], v20
    ds_read_b64_tr_b16 a[226:227], v13 offset:4096
    v_mfma_f32_16x16x32_bf16 v[108:111], a[208:211], a[184:187], v[108:111]
    buffer_load_dwordx4 v41, s[24:27], s40 offen offset:3072 lds
    v_mfma_f32_16x16x32_bf16 v[108:111], a[212:215], a[188:191], v[108:111]
    ds_read_b64_tr_b16 a[228:229], v13 offset:8192
    s_add_u32 m0, s68, 147456
    v_mfma_f32_16x16x32_bf16 v[104:107], a[212:215], a[180:183], v[104:107]
    s_xor_b32 s40, s42, 3
    s_mul_i32 s40, s40, 176128
    v_mfma_f32_16x16x32_bf16 v[104:107], a[208:211], a[176:179], v[104:107]
    ds_read_b64_tr_b16 a[230:231], v13 offset:12288
    v_mfma_f32_16x16x32_bf16 v[100:103], a[208:211], a[168:171], v[100:103]
    ds_read_b64_tr_b16 a[192:193], v56 offset:0
    v_mfma_f32_16x16x32_bf16 v[100:103], a[212:215], a[172:175], v[100:103]
    buffer_load_dwordx4 v42, s[28:31], s40 offen offset:0 lds
    v_mfma_f32_16x16x32_bf16 v[96:99], a[212:215], a[164:167], v[96:99]
    ds_read_b64_tr_b16 a[194:195], v56 offset:2048
    s_waitcnt vmcnt(19)
    v_mfma_f32_16x16x32_bf16 v[96:99], a[208:211], a[160:163], v[96:99]
    s_waitcnt lgkmcnt(6)
    ds_read_b128 a[128:131], v32 offset:0
    v_mfma_f32_16x16x32_bf16 v[240:243], a[216:219], a[160:163], v[240:243]
    ds_read_b64_tr_b16 a[196:197], v56 offset:4096
    v_mfma_f32_16x16x32_bf16 v[240:243], a[220:223], a[164:167], v[240:243]
    ds_read_b128 a[132:135], v33 offset:0
    v_mfma_f32_16x16x32_bf16 v[244:247], a[220:223], a[172:175], v[244:247]
    ds_read_b64_tr_b16 a[198:199], v56 offset:6144
    v_mfma_f32_16x16x32_bf16 v[244:247], a[216:219], a[168:171], v[244:247]
    ds_read_b128 a[136:139], v32 offset:2048
    v_mfma_f32_16x16x32_bf16 v[248:251], a[216:219], a[176:179], v[248:251]
    ds_read_b64_tr_b16 a[200:201], v57 offset:0
    v_mfma_f32_16x16x32_bf16 v[248:251], a[220:223], a[180:183], v[248:251]
    ds_read_b128 a[140:143], v33 offset:2048
    v_mfma_f32_16x16x32_bf16 v[252:255], a[220:223], a[188:191], v[252:255]
    ds_read_b64_tr_b16 a[202:203], v57 offset:2048
    v_mfma_f32_16x16x32_bf16 v[252:255], a[216:219], a[184:187], v[252:255]
    s_waitcnt lgkmcnt(10)
    ds_read_b128 a[144:147], v32 offset:4096
    v_mfma_f32_16x16x32_bf16 v[124:127], a[224:227], a[184:187], v[124:127]
    ds_read_b64_tr_b16 a[204:205], v57 offset:4096
    v_mfma_f32_16x16x32_bf16 v[124:127], a[228:231], a[188:191], v[124:127]
    ds_read_b128 a[148:151], v33 offset:4096
    v_mfma_f32_16x16x32_bf16 v[120:123], a[228:231], a[180:183], v[120:123]
    ds_read_b64_tr_b16 a[206:207], v57 offset:6144
    v_mfma_f32_16x16x32_bf16 v[120:123], a[224:227], a[176:179], v[120:123]
    ds_read_b128 a[152:155], v32 offset:6144
    v_mfma_f32_16x16x32_bf16 v[116:119], a[224:227], a[168:171], v[116:119]
    ds_read_b128 a[156:159], v33 offset:6144
    v_mfma_f32_16x16x32_bf16 v[116:119], a[228:231], a[172:175], v[116:119]
    buffer_load_dwordx4 v43, s[28:31], s40 offen offset:1024 lds
    v_mfma_f32_16x16x32_bf16 v[112:115], a[228:231], a[164:167], v[112:115]
    v_mfma_f32_16x16x32_bf16 v[112:115], a[224:227], a[160:163], v[112:115]
    s_waitcnt lgkmcnt(10)
    v_mfma_f32_16x16x32_bf16 v[128:131], a[192:195], a[160:163], v[128:131]
    v_mfma_f32_16x16x32_bf16 v[128:131], a[196:199], a[164:167], v[128:131]
    v_mfma_f32_16x16x32_bf16 v[132:135], a[196:199], a[172:175], v[132:135]
    v_mfma_f32_16x16x32_bf16 v[132:135], a[192:195], a[168:171], v[132:135]
    s_waitcnt vmcnt(14)
    v_mfma_f32_16x16x32_bf16 v[136:139], a[192:195], a[176:179], v[136:139]
    s_waitcnt lgkmcnt(2)
    s_barrier
    v_mfma_f32_16x16x32_bf16 v[136:139], a[196:199], a[180:183], v[136:139]
    ds_read_b64_tr_b16 a[208:209], v6 offset:16384
    v_mfma_f32_16x16x32_bf16 v[140:143], a[196:199], a[188:191], v[140:143]
    ds_read_b64_tr_b16 a[210:211], v6 offset:20480
    v_mfma_f32_16x16x32_bf16 v[140:143], a[192:195], a[184:187], v[140:143]
    ds_read_b64_tr_b16 a[212:213], v6 offset:24576
    v_mfma_f32_16x16x32_bf16 v[156:159], a[200:203], a[184:187], v[156:159]
    ds_read_b64_tr_b16 a[214:215], v6 offset:28672
    v_mfma_f32_16x16x32_bf16 v[156:159], a[204:207], a[188:191], v[156:159]
    ds_read_b64_tr_b16 a[216:217], v58 offset:8192
    v_mfma_f32_16x16x32_bf16 v[152:155], a[204:207], a[180:183], v[152:155]
    v_mfma_f32_16x16x32_bf16 v[152:155], a[200:203], a[176:179], v[152:155]
    ds_read_b64_tr_b16 a[218:219], v58 offset:10240
    v_mfma_f32_16x16x32_bf16 v[148:151], a[200:203], a[168:171], v[148:151]
    v_mfma_f32_16x16x32_bf16 v[148:151], a[204:207], a[172:175], v[148:151]
    ds_read_b64_tr_b16 a[220:221], v58 offset:12288
    v_mfma_f32_16x16x32_bf16 v[144:147], a[204:207], a[164:167], v[144:147]
    ds_read_b64_tr_b16 a[222:223], v58 offset:14336
    s_waitcnt lgkmcnt(8)
    v_mfma_f32_16x16x32_bf16 v[144:147], a[200:203], a[160:163], v[144:147]
    ds_read_b64_tr_b16 a[224:225], v7 offset:16384
    s_waitcnt lgkmcnt(5)
    v_mfma_f32_16x16x32_bf16 v[192:195], a[208:211], a[128:131], v[192:195]
    s_add_u32 m0, s47, 0
    s_xor_b32 s40, s78, 640
    v_mfma_f32_16x16x32_bf16 v[192:195], a[212:215], a[132:135], v[192:195]
    ds_read_b64_tr_b16 a[226:227], v7 offset:20480
    v_mfma_f32_16x16x32_bf16 v[196:199], a[212:215], a[140:143], v[196:199]
    buffer_load_dwordx4 v34, s[20:23], s40 offen offset:0 lds
    v_mfma_f32_16x16x32_bf16 v[196:199], a[208:211], a[136:139], v[196:199]
    ds_read_b64_tr_b16 a[228:229], v7 offset:24576
    v_mfma_f32_16x16x32_bf16 v[200:203], a[208:211], a[144:147], v[200:203]
    v_mfma_f32_16x16x32_bf16 v[200:203], a[212:215], a[148:151], v[200:203]
    ds_read_b64_tr_b16 a[230:231], v7 offset:28672
    v_mfma_f32_16x16x32_bf16 v[204:207], a[212:215], a[156:159], v[204:207]
    ds_read_b64_tr_b16 a[192:193], v8 offset:16384
    v_mfma_f32_16x16x32_bf16 v[204:207], a[208:211], a[152:155], v[204:207]
    s_waitcnt lgkmcnt(5)
    v_smfmac_f32_16x16x64_bf16 a[232:235], v[24:27], a[208:215], v20
    ds_read_b64_tr_b16 a[194:195], v8 offset:20480
    v_mfma_f32_16x16x32_bf16 v[160:163], a[216:219], a[128:131], v[160:163]
    buffer_load_dwordx4 v35, s[20:23], s40 offen offset:1024 lds
    v_mfma_f32_16x16x32_bf16 v[160:163], a[220:223], a[132:135], v[160:163]
    ds_read_b64_tr_b16 a[196:197], v8 offset:24576
    v_mfma_f32_16x16x32_bf16 v[164:167], a[220:223], a[140:143], v[164:167]
    buffer_load_dwordx4 v36, s[20:23], s40 offen offset:2048 lds
    v_mfma_f32_16x16x32_bf16 v[164:167], a[216:219], a[136:139], v[164:167]
    ds_read_b64_tr_b16 a[198:199], v8 offset:28672
    v_mfma_f32_16x16x32_bf16 v[168:171], a[216:219], a[144:147], v[168:171]
    v_mfma_f32_16x16x32_bf16 v[168:171], a[220:223], a[148:151], v[168:171]
    ds_read_b64_tr_b16 a[200:201], v59 offset:8192
    v_mfma_f32_16x16x32_bf16 v[172:175], a[220:223], a[156:159], v[172:175]
    v_mfma_f32_16x16x32_bf16 v[172:175], a[216:219], a[152:155], v[172:175]
    ds_read_b64_tr_b16 a[202:203], v59 offset:10240
    s_waitcnt lgkmcnt(6)
    v_mfma_f32_16x16x32_bf16 v[76:79], a[224:227], a[152:155], v[76:79]
    buffer_load_dwordx4 v37, s[20:23], s40 offen offset:3072 lds
    v_mfma_f32_16x16x32_bf16 v[76:79], a[228:231], a[156:159], v[76:79]
    ds_read_b64_tr_b16 a[204:205], v59 offset:12288
    v_mfma_f32_16x16x32_bf16 v[72:75], a[228:231], a[148:151], v[72:75]
    v_mfma_f32_16x16x32_bf16 v[72:75], a[224:227], a[144:147], v[72:75]
    ds_read_b64_tr_b16 a[206:207], v59 offset:14336
    s_add_u32 m0, s47, 4096
    v_mfma_f32_16x16x32_bf16 v[68:71], a[224:227], a[136:139], v[68:71]
    s_xor_b32 s40, s78, 33408
    v_mfma_f32_16x16x32_bf16 v[68:71], a[228:231], a[140:143], v[68:71]
    ds_read_b64_tr_b16 a[208:209], v9 offset:16384
    v_mfma_f32_16x16x32_bf16 v[64:67], a[228:231], a[132:135], v[64:67]
    buffer_load_dwordx4 v34, s[20:23], s40 offen offset:0 lds
    v_mfma_f32_16x16x32_bf16 v[64:67], a[224:227], a[128:131], v[64:67]
    ds_read_b64_tr_b16 a[210:211], v9 offset:20480
    v_smfmac_f32_16x16x64_bf16 a[236:239], v[24:27], a[224:231], v20
    s_waitcnt lgkmcnt(6)
    v_mfma_f32_16x16x32_bf16 v[208:211], a[192:195], a[128:131], v[208:211]
    ds_read_b64_tr_b16 a[212:213], v9 offset:24576
    v_mfma_f32_16x16x32_bf16 v[208:211], a[196:199], a[132:135], v[208:211]
    buffer_load_dwordx4 v35, s[20:23], s40 offen offset:1024 lds
    v_mfma_f32_16x16x32_bf16 v[212:215], a[196:199], a[140:143], v[212:215]
    ds_read_b64_tr_b16 a[214:215], v9 offset:28672
    v_mfma_f32_16x16x32_bf16 v[212:215], a[192:195], a[136:139], v[212:215]
    v_mfma_f32_16x16x32_bf16 v[216:219], a[192:195], a[144:147], v[216:219]
    ds_read_b64_tr_b16 a[216:217], v10 offset:16384
    v_mfma_f32_16x16x32_bf16 v[216:219], a[196:199], a[148:151], v[216:219]
    buffer_load_dwordx4 v36, s[20:23], s40 offen offset:2048 lds
    v_mfma_f32_16x16x32_bf16 v[220:223], a[196:199], a[156:159], v[220:223]
    ds_read_b64_tr_b16 a[218:219], v10 offset:20480
    v_mfma_f32_16x16x32_bf16 v[220:223], a[192:195], a[152:155], v[220:223]
    s_waitcnt lgkmcnt(6)
    v_mfma_f32_16x16x32_bf16 v[188:191], a[200:203], a[152:155], v[188:191]
    ds_read_b64_tr_b16 a[220:221], v10 offset:24576
    v_mfma_f32_16x16x32_bf16 v[188:191], a[204:207], a[156:159], v[188:191]
    v_mfma_f32_16x16x32_bf16 v[184:187], a[204:207], a[148:151], v[184:187]
    ds_read_b64_tr_b16 a[222:223], v10 offset:28672
    v_mfma_f32_16x16x32_bf16 v[184:187], a[200:203], a[144:147], v[184:187]
    buffer_load_dwordx4 v37, s[20:23], s40 offen offset:3072 lds
    v_mfma_f32_16x16x32_bf16 v[180:183], a[200:203], a[136:139], v[180:183]
    ds_read_b64_tr_b16 a[224:225], v60 offset:8192
L1_pa2:
    s_cbranch_execz L1_pc0
    v_mfma_f32_16x16x32_bf16 v[180:183], a[204:207], a[140:143], v[180:183]
    v_mfma_f32_16x16x32_bf16 v[176:179], a[204:207], a[132:135], v[176:179]
    ds_read_b64_tr_b16 a[226:227], v60 offset:10240
    s_add_u32 m0, s41, 65536
    v_mfma_f32_16x16x32_bf16 v[176:179], a[200:203], a[128:131], v[176:179]
    s_waitcnt lgkmcnt(6)
    s_xor_b32 s40, s79, 2621440
    v_mfma_f32_16x16x32_bf16 v[92:95], a[208:211], a[152:155], v[92:95]
    ds_read_b64_tr_b16 a[228:229], v60 offset:12288
    v_mfma_f32_16x16x32_bf16 v[92:95], a[212:215], a[156:159], v[92:95]
    buffer_load_dwordx4 v38, s[24:27], s40 offen offset:0 lds
    v_mfma_f32_16x16x32_bf16 v[88:91], a[212:215], a[148:151], v[88:91]
    ds_read_b64_tr_b16 a[230:231], v60 offset:14336
    v_mfma_f32_16x16x32_bf16 v[88:91], a[208:211], a[144:147], v[88:91]
    v_mfma_f32_16x16x32_bf16 v[84:87], a[208:211], a[136:139], v[84:87]
    ds_read_b64_tr_b16 a[192:193], v11 offset:16384
    v_mfma_f32_16x16x32_bf16 v[84:87], a[212:215], a[140:143], v[84:87]
    ds_read_b64_tr_b16 a[194:195], v11 offset:20480
    v_mfma_f32_16x16x32_bf16 v[80:83], a[212:215], a[132:135], v[80:83]
    ds_read_b64_tr_b16 a[196:197], v11 offset:24576
    v_mfma_f32_16x16x32_bf16 v[80:83], a[208:211], a[128:131], v[80:83]
    ds_read_b64_tr_b16 a[198:199], v11 offset:28672
    s_waitcnt lgkmcnt(8)
    v_mfma_f32_16x16x32_bf16 v[224:227], a[216:219], a[128:131], v[224:227]
    ds_read_b64_tr_b16 a[200:201], v12 offset:16384
    v_mfma_f32_16x16x32_bf16 v[224:227], a[220:223], a[132:135], v[224:227]
    buffer_load_dwordx4 v39, s[24:27], s40 offen offset:1024 lds
    v_mfma_f32_16x16x32_bf16 v[228:231], a[220:223], a[140:143], v[228:231]
    ds_read_b64_tr_b16 a[202:203], v12 offset:20480
    v_mfma_f32_16x16x32_bf16 v[228:231], a[216:219], a[136:139], v[228:231]
    buffer_load_dwordx4 v40, s[24:27], s40 offen offset:2048 lds
    v_mfma_f32_16x16x32_bf16 v[232:235], a[216:219], a[144:147], v[232:235]
    ds_read_b64_tr_b16 a[204:205], v12 offset:24576
    v_mfma_f32_16x16x32_bf16 v[232:235], a[220:223], a[148:151], v[232:235]
    ds_read_b64_tr_b16 a[206:207], v12 offset:28672
    v_mfma_f32_16x16x32_bf16 v[236:239], a[220:223], a[156:159], v[236:239]
    ds_read_b64_tr_b16 a[208:209], v13 offset:16384
    v_mfma_f32_16x16x32_bf16 v[236:239], a[216:219], a[152:155], v[236:239]
    s_waitcnt lgkmcnt(9)
    s_waitcnt lgkmcnt(5)
    v_smfmac_f32_16x16x64_bf16 a[240:243], v[24:27], a[224:231], v20
    ds_read_b64_tr_b16 a[210:211], v13 offset:20480
    v_mfma_f32_16x16x32_bf16 v[108:111], a[192:195], a[152:155], v[108:111]
    buffer_load_dwordx4 v41, s[24:27], s40 offen offset:3072 lds
    v_mfma_f32_16x16x32_bf16 v[108:111], a[196:199], a[156:159], v[108:111]
    ds_read_b64_tr_b16 a[212:213], v13 offset:24576
    s_add_u32 m0, s68, 131072
    v_mfma_f32_16x16x32_bf16 v[104:107], a[196:199], a[148:151], v[104:107]
    s_xor_b32 s40, s42, 5
    s_mul_i32 s40, s40, 176128
    v_mfma_f32_16x16x32_bf16 v[104:107], a[192:195], a[144:147], v[104:107]
    ds_read_b64_tr_b16 a[214:215], v13 offset:28672
    v_mfma_f32_16x16x32_bf16 v[100:103], a[192:195], a[136:139], v[100:103]
    ds_read_b64_tr_b16 a[216:217], v56 offset:8192
    v_mfma_f32_16x16x32_bf16 v[100:103], a[196:199], a[140:143], v[100:103]
    buffer_load_dwordx4 v42, s[28:31], s40 offen offset:0 lds
    v_mfma_f32_16x16x32_bf16 v[96:99], a[196:199], a[132:135], v[96:99]
    ds_read_b64_tr_b16 a[218:219], v56 offset:10240
    s_waitcnt vmcnt(19)
    v_mfma_f32_16x16x32_bf16 v[96:99], a[192:195], a[128:131], v[96:99]
    s_waitcnt lgkmcnt(6)
    ds_read_b128 a[160:163], v32 offset:8192
    v_mfma_f32_16x16x32_bf16 v[240:243], a[200:203], a[128:131], v[240:243]
    ds_read_b64_tr_b16 a[220:221], v56 offset:12288
    v_mfma_f32_16x16x32_bf16 v[240:243], a[204:207], a[132:135], v[240:243]
    ds_read_b128 a[164:167], v33 offset:8192
    v_mfma_f32_16x16x32_bf16 v[244:247], a[204:207], a[140:143], v[244:247]
    ds_read_b64_tr_b16 a[222:223], v56 offset:14336
    v_mfma_f32_16x16x32_bf16 v[244:247], a[200:203], a[136:139], v[244:247]
    ds_read_b128 a[168:171], v32 offset:10240
    v_mfma_f32_16x16x32_bf16 v[248:251], a[200:203], a[144:147], v[248:251]
    ds_read_b64_tr_b16 a[224:225], v57 offset:8192
    v_mfma_f32_16x16x32_bf16 v[248:251], a[204:207], a[148:151], v[248:251]
    ds_read_b128 a[172:175], v33 offset:10240
    v_mfma_f32_16x16x32_bf16 v[252:255], a[204:207], a[156:159], v[252:255]
    ds_read_b64_tr_b16 a[226:227], v57 offset:10240
    v_mfma_f32_16x16x32_bf16 v[252:255], a[200:203], a[152:155], v[252:255]
    s_waitcnt lgkmcnt(10)
    ds_read_b128 a[176:179], v32 offset:12288
    v_mfma_f32_16x16x32_bf16 v[124:127], a[208:211], a[152:155], v[124:127]
    ds_read_b64_tr_b16 a[228:229], v57 offset:12288
    v_mfma_f32_16x16x32_bf16 v[124:127], a[212:215], a[156:159], v[124:127]
    ds_read_b128 a[180:183], v33 offset:12288
    v_mfma_f32_16x16x32_bf16 v[120:123], a[212:215], a[148:151], v[120:123]
    ds_read_b64_tr_b16 a[230:231], v57 offset:14336
    v_mfma_f32_16x16x32_bf16 v[120:123], a[208:211], a[144:147], v[120:123]
    ds_read_b128 a[184:187], v32 offset:14336
    v_mfma_f32_16x16x32_bf16 v[116:119], a[208:211], a[136:139], v[116:119]
    ds_read_b128 a[188:191], v33 offset:14336
    v_mfma_f32_16x16x32_bf16 v[116:119], a[212:215], a[140:143], v[116:119]
    buffer_load_dwordx4 v43, s[28:31], s40 offen offset:1024 lds
    v_mfma_f32_16x16x32_bf16 v[112:115], a[212:215], a[132:135], v[112:115]
    v_mfma_f32_16x16x32_bf16 v[112:115], a[208:211], a[128:131], v[112:115]
    s_waitcnt lgkmcnt(10)
    v_mfma_f32_16x16x32_bf16 v[128:131], a[216:219], a[128:131], v[128:131]
    v_mfma_f32_16x16x32_bf16 v[128:131], a[220:223], a[132:135], v[128:131]
    v_mfma_f32_16x16x32_bf16 v[132:135], a[220:223], a[140:143], v[132:135]
    v_mfma_f32_16x16x32_bf16 v[132:135], a[216:219], a[136:139], v[132:135]
    s_waitcnt vmcnt(14)
    v_mfma_f32_16x16x32_bf16 v[136:139], a[216:219], a[144:147], v[136:139]
    s_waitcnt lgkmcnt(2)
    s_barrier
    v_mfma_f32_16x16x32_bf16 v[136:139], a[220:223], a[148:151], v[136:139]
    ds_read_b64_tr_b16 a[192:193], v6 offset:32768
    v_mfma_f32_16x16x32_bf16 v[140:143], a[220:223], a[156:159], v[140:143]
    ds_read_b64_tr_b16 a[194:195], v6 offset:36864
    v_mfma_f32_16x16x32_bf16 v[140:143], a[216:219], a[152:155], v[140:143]
    ds_read_b64_tr_b16 a[196:197], v6 offset:40960
    v_mfma_f32_16x16x32_bf16 v[156:159], a[224:227], a[152:155], v[156:159]
    ds_read_b64_tr_b16 a[198:199], v6 offset:45056
    v_mfma_f32_16x16x32_bf16 v[156:159], a[228:231], a[156:159], v[156:159]
    ds_read_b64_tr_b16 a[200:201], v58 offset:16384
    v_mfma_f32_16x16x32_bf16 v[152:155], a[228:231], a[148:151], v[152:155]
    v_mfma_f32_16x16x32_bf16 v[152:155], a[224:227], a[144:147], v[152:155]
    ds_read_b64_tr_b16 a[202:203], v58 offset:18432
    v_mfma_f32_16x16x32_bf16 v[148:151], a[224:227], a[136:139], v[148:151]
    v_mfma_f32_16x16x32_bf16 v[148:151], a[228:231], a[140:143], v[148:151]
    ds_read_b64_tr_b16 a[204:205], v58 offset:20480
    v_mfma_f32_16x16x32_bf16 v[144:147], a[228:231], a[132:135], v[144:147]
    ds_read_b64_tr_b16 a[206:207], v58 offset:22528
    s_waitcnt lgkmcnt(8)
    v_mfma_f32_16x16x32_bf16 v[144:147], a[224:227], a[128:131], v[144:147]
    ds_read_b64_tr_b16 a[208:209], v7 offset:32768
    s_waitcnt lgkmcnt(5)
    v_mfma_f32_16x16x32_bf16 v[192:195], a[192:195], a[160:163], v[192:195]
    s_add_u32 m0, s47, 8192
    s_xor_b32 s40, s78, 896
    v_mfma_f32_16x16x32_bf16 v[192:195], a[196:199], a[164:167], v[192:195]
    ds_read_b64_tr_b16 a[210:211], v7 offset:36864
    v_mfma_f32_16x16x32_bf16 v[196:199], a[196:199], a[172:175], v[196:199]
    buffer_load_dwordx4 v34, s[20:23], s40 offen offset:0 lds
    v_mfma_f32_16x16x32_bf16 v[196:199], a[192:195], a[168:171], v[196:199]
    ds_read_b64_tr_b16 a[212:213], v7 offset:40960
    v_mfma_f32_16x16x32_bf16 v[200:203], a[192:195], a[176:179], v[200:203]
    v_mfma_f32_16x16x32_bf16 v[200:203], a[196:199], a[180:183], v[200:203]
    ds_read_b64_tr_b16 a[214:215], v7 offset:45056
    v_mfma_f32_16x16x32_bf16 v[204:207], a[196:199], a[188:191], v[204:207]
    ds_read_b64_tr_b16 a[216:217], v8 offset:32768
    v_mfma_f32_16x16x32_bf16 v[204:207], a[192:195], a[184:187], v[204:207]
    s_waitcnt lgkmcnt(5)
    v_smfmac_f32_16x16x64_bf16 a[232:235], v[24:27], a[192:199], v20
    ds_read_b64_tr_b16 a[218:219], v8 offset:36864
    v_mfma_f32_16x16x32_bf16 v[160:163], a[200:203], a[160:163], v[160:163]
    buffer_load_dwordx4 v35, s[20:23], s40 offen offset:1024 lds
    v_mfma_f32_16x16x32_bf16 v[160:163], a[204:207], a[164:167], v[160:163]
    ds_read_b64_tr_b16 a[220:221], v8 offset:40960
    v_mfma_f32_16x16x32_bf16 v[164:167], a[204:207], a[172:175], v[164:167]
    buffer_load_dwordx4 v36, s[20:23], s40 offen offset:2048 lds
    v_mfma_f32_16x16x32_bf16 v[164:167], a[200:203], a[168:171], v[164:167]
    ds_read_b64_tr_b16 a[222:223], v8 offset:45056
    v_mfma_f32_16x16x32_bf16 v[168:171], a[200:203], a[176:179], v[168:171]
    v_mfma_f32_16x16x32_bf16 v[168:171], a[204:207], a[180:183], v[168:171]
    ds_read_b64_tr_b16 a[224:225], v59 offset:16384
    v_mfma_f32_16x16x32_bf16 v[172:175], a[204:207], a[188:191], v[172:175]
    v_mfma_f32_16x16x32_bf16 v[172:175], a[200:203], a[184:187], v[172:175]
    ds_read_b64_tr_b16 a[226:227], v59 offset:18432
    s_waitcnt lgkmcnt(6)
    v_mfma_f32_16x16x32_bf16 v[76:79], a[208:211], a[184:187], v[76:79]
    buffer_load_dwordx4 v37, s[20:23], s40 offen offset:3072 lds
    v_mfma_f32_16x16x32_bf16 v[76:79], a[212:215], a[188:191], v[76:79]
    ds_read_b64_tr_b16 a[228:229], v59 offset:20480
    v_mfma_f32_16x16x32_bf16 v[72:75], a[212:215], a[180:183], v[72:75]
    v_mfma_f32_16x16x32_bf16 v[72:75], a[208:211], a[176:179], v[72:75]
    ds_read_b64_tr_b16 a[230:231], v59 offset:22528
    s_add_u32 m0, s47, 12288
    v_mfma_f32_16x16x32_bf16 v[68:71], a[208:211], a[168:171], v[68:71]
    s_xor_b32 s40, s78, 33664
    v_mfma_f32_16x16x32_bf16 v[68:71], a[212:215], a[172:175], v[68:71]
    ds_read_b64_tr_b16 a[192:193], v9 offset:32768
    v_mfma_f32_16x16x32_bf16 v[64:67], a[212:215], a[164:167], v[64:67]
    buffer_load_dwordx4 v34, s[20:23], s40 offen offset:0 lds
    v_mfma_f32_16x16x32_bf16 v[64:67], a[208:211], a[160:163], v[64:67]
    ds_read_b64_tr_b16 a[194:195], v9 offset:36864
    v_smfmac_f32_16x16x64_bf16 a[236:239], v[24:27], a[208:215], v20
    s_waitcnt lgkmcnt(6)
    v_mfma_f32_16x16x32_bf16 v[208:211], a[216:219], a[160:163], v[208:211]
    ds_read_b64_tr_b16 a[196:197], v9 offset:40960
    v_mfma_f32_16x16x32_bf16 v[208:211], a[220:223], a[164:167], v[208:211]
    buffer_load_dwordx4 v35, s[20:23], s40 offen offset:1024 lds
    v_mfma_f32_16x16x32_bf16 v[212:215], a[220:223], a[172:175], v[212:215]
    ds_read_b64_tr_b16 a[198:199], v9 offset:45056
    v_mfma_f32_16x16x32_bf16 v[212:215], a[216:219], a[168:171], v[212:215]
    v_mfma_f32_16x16x32_bf16 v[216:219], a[216:219], a[176:179], v[216:219]
    ds_read_b64_tr_b16 a[200:201], v10 offset:32768
    v_mfma_f32_16x16x32_bf16 v[216:219], a[220:223], a[180:183], v[216:219]
    buffer_load_dwordx4 v36, s[20:23], s40 offen offset:2048 lds
    v_mfma_f32_16x16x32_bf16 v[220:223], a[220:223], a[188:191], v[220:223]
    ds_read_b64_tr_b16 a[202:203], v10 offset:36864
    v_mfma_f32_16x16x32_bf16 v[220:223], a[216:219], a[184:187], v[220:223]
    s_waitcnt lgkmcnt(6)
    v_mfma_f32_16x16x32_bf16 v[188:191], a[224:227], a[184:187], v[188:191]
    ds_read_b64_tr_b16 a[204:205], v10 offset:40960
    v_mfma_f32_16x16x32_bf16 v[188:191], a[228:231], a[188:191], v[188:191]
    v_mfma_f32_16x16x32_bf16 v[184:187], a[228:231], a[180:183], v[184:187]
    ds_read_b64_tr_b16 a[206:207], v10 offset:45056
    v_mfma_f32_16x16x32_bf16 v[184:187], a[224:227], a[176:179], v[184:187]
    buffer_load_dwordx4 v37, s[20:23], s40 offen offset:3072 lds
    v_mfma_f32_16x16x32_bf16 v[180:183], a[224:227], a[168:171], v[180:183]
    ds_read_b64_tr_b16 a[208:209], v60 offset:16384
    v_mfma_f32_16x16x32_bf16 v[180:183], a[228:231], a[172:175], v[180:183]
    v_mfma_f32_16x16x32_bf16 v[176:179], a[228:231], a[164:167], v[176:179]
    ds_read_b64_tr_b16 a[210:211], v60 offset:18432
    s_add_u32 m0, s41, 81920
    v_mfma_f32_16x16x32_bf16 v[176:179], a[224:227], a[160:163], v[176:179]
    s_waitcnt lgkmcnt(6)
    s_xor_b32 s40, s79, 3670016
    v_mfma_f32_16x16x32_bf16 v[92:95], a[192:195], a[184:187], v[92:95]
    ds_read_b64_tr_b16 a[212:213], v60 offset:20480
    v_mfma_f32_16x16x32_bf16 v[92:95], a[196:199], a[188:191], v[92:95]
    buffer_load_dwordx4 v38, s[24:27], s40 offen offset:0 lds
    v_mfma_f32_16x16x32_bf16 v[88:91], a[196:199], a[180:183], v[88:91]
    ds_read_b64_tr_b16 a[214:215], v60 offset:22528
    v_mfma_f32_16x16x32_bf16 v[88:91], a[192:195], a[176:179], v[88:91]
    v_mfma_f32_16x16x32_bf16 v[84:87], a[192:195], a[168:171], v[84:87]
    ds_read_b64_tr_b16 a[216:217], v11 offset:32768
    v_mfma_f32_16x16x32_bf16 v[84:87], a[196:199], a[172:175], v[84:87]
    ds_read_b64_tr_b16 a[218:219], v11 offset:36864
    v_mfma_f32_16x16x32_bf16 v[80:83], a[196:199], a[164:167], v[80:83]
    ds_read_b64_tr_b16 a[220:221], v11 offset:40960
    v_mfma_f32_16x16x32_bf16 v[80:83], a[192:195], a[160:163], v[80:83]
    ds_read_b64_tr_b16 a[222:223], v11 offset:45056
    s_waitcnt lgkmcnt(8)
    v_mfma_f32_16x16x32_bf16 v[224:227], a[200:203], a[160:163], v[224:227]
    ds_read_b64_tr_b16 a[224:225], v12 offset:32768
    v_mfma_f32_16x16x32_bf16 v[224:227], a[204:207], a[164:167], v[224:227]
    buffer_load_dwordx4 v39, s[24:27], s40 offen offset:1024 lds
    v_mfma_f32_16x16x32_bf16 v[228:231], a[204:207], a[172:175], v[228:231]
    ds_read_b64_tr_b16 a[226:227], v12 offset:36864
    v_mfma_f32_16x16x32_bf16 v[228:231], a[200:203], a[168:171], v[228:231]
    buffer_load_dwordx4 v40, s[24:27], s40 offen offset:2048 lds
    v_mfma_f32_16x16x32_bf16 v[232:235], a[200:203], a[176:179], v[232:235]
    ds_read_b64_tr_b16 a[228:229], v12 offset:40960
    v_mfma_f32_16x16x32_bf16 v[232:235], a[204:207], a[180:183], v[232:235]
    ds_read_b64_tr_b16 a[230:231], v12 offset:45056
    v_mfma_f32_16x16x32_bf16 v[236:239], a[204:207], a[188:191], v[236:239]
    ds_read_b64_tr_b16 a[192:193], v13 offset:32768
    v_mfma_f32_16x16x32_bf16 v[236:239], a[200:203], a[184:187], v[236:239]
    s_waitcnt lgkmcnt(9)
    s_waitcnt lgkmcnt(5)
    v_smfmac_f32_16x16x64_bf16 a[240:243], v[24:27], a[208:215], v20
    ds_read_b64_tr_b16 a[194:195], v13 offset:36864
    v_mfma_f32_16x16x32_bf16 v[108:111], a[216:219], a[184:187], v[108:111]
    buffer_load_dwordx4 v41, s[24:27], s40 offen offset:3072 lds
    v_mfma_f32_16x16x32_bf16 v[108:111], a[220:223], a[188:191], v[108:111]
    ds_read_b64_tr_b16 a[196:197], v13 offset:40960
    s_add_u32 m0, s68, 139264
    v_mfma_f32_16x16x32_bf16 v[104:107], a[220:223], a[180:183], v[104:107]
    s_xor_b32 s40, s42, 7
    s_mul_i32 s40, s40, 176128
    v_mfma_f32_16x16x32_bf16 v[104:107], a[216:219], a[176:179], v[104:107]
    ds_read_b64_tr_b16 a[198:199], v13 offset:45056
    v_mfma_f32_16x16x32_bf16 v[100:103], a[216:219], a[168:171], v[100:103]
    ds_read_b64_tr_b16 a[200:201], v56 offset:16384
    v_mfma_f32_16x16x32_bf16 v[100:103], a[220:223], a[172:175], v[100:103]
    buffer_load_dwordx4 v42, s[28:31], s40 offen offset:0 lds
    v_mfma_f32_16x16x32_bf16 v[96:99], a[220:223], a[164:167], v[96:99]
    ds_read_b64_tr_b16 a[202:203], v56 offset:18432
    s_waitcnt vmcnt(19)
    v_mfma_f32_16x16x32_bf16 v[96:99], a[216:219], a[160:163], v[96:99]
    s_waitcnt lgkmcnt(6)
    ds_read_b128 a[128:131], v32 offset:0
    v_mfma_f32_16x16x32_bf16 v[240:243], a[224:227], a[160:163], v[240:243]
    ds_read_b64_tr_b16 a[204:205], v56 offset:20480
    v_mfma_f32_16x16x32_bf16 v[240:243], a[228:231], a[164:167], v[240:243]
    ds_read_b128 a[132:135], v33 offset:0
    v_mfma_f32_16x16x32_bf16 v[244:247], a[228:231], a[172:175], v[244:247]
    ds_read_b64_tr_b16 a[206:207], v56 offset:22528
    v_mfma_f32_16x16x32_bf16 v[244:247], a[224:227], a[168:171], v[244:247]
    ds_read_b128 a[136:139], v32 offset:2048
    v_mfma_f32_16x16x32_bf16 v[248:251], a[224:227], a[176:179], v[248:251]
    ds_read_b64_tr_b16 a[208:209], v57 offset:16384
    v_mfma_f32_16x16x32_bf16 v[248:251], a[228:231], a[180:183], v[248:251]
    ds_read_b128 a[140:143], v33 offset:2048
    v_mfma_f32_16x16x32_bf16 v[252:255], a[228:231], a[188:191], v[252:255]
    ds_read_b64_tr_b16 a[210:211], v57 offset:18432
    v_mfma_f32_16x16x32_bf16 v[252:255], a[224:227], a[184:187], v[252:255]
    s_waitcnt lgkmcnt(10)
    ds_read_b128 a[144:147], v32 offset:4096
    v_mfma_f32_16x16x32_bf16 v[124:127], a[192:195], a[184:187], v[124:127]
    ds_read_b64_tr_b16 a[212:213], v57 offset:20480
    v_mfma_f32_16x16x32_bf16 v[124:127], a[196:199], a[188:191], v[124:127]
    ds_read_b128 a[148:151], v33 offset:4096
    v_mfma_f32_16x16x32_bf16 v[120:123], a[196:199], a[180:183], v[120:123]
    ds_read_b64_tr_b16 a[214:215], v57 offset:22528
    v_mfma_f32_16x16x32_bf16 v[120:123], a[192:195], a[176:179], v[120:123]
    ds_read_b128 a[152:155], v32 offset:6144
    v_mfma_f32_16x16x32_bf16 v[116:119], a[192:195], a[168:171], v[116:119]
    ds_read_b128 a[156:159], v33 offset:6144
    v_mfma_f32_16x16x32_bf16 v[116:119], a[196:199], a[172:175], v[116:119]
    buffer_load_dwordx4 v43, s[28:31], s40 offen offset:1024 lds
    v_mfma_f32_16x16x32_bf16 v[112:115], a[196:199], a[164:167], v[112:115]
    v_mfma_f32_16x16x32_bf16 v[112:115], a[192:195], a[160:163], v[112:115]
    s_waitcnt lgkmcnt(10)
    v_mfma_f32_16x16x32_bf16 v[128:131], a[200:203], a[160:163], v[128:131]
    v_mfma_f32_16x16x32_bf16 v[128:131], a[204:207], a[164:167], v[128:131]
    v_mfma_f32_16x16x32_bf16 v[132:135], a[204:207], a[172:175], v[132:135]
    v_mfma_f32_16x16x32_bf16 v[132:135], a[200:203], a[168:171], v[132:135]
    s_waitcnt vmcnt(14)
    v_mfma_f32_16x16x32_bf16 v[136:139], a[200:203], a[176:179], v[136:139]
    s_waitcnt lgkmcnt(2)
    s_barrier
    v_mfma_f32_16x16x32_bf16 v[136:139], a[204:207], a[180:183], v[136:139]
    ds_read_b64_tr_b16 a[216:217], v6 offset:0
    v_mfma_f32_16x16x32_bf16 v[140:143], a[204:207], a[188:191], v[140:143]
    ds_read_b64_tr_b16 a[218:219], v6 offset:4096
    v_mfma_f32_16x16x32_bf16 v[140:143], a[200:203], a[184:187], v[140:143]
    ds_read_b64_tr_b16 a[220:221], v6 offset:8192
    v_mfma_f32_16x16x32_bf16 v[156:159], a[208:211], a[184:187], v[156:159]
    ds_read_b64_tr_b16 a[222:223], v6 offset:12288
    v_mfma_f32_16x16x32_bf16 v[156:159], a[212:215], a[188:191], v[156:159]
    ds_read_b64_tr_b16 a[224:225], v58 offset:0
    v_mfma_f32_16x16x32_bf16 v[152:155], a[212:215], a[180:183], v[152:155]
    s_mov_b64 exec, 1
    buffer_load_dword v22, off, s[52:55], s65 sc1
    s_mov_b64 exec, -1
    v_mfma_f32_16x16x32_bf16 v[152:155], a[208:211], a[176:179], v[152:155]
    ds_read_b64_tr_b16 a[226:227], v58 offset:2048
    v_mfma_f32_16x16x32_bf16 v[148:151], a[208:211], a[168:171], v[148:151]
    buffer_load_dwordx2 v[48:49], v61, s[32:35], s80 offen offset:0
    v_mfma_f32_16x16x32_bf16 v[148:151], a[212:215], a[172:175], v[148:151]
    ds_read_b64_tr_b16 a[228:229], v58 offset:4096
    v_mfma_f32_16x16x32_bf16 v[144:147], a[212:215], a[164:167], v[144:147]
    ds_read_b64_tr_b16 a[230:231], v58 offset:6144
    s_waitcnt lgkmcnt(8)
    v_mfma_f32_16x16x32_bf16 v[144:147], a[208:211], a[160:163], v[144:147]
    ds_read_b64_tr_b16 a[192:193], v7 offset:0
    s_waitcnt lgkmcnt(5)
    v_mfma_f32_16x16x32_bf16 v[192:195], a[216:219], a[128:131], v[192:195]
    buffer_load_dwordx2 v[50:51], v61, s[32:35], s80 offen offset:32
    v_mfma_f32_16x16x32_bf16 v[192:195], a[220:223], a[132:135], v[192:195]
    ds_read_b64_tr_b16 a[194:195], v7 offset:4096
    v_mfma_f32_16x16x32_bf16 v[196:199], a[220:223], a[140:143], v[196:199]
    buffer_load_dwordx2 v[52:53], v61, s[32:35], s81 offen offset:0
    v_mfma_f32_16x16x32_bf16 v[196:199], a[216:219], a[136:139], v[196:199]
    ds_read_b64_tr_b16 a[196:197], v7 offset:8192
    v_mfma_f32_16x16x32_bf16 v[200:203], a[216:219], a[144:147], v[200:203]
    buffer_load_dwordx2 v[54:55], v61, s[32:35], s81 offen offset:32
    v_mfma_f32_16x16x32_bf16 v[200:203], a[220:223], a[148:151], v[200:203]
    ds_read_b64_tr_b16 a[198:199], v7 offset:12288
    v_mfma_f32_16x16x32_bf16 v[204:207], a[220:223], a[156:159], v[204:207]
    ds_read_b64_tr_b16 a[200:201], v8 offset:0
    v_mfma_f32_16x16x32_bf16 v[204:207], a[216:219], a[152:155], v[204:207]
    s_waitcnt lgkmcnt(5)
    v_smfmac_f32_16x16x64_bf16 a[232:235], v[24:27], a[216:223], v20
    ds_read_b64_tr_b16 a[202:203], v8 offset:4096
    v_mfma_f32_16x16x32_bf16 v[160:163], a[224:227], a[128:131], v[160:163]
    s_mov_b32 exec_hi, 0
    buffer_store_dwordx4 v[44:47], v1, s[84:87], s70 offen sc1
    s_mov_b64 exec, -1
    v_mfma_f32_16x16x32_bf16 v[160:163], a[228:231], a[132:135], v[160:163]
    ds_read_b64_tr_b16 a[204:205], v8 offset:8192
    s_mov_b32 s24, s82
    v_mfma_f32_16x16x32_bf16 v[164:167], a[228:231], a[140:143], v[164:167]
    s_mov_b32 s25, s83
    s_mov_b32 s26, 4194304
    v_mfma_f32_16x16x32_bf16 v[164:167], a[224:227], a[136:139], v[164:167]
    ds_read_b64_tr_b16 a[206:207], v8 offset:12288
    s_mov_b32 s27, 0x20000
    v_mfma_f32_16x16x32_bf16 v[168:171], a[224:227], a[144:147], v[168:171]
    s_mov_b32 s28, s88
    s_mov_b32 s29, s89
    v_mfma_f32_16x16x32_bf16 v[168:171], a[228:231], a[148:151], v[168:171]
    ds_read_b64_tr_b16 a[208:209], v59 offset:0
    s_mov_b32 s30, 1409024
    v_mfma_f32_16x16x32_bf16 v[172:175], a[228:231], a[156:159], v[172:175]
    s_mov_b32 s31, 0x20000
    s_mov_b32 s32, s90
    v_mfma_f32_16x16x32_bf16 v[172:175], a[224:227], a[152:155], v[172:175]
    ds_read_b64_tr_b16 a[210:211], v59 offset:2048
    s_waitcnt lgkmcnt(6)
    v_mfma_f32_16x16x32_bf16 v[76:79], a[192:195], a[152:155], v[76:79]
    s_mov_b32 s33, s91
    s_mov_b32 s34, 1024
    v_mfma_f32_16x16x32_bf16 v[76:79], a[196:199], a[156:159], v[76:79]
    ds_read_b64_tr_b16 a[212:213], v59 offset:4096
    s_mov_b32 s35, 0x20000
    v_mfma_f32_16x16x32_bf16 v[72:75], a[196:199], a[148:151], v[72:75]
    s_mov_b32 s48, s92
    s_mov_b32 s49, s93
    v_mfma_f32_16x16x32_bf16 v[72:75], a[192:195], a[144:147], v[72:75]
    ds_read_b64_tr_b16 a[214:215], v59 offset:6144
    s_mov_b32 s50, 2097152
    v_mfma_f32_16x16x32_bf16 v[68:71], a[192:195], a[136:139], v[68:71]
    s_mov_b32 s51, 0x20000
    s_bfe_u32 s82, s2, 0x20001
    v_mfma_f32_16x16x32_bf16 v[68:71], a[196:199], a[140:143], v[68:71]
    ds_read_b64_tr_b16 a[216:217], v9 offset:0
    s_and_b32 s3, s2, 1
    v_mfma_f32_16x16x32_bf16 v[64:67], a[196:199], a[132:135], v[64:67]
    s_lshl_b32 s3, s3, 3
    s_bfe_u32 s4, s2, 196611
    v_mfma_f32_16x16x32_bf16 v[64:67], a[192:195], a[128:131], v[64:67]
    ds_read_b64_tr_b16 a[218:219], v9 offset:4096
    s_add_u32 s56, s3, s4
    v_smfmac_f32_16x16x64_bf16 a[236:239], v[24:27], a[192:199], v20
    s_waitcnt lgkmcnt(6)
    v_mfma_f32_16x16x32_bf16 v[208:211], a[200:203], a[128:131], v[208:211]
    ds_read_b64_tr_b16 a[220:221], v9 offset:8192
    s_bfe_u32 s57, s2, 131078
    v_mfma_f32_16x16x32_bf16 v[208:211], a[204:207], a[132:135], v[208:211]
    s_lshl_b32 s3, s56, 3
    s_lshl_b32 s4, s45, 1
    v_mfma_f32_16x16x32_bf16 v[212:215], a[204:207], a[140:143], v[212:215]
    ds_read_b64_tr_b16 a[222:223], v9 offset:12288
    s_add_u32 s3, s3, s4
    v_mfma_f32_16x16x32_bf16 v[212:215], a[200:203], a[136:139], v[212:215]
    s_lshl_b32 s58, s3, 17
    s_lshl_b32 s4, s82, 15
    v_mfma_f32_16x16x32_bf16 v[216:219], a[200:203], a[144:147], v[216:219]
    ds_read_b64_tr_b16 a[224:225], v10 offset:0
    s_add_u32 s58, s58, s4
    v_mfma_f32_16x16x32_bf16 v[216:219], a[204:207], a[148:151], v[216:219]
    s_lshl_b32 s59, s3, 10
    s_mul_i32 s4, s82, 1441792
    v_mfma_f32_16x16x32_bf16 v[220:223], a[204:207], a[156:159], v[220:223]
    ds_read_b64_tr_b16 a[226:227], v10 offset:4096
    s_add_u32 s59, s59, s4
    v_mfma_f32_16x16x32_bf16 v[220:223], a[200:203], a[152:155], v[220:223]
    s_waitcnt lgkmcnt(6)
    s_lshl_b32 s71, s82, 20
    v_mfma_f32_16x16x32_bf16 v[188:191], a[208:211], a[152:155], v[188:191]
    ds_read_b64_tr_b16 a[228:229], v10 offset:8192
    s_mul_i32 s75, s82, 360448
    v_mfma_f32_16x16x32_bf16 v[188:191], a[212:215], a[156:159], v[188:191]
    s_mul_i32 s4, s57, 0
    s_add_u32 s71, s71, s4
    v_mfma_f32_16x16x32_bf16 v[184:187], a[212:215], a[148:151], v[184:187]
    ds_read_b64_tr_b16 a[230:231], v10 offset:12288
    s_mul_i32 s4, s57, 0
    v_mfma_f32_16x16x32_bf16 v[184:187], a[208:211], a[144:147], v[184:187]
    s_add_u32 s58, s58, s4
    s_mul_i32 s83, s2, 49152
    v_mfma_f32_16x16x32_bf16 v[180:183], a[208:211], a[136:139], v[180:183]
    ds_read_b64_tr_b16 a[192:193], v60 offset:0
    s_add_u32 s83, s83, s68
    v_mfma_f32_16x16x32_bf16 v[180:183], a[212:215], a[140:143], v[180:183]
    s_bfe_u32 s4, s58, 0x40014
    s_lshl_b32 s4, s4, 11
    v_mfma_f32_16x16x32_bf16 v[176:179], a[212:215], a[132:135], v[176:179]
    ds_read_b64_tr_b16 a[194:195], v60 offset:2048
    s_xor_b32 s58, s58, s4
    v_mfma_f32_16x16x32_bf16 v[176:179], a[208:211], a[128:131], v[176:179]
    s_waitcnt lgkmcnt(6)
    s_xor_b32 s4, s2, 6
    v_mfma_f32_16x16x32_bf16 v[92:95], a[216:219], a[152:155], v[92:95]
    ds_read_b64_tr_b16 a[196:197], v60 offset:4096
    s_mul_i32 s4, s4, 49152
    v_mfma_f32_16x16x32_bf16 v[92:95], a[220:223], a[156:159], v[92:95]
    s_add_u32 s4, s4, 0
    s_add_u32 s88, s4, s68
    v_mfma_f32_16x16x32_bf16 v[88:91], a[220:223], a[148:151], v[88:91]
    ds_read_b64_tr_b16 a[198:199], v60 offset:6144
    s_xor_b32 s4, s2, 4
    v_mfma_f32_16x16x32_bf16 v[88:91], a[216:219], a[144:147], v[88:91]
    s_mul_i32 s4, s4, 49152
    s_add_u32 s4, s4, 8192
    v_mfma_f32_16x16x32_bf16 v[84:87], a[216:219], a[136:139], v[84:87]
    ds_read_b64_tr_b16 a[200:201], v11 offset:0
    s_add_u32 s89, s4, s68
    v_mfma_f32_16x16x32_bf16 v[84:87], a[220:223], a[140:143], v[84:87]
    ds_read_b64_tr_b16 a[202:203], v11 offset:4096
    s_xor_b32 s4, s2, 2
    v_mfma_f32_16x16x32_bf16 v[80:83], a[220:223], a[132:135], v[80:83]
    ds_read_b64_tr_b16 a[204:205], v11 offset:8192
    s_mul_i32 s4, s4, 49152
    v_mfma_f32_16x16x32_bf16 v[80:83], a[216:219], a[128:131], v[80:83]
    ds_read_b64_tr_b16 a[206:207], v11 offset:12288
    s_waitcnt lgkmcnt(8)
    v_mfma_f32_16x16x32_bf16 v[224:227], a[224:227], a[128:131], v[224:227]
    ds_read_b64_tr_b16 a[208:209], v12 offset:0
    s_add_u32 s4, s4, 16384
    v_mfma_f32_16x16x32_bf16 v[224:227], a[228:231], a[132:135], v[224:227]
    s_add_u32 s90, s4, s68
    s_lshl_b32 s92, s57, 8
    v_mfma_f32_16x16x32_bf16 v[228:231], a[228:231], a[140:143], v[228:231]
    ds_read_b64_tr_b16 a[210:211], v12 offset:4096
    s_add_u32 s92, s92, s47
    v_mfma_f32_16x16x32_bf16 v[228:231], a[224:227], a[136:139], v[228:231]
    s_waitcnt vmcnt(12)
    s_and_b32 s3, s3, 12
    v_mfma_f32_16x16x32_bf16 v[232:235], a[224:227], a[144:147], v[232:235]
    ds_read_b64_tr_b16 a[212:213], v12 offset:8192
    s_lshl_b32 s3, s3, 7
    v_mfma_f32_16x16x32_bf16 v[232:235], a[228:231], a[148:151], v[232:235]
    ds_read_b64_tr_b16 a[214:215], v12 offset:12288
    s_lshr_b32 s4, s56, 1
    v_mfma_f32_16x16x32_bf16 v[236:239], a[228:231], a[156:159], v[236:239]
    ds_read_b64_tr_b16 a[216:217], v13 offset:0
    s_lshl_b32 s4, s4, 16
    v_mfma_f32_16x16x32_bf16 v[236:239], a[224:227], a[152:155], v[236:239]
    s_waitcnt lgkmcnt(9)
    s_waitcnt lgkmcnt(5)
    v_smfmac_f32_16x16x64_bf16 a[240:243], v[24:27], a[192:199], v20
    ds_read_b64_tr_b16 a[218:219], v13 offset:4096
    v_mfma_f32_16x16x32_bf16 v[108:111], a[200:203], a[152:155], v[108:111]
    ds_read_b128 a[160:163], v32 offset:8192
    s_add_u32 s3, s3, s4
    v_mfma_f32_16x16x32_bf16 v[108:111], a[204:207], a[156:159], v[108:111]
    ds_read_b64_tr_b16 a[220:221], v13 offset:8192
    s_lshl_b32 s4, s82, 12
    v_mfma_f32_16x16x32_bf16 v[104:107], a[204:207], a[148:151], v[104:107]
    ds_read_b128 a[164:167], v33 offset:8192
    s_add_u32 s3, s3, s4
    v_mfma_f32_16x16x32_bf16 v[104:107], a[200:203], a[144:147], v[104:107]
    ds_read_b64_tr_b16 a[222:223], v13 offset:12288
    s_add_u32 s93, s3, 12582912
    v_mfma_f32_16x16x32_bf16 v[100:103], a[200:203], a[136:139], v[100:103]
    ds_read_b64_tr_b16 a[224:225], v56 offset:0
    s_xor_b32 s94, s70, 12288
    v_mfma_f32_16x16x32_bf16 v[100:103], a[204:207], a[140:143], v[100:103]
    ds_read_b128 a[168:171], v32 offset:10240
    s_xor_b32 s95, s82, 3
    v_mfma_f32_16x16x32_bf16 v[96:99], a[204:207], a[132:135], v[96:99]
    ds_read_b64_tr_b16 a[226:227], v56 offset:2048
    s_lshl_b32 s95, s95, 6
    v_mfma_f32_16x16x32_bf16 v[96:99], a[200:203], a[128:131], v[96:99]
    s_waitcnt lgkmcnt(9)
    ds_read_b128 a[172:175], v33 offset:10240
    v_mfma_f32_16x16x32_bf16 v[240:243], a[208:211], a[128:131], v[240:243]
    ds_read_b64_tr_b16 a[228:229], v56 offset:4096
    s_lshl_b32 s91, s45, 6
    v_mfma_f32_16x16x32_bf16 v[240:243], a[212:215], a[132:135], v[240:243]
    ds_read_b128 a[176:179], v32 offset:12288
    v_mfma_f32_16x16x32_bf16 v[244:247], a[212:215], a[140:143], v[244:247]
    ds_read_b64_tr_b16 a[230:231], v56 offset:6144
    s_waitcnt vmcnt(5)
    v_mfma_f32_16x16x32_bf16 v[244:247], a[208:211], a[136:139], v[244:247]
    ds_read_b128 a[180:183], v33 offset:12288
    v_cmp_ne_u32 vcc, 15, v22
    s_nop 0
    s_and_b32 s6, vcc_lo, 1
    s_cbranch_scc1 L1_pta_spin
L1_pta_ok:
    v_mfma_f32_16x16x32_bf16 v[248:251], a[208:211], a[144:147], v[248:251]
    ds_read_b64_tr_b16 a[192:193], v57 offset:0
    v_mfma_f32_16x16x32_bf16 v[248:251], a[212:215], a[148:151], v[248:251]
    ds_read_b128 a[184:187], v32 offset:14336
    v_mfma_f32_16x16x32_bf16 v[252:255], a[212:215], a[156:159], v[252:255]
    ds_read_b64_tr_b16 a[194:195], v57 offset:2048
    v_mfma_f32_16x16x32_bf16 v[252:255], a[208:211], a[152:155], v[252:255]
    s_waitcnt lgkmcnt(11)
    ds_read_b128 a[188:191], v33 offset:14336
    v_mfma_f32_16x16x32_bf16 v[124:127], a[216:219], a[152:155], v[124:127]
    ds_read_b64_tr_b16 a[196:197], v57 offset:4096
    v_mfma_f32_16x16x32_bf16 v[124:127], a[220:223], a[156:159], v[124:127]
    buffer_load_dwordx2 a[244:245], v62, s[84:87], s66 offen offset:0 sc1
    v_mfma_f32_16x16x32_bf16 v[120:123], a[220:223], a[148:151], v[120:123]
    ds_read_b64_tr_b16 a[198:199], v57 offset:6144
    v_mfma_f32_16x16x32_bf16 v[120:123], a[216:219], a[144:147], v[120:123]
    buffer_load_dwordx2 a[246:247], v62, s[84:87], s66 offen offset:128 sc1
    v_mfma_f32_16x16x32_bf16 v[116:119], a[216:219], a[136:139], v[116:119]
    buffer_load_dwordx2 a[248:249], v62, s[84:87], s66 offen offset:256 sc1
    v_mfma_f32_16x16x32_bf16 v[116:119], a[220:223], a[140:143], v[116:119]
    buffer_load_dwordx2 a[250:251], v62, s[84:87], s66 offen offset:384 sc1
    v_mfma_f32_16x16x32_bf16 v[112:115], a[220:223], a[132:135], v[112:115]
    v_lshrrev_b32 v21, 8, v1
    v_xor_b32 v22, s45, v21
    v_mfma_f32_16x16x32_bf16 v[112:115], a[216:219], a[128:131], v[112:115]
    s_waitcnt lgkmcnt(7)
    v_lshl_add_u32 v22, v21, 2, v22
    v_mfma_f32_16x16x32_bf16 v[128:131], a[224:227], a[128:131], v[128:131]
    v_bfe_u32 v0, v1, 4, 4
    v_lshlrev_b32 v0, 2, v0
L1_pa3:
    s_cbranch_execz L1_pc1
    v_mfma_f32_16x16x32_bf16 v[128:131], a[228:231], a[132:135], v[128:131]
    v_lshl_add_u32 v22, v22, 7, v0
    s_lshl_b32 s4, s45, 6
    v_mfma_f32_16x16x32_bf16 v[132:135], a[228:231], a[140:143], v[132:135]
    v_add_u32 v22, 155648, v22
    s_add_u32 s4, s4, 157696
    v_mfma_f32_16x16x32_bf16 v[132:135], a[224:227], a[136:139], v[132:135]
    s_waitcnt vmcnt(10)
    v_add_u32 v0, s4, v0
    v_mfma_f32_16x16x32_bf16 v[136:139], a[224:227], a[144:147], v[136:139]
    s_waitcnt lgkmcnt(0)
    s_waitcnt lgkmcnt(2)
    s_barrier
    v_mfma_f32_16x16x32_bf16 v[136:139], a[228:231], a[148:151], v[136:139]
    ds_read_b64_tr_b16 a[200:201], v6 offset:16384
    s_add_u32 m0, s41, 0
    v_mfma_f32_16x16x32_bf16 v[140:143], a[228:231], a[156:159], v[140:143]
    ds_read_b64_tr_b16 a[202:203], v6 offset:20480
    s_mov_b32 s40, 0
    v_mfma_f32_16x16x32_bf16 v[140:143], a[224:227], a[152:155], v[140:143]
    ds_read_b64_tr_b16 a[204:205], v6 offset:24576
    v_mfma_f32_16x16x32_bf16 v[156:159], a[192:195], a[152:155], v[156:159]
    ds_read_b64_tr_b16 a[206:207], v6 offset:28672
    v_mfma_f32_16x16x32_bf16 v[156:159], a[196:199], a[156:159], v[156:159]
    ds_read_b64_tr_b16 a[208:209], v60 offset:8192
    v_mfma_f32_16x16x32_bf16 v[152:155], a[196:199], a[148:151], v[152:155]
    buffer_load_dwordx4 v14, s[8:11], s40 offen offset:0 lds
    v_mfma_f32_16x16x32_bf16 v[152:155], a[192:195], a[144:147], v[152:155]
    ds_read_b64_tr_b16 a[210:211], v60 offset:10240
    v_mfma_f32_16x16x32_bf16 v[148:151], a[192:195], a[136:139], v[148:151]
    buffer_load_dwordx4 v15, s[8:11], s40 offen offset:1024 lds
    v_mfma_f32_16x16x32_bf16 v[148:151], a[196:199], a[140:143], v[148:151]
    ds_read_b64_tr_b16 a[212:213], v60 offset:12288
    v_mfma_f32_16x16x32_bf16 v[144:147], a[196:199], a[132:135], v[144:147]
    ds_read_b64_tr_b16 a[214:215], v60 offset:14336
    v_mfma_f32_16x16x32_bf16 v[144:147], a[192:195], a[128:131], v[144:147]
    ds_read_b64_tr_b16 a[216:217], v7 offset:16384
    s_waitcnt lgkmcnt(5)
    v_mfma_f32_16x16x32_bf16 v[192:195], a[200:203], a[160:163], v[192:195]
    ds_read_b64_tr_b16 a[218:219], v7 offset:20480
    v_mfma_f32_16x16x32_bf16 v[192:195], a[204:207], a[164:167], v[192:195]
    ds_read_b64_tr_b16 a[220:221], v7 offset:24576
    v_mfma_f32_16x16x32_bf16 v[196:199], a[204:207], a[172:175], v[196:199]
    ds_read_b64_tr_b16 a[222:223], v7 offset:28672
    v_mfma_f32_16x16x32_bf16 v[196:199], a[200:203], a[168:171], v[196:199]
    ds_read_b64_tr_b16 a[224:225], v56 offset:8192
    v_mfma_f32_16x16x32_bf16 v[200:203], a[200:203], a[176:179], v[200:203]
    buffer_load_dwordx4 v16, s[8:11], s40 offen offset:2048 lds
    v_mfma_f32_16x16x32_bf16 v[200:203], a[204:207], a[180:183], v[200:203]
    ds_read_b64_tr_b16 a[226:227], v56 offset:10240
    v_mfma_f32_16x16x32_bf16 v[204:207], a[204:207], a[188:191], v[204:207]
    buffer_load_dwordx4 v17, s[8:11], s40 offen offset:3072 lds
    v_mfma_f32_16x16x32_bf16 v[204:207], a[200:203], a[184:187], v[204:207]
    ds_read_b64_tr_b16 a[228:229], v56 offset:12288
    s_waitcnt lgkmcnt(7)
    v_smfmac_f32_16x16x64_bf16 a[232:235], v[24:27], a[200:207], v20
    ds_read_b64_tr_b16 a[230:231], v56 offset:14336
    v_smfmac_f32_16x16x64_bf16 a[240:243], v[24:27], a[208:215], v20
    ds_read_b64_tr_b16 a[192:193], v58 offset:8192
    s_waitcnt lgkmcnt(5)
    v_mfma_f32_16x16x32_bf16 v[76:79], a[216:219], a[184:187], v[76:79]
    s_add_u32 m0, s41, 16384
    s_mov_b32 s40, 16384
    v_mfma_f32_16x16x32_bf16 v[76:79], a[220:223], a[188:191], v[76:79]
    ds_read_b64_tr_b16 a[194:195], v58 offset:10240
    v_mfma_f32_16x16x32_bf16 v[72:75], a[220:223], a[180:183], v[72:75]
    buffer_load_dwordx4 v14, s[8:11], s40 offen offset:0 lds
    v_mfma_f32_16x16x32_bf16 v[72:75], a[216:219], a[176:179], v[72:75]
    ds_read_b64_tr_b16 a[196:197], v58 offset:12288
    v_mfma_f32_16x16x32_bf16 v[68:71], a[216:219], a[168:171], v[68:71]
    v_mfma_f32_16x16x32_bf16 v[68:71], a[220:223], a[172:175], v[68:71]
    ds_read_b64_tr_b16 a[198:199], v58 offset:14336
    v_mfma_f32_16x16x32_bf16 v[64:67], a[220:223], a[164:167], v[64:67]
    ds_read_b64_tr_b16 a[200:201], v57 offset:8192
    v_mfma_f32_16x16x32_bf16 v[64:67], a[216:219], a[160:163], v[64:67]
    s_waitcnt lgkmcnt(5)
    v_smfmac_f32_16x16x64_bf16 a[236:239], v[24:27], a[216:223], v20
    ds_read_b64_tr_b16 a[202:203], v57 offset:10240
    v_mfma_f32_16x16x32_bf16 v[128:131], a[224:227], a[160:163], v[128:131]
    buffer_load_dwordx4 v15, s[8:11], s40 offen offset:1024 lds
    v_mfma_f32_16x16x32_bf16 v[128:131], a[228:231], a[164:167], v[128:131]
    ds_read_b64_tr_b16 a[204:205], v57 offset:12288
    v_mfma_f32_16x16x32_bf16 v[132:135], a[228:231], a[172:175], v[132:135]
    buffer_load_dwordx4 v16, s[8:11], s40 offen offset:2048 lds
    v_mfma_f32_16x16x32_bf16 v[132:135], a[224:227], a[168:171], v[132:135]
    ds_read_b64_tr_b16 a[206:207], v57 offset:14336
    v_mfma_f32_16x16x32_bf16 v[136:139], a[224:227], a[176:179], v[136:139]
    ds_read_b64_tr_b16 a[208:209], v8 offset:16384
    v_mfma_f32_16x16x32_bf16 v[136:139], a[228:231], a[180:183], v[136:139]
    v_accvgpr_read_b32 v33, a232
    v_accvgpr_read_b32 v34, a233
    v_mfma_f32_16x16x32_bf16 v[140:143], a[228:231], a[188:191], v[140:143]
    ds_read_b64_tr_b16 a[210:211], v8 offset:20480
    v_accvgpr_read_b32 v37, a236
    v_mfma_f32_16x16x32_bf16 v[140:143], a[224:227], a[184:187], v[140:143]
    s_waitcnt lgkmcnt(6)
    v_accvgpr_read_b32 v38, a237
    v_mfma_f32_16x16x32_bf16 v[160:163], a[192:195], a[160:163], v[160:163]
    ds_read_b64_tr_b16 a[212:213], v8 offset:24576
    v_accvgpr_read_b32 v41, a240
    v_mfma_f32_16x16x32_bf16 v[160:163], a[196:199], a[164:167], v[160:163]
    buffer_load_dwordx4 v17, s[8:11], s40 offen offset:3072 lds
    v_mfma_f32_16x16x32_bf16 v[164:167], a[196:199], a[172:175], v[164:167]
    ds_read_b64_tr_b16 a[214:215], v8 offset:28672
    v_accvgpr_read_b32 v42, a241
    v_mfma_f32_16x16x32_bf16 v[164:167], a[192:195], a[168:171], v[164:167]
    s_add_u32 m0, s41, 32768
    s_mov_b32 s40, 32768
    v_mfma_f32_16x16x32_bf16 v[168:171], a[192:195], a[176:179], v[168:171]
    ds_read_b64_tr_b16 a[216:217], v59 offset:8192
    v_add_f32 v33, v33, v34
    v_mfma_f32_16x16x32_bf16 v[168:171], a[196:199], a[180:183], v[168:171]
    buffer_load_dwordx4 v14, s[8:11], s40 offen offset:0 lds
    v_mfma_f32_16x16x32_bf16 v[172:175], a[196:199], a[188:191], v[172:175]
    ds_read_b64_tr_b16 a[218:219], v59 offset:10240
    v_add_f32 v37, v37, v38
    v_mfma_f32_16x16x32_bf16 v[172:175], a[192:195], a[184:187], v[172:175]
    s_waitcnt lgkmcnt(6)
    v_add_f32 v41, v41, v42
    v_mfma_f32_16x16x32_bf16 v[156:159], a[200:203], a[184:187], v[156:159]
    ds_read_b64_tr_b16 a[220:221], v59 offset:12288
    v_mfma_f32_16x16x32_bf16 v[156:159], a[204:207], a[188:191], v[156:159]
    ds_write_b32 v22, v33 offset:0
    v_mfma_f32_16x16x32_bf16 v[152:155], a[204:207], a[180:183], v[152:155]
    ds_read_b64_tr_b16 a[222:223], v59 offset:14336
    ds_write_b32 v22, v37 offset:64
    v_mfma_f32_16x16x32_bf16 v[152:155], a[200:203], a[176:179], v[152:155]
    buffer_load_dwordx4 v15, s[8:11], s40 offen offset:1024 lds
    v_mfma_f32_16x16x32_bf16 v[148:151], a[200:203], a[168:171], v[148:151]
    ds_read_b64_tr_b16 a[224:225], v9 offset:16384
    v_mfma_f32_16x16x32_bf16 v[148:151], a[204:207], a[172:175], v[148:151]
    ds_write_b32 v0, v41
    s_lshl_b32 s3, s45, 9
    v_mfma_f32_16x16x32_bf16 v[144:147], a[204:207], a[164:167], v[144:147]
    ds_read_b64_tr_b16 a[226:227], v9 offset:20480
    v_lshlrev_b32 v21, 4, v21
    v_mfma_f32_16x16x32_bf16 v[144:147], a[200:203], a[160:163], v[144:147]
    s_waitcnt lgkmcnt(9)
    s_add_u32 s3, s3, 155648
    v_mfma_f32_16x16x32_bf16 v[208:211], a[208:211], a[160:163], v[208:211]
    ds_read_b64_tr_b16 a[228:229], v9 offset:24576
    v_add_u32 v22, 157696, v21
    v_mfma_f32_16x16x32_bf16 v[208:211], a[212:215], a[164:167], v[208:211]
    buffer_load_dwordx4 v16, s[8:11], s40 offen offset:2048 lds
    v_mfma_f32_16x16x32_bf16 v[212:215], a[212:215], a[172:175], v[212:215]
    ds_read_b64_tr_b16 a[230:231], v9 offset:28672
    v_add_u32 v21, s3, v21
    v_mfma_f32_16x16x32_bf16 v[212:215], a[208:211], a[168:171], v[212:215]
    s_waitcnt lgkmcnt(3)
    s_barrier
    v_mfma_f32_16x16x32_bf16 v[216:219], a[208:211], a[176:179], v[216:219]
    ds_read_b64_tr_b16 a[192:193], v10 offset:16384
    v_mfma_f32_16x16x32_bf16 v[216:219], a[212:215], a[180:183], v[216:219]
    buffer_load_dwordx4 v17, s[8:11], s40 offen offset:3072 lds
    v_mfma_f32_16x16x32_bf16 v[220:223], a[212:215], a[188:191], v[220:223]
    ds_read_b64_tr_b16 a[194:195], v10 offset:20480
    v_mfma_f32_16x16x32_bf16 v[220:223], a[208:211], a[184:187], v[220:223]
    s_waitcnt lgkmcnt(8)
    ds_read_b128 v[32:35], v21 offset:0
    v_mfma_f32_16x16x32_bf16 v[188:191], a[216:219], a[184:187], v[188:191]
    ds_read_b64_tr_b16 a[196:197], v10 offset:24576
    s_add_u32 m0, s41, 65536
    v_mfma_f32_16x16x32_bf16 v[188:191], a[220:223], a[188:191], v[188:191]
    s_mov_b32 s40, 0
    ds_read_b128 v[36:39], v21 offset:64
    v_mfma_f32_16x16x32_bf16 v[184:187], a[220:223], a[180:183], v[184:187]
    ds_read_b64_tr_b16 a[198:199], v10 offset:28672
    v_mfma_f32_16x16x32_bf16 v[184:187], a[216:219], a[176:179], v[184:187]
    buffer_load_dwordx4 v18, s[12:15], s40 offen offset:0 lds
    v_mfma_f32_16x16x32_bf16 v[180:183], a[216:219], a[168:171], v[180:183]
    ds_read_b64_tr_b16 a[200:201], v11 offset:16384
    v_mfma_f32_16x16x32_bf16 v[180:183], a[220:223], a[172:175], v[180:183]
    ds_read_b128 v[40:43], v21 offset:128
    v_mfma_f32_16x16x32_bf16 v[176:179], a[220:223], a[164:167], v[176:179]
    ds_read_b64_tr_b16 a[202:203], v11 offset:20480
    v_mfma_f32_16x16x32_bf16 v[176:179], a[216:219], a[160:163], v[176:179]
    s_waitcnt lgkmcnt(9)
    ds_read_b128 v[44:47], v21 offset:192
    v_mfma_f32_16x16x32_bf16 v[92:95], a[224:227], a[184:187], v[92:95]
    ds_read_b64_tr_b16 a[204:205], v11 offset:24576
    v_mfma_f32_16x16x32_bf16 v[92:95], a[228:231], a[188:191], v[92:95]
    buffer_load_dwordx4 v19, s[12:15], s40 offen offset:1024 lds
    v_mfma_f32_16x16x32_bf16 v[88:91], a[228:231], a[180:183], v[88:91]
    ds_read_b64_tr_b16 a[206:207], v11 offset:28672
    v_mfma_f32_16x16x32_bf16 v[88:91], a[224:227], a[176:179], v[88:91]
    v_mfma_f32_16x16x32_bf16 v[84:87], a[224:227], a[168:171], v[84:87]
    ds_read_b64_tr_b16 a[208:209], v12 offset:16384
    v_mfma_f32_16x16x32_bf16 v[84:87], a[228:231], a[172:175], v[84:87]
    buffer_load_dwordx4 v18, s[12:15], s40 offen offset:2048 lds
    v_mfma_f32_16x16x32_bf16 v[80:83], a[228:231], a[164:167], v[80:83]
    ds_read_b64_tr_b16 a[210:211], v12 offset:20480
    v_mfma_f32_16x16x32_bf16 v[80:83], a[224:227], a[160:163], v[80:83]
    s_waitcnt lgkmcnt(8)
    v_mfma_f32_16x16x32_bf16 v[224:227], a[192:195], a[160:163], v[224:227]
    ds_read_b64_tr_b16 a[212:213], v12 offset:24576
    v_mfma_f32_16x16x32_bf16 v[224:227], a[196:199], a[164:167], v[224:227]
    v_mfma_f32_16x16x32_bf16 v[228:231], a[196:199], a[172:175], v[228:231]
    ds_read_b64_tr_b16 a[214:215], v12 offset:28672
    v_mfma_f32_16x16x32_bf16 v[228:231], a[192:195], a[168:171], v[228:231]
    buffer_load_dwordx4 v19, s[12:15], s40 offen offset:3072 lds
    v_mfma_f32_16x16x32_bf16 v[232:235], a[192:195], a[176:179], v[232:235]
    ds_read_b64_tr_b16 a[216:217], v13 offset:16384
    v_mfma_f32_16x16x32_bf16 v[232:235], a[196:199], a[180:183], v[232:235]
    v_mfma_f32_16x16x32_bf16 v[236:239], a[196:199], a[188:191], v[236:239]
    ds_read_b64_tr_b16 a[218:219], v13 offset:20480
    v_mfma_f32_16x16x32_bf16 v[236:239], a[192:195], a[184:187], v[236:239]
    s_waitcnt lgkmcnt(6)
    v_mfma_f32_16x16x32_bf16 v[108:111], a[200:203], a[184:187], v[108:111]
    ds_read_b64_tr_b16 a[220:221], v13 offset:24576
    v_mfma_f32_16x16x32_bf16 v[108:111], a[204:207], a[188:191], v[108:111]
    v_mfma_f32_16x16x32_bf16 v[104:107], a[204:207], a[180:183], v[104:107]
    ds_read_b64_tr_b16 a[222:223], v13 offset:28672
    v_mfma_f32_16x16x32_bf16 v[104:107], a[200:203], a[176:179], v[104:107]
    v_mfma_f32_16x16x32_bf16 v[100:103], a[200:203], a[168:171], v[100:103]
    s_waitcnt vmcnt(16)
    v_accvgpr_read_b32 v28, a245
    v_mfma_f32_16x16x32_bf16 v[100:103], a[204:207], a[172:175], v[100:103]
    v_accvgpr_read_b32 v29, a247
    v_accvgpr_read_b32 v30, a249
    v_mfma_f32_16x16x32_bf16 v[96:99], a[204:207], a[164:167], v[96:99]
    v_accvgpr_read_b32 v31, a251
    v_accvgpr_read_b32 v56, a244
    v_mfma_f32_16x16x32_bf16 v[96:99], a[200:203], a[160:163], v[96:99]
    s_waitcnt lgkmcnt(4)
    v_accvgpr_read_b32 v58, a246
    v_mfma_f32_16x16x32_bf16 v[240:243], a[208:211], a[160:163], v[240:243]
    v_accvgpr_read_b32 v60, a248
    v_accvgpr_read_b32 v62, a250
    v_mfma_f32_16x16x32_bf16 v[240:243], a[212:215], a[164:167], v[240:243]
    v_mul_f32 v57, 0x3e0293ee, v28
    v_mul_f32 v59, 0x3e0293ee, v29
    v_mfma_f32_16x16x32_bf16 v[244:247], a[212:215], a[172:175], v[244:247]
    v_mul_f32 v61, 0x3e0293ee, v30
    v_mul_f32 v63, 0x3e0293ee, v31
    v_mfma_f32_16x16x32_bf16 v[244:247], a[208:211], a[168:171], v[244:247]
    v_mfma_f32_16x16x32_bf16 v[248:251], a[208:211], a[176:179], v[248:251]
    v_mfma_f32_16x16x32_bf16 v[248:251], a[212:215], a[180:183], v[248:251]
    v_mfma_f32_16x16x32_bf16 v[252:255], a[212:215], a[188:191], v[252:255]
    v_mfma_f32_16x16x32_bf16 v[252:255], a[208:211], a[184:187], v[252:255]
    s_waitcnt lgkmcnt(0)
    v_mfma_f32_16x16x32_bf16 v[124:127], a[216:219], a[184:187], v[124:127]
    v_mfma_f32_16x16x32_bf16 v[124:127], a[220:223], a[188:191], v[124:127]
    v_mfma_f32_16x16x32_bf16 v[120:123], a[220:223], a[180:183], v[120:123]
    v_mfma_f32_16x16x32_bf16 v[120:123], a[216:219], a[176:179], v[120:123]
    v_mfma_f32_16x16x32_bf16 v[116:119], a[216:219], a[168:171], v[116:119]
    v_mfma_f32_16x16x32_bf16 v[116:119], a[220:223], a[172:175], v[116:119]
    v_mfma_f32_16x16x32_bf16 v[112:115], a[220:223], a[164:167], v[112:115]
    v_mfma_f32_16x16x32_bf16 v[112:115], a[216:219], a[160:163], v[112:115]
    s_waitcnt lgkmcnt(15)
    v_pk_fma_f32 v[192:193], v[32:33], v[56:57], v[192:193] op_sel_hi:[1,0,1]
    v_pk_fma_f32 v[194:195], v[34:35], v[56:57], v[194:195] op_sel_hi:[1,0,1]
    v_pk_fma_f32 v[64:65], v[36:37], v[56:57], v[64:65] op_sel_hi:[1,0,1]
    v_pk_fma_f32 v[66:67], v[38:39], v[56:57], v[66:67] op_sel_hi:[1,0,1]
    v_pk_mul_f32 v[192:193], v[192:193], v[56:57] op_sel:[0,1]
    v_pk_mul_f32 v[194:195], v[194:195], v[56:57] op_sel:[0,1]
    v_pk_mul_f32 v[64:65], v[64:65], v[56:57] op_sel:[0,1]
    v_pk_mul_f32 v[66:67], v[66:67], v[56:57] op_sel:[0,1]
    v_cvt_pk_bf16_f32 v192, v192, v193
    v_cvt_pk_bf16_f32 v193, v194, v195
    v_cvt_pk_bf16_f32 v194, v64, v65
    v_cvt_pk_bf16_f32 v195, v66, v67
    v_pk_fma_f32 v[196:197], v[32:33], v[58:59], v[196:197] op_sel_hi:[1,0,1]
    v_pk_fma_f32 v[198:199], v[34:35], v[58:59], v[198:199] op_sel_hi:[1,0,1]
    v_pk_fma_f32 v[68:69], v[36:37], v[58:59], v[68:69] op_sel_hi:[1,0,1]
    v_pk_fma_f32 v[70:71], v[38:39], v[58:59], v[70:71] op_sel_hi:[1,0,1]
    v_pk_mul_f32 v[196:197], v[196:197], v[58:59] op_sel:[0,1]
    v_pk_mul_f32 v[198:199], v[198:199], v[58:59] op_sel:[0,1]
    v_pk_mul_f32 v[68:69], v[68:69], v[58:59] op_sel:[0,1]
    v_pk_mul_f32 v[70:71], v[70:71], v[58:59] op_sel:[0,1]
    v_cvt_pk_bf16_f32 v196, v196, v197
    v_cvt_pk_bf16_f32 v197, v198, v199
    v_cvt_pk_bf16_f32 v198, v68, v69
    v_cvt_pk_bf16_f32 v199, v70, v71
    v_pk_fma_f32 v[200:201], v[32:33], v[60:61], v[200:201] op_sel_hi:[1,0,1]
    v_pk_fma_f32 v[202:203], v[34:35], v[60:61], v[202:203] op_sel_hi:[1,0,1]
    v_pk_fma_f32 v[72:73], v[36:37], v[60:61], v[72:73] op_sel_hi:[1,0,1]
    v_pk_fma_f32 v[74:75], v[38:39], v[60:61], v[74:75] op_sel_hi:[1,0,1]
    v_pk_mul_f32 v[200:201], v[200:201], v[60:61] op_sel:[0,1]
    v_pk_mul_f32 v[202:203], v[202:203], v[60:61] op_sel:[0,1]
    v_pk_mul_f32 v[72:73], v[72:73], v[60:61] op_sel:[0,1]
    v_pk_mul_f32 v[74:75], v[74:75], v[60:61] op_sel:[0,1]
    v_cvt_pk_bf16_f32 v200, v200, v201
    v_cvt_pk_bf16_f32 v201, v202, v203
    v_cvt_pk_bf16_f32 v202, v72, v73
    v_cvt_pk_bf16_f32 v203, v74, v75
    v_pk_fma_f32 v[204:205], v[32:33], v[62:63], v[204:205] op_sel_hi:[1,0,1]
    v_pk_fma_f32 v[206:207], v[34:35], v[62:63], v[206:207] op_sel_hi:[1,0,1]
    v_pk_fma_f32 v[76:77], v[36:37], v[62:63], v[76:77] op_sel_hi:[1,0,1]
    v_pk_fma_f32 v[78:79], v[38:39], v[62:63], v[78:79] op_sel_hi:[1,0,1]
    v_pk_mul_f32 v[204:205], v[204:205], v[62:63] op_sel:[0,1]
    v_pk_mul_f32 v[206:207], v[206:207], v[62:63] op_sel:[0,1]
    v_pk_mul_f32 v[76:77], v[76:77], v[62:63] op_sel:[0,1]
    v_pk_mul_f32 v[78:79], v[78:79], v[62:63] op_sel:[0,1]
    v_cvt_pk_bf16_f32 v204, v204, v205
    v_cvt_pk_bf16_f32 v205, v206, v207
    v_cvt_pk_bf16_f32 v206, v76, v77
    v_cvt_pk_bf16_f32 v207, v78, v79
    ds_read_b128 v[64:67], v21 offset:256
    ds_read_b128 v[68:71], v21 offset:320
    ds_read_b128 v[72:75], v21 offset:384
    ds_read_b128 v[76:79], v21 offset:448
    s_waitcnt lgkmcnt(14)
    v_pk_fma_f32 v[208:209], v[40:41], v[56:57], v[208:209] op_sel_hi:[1,0,1]
    v_pk_fma_f32 v[210:211], v[42:43], v[56:57], v[210:211] op_sel_hi:[1,0,1]
    v_pk_fma_f32 v[80:81], v[44:45], v[56:57], v[80:81] op_sel_hi:[1,0,1]
    v_pk_fma_f32 v[82:83], v[46:47], v[56:57], v[82:83] op_sel_hi:[1,0,1]
    v_pk_mul_f32 v[208:209], v[208:209], v[56:57] op_sel:[0,1]
    v_pk_mul_f32 v[210:211], v[210:211], v[56:57] op_sel:[0,1]
    v_pk_mul_f32 v[80:81], v[80:81], v[56:57] op_sel:[0,1]
    v_pk_mul_f32 v[82:83], v[82:83], v[56:57] op_sel:[0,1]
    v_cvt_pk_bf16_f32 v208, v208, v209
    v_cvt_pk_bf16_f32 v209, v210, v211
    v_cvt_pk_bf16_f32 v210, v80, v81
    v_cvt_pk_bf16_f32 v211, v82, v83
    v_pk_fma_f32 v[212:213], v[40:41], v[58:59], v[212:213] op_sel_hi:[1,0,1]
    v_pk_fma_f32 v[214:215], v[42:43], v[58:59], v[214:215] op_sel_hi:[1,0,1]
    v_pk_fma_f32 v[84:85], v[44:45], v[58:59], v[84:85] op_sel_hi:[1,0,1]
    v_pk_fma_f32 v[86:87], v[46:47], v[58:59], v[86:87] op_sel_hi:[1,0,1]
    v_pk_mul_f32 v[212:213], v[212:213], v[58:59] op_sel:[0,1]
    v_pk_mul_f32 v[214:215], v[214:215], v[58:59] op_sel:[0,1]
    v_pk_mul_f32 v[84:85], v[84:85], v[58:59] op_sel:[0,1]
    v_pk_mul_f32 v[86:87], v[86:87], v[58:59] op_sel:[0,1]
    v_cvt_pk_bf16_f32 v212, v212, v213
    v_cvt_pk_bf16_f32 v213, v214, v215
    v_cvt_pk_bf16_f32 v214, v84, v85
    v_cvt_pk_bf16_f32 v215, v86, v87
    v_pk_fma_f32 v[216:217], v[40:41], v[60:61], v[216:217] op_sel_hi:[1,0,1]
    v_pk_fma_f32 v[218:219], v[42:43], v[60:61], v[218:219] op_sel_hi:[1,0,1]
    v_pk_fma_f32 v[88:89], v[44:45], v[60:61], v[88:89] op_sel_hi:[1,0,1]
    v_pk_fma_f32 v[90:91], v[46:47], v[60:61], v[90:91] op_sel_hi:[1,0,1]
    v_pk_mul_f32 v[216:217], v[216:217], v[60:61] op_sel:[0,1]
    v_pk_mul_f32 v[218:219], v[218:219], v[60:61] op_sel:[0,1]
    v_pk_mul_f32 v[88:89], v[88:89], v[60:61] op_sel:[0,1]
    v_pk_mul_f32 v[90:91], v[90:91], v[60:61] op_sel:[0,1]
    v_cvt_pk_bf16_f32 v216, v216, v217
    v_cvt_pk_bf16_f32 v217, v218, v219
    v_cvt_pk_bf16_f32 v218, v88, v89
    v_cvt_pk_bf16_f32 v219, v90, v91
    v_pk_fma_f32 v[220:221], v[40:41], v[62:63], v[220:221] op_sel_hi:[1,0,1]
    v_pk_fma_f32 v[222:223], v[42:43], v[62:63], v[222:223] op_sel_hi:[1,0,1]
    v_pk_fma_f32 v[92:93], v[44:45], v[62:63], v[92:93] op_sel_hi:[1,0,1]
    v_pk_fma_f32 v[94:95], v[46:47], v[62:63], v[94:95] op_sel_hi:[1,0,1]
    v_pk_mul_f32 v[220:221], v[220:221], v[62:63] op_sel:[0,1]
    v_pk_mul_f32 v[222:223], v[222:223], v[62:63] op_sel:[0,1]
    v_pk_mul_f32 v[92:93], v[92:93], v[62:63] op_sel:[0,1]
    v_pk_mul_f32 v[94:95], v[94:95], v[62:63] op_sel:[0,1]
    v_cvt_pk_bf16_f32 v220, v220, v221
    v_cvt_pk_bf16_f32 v221, v222, v223
    v_cvt_pk_bf16_f32 v222, v92, v93
    v_cvt_pk_bf16_f32 v223, v94, v95
    ds_read_b128 v[32:35], v22 offset:0
    ds_read_b128 v[36:39], v22 offset:64
    ds_read_b128 v[40:43], v22 offset:128
    ds_read_b128 v[44:47], v22 offset:192
    s_waitcnt lgkmcnt(6)
    v_pk_fma_f32 v[224:225], v[64:65], v[56:57], v[224:225] op_sel_hi:[1,0,1]
    v_pk_fma_f32 v[226:227], v[66:67], v[56:57], v[226:227] op_sel_hi:[1,0,1]
    v_pk_fma_f32 v[96:97], v[68:69], v[56:57], v[96:97] op_sel_hi:[1,0,1]
    v_pk_fma_f32 v[98:99], v[70:71], v[56:57], v[98:99] op_sel_hi:[1,0,1]
    v_pk_mul_f32 v[224:225], v[224:225], v[56:57] op_sel:[0,1]
    v_pk_mul_f32 v[226:227], v[226:227], v[56:57] op_sel:[0,1]
    v_pk_mul_f32 v[96:97], v[96:97], v[56:57] op_sel:[0,1]
    v_pk_mul_f32 v[98:99], v[98:99], v[56:57] op_sel:[0,1]
    v_cvt_pk_bf16_f32 v224, v224, v225
    v_cvt_pk_bf16_f32 v225, v226, v227
    v_cvt_pk_bf16_f32 v226, v96, v97
    v_cvt_pk_bf16_f32 v227, v98, v99
    v_pk_fma_f32 v[228:229], v[64:65], v[58:59], v[228:229] op_sel_hi:[1,0,1]
    v_pk_fma_f32 v[230:231], v[66:67], v[58:59], v[230:231] op_sel_hi:[1,0,1]
    v_pk_fma_f32 v[100:101], v[68:69], v[58:59], v[100:101] op_sel_hi:[1,0,1]
    v_pk_fma_f32 v[102:103], v[70:71], v[58:59], v[102:103] op_sel_hi:[1,0,1]
    v_pk_mul_f32 v[228:229], v[228:229], v[58:59] op_sel:[0,1]
    v_pk_mul_f32 v[230:231], v[230:231], v[58:59] op_sel:[0,1]
    v_pk_mul_f32 v[100:101], v[100:101], v[58:59] op_sel:[0,1]
    v_pk_mul_f32 v[102:103], v[102:103], v[58:59] op_sel:[0,1]
    v_cvt_pk_bf16_f32 v228, v228, v229
    v_cvt_pk_bf16_f32 v229, v230, v231
    v_cvt_pk_bf16_f32 v230, v100, v101
    v_cvt_pk_bf16_f32 v231, v102, v103
    v_pk_fma_f32 v[232:233], v[64:65], v[60:61], v[232:233] op_sel_hi:[1,0,1]
    v_pk_fma_f32 v[234:235], v[66:67], v[60:61], v[234:235] op_sel_hi:[1,0,1]
    v_pk_fma_f32 v[104:105], v[68:69], v[60:61], v[104:105] op_sel_hi:[1,0,1]
    v_pk_fma_f32 v[106:107], v[70:71], v[60:61], v[106:107] op_sel_hi:[1,0,1]
    v_pk_mul_f32 v[232:233], v[232:233], v[60:61] op_sel:[0,1]
    v_pk_mul_f32 v[234:235], v[234:235], v[60:61] op_sel:[0,1]
    v_pk_mul_f32 v[104:105], v[104:105], v[60:61] op_sel:[0,1]
    v_pk_mul_f32 v[106:107], v[106:107], v[60:61] op_sel:[0,1]
    v_cvt_pk_bf16_f32 v232, v232, v233
    v_cvt_pk_bf16_f32 v233, v234, v235
    v_cvt_pk_bf16_f32 v234, v104, v105
    v_cvt_pk_bf16_f32 v235, v106, v107
    v_pk_fma_f32 v[236:237], v[64:65], v[62:63], v[236:237] op_sel_hi:[1,0,1]
    v_pk_fma_f32 v[238:239], v[66:67], v[62:63], v[238:239] op_sel_hi:[1,0,1]
    v_pk_fma_f32 v[108:109], v[68:69], v[62:63], v[108:109] op_sel_hi:[1,0,1]
    v_pk_fma_f32 v[110:111], v[70:71], v[62:63], v[110:111] op_sel_hi:[1,0,1]
    v_pk_mul_f32 v[236:237], v[236:237], v[62:63] op_sel:[0,1]
    v_pk_mul_f32 v[238:239], v[238:239], v[62:63] op_sel:[0,1]
    v_pk_mul_f32 v[108:109], v[108:109], v[62:63] op_sel:[0,1]
    v_pk_mul_f32 v[110:111], v[110:111], v[62:63] op_sel:[0,1]
    v_cvt_pk_bf16_f32 v236, v236, v237
    v_cvt_pk_bf16_f32 v237, v238, v239
    v_cvt_pk_bf16_f32 v238, v108, v109
    v_cvt_pk_bf16_f32 v239, v110, v111
    s_waitcnt lgkmcnt(4)
    v_pk_fma_f32 v[240:241], v[72:73], v[56:57], v[240:241] op_sel_hi:[1,0,1]
    v_pk_fma_f32 v[242:243], v[74:75], v[56:57], v[242:243] op_sel_hi:[1,0,1]
    v_pk_fma_f32 v[112:113], v[76:77], v[56:57], v[112:113] op_sel_hi:[1,0,1]
    v_pk_fma_f32 v[114:115], v[78:79], v[56:57], v[114:115] op_sel_hi:[1,0,1]
    v_pk_mul_f32 v[240:241], v[240:241], v[56:57] op_sel:[0,1]
    v_pk_mul_f32 v[242:243], v[242:243], v[56:57] op_sel:[0,1]
    v_pk_mul_f32 v[112:113], v[112:113], v[56:57] op_sel:[0,1]
    v_pk_mul_f32 v[114:115], v[114:115], v[56:57] op_sel:[0,1]
    v_cvt_pk_bf16_f32 v240, v240, v241
    v_cvt_pk_bf16_f32 v241, v242, v243
    v_cvt_pk_bf16_f32 v242, v112, v113
    v_cvt_pk_bf16_f32 v243, v114, v115
    v_pk_fma_f32 v[244:245], v[72:73], v[58:59], v[244:245] op_sel_hi:[1,0,1]
    v_pk_fma_f32 v[246:247], v[74:75], v[58:59], v[246:247] op_sel_hi:[1,0,1]
    v_pk_fma_f32 v[116:117], v[76:77], v[58:59], v[116:117] op_sel_hi:[1,0,1]
    v_pk_fma_f32 v[118:119], v[78:79], v[58:59], v[118:119] op_sel_hi:[1,0,1]
    v_pk_mul_f32 v[244:245], v[244:245], v[58:59] op_sel:[0,1]
    v_pk_mul_f32 v[246:247], v[246:247], v[58:59] op_sel:[0,1]
    v_pk_mul_f32 v[116:117], v[116:117], v[58:59] op_sel:[0,1]
    v_pk_mul_f32 v[118:119], v[118:119], v[58:59] op_sel:[0,1]
    v_cvt_pk_bf16_f32 v244, v244, v245
    v_cvt_pk_bf16_f32 v245, v246, v247
    v_cvt_pk_bf16_f32 v246, v116, v117
    v_cvt_pk_bf16_f32 v247, v118, v119
    v_pk_fma_f32 v[248:249], v[72:73], v[60:61], v[248:249] op_sel_hi:[1,0,1]
    v_pk_fma_f32 v[250:251], v[74:75], v[60:61], v[250:251] op_sel_hi:[1,0,1]
    v_pk_fma_f32 v[120:121], v[76:77], v[60:61], v[120:121] op_sel_hi:[1,0,1]
    v_pk_fma_f32 v[122:123], v[78:79], v[60:61], v[122:123] op_sel_hi:[1,0,1]
    v_pk_mul_f32 v[248:249], v[248:249], v[60:61] op_sel:[0,1]
    v_pk_mul_f32 v[250:251], v[250:251], v[60:61] op_sel:[0,1]
    v_pk_mul_f32 v[120:121], v[120:121], v[60:61] op_sel:[0,1]
    v_pk_mul_f32 v[122:123], v[122:123], v[60:61] op_sel:[0,1]
    v_cvt_pk_bf16_f32 v248, v248, v249
    v_cvt_pk_bf16_f32 v249, v250, v251
    v_cvt_pk_bf16_f32 v250, v120, v121
    v_cvt_pk_bf16_f32 v251, v122, v123
    v_pk_fma_f32 v[252:253], v[72:73], v[62:63], v[252:253] op_sel_hi:[1,0,1]
    v_pk_fma_f32 v[254:255], v[74:75], v[62:63], v[254:255] op_sel_hi:[1,0,1]
    v_pk_fma_f32 v[124:125], v[76:77], v[62:63], v[124:125] op_sel_hi:[1,0,1]
    v_pk_fma_f32 v[126:127], v[78:79], v[62:63], v[126:127] op_sel_hi:[1,0,1]
    v_pk_mul_f32 v[252:253], v[252:253], v[62:63] op_sel:[0,1]
    v_pk_mul_f32 v[254:255], v[254:255], v[62:63] op_sel:[0,1]
    v_pk_mul_f32 v[124:125], v[124:125], v[62:63] op_sel:[0,1]
    v_pk_mul_f32 v[126:127], v[126:127], v[62:63] op_sel:[0,1]
    v_cvt_pk_bf16_f32 v252, v252, v253
    v_cvt_pk_bf16_f32 v253, v254, v255
    v_cvt_pk_bf16_f32 v254, v124, v125
    v_cvt_pk_bf16_f32 v255, v126, v127
    s_waitcnt vmcnt(8)
    s_barrier
    ds_read_b128 a[192:195], v2 offset:0
    ds_read_b128 a[196:199], v3 offset:0
    ds_read_b128 a[200:203], v4 offset:0
    ds_read_b128 a[204:207], v5 offset:0
    v_lshlrev_b32 v112, 16, v48
    v_and_b32 v113, 0xffff0000, v48
    v_lshlrev_b32 v114, 16, v49
    v_and_b32 v115, 0xffff0000, v49
    v_lshlrev_b32 v116, 16, v50
    v_and_b32 v117, 0xffff0000, v50
    v_lshlrev_b32 v118, 16, v51
    v_and_b32 v119, 0xffff0000, v51
    v_lshlrev_b32 v120, 16, v52
    v_and_b32 v121, 0xffff0000, v52
    v_lshlrev_b32 v122, 16, v53
    v_and_b32 v123, 0xffff0000, v53
    v_lshlrev_b32 v124, 16, v54
    v_and_b32 v125, 0xffff0000, v54
    v_lshlrev_b32 v126, 16, v55
    v_and_b32 v127, 0xffff0000, v55
    v_mov_b32 v48, 0xbdd2d3e8
    v_mov_b32 v49, 0xc0135761
    s_waitcnt lgkmcnt(4)
    v_pk_fma_f32 v[128:129], v[32:33], v[56:57], v[128:129] op_sel_hi:[1,0,1]
    v_pk_fma_f32 v[130:131], v[34:35], v[56:57], v[130:131] op_sel_hi:[1,0,1]
    v_pk_fma_f32 v[144:145], v[36:37], v[56:57], v[144:145] op_sel_hi:[1,0,1]
    v_pk_fma_f32 v[146:147], v[38:39], v[56:57], v[146:147] op_sel_hi:[1,0,1]
    v_pk_fma_f32 v[132:133], v[32:33], v[58:59], v[132:133] op_sel_hi:[1,0,1]
    v_pk_fma_f32 v[134:135], v[34:35], v[58:59], v[134:135] op_sel_hi:[1,0,1]
    v_pk_fma_f32 v[148:149], v[36:37], v[58:59], v[148:149] op_sel_hi:[1,0,1]
    v_pk_fma_f32 v[150:151], v[38:39], v[58:59], v[150:151] op_sel_hi:[1,0,1]
    v_pk_fma_f32 v[128:129], v[128:129], v[28:29], v[112:113] op_sel:[0,0,0] op_sel_hi:[1,0,1]
    v_pk_fma_f32 v[130:131], v[130:131], v[28:29], v[114:115] op_sel:[0,0,0] op_sel_hi:[1,0,1]
    v_pk_fma_f32 v[144:145], v[144:145], v[28:29], v[116:117] op_sel:[0,0,0] op_sel_hi:[1,0,1]
    v_pk_fma_f32 v[146:147], v[146:147], v[28:29], v[118:119] op_sel:[0,0,0] op_sel_hi:[1,0,1]
    v_pk_fma_f32 v[132:133], v[132:133], v[28:29], v[112:113] op_sel:[0,1,0] op_sel_hi:[1,1,1]
    v_pk_fma_f32 v[134:135], v[134:135], v[28:29], v[114:115] op_sel:[0,1,0] op_sel_hi:[1,1,1]
    v_pk_fma_f32 v[148:149], v[148:149], v[28:29], v[116:117] op_sel:[0,1,0] op_sel_hi:[1,1,1]
    v_pk_fma_f32 v[150:151], v[150:151], v[28:29], v[118:119] op_sel:[0,1,0] op_sel_hi:[1,1,1]
    v_pk_mul_f32 v[64:65], v[128:129], v[128:129]
    v_pk_mul_f32 v[66:67], v[130:131], v[130:131]
    v_pk_mul_f32 v[68:69], v[144:145], v[144:145]
    v_pk_mul_f32 v[70:71], v[146:147], v[146:147]
    v_pk_mul_f32 v[72:73], v[132:133], v[132:133]
    v_pk_mul_f32 v[74:75], v[134:135], v[134:135]
    v_pk_mul_f32 v[76:77], v[148:149], v[148:149]
    v_pk_mul_f32 v[78:79], v[150:151], v[150:151]
    v_pk_fma_f32 v[64:65], v[64:65], v[48:49], v[48:49] op_sel:[0,0,1] op_sel_hi:[1,0,1]
    v_pk_fma_f32 v[66:67], v[66:67], v[48:49], v[48:49] op_sel:[0,0,1] op_sel_hi:[1,0,1]
    v_pk_fma_f32 v[68:69], v[68:69], v[48:49], v[48:49] op_sel:[0,0,1] op_sel_hi:[1,0,1]
    v_pk_fma_f32 v[70:71], v[70:71], v[48:49], v[48:49] op_sel:[0,0,1] op_sel_hi:[1,0,1]
    v_pk_fma_f32 v[72:73], v[72:73], v[48:49], v[48:49] op_sel:[0,0,1] op_sel_hi:[1,0,1]
    v_pk_fma_f32 v[74:75], v[74:75], v[48:49], v[48:49] op_sel:[0,0,1] op_sel_hi:[1,0,1]
    v_pk_fma_f32 v[76:77], v[76:77], v[48:49], v[48:49] op_sel:[0,0,1] op_sel_hi:[1,0,1]
    v_pk_fma_f32 v[78:79], v[78:79], v[48:49], v[48:49] op_sel:[0,0,1] op_sel_hi:[1,0,1]
    v_pk_mul_f32 v[64:65], v[64:65], v[128:129]
    v_pk_mul_f32 v[66:67], v[66:67], v[130:131]
    v_pk_mul_f32 v[68:69], v[68:69], v[144:145]
    v_pk_mul_f32 v[70:71], v[70:71], v[146:147]
    v_pk_mul_f32 v[72:73], v[72:73], v[132:133]
    v_pk_mul_f32 v[74:75], v[74:75], v[134:135]
    v_pk_mul_f32 v[76:77], v[76:77], v[148:149]
    v_pk_mul_f32 v[78:79], v[78:79], v[150:151]
    v_exp_f32 v64, v64
    v_exp_f32 v65, v65
    v_exp_f32 v66, v66
    v_exp_f32 v67, v67
    v_exp_f32 v68, v68
    v_exp_f32 v69, v69
    v_exp_f32 v70, v70
    v_exp_f32 v71, v71
    v_exp_f32 v72, v72
    v_exp_f32 v73, v73
    v_exp_f32 v74, v74
    v_exp_f32 v75, v75
    v_exp_f32 v76, v76
    v_exp_f32 v77, v77
    v_exp_f32 v78, v78
    v_exp_f32 v79, v79
    v_pk_add_f32 v[64:65], v[64:65], 1.0 op_sel_hi:[1,0]
    v_pk_add_f32 v[66:67], v[66:67], 1.0 op_sel_hi:[1,0]
    v_pk_add_f32 v[68:69], v[68:69], 1.0 op_sel_hi:[1,0]
    v_pk_add_f32 v[70:71], v[70:71], 1.0 op_sel_hi:[1,0]
    v_pk_add_f32 v[72:73], v[72:73], 1.0 op_sel_hi:[1,0]
    v_pk_add_f32 v[74:75], v[74:75], 1.0 op_sel_hi:[1,0]
    v_pk_add_f32 v[76:77], v[76:77], 1.0 op_sel_hi:[1,0]
    v_pk_add_f32 v[78:79], v[78:79], 1.0 op_sel_hi:[1,0]
    v_rcp_f32 v64, v64
    v_rcp_f32 v65, v65
    v_rcp_f32 v66, v66
L1_pa4:
    s_cbranch_execz L1_pc2
    v_rcp_f32 v67, v67
    v_rcp_f32 v68, v68
    v_rcp_f32 v69, v69
    v_rcp_f32 v70, v70
    v_rcp_f32 v71, v71
    v_rcp_f32 v72, v72
    v_rcp_f32 v73, v73
    v_rcp_f32 v74, v74
    v_rcp_f32 v75, v75
    v_rcp_f32 v76, v76
    v_rcp_f32 v77, v77
    v_rcp_f32 v78, v78
    v_rcp_f32 v79, v79
    v_pk_mul_f32 v[64:65], v[64:65], v[128:129]
    v_pk_mul_f32 v[66:67], v[66:67], v[130:131]
    v_pk_mul_f32 v[68:69], v[68:69], v[144:145]
    v_pk_mul_f32 v[70:71], v[70:71], v[146:147]
    v_pk_mul_f32 v[72:73], v[72:73], v[132:133]
    v_pk_mul_f32 v[74:75], v[74:75], v[134:135]
    v_pk_mul_f32 v[76:77], v[76:77], v[148:149]
    v_pk_mul_f32 v[78:79], v[78:79], v[150:151]
    v_cvt_pk_bf16_f32 v128, v64, v65
    v_cvt_pk_bf16_f32 v129, v66, v67
    v_cvt_pk_bf16_f32 v130, v68, v69
    v_cvt_pk_bf16_f32 v131, v70, v71
    buffer_store_dwordx4 v[128:131], v1, s[36:39], s72 offen offset:0 sc1
    v_cvt_pk_bf16_f32 v132, v72, v73
    v_cvt_pk_bf16_f32 v133, v74, v75
    v_cvt_pk_bf16_f32 v134, v76, v77
    v_cvt_pk_bf16_f32 v135, v78, v79
    buffer_store_dwordx4 v[132:135], v1, s[36:39], s72 offen offset:1024 sc1
    v_pk_fma_f32 v[136:137], v[32:33], v[60:61], v[136:137] op_sel_hi:[1,0,1]
    v_pk_fma_f32 v[138:139], v[34:35], v[60:61], v[138:139] op_sel_hi:[1,0,1]
    v_pk_fma_f32 v[152:153], v[36:37], v[60:61], v[152:153] op_sel_hi:[1,0,1]
    v_pk_fma_f32 v[154:155], v[38:39], v[60:61], v[154:155] op_sel_hi:[1,0,1]
    v_pk_fma_f32 v[140:141], v[32:33], v[62:63], v[140:141] op_sel_hi:[1,0,1]
    v_pk_fma_f32 v[142:143], v[34:35], v[62:63], v[142:143] op_sel_hi:[1,0,1]
    v_pk_fma_f32 v[156:157], v[36:37], v[62:63], v[156:157] op_sel_hi:[1,0,1]
    v_pk_fma_f32 v[158:159], v[38:39], v[62:63], v[158:159] op_sel_hi:[1,0,1]
    v_pk_fma_f32 v[136:137], v[136:137], v[30:31], v[112:113] op_sel:[0,0,0] op_sel_hi:[1,0,1]
    v_pk_fma_f32 v[138:139], v[138:139], v[30:31], v[114:115] op_sel:[0,0,0] op_sel_hi:[1,0,1]
    v_pk_fma_f32 v[152:153], v[152:153], v[30:31], v[116:117] op_sel:[0,0,0] op_sel_hi:[1,0,1]
    v_pk_fma_f32 v[154:155], v[154:155], v[30:31], v[118:119] op_sel:[0,0,0] op_sel_hi:[1,0,1]
    v_pk_fma_f32 v[140:141], v[140:141], v[30:31], v[112:113] op_sel:[0,1,0] op_sel_hi:[1,1,1]
    v_pk_fma_f32 v[142:143], v[142:143], v[30:31], v[114:115] op_sel:[0,1,0] op_sel_hi:[1,1,1]
    v_pk_fma_f32 v[156:157], v[156:157], v[30:31], v[116:117] op_sel:[0,1,0] op_sel_hi:[1,1,1]
    v_pk_fma_f32 v[158:159], v[158:159], v[30:31], v[118:119] op_sel:[0,1,0] op_sel_hi:[1,1,1]
    v_pk_mul_f32 v[80:81], v[136:137], v[136:137]
    v_pk_mul_f32 v[82:83], v[138:139], v[138:139]
    v_pk_mul_f32 v[84:85], v[152:153], v[152:153]
    v_pk_mul_f32 v[86:87], v[154:155], v[154:155]
    v_pk_mul_f32 v[88:89], v[140:141], v[140:141]
    v_pk_mul_f32 v[90:91], v[142:143], v[142:143]
    v_pk_mul_f32 v[92:93], v[156:157], v[156:157]
    v_pk_mul_f32 v[94:95], v[158:159], v[158:159]
    v_pk_fma_f32 v[80:81], v[80:81], v[48:49], v[48:49] op_sel:[0,0,1] op_sel_hi:[1,0,1]
    v_pk_fma_f32 v[82:83], v[82:83], v[48:49], v[48:49] op_sel:[0,0,1] op_sel_hi:[1,0,1]
    v_pk_fma_f32 v[84:85], v[84:85], v[48:49], v[48:49] op_sel:[0,0,1] op_sel_hi:[1,0,1]
    v_pk_fma_f32 v[86:87], v[86:87], v[48:49], v[48:49] op_sel:[0,0,1] op_sel_hi:[1,0,1]
    v_pk_fma_f32 v[88:89], v[88:89], v[48:49], v[48:49] op_sel:[0,0,1] op_sel_hi:[1,0,1]
    v_pk_fma_f32 v[90:91], v[90:91], v[48:49], v[48:49] op_sel:[0,0,1] op_sel_hi:[1,0,1]
    v_pk_fma_f32 v[92:93], v[92:93], v[48:49], v[48:49] op_sel:[0,0,1] op_sel_hi:[1,0,1]
    v_pk_fma_f32 v[94:95], v[94:95], v[48:49], v[48:49] op_sel:[0,0,1] op_sel_hi:[1,0,1]
    v_pk_mul_f32 v[80:81], v[80:81], v[136:137]
    v_pk_mul_f32 v[82:83], v[82:83], v[138:139]
    v_pk_mul_f32 v[84:85], v[84:85], v[152:153]
    v_pk_mul_f32 v[86:87], v[86:87], v[154:155]
    v_pk_mul_f32 v[88:89], v[88:89], v[140:141]
    v_pk_mul_f32 v[90:91], v[90:91], v[142:143]
    v_pk_mul_f32 v[92:93], v[92:93], v[156:157]
    v_pk_mul_f32 v[94:95], v[94:95], v[158:159]
    v_exp_f32 v80, v80
    v_exp_f32 v81, v81
    v_exp_f32 v82, v82
    v_exp_f32 v83, v83
    v_exp_f32 v84, v84
    v_exp_f32 v85, v85
    v_exp_f32 v86, v86
    v_exp_f32 v87, v87
    v_exp_f32 v88, v88
    v_exp_f32 v89, v89
    v_exp_f32 v90, v90
    v_exp_f32 v91, v91
    v_exp_f32 v92, v92
    v_exp_f32 v93, v93
    v_exp_f32 v94, v94
    v_exp_f32 v95, v95
    v_pk_add_f32 v[80:81], v[80:81], 1.0 op_sel_hi:[1,0]
    v_pk_add_f32 v[82:83], v[82:83], 1.0 op_sel_hi:[1,0]
    v_pk_add_f32 v[84:85], v[84:85], 1.0 op_sel_hi:[1,0]
    v_pk_add_f32 v[86:87], v[86:87], 1.0 op_sel_hi:[1,0]
    v_pk_add_f32 v[88:89], v[88:89], 1.0 op_sel_hi:[1,0]
    v_pk_add_f32 v[90:91], v[90:91], 1.0 op_sel_hi:[1,0]
    v_pk_add_f32 v[92:93], v[92:93], 1.0 op_sel_hi:[1,0]
    v_pk_add_f32 v[94:95], v[94:95], 1.0 op_sel_hi:[1,0]
    v_rcp_f32 v80, v80
    v_rcp_f32 v81, v81
    v_rcp_f32 v82, v82
    v_rcp_f32 v83, v83
    v_rcp_f32 v84, v84
    v_rcp_f32 v85, v85
    v_rcp_f32 v86, v86
    v_rcp_f32 v87, v87
    v_rcp_f32 v88, v88
    v_rcp_f32 v89, v89
    v_rcp_f32 v90, v90
    v_rcp_f32 v91, v91
    v_rcp_f32 v92, v92
    v_rcp_f32 v93, v93
    v_rcp_f32 v94, v94
    v_rcp_f32 v95, v95
    v_pk_mul_f32 v[80:81], v[80:81], v[136:137]
    v_pk_mul_f32 v[82:83], v[82:83], v[138:139]
    v_pk_mul_f32 v[84:85], v[84:85], v[152:153]
    v_pk_mul_f32 v[86:87], v[86:87], v[154:155]
    v_pk_mul_f32 v[88:89], v[88:89], v[140:141]
    v_pk_mul_f32 v[90:91], v[90:91], v[142:143]
    v_pk_mul_f32 v[92:93], v[92:93], v[156:157]
    v_pk_mul_f32 v[94:95], v[94:95], v[158:159]
    v_cvt_pk_bf16_f32 v136, v80, v81
    v_cvt_pk_bf16_f32 v137, v82, v83
    v_cvt_pk_bf16_f32 v138, v84, v85
    v_cvt_pk_bf16_f32 v139, v86, v87
    buffer_store_dwordx4 v[136:139], v1, s[36:39], s72 offen offset:2048 sc1
    v_cvt_pk_bf16_f32 v140, v88, v89
    v_cvt_pk_bf16_f32 v141, v90, v91
    v_cvt_pk_bf16_f32 v142, v92, v93
    v_cvt_pk_bf16_f32 v143, v94, v95
    buffer_store_dwordx4 v[140:143], v1, s[36:39], s72 offen offset:3072 sc1
    v_pk_fma_f32 v[160:161], v[40:41], v[56:57], v[160:161] op_sel_hi:[1,0,1]
    v_pk_fma_f32 v[162:163], v[42:43], v[56:57], v[162:163] op_sel_hi:[1,0,1]
    v_pk_fma_f32 v[176:177], v[44:45], v[56:57], v[176:177] op_sel_hi:[1,0,1]
    v_pk_fma_f32 v[178:179], v[46:47], v[56:57], v[178:179] op_sel_hi:[1,0,1]
    v_pk_fma_f32 v[164:165], v[40:41], v[58:59], v[164:165] op_sel_hi:[1,0,1]
    v_pk_fma_f32 v[166:167], v[42:43], v[58:59], v[166:167] op_sel_hi:[1,0,1]
    v_pk_fma_f32 v[180:181], v[44:45], v[58:59], v[180:181] op_sel_hi:[1,0,1]
    v_pk_fma_f32 v[182:183], v[46:47], v[58:59], v[182:183] op_sel_hi:[1,0,1]
    v_pk_fma_f32 v[160:161], v[160:161], v[28:29], v[120:121] op_sel:[0,0,0] op_sel_hi:[1,0,1]
    v_pk_fma_f32 v[162:163], v[162:163], v[28:29], v[122:123] op_sel:[0,0,0] op_sel_hi:[1,0,1]
    v_pk_fma_f32 v[176:177], v[176:177], v[28:29], v[124:125] op_sel:[0,0,0] op_sel_hi:[1,0,1]
    v_pk_fma_f32 v[178:179], v[178:179], v[28:29], v[126:127] op_sel:[0,0,0] op_sel_hi:[1,0,1]
    v_pk_fma_f32 v[164:165], v[164:165], v[28:29], v[120:121] op_sel:[0,1,0] op_sel_hi:[1,1,1]
    v_pk_fma_f32 v[166:167], v[166:167], v[28:29], v[122:123] op_sel:[0,1,0] op_sel_hi:[1,1,1]
    v_pk_fma_f32 v[180:181], v[180:181], v[28:29], v[124:125] op_sel:[0,1,0] op_sel_hi:[1,1,1]
    v_pk_fma_f32 v[182:183], v[182:183], v[28:29], v[126:127] op_sel:[0,1,0] op_sel_hi:[1,1,1]
    v_pk_mul_f32 v[96:97], v[160:161], v[160:161]
    v_pk_mul_f32 v[98:99], v[162:163], v[162:163]
    v_pk_mul_f32 v[100:101], v[176:177], v[176:177]
    v_pk_mul_f32 v[102:103], v[178:179], v[178:179]
    v_pk_mul_f32 v[104:105], v[164:165], v[164:165]
    v_pk_mul_f32 v[106:107], v[166:167], v[166:167]
    v_pk_mul_f32 v[108:109], v[180:181], v[180:181]
    v_pk_mul_f32 v[110:111], v[182:183], v[182:183]
    v_pk_fma_f32 v[96:97], v[96:97], v[48:49], v[48:49] op_sel:[0,0,1] op_sel_hi:[1,0,1]
    v_pk_fma_f32 v[98:99], v[98:99], v[48:49], v[48:49] op_sel:[0,0,1] op_sel_hi:[1,0,1]
    v_pk_fma_f32 v[100:101], v[100:101], v[48:49], v[48:49] op_sel:[0,0,1] op_sel_hi:[1,0,1]
    v_pk_fma_f32 v[102:103], v[102:103], v[48:49], v[48:49] op_sel:[0,0,1] op_sel_hi:[1,0,1]
    v_pk_fma_f32 v[104:105], v[104:105], v[48:49], v[48:49] op_sel:[0,0,1] op_sel_hi:[1,0,1]
    v_pk_fma_f32 v[106:107], v[106:107], v[48:49], v[48:49] op_sel:[0,0,1] op_sel_hi:[1,0,1]
    v_pk_fma_f32 v[108:109], v[108:109], v[48:49], v[48:49] op_sel:[0,0,1] op_sel_hi:[1,0,1]
    v_pk_fma_f32 v[110:111], v[110:111], v[48:49], v[48:49] op_sel:[0,0,1] op_sel_hi:[1,0,1]
    v_pk_mul_f32 v[96:97], v[96:97], v[160:161]
    v_pk_mul_f32 v[98:99], v[98:99], v[162:163]
    v_pk_mul_f32 v[100:101], v[100:101], v[176:177]
    v_pk_mul_f32 v[102:103], v[102:103], v[178:179]
    v_pk_mul_f32 v[104:105], v[104:105], v[164:165]
    v_pk_mul_f32 v[106:107], v[106:107], v[166:167]
    v_pk_mul_f32 v[108:109], v[108:109], v[180:181]
    v_pk_mul_f32 v[110:111], v[110:111], v[182:183]
    v_exp_f32 v96, v96
    v_exp_f32 v97, v97
    v_exp_f32 v98, v98
    v_exp_f32 v99, v99
    v_exp_f32 v100, v100
    v_exp_f32 v101, v101
    v_exp_f32 v102, v102
    v_exp_f32 v103, v103
    v_exp_f32 v104, v104
    v_exp_f32 v105, v105
    v_exp_f32 v106, v106
    v_exp_f32 v107, v107
    v_exp_f32 v108, v108
    v_exp_f32 v109, v109
    v_exp_f32 v110, v110
    v_exp_f32 v111, v111
    v_pk_add_f32 v[96:97], v[96:97], 1.0 op_sel_hi:[1,0]
    v_pk_add_f32 v[98:99], v[98:99], 1.0 op_sel_hi:[1,0]
    v_pk_add_f32 v[100:101], v[100:101], 1.0 op_sel_hi:[1,0]
    v_pk_add_f32 v[102:103], v[102:103], 1.0 op_sel_hi:[1,0]
    v_pk_add_f32 v[104:105], v[104:105], 1.0 op_sel_hi:[1,0]
    v_pk_add_f32 v[106:107], v[106:107], 1.0 op_sel_hi:[1,0]
    v_pk_add_f32 v[108:109], v[108:109], 1.0 op_sel_hi:[1,0]
    v_pk_add_f32 v[110:111], v[110:111], 1.0 op_sel_hi:[1,0]
    v_rcp_f32 v96, v96
    v_rcp_f32 v97, v97
    v_rcp_f32 v98, v98
    v_rcp_f32 v99, v99
    v_rcp_f32 v100, v100
    v_rcp_f32 v101, v101
    v_rcp_f32 v102, v102
    v_rcp_f32 v103, v103
    v_rcp_f32 v104, v104
    v_rcp_f32 v105, v105
    v_rcp_f32 v106, v106
    v_rcp_f32 v107, v107
    v_rcp_f32 v108, v108
    v_rcp_f32 v109, v109
    v_rcp_f32 v110, v110
    v_rcp_f32 v111, v111
    v_pk_mul_f32 v[96:97], v[96:97], v[160:161]
    v_pk_mul_f32 v[98:99], v[98:99], v[162:163]
    v_pk_mul_f32 v[100:101], v[100:101], v[176:177]
    v_pk_mul_f32 v[102:103], v[102:103], v[178:179]
    v_pk_mul_f32 v[104:105], v[104:105], v[164:165]
    v_pk_mul_f32 v[106:107], v[106:107], v[166:167]
    v_pk_mul_f32 v[108:109], v[108:109], v[180:181]
    v_pk_mul_f32 v[110:111], v[110:111], v[182:183]
    v_cvt_pk_bf16_f32 v160, v96, v97
    v_cvt_pk_bf16_f32 v161, v98, v99
    v_cvt_pk_bf16_f32 v162, v100, v101
    v_cvt_pk_bf16_f32 v163, v102, v103
    buffer_store_dwordx4 v[160:163], v1, s[36:39], s74 offen offset:0 sc1
    v_cvt_pk_bf16_f32 v164, v104, v105
    v_cvt_pk_bf16_f32 v165, v106, v107
    v_cvt_pk_bf16_f32 v166, v108, v109
    v_cvt_pk_bf16_f32 v167, v110, v111
    buffer_store_dwordx4 v[164:167], v1, s[36:39], s74 offen offset:1024 sc1
    v_pk_fma_f32 v[168:169], v[40:41], v[60:61], v[168:169] op_sel_hi:[1,0,1]
    v_pk_fma_f32 v[170:171], v[42:43], v[60:61], v[170:171] op_sel_hi:[1,0,1]
    v_pk_fma_f32 v[184:185], v[44:45], v[60:61], v[184:185] op_sel_hi:[1,0,1]
    v_pk_fma_f32 v[186:187], v[46:47], v[60:61], v[186:187] op_sel_hi:[1,0,1]
    v_pk_fma_f32 v[172:173], v[40:41], v[62:63], v[172:173] op_sel_hi:[1,0,1]
    v_pk_fma_f32 v[174:175], v[42:43], v[62:63], v[174:175] op_sel_hi:[1,0,1]
    v_pk_fma_f32 v[188:189], v[44:45], v[62:63], v[188:189] op_sel_hi:[1,0,1]
    v_pk_fma_f32 v[190:191], v[46:47], v[62:63], v[190:191] op_sel_hi:[1,0,1]
    v_pk_fma_f32 v[168:169], v[168:169], v[30:31], v[120:121] op_sel:[0,0,0] op_sel_hi:[1,0,1]
    v_pk_fma_f32 v[170:171], v[170:171], v[30:31], v[122:123] op_sel:[0,0,0] op_sel_hi:[1,0,1]
    v_pk_fma_f32 v[184:185], v[184:185], v[30:31], v[124:125] op_sel:[0,0,0] op_sel_hi:[1,0,1]
    v_pk_fma_f32 v[186:187], v[186:187], v[30:31], v[126:127] op_sel:[0,0,0] op_sel_hi:[1,0,1]
    v_pk_fma_f32 v[172:173], v[172:173], v[30:31], v[120:121] op_sel:[0,1,0] op_sel_hi:[1,1,1]
    v_pk_fma_f32 v[174:175], v[174:175], v[30:31], v[122:123] op_sel:[0,1,0] op_sel_hi:[1,1,1]
    v_pk_fma_f32 v[188:189], v[188:189], v[30:31], v[124:125] op_sel:[0,1,0] op_sel_hi:[1,1,1]
    v_pk_fma_f32 v[190:191], v[190:191], v[30:31], v[126:127] op_sel:[0,1,0] op_sel_hi:[1,1,1]
    v_pk_mul_f32 v[64:65], v[168:169], v[168:169]
    v_pk_mul_f32 v[66:67], v[170:171], v[170:171]
    v_pk_mul_f32 v[68:69], v[184:185], v[184:185]
    v_pk_mul_f32 v[70:71], v[186:187], v[186:187]
    v_pk_mul_f32 v[72:73], v[172:173], v[172:173]
    v_pk_mul_f32 v[74:75], v[174:175], v[174:175]
    v_pk_mul_f32 v[76:77], v[188:189], v[188:189]
    v_pk_mul_f32 v[78:79], v[190:191], v[190:191]
    v_pk_fma_f32 v[64:65], v[64:65], v[48:49], v[48:49] op_sel:[0,0,1] op_sel_hi:[1,0,1]
    v_pk_fma_f32 v[66:67], v[66:67], v[48:49], v[48:49] op_sel:[0,0,1] op_sel_hi:[1,0,1]
    v_pk_fma_f32 v[68:69], v[68:69], v[48:49], v[48:49] op_sel:[0,0,1] op_sel_hi:[1,0,1]
    v_pk_fma_f32 v[70:71], v[70:71], v[48:49], v[48:49] op_sel:[0,0,1] op_sel_hi:[1,0,1]
    v_pk_fma_f32 v[72:73], v[72:73], v[48:49], v[48:49] op_sel:[0,0,1] op_sel_hi:[1,0,1]
    v_pk_fma_f32 v[74:75], v[74:75], v[48:49], v[48:49] op_sel:[0,0,1] op_sel_hi:[1,0,1]
    v_pk_fma_f32 v[76:77], v[76:77], v[48:49], v[48:49] op_sel:[0,0,1] op_sel_hi:[1,0,1]
    v_pk_fma_f32 v[78:79], v[78:79], v[48:49], v[48:49] op_sel:[0,0,1] op_sel_hi:[1,0,1]
    v_pk_mul_f32 v[64:65], v[64:65], v[168:169]
    v_pk_mul_f32 v[66:67], v[66:67], v[170:171]
    v_pk_mul_f32 v[68:69], v[68:69], v[184:185]
    v_pk_mul_f32 v[70:71], v[70:71], v[186:187]
    v_pk_mul_f32 v[72:73], v[72:73], v[172:173]
    v_pk_mul_f32 v[74:75], v[74:75], v[174:175]
    v_pk_mul_f32 v[76:77], v[76:77], v[188:189]
    v_pk_mul_f32 v[78:79], v[78:79], v[190:191]
    v_exp_f32 v64, v64
    v_exp_f32 v65, v65
    v_exp_f32 v66, v66
    v_exp_f32 v67, v67
    v_exp_f32 v68, v68
    v_exp_f32 v69, v69
    v_exp_f32 v70, v70
    v_exp_f32 v71, v71
    v_exp_f32 v72, v72
    v_exp_f32 v73, v73
    v_exp_f32 v74, v74
    v_exp_f32 v75, v75
    v_exp_f32 v76, v76
    v_exp_f32 v77, v77
    v_exp_f32 v78, v78
    v_exp_f32 v79, v79
    v_pk_add_f32 v[64:65], v[64:65], 1.0 op_sel_hi:[1,0]
    v_pk_add_f32 v[66:67], v[66:67], 1.0 op_sel_hi:[1,0]
    v_pk_add_f32 v[68:69], v[68:69], 1.0 op_sel_hi:[1,0]
    v_pk_add_f32 v[70:71], v[70:71], 1.0 op_sel_hi:[1,0]
    v_pk_add_f32 v[72:73], v[72:73], 1.0 op_sel_hi:[1,0]
    v_pk_add_f32 v[74:75], v[74:75], 1.0 op_sel_hi:[1,0]
    v_pk_add_f32 v[76:77], v[76:77], 1.0 op_sel_hi:[1,0]
    v_pk_add_f32 v[78:79], v[78:79], 1.0 op_sel_hi:[1,0]
    v_rcp_f32 v64, v64
    v_rcp_f32 v65, v65
    v_rcp_f32 v66, v66
    v_rcp_f32 v67, v67
    v_rcp_f32 v68, v68
    v_rcp_f32 v69, v69
    v_rcp_f32 v70, v70
    v_rcp_f32 v71, v71
    v_rcp_f32 v72, v72
    v_rcp_f32 v73, v73
    v_rcp_f32 v74, v74
    v_rcp_f32 v75, v75
    v_rcp_f32 v76, v76
    v_rcp_f32 v77, v77
    v_rcp_f32 v78, v78
    v_rcp_f32 v79, v79
    v_pk_mul_f32 v[64:65], v[64:65], v[168:169]
    v_pk_mul_f32 v[66:67], v[66:67], v[170:171]
    v_pk_mul_f32 v[68:69], v[68:69], v[184:185]
    v_pk_mul_f32 v[70:71], v[70:71], v[186:187]
    v_pk_mul_f32 v[72:73], v[72:73], v[172:173]
    v_pk_mul_f32 v[74:75], v[74:75], v[174:175]
    v_pk_mul_f32 v[76:77], v[76:77], v[188:189]
    v_pk_mul_f32 v[78:79], v[78:79], v[190:191]
    v_cvt_pk_bf16_f32 v168, v64, v65
    v_cvt_pk_bf16_f32 v169, v66, v67
    v_cvt_pk_bf16_f32 v170, v68, v69
    v_cvt_pk_bf16_f32 v171, v70, v71
    buffer_store_dwordx4 v[168:171], v1, s[36:39], s74 offen offset:2048 sc1
    v_cvt_pk_bf16_f32 v172, v72, v73
    v_cvt_pk_bf16_f32 v173, v74, v75
    v_cvt_pk_bf16_f32 v174, v76, v77
    v_cvt_pk_bf16_f32 v175, v78, v79
    buffer_store_dwordx4 v[172:175], v1, s[36:39], s74 offen offset:3072 sc1
    s_branch L1_join
L1_maxpass:
    s_waitcnt vmcnt(0) lgkmcnt(0)
    s_barrier
    v_mov_b32 v48, 0xff800000
    v_mov_b32 v52, 0xff800000
    v_mov_b32 v56, 0xff800000
    v_mov_b32 v60, 0xff800000
    s_mov_b32 s40, 0
    s_mov_b32 m0, s41
L1_fbloop:
    s_nop 0
    buffer_load_dwordx4 v14, s[8:11], s40 offen offset:0 lds
    buffer_load_dwordx4 v15, s[8:11], s40 offen offset:1024 lds
    buffer_load_dwordx4 v16, s[8:11], s40 offen offset:2048 lds
    buffer_load_dwordx4 v17, s[8:11], s40 offen offset:3072 lds
    s_waitcnt vmcnt(0)
    s_barrier
    ds_read_b128 a[192:195], v2 offset:0
    ds_read_b128 a[196:199], v3 offset:0
    ds_read_b128 a[200:203], v4 offset:0
    ds_read_b128 a[204:207], v5 offset:0
    s_waitcnt lgkmcnt(0)
    v_mfma_f32_16x16x32_bf16 v[128:131], a[192:195], v[192:195], 0
    v_mfma_f32_16x16x32_bf16 v[128:131], a[196:199], v[208:211], v[128:131]
    v_mfma_f32_16x16x32_bf16 v[128:131], a[200:203], v[224:227], v[128:131]
    v_mfma_f32_16x16x32_bf16 v[128:131], a[204:207], v[240:243], v[128:131]
    v_mfma_f32_16x16x32_bf16 v[144:147], a[204:207], v[244:247], 0
    v_mfma_f32_16x16x32_bf16 v[144:147], a[200:203], v[228:231], v[144:147]
    v_mfma_f32_16x16x32_bf16 v[144:147], a[196:199], v[212:215], v[144:147]
    v_mfma_f32_16x16x32_bf16 v[144:147], a[192:195], v[196:199], v[144:147]
    v_mfma_f32_16x16x32_bf16 v[160:163], a[192:195], v[200:203], 0
    v_mfma_f32_16x16x32_bf16 v[160:163], a[196:199], v[216:219], v[160:163]
    v_mfma_f32_16x16x32_bf16 v[160:163], a[200:203], v[232:235], v[160:163]
    v_mfma_f32_16x16x32_bf16 v[160:163], a[204:207], v[248:251], v[160:163]
    v_mfma_f32_16x16x32_bf16 v[176:179], a[204:207], v[252:255], 0
    v_mfma_f32_16x16x32_bf16 v[176:179], a[200:203], v[236:239], v[176:179]
    v_mfma_f32_16x16x32_bf16 v[176:179], a[196:199], v[220:223], v[176:179]
    v_mfma_f32_16x16x32_bf16 v[176:179], a[192:195], v[204:207], v[176:179]
    ds_read_b128 a[208:211], v2 offset:4096
    ds_read_b128 a[212:215], v3 offset:4096
    ds_read_b128 a[216:219], v4 offset:4096
    ds_read_b128 a[220:223], v5 offset:4096
    s_waitcnt lgkmcnt(0)
    v_mfma_f32_16x16x32_bf16 v[64:67], a[208:211], v[192:195], 0
    v_mfma_f32_16x16x32_bf16 v[64:67], a[212:215], v[208:211], v[64:67]
    v_mfma_f32_16x16x32_bf16 v[64:67], a[216:219], v[224:227], v[64:67]
    v_mfma_f32_16x16x32_bf16 v[64:67], a[220:223], v[240:243], v[64:67]
    v_mfma_f32_16x16x32_bf16 v[68:71], a[220:223], v[244:247], 0
    v_mfma_f32_16x16x32_bf16 v[68:71], a[216:219], v[228:231], v[68:71]
    v_mfma_f32_16x16x32_bf16 v[68:71], a[212:215], v[212:215], v[68:71]
    v_mfma_f32_16x16x32_bf16 v[68:71], a[208:211], v[196:199], v[68:71]
    v_mfma_f32_16x16x32_bf16 v[72:75], a[208:211], v[200:203], 0
    v_mfma_f32_16x16x32_bf16 v[72:75], a[212:215], v[216:219], v[72:75]
    v_mfma_f32_16x16x32_bf16 v[72:75], a[216:219], v[232:235], v[72:75]
    v_mfma_f32_16x16x32_bf16 v[72:75], a[220:223], v[248:251], v[72:75]
    v_mfma_f32_16x16x32_bf16 v[76:79], a[220:223], v[252:255], 0
    v_mfma_f32_16x16x32_bf16 v[76:79], a[216:219], v[236:239], v[76:79]
    v_mfma_f32_16x16x32_bf16 v[76:79], a[212:215], v[220:223], v[76:79]
    v_mfma_f32_16x16x32_bf16 v[76:79], a[208:211], v[204:207], v[76:79]
    ds_read_b128 a[224:227], v2 offset:8192
    ds_read_b128 a[228:231], v3 offset:8192
    ds_read_b128 a[232:235], v4 offset:8192
    ds_read_b128 a[236:239], v5 offset:8192
    s_waitcnt lgkmcnt(0)
    v_mfma_f32_16x16x32_bf16 v[132:135], a[224:227], v[192:195], 0
    v_mfma_f32_16x16x32_bf16 v[132:135], a[228:231], v[208:211], v[132:135]
    v_mfma_f32_16x16x32_bf16 v[132:135], a[232:235], v[224:227], v[132:135]
    v_mfma_f32_16x16x32_bf16 v[132:135], a[236:239], v[240:243], v[132:135]
    v_mfma_f32_16x16x32_bf16 v[148:151], a[236:239], v[244:247], 0
    v_mfma_f32_16x16x32_bf16 v[148:151], a[232:235], v[228:231], v[148:151]
    v_mfma_f32_16x16x32_bf16 v[148:151], a[228:231], v[212:215], v[148:151]
    v_mfma_f32_16x16x32_bf16 v[148:151], a[224:227], v[196:199], v[148:151]
    v_mfma_f32_16x16x32_bf16 v[164:167], a[224:227], v[200:203], 0
    v_mfma_f32_16x16x32_bf16 v[164:167], a[228:231], v[216:219], v[164:167]
    v_mfma_f32_16x16x32_bf16 v[164:167], a[232:235], v[232:235], v[164:167]
    v_mfma_f32_16x16x32_bf16 v[164:167], a[236:239], v[248:251], v[164:167]
    v_mfma_f32_16x16x32_bf16 v[180:183], a[236:239], v[252:255], 0
    v_mfma_f32_16x16x32_bf16 v[180:183], a[232:235], v[236:239], v[180:183]
    v_mfma_f32_16x16x32_bf16 v[180:183], a[228:231], v[220:223], v[180:183]
    v_mfma_f32_16x16x32_bf16 v[180:183], a[224:227], v[204:207], v[180:183]
    ds_read_b128 a[240:243], v2 offset:12288
    ds_read_b128 a[244:247], v3 offset:12288
    ds_read_b128 a[248:251], v4 offset:12288
    ds_read_b128 a[252:255], v5 offset:12288
    s_waitcnt lgkmcnt(0)
    v_mfma_f32_16x16x32_bf16 v[80:83], a[240:243], v[192:195], 0
    v_mfma_f32_16x16x32_bf16 v[80:83], a[244:247], v[208:211], v[80:83]
    v_mfma_f32_16x16x32_bf16 v[80:83], a[248:251], v[224:227], v[80:83]
    v_mfma_f32_16x16x32_bf16 v[80:83], a[252:255], v[240:243], v[80:83]
    v_mfma_f32_16x16x32_bf16 v[84:87], a[252:255], v[244:247], 0
    v_mfma_f32_16x16x32_bf16 v[84:87], a[248:251], v[228:231], v[84:87]
    v_mfma_f32_16x16x32_bf16 v[84:87], a[244:247], v[212:215], v[84:87]
    v_mfma_f32_16x16x32_bf16 v[84:87], a[240:243], v[196:199], v[84:87]
    v_mfma_f32_16x16x32_bf16 v[88:91], a[240:243], v[200:203], 0
    v_mfma_f32_16x16x32_bf16 v[88:91], a[244:247], v[216:219], v[88:91]
    v_mfma_f32_16x16x32_bf16 v[88:91], a[248:251], v[232:235], v[88:91]
    v_mfma_f32_16x16x32_bf16 v[88:91], a[252:255], v[248:251], v[88:91]
    v_mfma_f32_16x16x32_bf16 v[92:95], a[252:255], v[252:255], 0
    v_mfma_f32_16x16x32_bf16 v[92:95], a[248:251], v[236:239], v[92:95]
    v_mfma_f32_16x16x32_bf16 v[92:95], a[244:247], v[220:223], v[92:95]
    v_mfma_f32_16x16x32_bf16 v[92:95], a[240:243], v[204:207], v[92:95]
    s_barrier
    s_nop 7
    v_max3_f32 v48, v48, v128, v129
    v_max3_f32 v48, v48, v130, v131
    v_max3_f32 v52, v52, v144, v145
    v_max3_f32 v52, v52, v146, v147
    v_max3_f32 v56, v56, v160, v161
    v_max3_f32 v56, v56, v162, v163
    v_max3_f32 v60, v60, v176, v177
    v_max3_f32 v60, v60, v178, v179
    v_max3_f32 v48, v48, v64, v65
    v_max3_f32 v48, v48, v66, v67
    v_max3_f32 v52, v52, v68, v69
    v_max3_f32 v52, v52, v70, v71
    v_max3_f32 v56, v56, v72, v73
    v_max3_f32 v56, v56, v74, v75
    v_max3_f32 v60, v60, v76, v77
    v_max3_f32 v60, v60, v78, v79
    v_max3_f32 v48, v48, v132, v133
    v_max3_f32 v48, v48, v134, v135
    v_max3_f32 v52, v52, v148, v149
    v_max3_f32 v52, v52, v150, v151
    v_max3_f32 v56, v56, v164, v165
    v_max3_f32 v56, v56, v166, v167
    v_max3_f32 v60, v60, v180, v181
    v_max3_f32 v60, v60, v182, v183
    v_max3_f32 v48, v48, v80, v81
    v_max3_f32 v48, v48, v82, v83
    v_max3_f32 v52, v52, v84, v85
    v_max3_f32 v52, v52, v86, v87
    v_max3_f32 v56, v56, v88, v89
    v_max3_f32 v56, v56, v90, v91
    v_max3_f32 v60, v60, v92, v93
    v_max3_f32 v60, v60, v94, v95
    s_add_u32 s40, s40, 16384
    s_cmp_lt_u32 s40, 524288
    s_cbranch_scc1 L1_fbloop
    v_mov_b32 v49, v48
    v_mov_b32 v53, v52
    v_mov_b32 v57, v56
    v_mov_b32 v61, v60
    v_permlane32_swap_b32 v48, v49
    v_permlane32_swap_b32 v52, v53
    v_permlane32_swap_b32 v56, v57
    v_permlane32_swap_b32 v60, v61
    v_max_f32 v48, v48, v49
    v_max_f32 v52, v52, v53
    v_max_f32 v56, v56, v57
    v_max_f32 v60, v60, v61
    v_mov_b32 v49, v48
    v_mov_b32 v53, v52
    v_mov_b32 v57, v56
    v_mov_b32 v61, v60
    v_permlane16_swap_b32 v48, v49
    v_permlane16_swap_b32 v52, v53
    v_permlane16_swap_b32 v56, v57
    v_permlane16_swap_b32 v60, v61
    v_max_f32 v48, v48, v49
    v_max_f32 v52, v52, v53
    v_max_f32 v56, v56, v57
    v_max_f32 v60, v60, v61
    v_sub_f32 v32, 0x80000000, v48
    v_sub_f32 v33, 0x80000000, v48
    v_sub_f32 v34, 0x80000000, v48
    v_sub_f32 v35, 0x80000000, v48
    v_sub_f32 v36, 0x80000000, v52
    v_sub_f32 v37, 0x80000000, v52
    v_sub_f32 v38, 0x80000000, v52
    v_sub_f32 v39, 0x80000000, v52
    v_sub_f32 v40, 0x80000000, v56
    v_sub_f32 v41, 0x80000000, v56
    v_sub_f32 v42, 0x80000000, v56
    v_sub_f32 v43, 0x80000000, v56
    v_sub_f32 v44, 0x80000000, v60
    v_sub_f32 v45, 0x80000000, v60
    v_sub_f32 v46, 0x80000000, v60
    v_sub_f32 v47, 0x80000000, v60
    s_mov_b32 s40, 0
    s_nop 0
    buffer_load_dwordx4 v14, s[8:11], s40 offen offset:0 lds
    buffer_load_dwordx4 v15, s[8:11], s40 offen offset:1024 lds
    buffer_load_dwordx4 v16, s[8:11], s40 offen offset:2048 lds
    buffer_load_dwordx4 v17, s[8:11], s40 offen offset:3072 lds
    s_waitcnt vmcnt(0)
    s_barrier
    ds_read_b128 a[192:195], v2 offset:0
    ds_read_b128 a[196:199], v3 offset:0
    ds_read_b128 a[200:203], v4 offset:0
    ds_read_b128 a[204:207], v5 offset:0
    s_branch L1_attn
L1_fallback:
    s_mov_b32 s46, -1
    s_waitcnt vmcnt(0) lgkmcnt(0)
    s_barrier
    s_lshl_b32 s3, s45, 6
    v_lshrrev_b32 v0, 4, v1
    v_add_u32 v0, s3, v0
    s_nop 7
    s_nop 7
    s_branch L1_top
.p2align 12
L1_bodyb:
L1_pb0:
    s_cbranch_execz L1_pc0
    ds_read_b64_tr_b16 a[192:193], v6 offset:0
    ds_read_b64_tr_b16 a[194:195], v6 offset:4096
    ds_read_b64_tr_b16 a[196:197], v6 offset:8192
    ds_read_b64_tr_b16 a[198:199], v6 offset:12288
    ds_read_b64_tr_b16 a[200:201], v7 offset:0
    ds_read_b64_tr_b16 a[202:203], v7 offset:4096
    ds_read_b64_tr_b16 a[204:205], v7 offset:8192
    ds_read_b64_tr_b16 a[206:207], v7 offset:12288
    ds_read_b64_tr_b16 a[208:209], v8 offset:0
    ds_read_b64_tr_b16 a[210:211], v8 offset:4096
    ds_read_b64_tr_b16 a[212:213], v8 offset:8192
    ds_read_b64_tr_b16 a[214:215], v8 offset:12288
    s_waitcnt lgkmcnt(8)
    v_mfma_f32_16x16x32_bf16 v[192:195], a[192:195], a[128:131], 0
    s_add_u32 m0, s47, 0
    s_xor_b32 s40, s78, 512
    v_mfma_f32_16x16x32_bf16 v[192:195], a[196:199], a[132:135], v[192:195]
    buffer_load_dwordx4 v34, s[20:23], s40 offen offset:0 lds
    v_mfma_f32_16x16x32_bf16 v[196:199], a[196:199], a[140:143], 0
    s_add_u32 s84, s60, 25165824
    s_addc_u32 s85, s61, 0
    v_mfma_f32_16x16x32_bf16 v[196:199], a[192:195], a[136:139], v[196:199]
    s_mov_b32 s86, 13123584
    s_mov_b32 s87, 0x20000
    v_mfma_f32_16x16x32_bf16 v[200:203], a[192:195], a[144:147], 0
    v_bfe_u32 v45, v1, 4, 4
    v_lshlrev_b32 v62, 3, v45
    v_mfma_f32_16x16x32_bf16 v[200:203], a[196:199], a[148:151], v[200:203]
    s_mov_b64 exec, 0xffff
    buffer_store_dwordx2 v[28:29], v62, s[84:87], s67 offen sc1
    s_mov_b64 exec, -1
    v_mfma_f32_16x16x32_bf16 v[204:207], a[196:199], a[156:159], 0
    ds_read_b64_tr_b16 a[216:217], v9 offset:0
    s_lshl_b32 s3, s43, 19
    v_mfma_f32_16x16x32_bf16 v[204:207], a[192:195], a[152:155], v[204:207]
    s_waitcnt lgkmcnt(5)
    s_add_u32 s12, s52, s3
    s_addc_u32 s13, s53, 0
    v_smfmac_f32_16x16x64_bf16 a[232:235], v[24:27], a[192:199], v20
    ds_read_b64_tr_b16 a[218:219], v9 offset:4096
    v_mfma_f32_16x16x32_bf16 v[76:79], a[200:203], a[152:155], 0
    buffer_load_dwordx4 v35, s[20:23], s40 offen offset:1024 lds
    v_mfma_f32_16x16x32_bf16 v[76:79], a[204:207], a[156:159], v[76:79]
    ds_read_b64_tr_b16 a[220:221], v9 offset:8192
    s_mov_b32 s14, 524288
    v_mfma_f32_16x16x32_bf16 v[72:75], a[204:207], a[148:151], 0
    buffer_load_dwordx4 v36, s[20:23], s40 offen offset:2048 lds
    v_mfma_f32_16x16x32_bf16 v[72:75], a[200:203], a[144:147], v[72:75]
    ds_read_b64_tr_b16 a[222:223], v9 offset:12288
    s_mov_b32 s15, 0x20000
    v_mfma_f32_16x16x32_bf16 v[68:71], a[200:203], a[136:139], 0
    s_add_u32 s8, s50, s3
    s_addc_u32 s9, s51, 0
    v_mfma_f32_16x16x32_bf16 v[68:71], a[204:207], a[140:143], v[68:71]
    ds_read_b64_tr_b16 a[224:225], v10 offset:0
    s_mov_b32 s10, 524288
    v_mfma_f32_16x16x32_bf16 v[64:67], a[204:207], a[132:135], 0
    s_mov_b32 s11, 0x20000
    s_mov_b32 s52, s94
    v_mfma_f32_16x16x32_bf16 v[64:67], a[200:203], a[128:131], v[64:67]
    ds_read_b64_tr_b16 a[226:227], v10 offset:4096
    s_mov_b32 s53, s95
    v_smfmac_f32_16x16x64_bf16 a[236:239], v[24:27], a[200:207], v20
    s_waitcnt lgkmcnt(6)
    v_mfma_f32_16x16x32_bf16 v[208:211], a[208:211], a[128:131], 0
    ds_read_b64_tr_b16 a[228:229], v10 offset:8192
    s_mov_b32 s54, 256
    v_mfma_f32_16x16x32_bf16 v[208:211], a[212:215], a[132:135], v[208:211]
    buffer_load_dwordx4 v37, s[20:23], s40 offen offset:3072 lds
    v_mfma_f32_16x16x32_bf16 v[212:215], a[212:215], a[140:143], 0
    ds_read_b64_tr_b16 a[230:231], v10 offset:12288
    s_add_u32 m0, s47, 4096
    v_mfma_f32_16x16x32_bf16 v[212:215], a[208:211], a[136:139], v[212:215]
    s_xor_b32 s40, s78, 33280
    s_mov_b32 s55, 0x20000
    v_mfma_f32_16x16x32_bf16 v[216:219], a[208:211], a[144:147], 0
    ds_read_b64_tr_b16 a[192:193], v60 offset:0
    s_bfe_u32 s4, s2, 0x20001
    v_mfma_f32_16x16x32_bf16 v[216:219], a[212:215], a[148:151], v[216:219]
    buffer_load_dwordx4 v34, s[20:23], s40 offen offset:0 lds
    v_mfma_f32_16x16x32_bf16 v[220:223], a[212:215], a[156:159], 0
    ds_read_b64_tr_b16 a[194:195], v60 offset:2048
    s_lshl_b32 s4, 1, s4
    v_mfma_f32_16x16x32_bf16 v[220:223], a[208:211], a[152:155], v[220:223]
    s_waitcnt lgkmcnt(6)
    v_mov_b32 v21, s4
    v_mfma_f32_16x16x32_bf16 v[92:95], a[216:219], a[152:155], 0
    ds_read_b64_tr_b16 a[196:197], v60 offset:4096
    v_accvgpr_write_b32 a0, 0
    v_mfma_f32_16x16x32_bf16 v[92:95], a[220:223], a[156:159], v[92:95]
    buffer_load_dwordx4 v35, s[20:23], s40 offen offset:1024 lds
    v_mfma_f32_16x16x32_bf16 v[88:91], a[220:223], a[148:151], 0
    ds_read_b64_tr_b16 a[198:199], v60 offset:6144
    v_accvgpr_write_b32 a1, 0
    v_mfma_f32_16x16x32_bf16 v[88:91], a[216:219], a[144:147], v[88:91]
    v_accvgpr_write_b32 a2, 0
    v_accvgpr_write_b32 a3, 0
    v_mfma_f32_16x16x32_bf16 v[84:87], a[216:219], a[136:139], 0
    ds_read_b64_tr_b16 a[200:201], v11 offset:0
    v_accvgpr_write_b32 a4, 0
    v_mfma_f32_16x16x32_bf16 v[84:87], a[220:223], a[140:143], v[84:87]
    ds_read_b64_tr_b16 a[202:203], v11 offset:4096
    v_accvgpr_write_b32 a5, 0
    v_mfma_f32_16x16x32_bf16 v[80:83], a[220:223], a[132:135], 0
    ds_read_b64_tr_b16 a[204:205], v11 offset:8192
    v_accvgpr_write_b32 a6, 0
    v_mfma_f32_16x16x32_bf16 v[80:83], a[216:219], a[128:131], v[80:83]
    ds_read_b64_tr_b16 a[206:207], v11 offset:12288
    s_waitcnt lgkmcnt(8)
    v_mfma_f32_16x16x32_bf16 v[224:227], a[224:227], a[128:131], 0
    ds_read_b64_tr_b16 a[208:209], v12 offset:0
    v_accvgpr_write_b32 a7, 0
    v_mfma_f32_16x16x32_bf16 v[224:227], a[228:231], a[132:135], v[224:227]
    buffer_load_dwordx4 v36, s[20:23], s40 offen offset:2048 lds
    v_mfma_f32_16x16x32_bf16 v[228:231], a[228:231], a[140:143], 0
    ds_read_b64_tr_b16 a[210:211], v12 offset:4096
    v_accvgpr_write_b32 a8, 0
    v_mfma_f32_16x16x32_bf16 v[228:231], a[224:227], a[136:139], v[228:231]
    buffer_load_dwordx4 v37, s[20:23], s40 offen offset:3072 lds
    v_mfma_f32_16x16x32_bf16 v[232:235], a[224:227], a[144:147], 0
    ds_read_b64_tr_b16 a[212:213], v12 offset:8192
    v_accvgpr_write_b32 a9, 0
    v_mfma_f32_16x16x32_bf16 v[232:235], a[228:231], a[148:151], v[232:235]
    ds_read_b64_tr_b16 a[214:215], v12 offset:12288
    v_accvgpr_write_b32 a10, 0
    v_mfma_f32_16x16x32_bf16 v[236:239], a[228:231], a[156:159], 0
    ds_read_b64_tr_b16 a[216:217], v13 offset:0
    s_add_u32 m0, s41, 98304
    v_mfma_f32_16x16x32_bf16 v[236:239], a[224:227], a[152:155], v[236:239]
    s_waitcnt lgkmcnt(9)
    s_waitcnt lgkmcnt(5)
    v_smfmac_f32_16x16x64_bf16 a[240:243], v[24:27], a[192:199], v20
    ds_read_b64_tr_b16 a[218:219], v13 offset:4096
    v_mfma_f32_16x16x32_bf16 v[108:111], a[200:203], a[152:155], 0
    s_xor_b32 s40, s79, 2097152
    v_accvgpr_write_b32 a11, 0
    v_mfma_f32_16x16x32_bf16 v[108:111], a[204:207], a[156:159], v[108:111]
    ds_read_b64_tr_b16 a[220:221], v13 offset:8192
    v_accvgpr_write_b32 a12, 0
    v_mfma_f32_16x16x32_bf16 v[104:107], a[204:207], a[148:151], 0
    buffer_load_dwordx4 v38, s[24:27], s40 offen offset:0 lds
    v_mfma_f32_16x16x32_bf16 v[104:107], a[200:203], a[144:147], v[104:107]
    ds_read_b64_tr_b16 a[222:223], v13 offset:12288
    v_accvgpr_write_b32 a13, 0
    v_mfma_f32_16x16x32_bf16 v[100:103], a[200:203], a[136:139], 0
    ds_read_b64_tr_b16 a[224:225], v56 offset:0
    v_accvgpr_write_b32 a14, 0
    v_mfma_f32_16x16x32_bf16 v[100:103], a[204:207], a[140:143], v[100:103]
    buffer_load_dwordx4 v39, s[24:27], s40 offen offset:1024 lds
    v_mfma_f32_16x16x32_bf16 v[96:99], a[204:207], a[132:135], 0
    ds_read_b64_tr_b16 a[226:227], v56 offset:2048
    s_waitcnt vmcnt(17)
    v_mfma_f32_16x16x32_bf16 v[96:99], a[200:203], a[128:131], v[96:99]
    s_waitcnt lgkmcnt(6)
    ds_read_b128 a[160:163], v32 offset:8192
    v_mfma_f32_16x16x32_bf16 v[240:243], a[208:211], a[128:131], 0
    ds_read_b64_tr_b16 a[228:229], v56 offset:4096
    v_accvgpr_write_b32 a15, 0
    v_mfma_f32_16x16x32_bf16 v[240:243], a[212:215], a[132:135], v[240:243]
    ds_read_b128 a[164:167], v33 offset:8192
    v_accvgpr_write_b32 a16, 0
    v_mfma_f32_16x16x32_bf16 v[244:247], a[212:215], a[140:143], 0
    ds_read_b64_tr_b16 a[230:231], v56 offset:6144
    v_accvgpr_write_b32 a17, 0
    v_mfma_f32_16x16x32_bf16 v[244:247], a[208:211], a[136:139], v[244:247]
    ds_read_b128 a[168:171], v32 offset:10240
    v_accvgpr_write_b32 a18, 0
    v_mfma_f32_16x16x32_bf16 v[248:251], a[208:211], a[144:147], 0
    ds_read_b64_tr_b16 a[192:193], v57 offset:0
    v_accvgpr_write_b32 a19, 0
    v_mfma_f32_16x16x32_bf16 v[248:251], a[212:215], a[148:151], v[248:251]
    ds_read_b128 a[172:175], v33 offset:10240
    v_accvgpr_write_b32 a20, 0
    v_mfma_f32_16x16x32_bf16 v[252:255], a[212:215], a[156:159], 0
    ds_read_b64_tr_b16 a[194:195], v57 offset:2048
    v_accvgpr_write_b32 a21, 0
    v_mfma_f32_16x16x32_bf16 v[252:255], a[208:211], a[152:155], v[252:255]
    s_waitcnt lgkmcnt(10)
    ds_read_b128 a[176:179], v32 offset:12288
    v_mfma_f32_16x16x32_bf16 v[124:127], a[216:219], a[152:155], 0
    ds_read_b64_tr_b16 a[196:197], v57 offset:4096
    v_accvgpr_write_b32 a22, 0
    v_mfma_f32_16x16x32_bf16 v[124:127], a[220:223], a[156:159], v[124:127]
    ds_read_b128 a[180:183], v33 offset:12288
    v_accvgpr_write_b32 a23, 0
    v_mfma_f32_16x16x32_bf16 v[120:123], a[220:223], a[148:151], 0
    ds_read_b64_tr_b16 a[198:199], v57 offset:6144
    v_accvgpr_write_b32 a24, 0
    v_mfma_f32_16x16x32_bf16 v[120:123], a[216:219], a[144:147], v[120:123]
    ds_read_b128 a[184:187], v32 offset:14336
    v_accvgpr_write_b32 a25, 0
    v_mfma_f32_16x16x32_bf16 v[116:119], a[216:219], a[136:139], 0
    ds_read_b128 a[188:191], v33 offset:14336
    v_accvgpr_write_b32 a26, 0
    v_mfma_f32_16x16x32_bf16 v[116:119], a[220:223], a[140:143], v[116:119]
    buffer_load_dwordx4 v40, s[24:27], s40 offen offset:2048 lds
    v_mfma_f32_16x16x32_bf16 v[112:115], a[220:223], a[132:135], 0
    buffer_load_dwordx4 v41, s[24:27], s40 offen offset:3072 lds
    v_mfma_f32_16x16x32_bf16 v[112:115], a[216:219], a[128:131], v[112:115]
    s_waitcnt lgkmcnt(10)
    s_add_u32 m0, s68, 147456
    v_mfma_f32_16x16x32_bf16 v[128:131], a[224:227], a[128:131], 0
    s_xor_b32 s40, s42, 4
    s_mul_i32 s40, s40, 176128
    v_mfma_f32_16x16x32_bf16 v[128:131], a[228:231], a[132:135], v[128:131]
    buffer_load_dwordx4 v42, s[28:31], s40 offen offset:0 lds
    v_mfma_f32_16x16x32_bf16 v[132:135], a[228:231], a[140:143], 0
    buffer_load_dwordx4 v43, s[28:31], s40 offen offset:1024 lds
    v_mfma_f32_16x16x32_bf16 v[132:135], a[224:227], a[136:139], v[132:135]
    s_waitcnt vmcnt(15)
    v_accvgpr_write_b32 a27, 0
    v_mfma_f32_16x16x32_bf16 v[136:139], a[224:227], a[144:147], 0
    s_waitcnt lgkmcnt(2)
    s_barrier
    v_mfma_f32_16x16x32_bf16 v[136:139], a[228:231], a[148:151], v[136:139]
    ds_read_b64_tr_b16 a[200:201], v6 offset:16384
    v_accvgpr_write_b32 a28, 0
    v_mfma_f32_16x16x32_bf16 v[140:143], a[228:231], a[156:159], 0
    ds_read_b64_tr_b16 a[202:203], v6 offset:20480
    v_accvgpr_write_b32 a29, 0
    v_mfma_f32_16x16x32_bf16 v[140:143], a[224:227], a[152:155], v[140:143]
    ds_read_b64_tr_b16 a[204:205], v6 offset:24576
    v_accvgpr_write_b32 a30, 0
    v_mfma_f32_16x16x32_bf16 v[156:159], a[192:195], a[152:155], 0
    ds_read_b64_tr_b16 a[206:207], v6 offset:28672
    v_accvgpr_write_b32 a31, 0
    v_mfma_f32_16x16x32_bf16 v[156:159], a[196:199], a[156:159], v[156:159]
    ds_read_b64_tr_b16 a[208:209], v7 offset:16384
    v_accvgpr_write_b32 a32, 0
    v_mfma_f32_16x16x32_bf16 v[152:155], a[196:199], a[148:151], 0
    v_accvgpr_write_b32 a33, 0
    v_accvgpr_write_b32 a34, 0
    v_mfma_f32_16x16x32_bf16 v[152:155], a[192:195], a[144:147], v[152:155]
    ds_read_b64_tr_b16 a[210:211], v7 offset:20480
    v_accvgpr_write_b32 a35, 0
    v_mfma_f32_16x16x32_bf16 v[148:151], a[192:195], a[136:139], 0
    v_accvgpr_write_b32 a36, 0
    v_accvgpr_write_b32 a37, 0
    v_mfma_f32_16x16x32_bf16 v[148:151], a[196:199], a[140:143], v[148:151]
    ds_read_b64_tr_b16 a[212:213], v7 offset:24576
    s_waitcnt vmcnt(13)
    v_mfma_f32_16x16x32_bf16 v[144:147], a[196:199], a[132:135], 0
    ds_read_b64_tr_b16 a[214:215], v7 offset:28672
    s_waitcnt lgkmcnt(8)
    s_mov_b64 exec, 1
    buffer_atomic_or v21, off, s[52:55], s64
    s_mov_b64 exec, -1
    v_mfma_f32_16x16x32_bf16 v[144:147], a[192:195], a[128:131], v[144:147]
    ds_read_b64_tr_b16 a[216:217], v8 offset:16384
    s_waitcnt lgkmcnt(5)
    v_mfma_f32_16x16x32_bf16 v[192:195], a[200:203], a[160:163], v[192:195]
    s_add_u32 m0, s47, 8192
    s_xor_b32 s40, s78, 768
    v_mfma_f32_16x16x32_bf16 v[192:195], a[204:207], a[164:167], v[192:195]
    ds_read_b64_tr_b16 a[218:219], v8 offset:20480
    s_mov_b32 s32, s58
    v_mfma_f32_16x16x32_bf16 v[196:199], a[204:207], a[172:175], v[196:199]
    buffer_load_dwordx4 v34, s[20:23], s40 offen offset:0 lds
    v_mfma_f32_16x16x32_bf16 v[196:199], a[200:203], a[168:171], v[196:199]
    ds_read_b64_tr_b16 a[220:221], v8 offset:24576
    s_mov_b32 s33, s59
    v_mfma_f32_16x16x32_bf16 v[200:203], a[200:203], a[176:179], v[200:203]
    s_mov_b32 s34, 2752
    s_mov_b32 s35, 0x20000
    v_mfma_f32_16x16x32_bf16 v[200:203], a[204:207], a[180:183], v[200:203]
    ds_read_b64_tr_b16 a[222:223], v8 offset:28672
    v_lshrrev_b32 v44, 8, v1
    v_mfma_f32_16x16x32_bf16 v[204:207], a[204:207], a[188:191], v[204:207]
    ds_read_b64_tr_b16 a[224:225], v9 offset:16384
    v_accvgpr_write_b32 a38, 0
    v_mfma_f32_16x16x32_bf16 v[204:207], a[200:203], a[184:187], v[204:207]
    s_waitcnt lgkmcnt(5)
    v_accvgpr_write_b32 a39, 0
    v_smfmac_f32_16x16x64_bf16 a[232:235], v[24:27], a[200:207], v20
    ds_read_b64_tr_b16 a[226:227], v9 offset:20480
    v_mfma_f32_16x16x32_bf16 v[76:79], a[208:211], a[184:187], v[76:79]
    buffer_load_dwordx4 v35, s[20:23], s40 offen offset:1024 lds
    v_mfma_f32_16x16x32_bf16 v[76:79], a[212:215], a[188:191], v[76:79]
    ds_read_b64_tr_b16 a[228:229], v9 offset:24576
    v_accvgpr_write_b32 a40, 0
    v_mfma_f32_16x16x32_bf16 v[72:75], a[212:215], a[180:183], v[72:75]
    buffer_load_dwordx4 v36, s[20:23], s40 offen offset:2048 lds
    v_mfma_f32_16x16x32_bf16 v[72:75], a[208:211], a[176:179], v[72:75]
    ds_read_b64_tr_b16 a[230:231], v9 offset:28672
    v_accvgpr_write_b32 a41, 0
    v_mfma_f32_16x16x32_bf16 v[68:71], a[208:211], a[168:171], v[68:71]
    s_add_u32 s16, s60, 0
    s_addc_u32 s17, s61, 0
    v_mfma_f32_16x16x32_bf16 v[68:71], a[212:215], a[172:175], v[68:71]
    ds_read_b64_tr_b16 a[192:193], v10 offset:16384
    s_mov_b32 s18, 16777216
    v_mfma_f32_16x16x32_bf16 v[64:67], a[212:215], a[164:167], v[64:67]
    s_mov_b32 s19, 0x20000
    v_accvgpr_write_b32 a42, 0
    v_mfma_f32_16x16x32_bf16 v[64:67], a[208:211], a[160:163], v[64:67]
    ds_read_b64_tr_b16 a[194:195], v10 offset:20480
    v_accvgpr_write_b32 a43, 0
    v_smfmac_f32_16x16x64_bf16 a[236:239], v[24:27], a[208:215], v20
    s_waitcnt lgkmcnt(6)
    v_mfma_f32_16x16x32_bf16 v[208:211], a[216:219], a[160:163], v[208:211]
    ds_read_b64_tr_b16 a[196:197], v10 offset:24576
    v_accvgpr_write_b32 a44, 0
    v_mfma_f32_16x16x32_bf16 v[208:211], a[220:223], a[164:167], v[208:211]
    buffer_load_dwordx4 v37, s[20:23], s40 offen offset:3072 lds
    v_mfma_f32_16x16x32_bf16 v[212:215], a[220:223], a[172:175], v[212:215]
    ds_read_b64_tr_b16 a[198:199], v10 offset:28672
    s_add_u32 m0, s47, 12288
    v_mfma_f32_16x16x32_bf16 v[212:215], a[216:219], a[168:171], v[212:215]
    s_xor_b32 s40, s78, 33536
    v_accvgpr_write_b32 a45, 0
    v_mfma_f32_16x16x32_bf16 v[216:219], a[216:219], a[176:179], v[216:219]
    ds_read_b64_tr_b16 a[200:201], v60 offset:8192
    v_accvgpr_write_b32 a46, 0
    v_mfma_f32_16x16x32_bf16 v[216:219], a[220:223], a[180:183], v[216:219]
    buffer_load_dwordx4 v34, s[20:23], s40 offen offset:0 lds
    v_mfma_f32_16x16x32_bf16 v[220:223], a[220:223], a[188:191], v[220:223]
    ds_read_b64_tr_b16 a[202:203], v60 offset:10240
    v_accvgpr_write_b32 a47, 0
    v_mfma_f32_16x16x32_bf16 v[220:223], a[216:219], a[184:187], v[220:223]
    s_waitcnt lgkmcnt(6)
    v_accvgpr_write_b32 a48, 0
    v_mfma_f32_16x16x32_bf16 v[92:95], a[224:227], a[184:187], v[92:95]
    ds_read_b64_tr_b16 a[204:205], v60 offset:12288
    v_accvgpr_write_b32 a49, 0
    v_mfma_f32_16x16x32_bf16 v[92:95], a[228:231], a[188:191], v[92:95]
    buffer_load_dwordx4 v35, s[20:23], s40 offen offset:1024 lds
    v_mfma_f32_16x16x32_bf16 v[88:91], a[228:231], a[180:183], v[88:91]
    ds_read_b64_tr_b16 a[206:207], v60 offset:14336
    v_accvgpr_write_b32 a50, 0
    v_mfma_f32_16x16x32_bf16 v[88:91], a[224:227], a[176:179], v[88:91]
    s_add_u32 s36, s60, 16777216
    s_addc_u32 s37, s61, 0
    v_mfma_f32_16x16x32_bf16 v[84:87], a[224:227], a[168:171], v[84:87]
    ds_read_b64_tr_b16 a[208:209], v11 offset:16384
    s_mov_b32 s38, 5636096
    v_mfma_f32_16x16x32_bf16 v[84:87], a[228:231], a[172:175], v[84:87]
    ds_read_b64_tr_b16 a[210:211], v11 offset:20480
    s_mov_b32 s39, 0x20000
    v_mfma_f32_16x16x32_bf16 v[80:83], a[228:231], a[164:167], v[80:83]
    ds_read_b64_tr_b16 a[212:213], v11 offset:24576
    s_lshl_b32 s5, s44, 14
    v_mfma_f32_16x16x32_bf16 v[80:83], a[224:227], a[160:163], v[80:83]
    ds_read_b64_tr_b16 a[214:215], v11 offset:28672
    s_waitcnt lgkmcnt(8)
    v_mfma_f32_16x16x32_bf16 v[224:227], a[192:195], a[160:163], v[224:227]
    ds_read_b64_tr_b16 a[216:217], v12 offset:16384
    s_add_u32 s5, s5, s41
    v_mfma_f32_16x16x32_bf16 v[224:227], a[196:199], a[164:167], v[224:227]
    buffer_load_dwordx4 v36, s[20:23], s40 offen offset:2048 lds
    v_mfma_f32_16x16x32_bf16 v[228:231], a[196:199], a[172:175], v[228:231]
    ds_read_b64_tr_b16 a[218:219], v12 offset:20480
    s_lshr_b32 s6, s69, 4
    v_mfma_f32_16x16x32_bf16 v[228:231], a[192:195], a[168:171], v[228:231]
    buffer_load_dwordx4 v37, s[20:23], s40 offen offset:3072 lds
    v_mfma_f32_16x16x32_bf16 v[232:235], a[192:195], a[176:179], v[232:235]
    ds_read_b64_tr_b16 a[220:221], v12 offset:24576
    s_add_u32 s5, s5, s6
    v_mfma_f32_16x16x32_bf16 v[232:235], a[196:199], a[180:183], v[232:235]
    ds_read_b64_tr_b16 a[222:223], v12 offset:28672
    s_lshl_b32 s3, s43, 17
    v_mfma_f32_16x16x32_bf16 v[236:239], a[196:199], a[188:191], v[236:239]
    ds_read_b64_tr_b16 a[224:225], v13 offset:16384
    s_add_u32 m0, s41, 65536
    v_mfma_f32_16x16x32_bf16 v[236:239], a[192:195], a[184:187], v[236:239]
    s_waitcnt lgkmcnt(9)
    s_waitcnt lgkmcnt(5)
    v_smfmac_f32_16x16x64_bf16 a[240:243], v[24:27], a[200:207], v20
    ds_read_b64_tr_b16 a[226:227], v13 offset:20480
    v_mfma_f32_16x16x32_bf16 v[108:111], a[208:211], a[184:187], v[108:111]
    s_xor_b32 s40, s79, 3145728
    s_add_u32 s72, s3, s5
    v_mfma_f32_16x16x32_bf16 v[108:111], a[212:215], a[188:191], v[108:111]
    ds_read_b64_tr_b16 a[228:229], v13 offset:24576
    s_xor_b32 s73, s72, 2048
    v_mfma_f32_16x16x32_bf16 v[104:107], a[212:215], a[180:183], v[104:107]
    buffer_load_dwordx4 v38, s[24:27], s40 offen offset:0 lds
    v_mfma_f32_16x16x32_bf16 v[104:107], a[208:211], a[176:179], v[104:107]
    ds_read_b64_tr_b16 a[230:231], v13 offset:28672
    s_lshl_b32 s3, s70, 17
    v_mfma_f32_16x16x32_bf16 v[100:103], a[208:211], a[168:171], v[100:103]
    ds_read_b64_tr_b16 a[192:193], v56 offset:8192
    s_add_u32 s74, s3, s5
    v_mfma_f32_16x16x32_bf16 v[100:103], a[212:215], a[172:175], v[100:103]
    buffer_load_dwordx4 v39, s[24:27], s40 offen offset:1024 lds
    v_mfma_f32_16x16x32_bf16 v[96:99], a[212:215], a[164:167], v[96:99]
    ds_read_b64_tr_b16 a[194:195], v56 offset:10240
    s_waitcnt vmcnt(17)
    v_mfma_f32_16x16x32_bf16 v[96:99], a[208:211], a[160:163], v[96:99]
    s_waitcnt lgkmcnt(6)
    ds_read_b128 a[128:131], v32 offset:0
    v_mfma_f32_16x16x32_bf16 v[240:243], a[216:219], a[160:163], v[240:243]
    ds_read_b64_tr_b16 a[196:197], v56 offset:12288
    s_lshl_b32 s70, s2, 11
    v_mfma_f32_16x16x32_bf16 v[240:243], a[220:223], a[164:167], v[240:243]
    ds_read_b128 a[132:135], v33 offset:0
    s_lshl_b32 s3, s45, 9
    v_mfma_f32_16x16x32_bf16 v[244:247], a[220:223], a[172:175], v[244:247]
    ds_read_b64_tr_b16 a[198:199], v56 offset:14336
    s_add_u32 s70, s70, s3
    v_mfma_f32_16x16x32_bf16 v[244:247], a[216:219], a[168:171], v[244:247]
    ds_read_b128 a[136:139], v32 offset:2048
    s_add_u32 s70, s70, 12582912
    v_mfma_f32_16x16x32_bf16 v[248:251], a[216:219], a[176:179], v[248:251]
    ds_read_b64_tr_b16 a[200:201], v57 offset:8192
    s_lshl_b32 s3, s45, 2
    v_mfma_f32_16x16x32_bf16 v[248:251], a[220:223], a[180:183], v[248:251]
    ds_read_b128 a[140:143], v33 offset:2048
    s_lshl_b32 s5, s44, 21
    v_mfma_f32_16x16x32_bf16 v[252:255], a[220:223], a[188:191], v[252:255]
    ds_read_b64_tr_b16 a[202:203], v57 offset:10240
    s_lshl_b32 s6, s45, 19
    v_mfma_f32_16x16x32_bf16 v[252:255], a[216:219], a[184:187], v[252:255]
    s_waitcnt lgkmcnt(10)
    ds_read_b128 a[144:147], v32 offset:4096
    v_mfma_f32_16x16x32_bf16 v[124:127], a[224:227], a[184:187], v[124:127]
    ds_read_b64_tr_b16 a[204:205], v57 offset:12288
    s_add_u32 s5, s5, s6
    v_mfma_f32_16x16x32_bf16 v[124:127], a[228:231], a[188:191], v[124:127]
    ds_read_b128 a[148:151], v33 offset:4096
    s_lshl_b32 s6, s43, 12
    v_mfma_f32_16x16x32_bf16 v[120:123], a[228:231], a[180:183], v[120:123]
    ds_read_b64_tr_b16 a[206:207], v57 offset:14336
    s_add_u32 s76, s5, s6
    v_mfma_f32_16x16x32_bf16 v[120:123], a[224:227], a[176:179], v[120:123]
    ds_read_b128 a[152:155], v32 offset:6144
    v_lshrrev_b32 v46, 1, v44
    v_mfma_f32_16x16x32_bf16 v[116:119], a[224:227], a[168:171], v[116:119]
    ds_read_b128 a[156:159], v33 offset:6144
    v_and_b32 v47, 1, v44
    v_mfma_f32_16x16x32_bf16 v[116:119], a[228:231], a[172:175], v[116:119]
    buffer_load_dwordx4 v40, s[24:27], s40 offen offset:2048 lds
    v_mfma_f32_16x16x32_bf16 v[112:115], a[228:231], a[164:167], v[112:115]
    buffer_load_dwordx4 v41, s[24:27], s40 offen offset:3072 lds
    v_mfma_f32_16x16x32_bf16 v[112:115], a[224:227], a[160:163], v[112:115]
    s_waitcnt lgkmcnt(10)
    s_add_u32 m0, s68, 131072
    v_mfma_f32_16x16x32_bf16 v[128:131], a[192:195], a[160:163], v[128:131]
    s_xor_b32 s40, s42, 6
    s_mul_i32 s40, s40, 176128
    v_mfma_f32_16x16x32_bf16 v[128:131], a[196:199], a[164:167], v[128:131]
    buffer_load_dwordx4 v42, s[28:31], s40 offen offset:0 lds
    v_mfma_f32_16x16x32_bf16 v[132:135], a[196:199], a[172:175], v[132:135]
    buffer_load_dwordx4 v43, s[28:31], s40 offen offset:1024 lds
    v_mfma_f32_16x16x32_bf16 v[132:135], a[192:195], a[168:171], v[132:135]
    s_waitcnt vmcnt(15)
    v_lshl_or_b32 v46, v47, 1, v46
    v_mfma_f32_16x16x32_bf16 v[136:139], a[192:195], a[176:179], v[136:139]
    s_waitcnt lgkmcnt(2)
    s_barrier
    v_mfma_f32_16x16x32_bf16 v[136:139], a[196:199], a[180:183], v[136:139]
    ds_read_b64_tr_b16 a[208:209], v6 offset:32768
    v_xor_b32 v46, v44, v45
    v_mfma_f32_16x16x32_bf16 v[140:143], a[196:199], a[188:191], v[140:143]
    ds_read_b64_tr_b16 a[210:211], v6 offset:36864
    v_xor_b32 v46, s3, v46
    v_mfma_f32_16x16x32_bf16 v[140:143], a[192:195], a[184:187], v[140:143]
    ds_read_b64_tr_b16 a[212:213], v6 offset:40960
    v_lshlrev_b32 v47, 8, v45
    v_mfma_f32_16x16x32_bf16 v[156:159], a[200:203], a[184:187], v[156:159]
    ds_read_b64_tr_b16 a[214:215], v6 offset:45056
    v_lshl_add_u32 v2, v46, 4, v47
    v_mfma_f32_16x16x32_bf16 v[156:159], a[204:207], a[188:191], v[156:159]
    ds_read_b64_tr_b16 a[216:217], v7 offset:32768
    v_xor_b32 v3, 64, v2
    v_mfma_f32_16x16x32_bf16 v[152:155], a[204:207], a[180:183], v[152:155]
    v_xor_b32 v4, 128, v2
    v_xor_b32 v5, 192, v2
    v_mfma_f32_16x16x32_bf16 v[152:155], a[200:203], a[176:179], v[152:155]
    ds_read_b64_tr_b16 a[218:219], v7 offset:36864
    v_lshl_add_u32 v46, v44, 8, s41
    v_mfma_f32_16x16x32_bf16 v[148:151], a[200:203], a[168:171], v[148:151]
    v_xor_b32 v47, v44, v45
    v_lshl_add_u32 v14, v47, 4, v46
    v_mfma_f32_16x16x32_bf16 v[148:151], a[204:207], a[172:175], v[148:151]
    ds_read_b64_tr_b16 a[220:221], v7 offset:40960
    v_lshlrev_b32 v47, 1, v44
    v_mfma_f32_16x16x32_bf16 v[144:147], a[204:207], a[164:167], v[144:147]
    ds_read_b64_tr_b16 a[222:223], v7 offset:45056
    s_waitcnt lgkmcnt(8)
    v_mfma_f32_16x16x32_bf16 v[144:147], a[200:203], a[160:163], v[144:147]
    ds_read_b64_tr_b16 a[224:225], v8 offset:32768
    s_waitcnt lgkmcnt(5)
    v_mfma_f32_16x16x32_bf16 v[192:195], a[208:211], a[128:131], v[192:195]
    s_add_u32 m0, s47, 0
    s_xor_b32 s40, s78, 128
    v_mfma_f32_16x16x32_bf16 v[192:195], a[212:215], a[132:135], v[192:195]
    ds_read_b64_tr_b16 a[226:227], v8 offset:36864
    v_xor_b32 v47, v47, v45
    v_mfma_f32_16x16x32_bf16 v[196:199], a[212:215], a[140:143], v[196:199]
    buffer_load_dwordx4 v34, s[20:23], s40 offen offset:0 lds
    v_mfma_f32_16x16x32_bf16 v[196:199], a[208:211], a[136:139], v[196:199]
    ds_read_b64_tr_b16 a[228:229], v8 offset:40960
    v_lshl_add_u32 v18, v47, 4, v46
    v_mfma_f32_16x16x32_bf16 v[200:203], a[208:211], a[144:147], v[200:203]
    v_xor_b32 v19, 128, v18
    v_xor_b32 v15, 64, v14
    v_mfma_f32_16x16x32_bf16 v[200:203], a[212:215], a[148:151], v[200:203]
    ds_read_b64_tr_b16 a[230:231], v8 offset:45056
    v_xor_b32 v16, 128, v14
    v_mfma_f32_16x16x32_bf16 v[204:207], a[212:215], a[156:159], v[204:207]
    ds_read_b64_tr_b16 a[192:193], v9 offset:32768
    v_xor_b32 v17, 192, v14
    v_mfma_f32_16x16x32_bf16 v[204:207], a[208:211], a[152:155], v[204:207]
    s_waitcnt lgkmcnt(5)
    v_lshlrev_b32 v61, 3, v44
    v_smfmac_f32_16x16x64_bf16 a[232:235], v[24:27], a[208:215], v20
    ds_read_b64_tr_b16 a[194:195], v9 offset:36864
    v_mfma_f32_16x16x32_bf16 v[76:79], a[216:219], a[152:155], v[76:79]
    buffer_load_dwordx4 v35, s[20:23], s40 offen offset:1024 lds
    v_mfma_f32_16x16x32_bf16 v[76:79], a[220:223], a[156:159], v[76:79]
    ds_read_b64_tr_b16 a[196:197], v9 offset:40960
    v_mov_b32 v44, 0
    v_mfma_f32_16x16x32_bf16 v[72:75], a[220:223], a[148:151], v[72:75]
    buffer_load_dwordx4 v36, s[20:23], s40 offen offset:2048 lds
    v_mfma_f32_16x16x32_bf16 v[72:75], a[216:219], a[144:147], v[72:75]
    ds_read_b64_tr_b16 a[198:199], v9 offset:45056
    v_mov_b32 v45, 0
    v_mfma_f32_16x16x32_bf16 v[68:71], a[216:219], a[136:139], v[68:71]
    v_mov_b32 v46, 0
    v_mov_b32 v47, 0
    v_mfma_f32_16x16x32_bf16 v[68:71], a[220:223], a[140:143], v[68:71]
    ds_read_b64_tr_b16 a[200:201], v10 offset:32768
    v_accvgpr_write_b32 a51, 0
    v_mfma_f32_16x16x32_bf16 v[64:67], a[220:223], a[132:135], v[64:67]
    v_accvgpr_write_b32 a52, 0
    v_accvgpr_write_b32 a53, 0
    v_mfma_f32_16x16x32_bf16 v[64:67], a[216:219], a[128:131], v[64:67]
    ds_read_b64_tr_b16 a[202:203], v10 offset:36864
    v_accvgpr_write_b32 a54, 0
    v_smfmac_f32_16x16x64_bf16 a[236:239], v[24:27], a[216:223], v20
    s_waitcnt lgkmcnt(6)
    v_mfma_f32_16x16x32_bf16 v[208:211], a[224:227], a[128:131], v[208:211]
    ds_read_b64_tr_b16 a[204:205], v10 offset:40960
    v_accvgpr_write_b32 a55, 0
    v_mfma_f32_16x16x32_bf16 v[208:211], a[228:231], a[132:135], v[208:211]
    buffer_load_dwordx4 v37, s[20:23], s40 offen offset:3072 lds
    v_mfma_f32_16x16x32_bf16 v[212:215], a[228:231], a[140:143], v[212:215]
    ds_read_b64_tr_b16 a[206:207], v10 offset:45056
    s_add_u32 m0, s47, 4096
    v_mfma_f32_16x16x32_bf16 v[212:215], a[224:227], a[136:139], v[212:215]
    s_xor_b32 s40, s78, 32896
    v_accvgpr_write_b32 a56, 0
    v_mfma_f32_16x16x32_bf16 v[216:219], a[224:227], a[144:147], v[216:219]
    ds_read_b64_tr_b16 a[208:209], v60 offset:16384
    v_accvgpr_write_b32 a57, 0
    v_mfma_f32_16x16x32_bf16 v[216:219], a[228:231], a[148:151], v[216:219]
    buffer_load_dwordx4 v34, s[20:23], s40 offen offset:0 lds
    v_mfma_f32_16x16x32_bf16 v[220:223], a[228:231], a[156:159], v[220:223]
    ds_read_b64_tr_b16 a[210:211], v60 offset:18432
    v_accvgpr_write_b32 a58, 0
    v_mfma_f32_16x16x32_bf16 v[220:223], a[224:227], a[152:155], v[220:223]
    s_waitcnt lgkmcnt(6)
    v_accvgpr_write_b32 a59, 0
    v_mfma_f32_16x16x32_bf16 v[92:95], a[192:195], a[152:155], v[92:95]
    ds_read_b64_tr_b16 a[212:213], v60 offset:20480
    v_accvgpr_write_b32 a60, 0
    v_mfma_f32_16x16x32_bf16 v[92:95], a[196:199], a[156:159], v[92:95]
L1_pb1:
    s_cbranch_execz L1_pc1
    buffer_load_dwordx4 v35, s[20:23], s40 offen offset:1024 lds
    v_mfma_f32_16x16x32_bf16 v[88:91], a[196:199], a[148:151], v[88:91]
    ds_read_b64_tr_b16 a[214:215], v60 offset:22528
    v_accvgpr_write_b32 a61, 0
    v_mfma_f32_16x16x32_bf16 v[88:91], a[192:195], a[144:147], v[88:91]
    v_accvgpr_write_b32 a62, 0
    v_accvgpr_write_b32 a63, 0
    v_mfma_f32_16x16x32_bf16 v[84:87], a[192:195], a[136:139], v[84:87]
    ds_read_b64_tr_b16 a[216:217], v11 offset:32768
    v_accvgpr_write_b32 a64, 0
    v_mfma_f32_16x16x32_bf16 v[84:87], a[196:199], a[140:143], v[84:87]
    ds_read_b64_tr_b16 a[218:219], v11 offset:36864
    v_accvgpr_write_b32 a65, 0
    v_mfma_f32_16x16x32_bf16 v[80:83], a[196:199], a[132:135], v[80:83]
    ds_read_b64_tr_b16 a[220:221], v11 offset:40960
    v_accvgpr_write_b32 a66, 0
    v_mfma_f32_16x16x32_bf16 v[80:83], a[192:195], a[128:131], v[80:83]
    ds_read_b64_tr_b16 a[222:223], v11 offset:45056
    s_waitcnt lgkmcnt(8)
    v_mfma_f32_16x16x32_bf16 v[224:227], a[200:203], a[128:131], v[224:227]
    ds_read_b64_tr_b16 a[224:225], v12 offset:32768
    v_accvgpr_write_b32 a67, 0
    v_mfma_f32_16x16x32_bf16 v[224:227], a[204:207], a[132:135], v[224:227]
    buffer_load_dwordx4 v36, s[20:23], s40 offen offset:2048 lds
    v_mfma_f32_16x16x32_bf16 v[228:231], a[204:207], a[140:143], v[228:231]
    ds_read_b64_tr_b16 a[226:227], v12 offset:36864
    v_accvgpr_write_b32 a68, 0
    v_mfma_f32_16x16x32_bf16 v[228:231], a[200:203], a[136:139], v[228:231]
    buffer_load_dwordx4 v37, s[20:23], s40 offen offset:3072 lds
    v_mfma_f32_16x16x32_bf16 v[232:235], a[200:203], a[144:147], v[232:235]
    ds_read_b64_tr_b16 a[228:229], v12 offset:40960
    v_accvgpr_write_b32 a69, 0
    v_mfma_f32_16x16x32_bf16 v[232:235], a[204:207], a[148:151], v[232:235]
    ds_read_b64_tr_b16 a[230:231], v12 offset:45056
    v_accvgpr_write_b32 a70, 0
    v_mfma_f32_16x16x32_bf16 v[236:239], a[204:207], a[156:159], v[236:239]
    ds_read_b64_tr_b16 a[192:193], v13 offset:32768
    s_add_u32 m0, s41, 81920
    v_mfma_f32_16x16x32_bf16 v[236:239], a[200:203], a[152:155], v[236:239]
    s_waitcnt lgkmcnt(9)
    s_waitcnt lgkmcnt(5)
    v_smfmac_f32_16x16x64_bf16 a[240:243], v[24:27], a[208:215], v20
    ds_read_b64_tr_b16 a[194:195], v13 offset:36864
    v_mfma_f32_16x16x32_bf16 v[108:111], a[216:219], a[152:155], v[108:111]
    s_xor_b32 s40, s79, 524288
    v_accvgpr_write_b32 a71, 0
    v_mfma_f32_16x16x32_bf16 v[108:111], a[220:223], a[156:159], v[108:111]
    ds_read_b64_tr_b16 a[196:197], v13 offset:40960
    v_accvgpr_write_b32 a72, 0
    v_mfma_f32_16x16x32_bf16 v[104:107], a[220:223], a[148:151], v[104:107]
    buffer_load_dwordx4 v38, s[24:27], s40 offen offset:0 lds
    v_mfma_f32_16x16x32_bf16 v[104:107], a[216:219], a[144:147], v[104:107]
    ds_read_b64_tr_b16 a[198:199], v13 offset:45056
    v_accvgpr_write_b32 a73, 0
    v_mfma_f32_16x16x32_bf16 v[100:103], a[216:219], a[136:139], v[100:103]
    ds_read_b64_tr_b16 a[200:201], v56 offset:16384
    v_accvgpr_write_b32 a74, 0
    v_mfma_f32_16x16x32_bf16 v[100:103], a[220:223], a[140:143], v[100:103]
    buffer_load_dwordx4 v39, s[24:27], s40 offen offset:1024 lds
    v_mfma_f32_16x16x32_bf16 v[96:99], a[220:223], a[132:135], v[96:99]
    ds_read_b64_tr_b16 a[202:203], v56 offset:18432
    s_waitcnt vmcnt(16)
    v_mfma_f32_16x16x32_bf16 v[96:99], a[216:219], a[128:131], v[96:99]
    s_waitcnt lgkmcnt(6)
    ds_read_b128 a[160:163], v32 offset:8192
    v_mfma_f32_16x16x32_bf16 v[240:243], a[224:227], a[128:131], v[240:243]
    ds_read_b64_tr_b16 a[204:205], v56 offset:20480
    v_accvgpr_write_b32 a75, 0
    v_mfma_f32_16x16x32_bf16 v[240:243], a[228:231], a[132:135], v[240:243]
    ds_read_b128 a[164:167], v33 offset:8192
    v_accvgpr_write_b32 a76, 0
    v_mfma_f32_16x16x32_bf16 v[244:247], a[228:231], a[140:143], v[244:247]
    ds_read_b64_tr_b16 a[206:207], v56 offset:22528
    v_accvgpr_write_b32 a77, 0
    v_mfma_f32_16x16x32_bf16 v[244:247], a[224:227], a[136:139], v[244:247]
    ds_read_b128 a[168:171], v32 offset:10240
    v_accvgpr_write_b32 a78, 0
    v_mfma_f32_16x16x32_bf16 v[248:251], a[224:227], a[144:147], v[248:251]
    ds_read_b64_tr_b16 a[208:209], v57 offset:16384
    v_accvgpr_write_b32 a79, 0
    v_mfma_f32_16x16x32_bf16 v[248:251], a[228:231], a[148:151], v[248:251]
    ds_read_b128 a[172:175], v33 offset:10240
    v_accvgpr_write_b32 a80, 0
    v_mfma_f32_16x16x32_bf16 v[252:255], a[228:231], a[156:159], v[252:255]
    ds_read_b64_tr_b16 a[210:211], v57 offset:18432
    v_accvgpr_write_b32 a81, 0
    v_mfma_f32_16x16x32_bf16 v[252:255], a[224:227], a[152:155], v[252:255]
    s_waitcnt lgkmcnt(10)
    ds_read_b128 a[176:179], v32 offset:12288
    v_mfma_f32_16x16x32_bf16 v[124:127], a[192:195], a[152:155], v[124:127]
    ds_read_b64_tr_b16 a[212:213], v57 offset:20480
    v_accvgpr_write_b32 a82, 0
    v_mfma_f32_16x16x32_bf16 v[124:127], a[196:199], a[156:159], v[124:127]
    ds_read_b128 a[180:183], v33 offset:12288
    v_accvgpr_write_b32 a83, 0
    v_mfma_f32_16x16x32_bf16 v[120:123], a[196:199], a[148:151], v[120:123]
    ds_read_b64_tr_b16 a[214:215], v57 offset:22528
    v_accvgpr_write_b32 a84, 0
    v_mfma_f32_16x16x32_bf16 v[120:123], a[192:195], a[144:147], v[120:123]
    ds_read_b128 a[184:187], v32 offset:14336
    v_accvgpr_write_b32 a85, 0
    v_mfma_f32_16x16x32_bf16 v[116:119], a[192:195], a[136:139], v[116:119]
    ds_read_b128 a[188:191], v33 offset:14336
    v_accvgpr_write_b32 a86, 0
    v_mfma_f32_16x16x32_bf16 v[116:119], a[196:199], a[140:143], v[116:119]
    buffer_load_dwordx4 v40, s[24:27], s40 offen offset:2048 lds
    v_mfma_f32_16x16x32_bf16 v[112:115], a[196:199], a[132:135], v[112:115]
    buffer_load_dwordx4 v41, s[24:27], s40 offen offset:3072 lds
    v_mfma_f32_16x16x32_bf16 v[112:115], a[192:195], a[128:131], v[112:115]
    s_waitcnt lgkmcnt(10)
    s_add_u32 m0, s68, 139264
    v_mfma_f32_16x16x32_bf16 v[128:131], a[200:203], a[128:131], v[128:131]
    s_xor_b32 s40, s42, 1
    s_mul_i32 s40, s40, 176128
    v_mfma_f32_16x16x32_bf16 v[128:131], a[204:207], a[132:135], v[128:131]
    buffer_load_dwordx4 v42, s[28:31], s40 offen offset:0 lds
    v_mfma_f32_16x16x32_bf16 v[132:135], a[204:207], a[140:143], v[132:135]
    buffer_load_dwordx4 v43, s[28:31], s40 offen offset:1024 lds
    v_mfma_f32_16x16x32_bf16 v[132:135], a[200:203], a[136:139], v[132:135]
    s_waitcnt vmcnt(14)
    v_accvgpr_write_b32 a87, 0
    v_mfma_f32_16x16x32_bf16 v[136:139], a[200:203], a[144:147], v[136:139]
    s_waitcnt lgkmcnt(2)
    s_barrier
    v_mfma_f32_16x16x32_bf16 v[136:139], a[204:207], a[148:151], v[136:139]
    ds_read_b64_tr_b16 a[216:217], v6 offset:0
    v_accvgpr_write_b32 a88, 0
    v_mfma_f32_16x16x32_bf16 v[140:143], a[204:207], a[156:159], v[140:143]
    ds_read_b64_tr_b16 a[218:219], v6 offset:4096
    v_accvgpr_write_b32 a89, 0
    v_mfma_f32_16x16x32_bf16 v[140:143], a[200:203], a[152:155], v[140:143]
    ds_read_b64_tr_b16 a[220:221], v6 offset:8192
    v_accvgpr_write_b32 a90, 0
    v_mfma_f32_16x16x32_bf16 v[156:159], a[208:211], a[152:155], v[156:159]
    ds_read_b64_tr_b16 a[222:223], v6 offset:12288
    v_accvgpr_write_b32 a91, 0
    v_mfma_f32_16x16x32_bf16 v[156:159], a[212:215], a[156:159], v[156:159]
    ds_read_b64_tr_b16 a[224:225], v7 offset:0
    v_accvgpr_write_b32 a92, 0
    v_mfma_f32_16x16x32_bf16 v[152:155], a[212:215], a[148:151], v[152:155]
    v_accvgpr_write_b32 a93, 0
    v_accvgpr_write_b32 a94, 0
    v_mfma_f32_16x16x32_bf16 v[152:155], a[208:211], a[144:147], v[152:155]
    ds_read_b64_tr_b16 a[226:227], v7 offset:4096
    v_accvgpr_write_b32 a95, 0
    v_mfma_f32_16x16x32_bf16 v[148:151], a[208:211], a[136:139], v[148:151]
    v_accvgpr_write_b32 a96, 0
    v_accvgpr_write_b32 a97, 0
    v_mfma_f32_16x16x32_bf16 v[148:151], a[212:215], a[140:143], v[148:151]
    ds_read_b64_tr_b16 a[228:229], v7 offset:8192
    v_accvgpr_write_b32 a98, 0
    v_mfma_f32_16x16x32_bf16 v[144:147], a[212:215], a[132:135], v[144:147]
    ds_read_b64_tr_b16 a[230:231], v7 offset:12288
    s_waitcnt lgkmcnt(8)
    v_mfma_f32_16x16x32_bf16 v[144:147], a[208:211], a[128:131], v[144:147]
    ds_read_b64_tr_b16 a[192:193], v8 offset:0
    s_waitcnt lgkmcnt(5)
    v_mfma_f32_16x16x32_bf16 v[192:195], a[216:219], a[160:163], v[192:195]
    s_add_u32 m0, s47, 8192
    s_xor_b32 s40, s78, 384
    v_mfma_f32_16x16x32_bf16 v[192:195], a[220:223], a[164:167], v[192:195]
    ds_read_b64_tr_b16 a[194:195], v8 offset:4096
    v_accvgpr_write_b32 a99, 0
    v_mfma_f32_16x16x32_bf16 v[196:199], a[220:223], a[172:175], v[196:199]
    buffer_load_dwordx4 v34, s[20:23], s40 offen offset:0 lds
    v_mfma_f32_16x16x32_bf16 v[196:199], a[216:219], a[168:171], v[196:199]
    ds_read_b64_tr_b16 a[196:197], v8 offset:8192
    v_accvgpr_write_b32 a100, 0
    v_mfma_f32_16x16x32_bf16 v[200:203], a[216:219], a[176:179], v[200:203]
    v_accvgpr_write_b32 a101, 0
    v_accvgpr_write_b32 a102, 0
    v_mfma_f32_16x16x32_bf16 v[200:203], a[220:223], a[180:183], v[200:203]
    ds_read_b64_tr_b16 a[198:199], v8 offset:12288
    v_accvgpr_write_b32 a103, 0
    v_mfma_f32_16x16x32_bf16 v[204:207], a[220:223], a[188:191], v[204:207]
    ds_read_b64_tr_b16 a[200:201], v9 offset:0
    v_accvgpr_write_b32 a104, 0
    v_mfma_f32_16x16x32_bf16 v[204:207], a[216:219], a[184:187], v[204:207]
    s_waitcnt lgkmcnt(5)
    v_accvgpr_write_b32 a105, 0
    v_smfmac_f32_16x16x64_bf16 a[232:235], v[24:27], a[216:223], v20
    ds_read_b64_tr_b16 a[202:203], v9 offset:4096
    v_mfma_f32_16x16x32_bf16 v[76:79], a[224:227], a[184:187], v[76:79]
    buffer_load_dwordx4 v35, s[20:23], s40 offen offset:1024 lds
    v_mfma_f32_16x16x32_bf16 v[76:79], a[228:231], a[188:191], v[76:79]
    ds_read_b64_tr_b16 a[204:205], v9 offset:8192
    v_accvgpr_write_b32 a106, 0
    v_mfma_f32_16x16x32_bf16 v[72:75], a[228:231], a[180:183], v[72:75]
    buffer_load_dwordx4 v36, s[20:23], s40 offen offset:2048 lds
    v_mfma_f32_16x16x32_bf16 v[72:75], a[224:227], a[176:179], v[72:75]
    ds_read_b64_tr_b16 a[206:207], v9 offset:12288
    v_accvgpr_write_b32 a107, 0
    v_mfma_f32_16x16x32_bf16 v[68:71], a[224:227], a[168:171], v[68:71]
    v_accvgpr_write_b32 a108, 0
    v_accvgpr_write_b32 a109, 0
    v_mfma_f32_16x16x32_bf16 v[68:71], a[228:231], a[172:175], v[68:71]
    ds_read_b64_tr_b16 a[208:209], v10 offset:0
    v_accvgpr_write_b32 a110, 0
    v_mfma_f32_16x16x32_bf16 v[64:67], a[228:231], a[164:167], v[64:67]
    v_accvgpr_write_b32 a111, 0
    v_accvgpr_write_b32 a112, 0
    v_mfma_f32_16x16x32_bf16 v[64:67], a[224:227], a[160:163], v[64:67]
    ds_read_b64_tr_b16 a[210:211], v10 offset:4096
    v_accvgpr_write_b32 a113, 0
    v_smfmac_f32_16x16x64_bf16 a[236:239], v[24:27], a[224:231], v20
    s_waitcnt lgkmcnt(6)
    v_mfma_f32_16x16x32_bf16 v[208:211], a[192:195], a[160:163], v[208:211]
    ds_read_b64_tr_b16 a[212:213], v10 offset:8192
    v_accvgpr_write_b32 a114, 0
    v_mfma_f32_16x16x32_bf16 v[208:211], a[196:199], a[164:167], v[208:211]
    buffer_load_dwordx4 v37, s[20:23], s40 offen offset:3072 lds
    v_mfma_f32_16x16x32_bf16 v[212:215], a[196:199], a[172:175], v[212:215]
    ds_read_b64_tr_b16 a[214:215], v10 offset:12288
    s_add_u32 m0, s47, 12288
    v_mfma_f32_16x16x32_bf16 v[212:215], a[192:195], a[168:171], v[212:215]
    s_xor_b32 s40, s78, 33152
    v_accvgpr_write_b32 a115, 0
    v_mfma_f32_16x16x32_bf16 v[216:219], a[192:195], a[176:179], v[216:219]
    ds_read_b64_tr_b16 a[216:217], v60 offset:0
    v_accvgpr_write_b32 a116, 0
    v_mfma_f32_16x16x32_bf16 v[216:219], a[196:199], a[180:183], v[216:219]
    buffer_load_dwordx4 v34, s[20:23], s40 offen offset:0 lds
    v_mfma_f32_16x16x32_bf16 v[220:223], a[196:199], a[188:191], v[220:223]
    ds_read_b64_tr_b16 a[218:219], v60 offset:2048
    v_accvgpr_write_b32 a117, 0
    v_mfma_f32_16x16x32_bf16 v[220:223], a[192:195], a[184:187], v[220:223]
    s_waitcnt lgkmcnt(6)
    v_accvgpr_write_b32 a118, 0
    v_mfma_f32_16x16x32_bf16 v[92:95], a[200:203], a[184:187], v[92:95]
    ds_read_b64_tr_b16 a[220:221], v60 offset:4096
    v_accvgpr_write_b32 a119, 0
    v_mfma_f32_16x16x32_bf16 v[92:95], a[204:207], a[188:191], v[92:95]
    buffer_load_dwordx4 v35, s[20:23], s40 offen offset:1024 lds
    v_mfma_f32_16x16x32_bf16 v[88:91], a[204:207], a[180:183], v[88:91]
    ds_read_b64_tr_b16 a[222:223], v60 offset:6144
    v_accvgpr_write_b32 a120, 0
    v_mfma_f32_16x16x32_bf16 v[88:91], a[200:203], a[176:179], v[88:91]
    v_accvgpr_write_b32 a121, 0
    v_accvgpr_write_b32 a122, 0
    v_mfma_f32_16x16x32_bf16 v[84:87], a[200:203], a[168:171], v[84:87]
    ds_read_b64_tr_b16 a[224:225], v11 offset:0
    v_accvgpr_write_b32 a123, 0
    v_mfma_f32_16x16x32_bf16 v[84:87], a[204:207], a[172:175], v[84:87]
    ds_read_b64_tr_b16 a[226:227], v11 offset:4096
    v_accvgpr_write_b32 a124, 0
    v_mfma_f32_16x16x32_bf16 v[80:83], a[204:207], a[164:167], v[80:83]
    ds_read_b64_tr_b16 a[228:229], v11 offset:8192
    v_accvgpr_write_b32 a125, 0
    v_mfma_f32_16x16x32_bf16 v[80:83], a[200:203], a[160:163], v[80:83]
    ds_read_b64_tr_b16 a[230:231], v11 offset:12288
    s_waitcnt lgkmcnt(8)
    v_mfma_f32_16x16x32_bf16 v[224:227], a[208:211], a[160:163], v[224:227]
    ds_read_b64_tr_b16 a[192:193], v12 offset:0
    v_accvgpr_write_b32 a126, 0
    v_mfma_f32_16x16x32_bf16 v[224:227], a[212:215], a[164:167], v[224:227]
    buffer_load_dwordx4 v36, s[20:23], s40 offen offset:2048 lds
    v_mfma_f32_16x16x32_bf16 v[228:231], a[212:215], a[172:175], v[228:231]
    ds_read_b64_tr_b16 a[194:195], v12 offset:4096
    v_accvgpr_write_b32 a127, 0
    v_mfma_f32_16x16x32_bf16 v[228:231], a[208:211], a[168:171], v[228:231]
    buffer_load_dwordx4 v37, s[20:23], s40 offen offset:3072 lds
    v_mfma_f32_16x16x32_bf16 v[232:235], a[208:211], a[176:179], v[232:235]
    ds_read_b64_tr_b16 a[196:197], v12 offset:8192
    v_mfma_f32_16x16x32_bf16 v[232:235], a[212:215], a[180:183], v[232:235]
    ds_read_b64_tr_b16 a[198:199], v12 offset:12288
    v_mfma_f32_16x16x32_bf16 v[236:239], a[212:215], a[188:191], v[236:239]
    ds_read_b64_tr_b16 a[200:201], v13 offset:0
    s_add_u32 m0, s41, 98304
    v_mfma_f32_16x16x32_bf16 v[236:239], a[208:211], a[184:187], v[236:239]
    s_waitcnt lgkmcnt(9)
    s_waitcnt lgkmcnt(5)
    v_smfmac_f32_16x16x64_bf16 a[240:243], v[24:27], a[216:223], v20
    ds_read_b64_tr_b16 a[202:203], v13 offset:4096
    v_mfma_f32_16x16x32_bf16 v[108:111], a[224:227], a[184:187], v[108:111]
    s_xor_b32 s40, s79, 1572864
    v_mfma_f32_16x16x32_bf16 v[108:111], a[228:231], a[188:191], v[108:111]
    ds_read_b64_tr_b16 a[204:205], v13 offset:8192
    v_mfma_f32_16x16x32_bf16 v[104:107], a[228:231], a[180:183], v[104:107]
    buffer_load_dwordx4 v38, s[24:27], s40 offen offset:0 lds
    v_mfma_f32_16x16x32_bf16 v[104:107], a[224:227], a[176:179], v[104:107]
    ds_read_b64_tr_b16 a[206:207], v13 offset:12288
    v_mfma_f32_16x16x32_bf16 v[100:103], a[224:227], a[168:171], v[100:103]
    ds_read_b64_tr_b16 a[208:209], v56 offset:0
    v_mfma_f32_16x16x32_bf16 v[100:103], a[228:231], a[172:175], v[100:103]
    buffer_load_dwordx4 v39, s[24:27], s40 offen offset:1024 lds
    v_mfma_f32_16x16x32_bf16 v[96:99], a[228:231], a[164:167], v[96:99]
    ds_read_b64_tr_b16 a[210:211], v56 offset:2048
    s_waitcnt vmcnt(16)
    v_mfma_f32_16x16x32_bf16 v[96:99], a[224:227], a[160:163], v[96:99]
    s_waitcnt lgkmcnt(6)
    ds_read_b128 a[128:131], v32 offset:0
    v_mfma_f32_16x16x32_bf16 v[240:243], a[192:195], a[160:163], v[240:243]
    ds_read_b64_tr_b16 a[212:213], v56 offset:4096
    v_mfma_f32_16x16x32_bf16 v[240:243], a[196:199], a[164:167], v[240:243]
    ds_read_b128 a[132:135], v33 offset:0
    v_mfma_f32_16x16x32_bf16 v[244:247], a[196:199], a[172:175], v[244:247]
    ds_read_b64_tr_b16 a[214:215], v56 offset:6144
    v_mfma_f32_16x16x32_bf16 v[244:247], a[192:195], a[168:171], v[244:247]
    ds_read_b128 a[136:139], v32 offset:2048
    v_mfma_f32_16x16x32_bf16 v[248:251], a[192:195], a[176:179], v[248:251]
    ds_read_b64_tr_b16 a[216:217], v57 offset:0
    v_mfma_f32_16x16x32_bf16 v[248:251], a[196:199], a[180:183], v[248:251]
    ds_read_b128 a[140:143], v33 offset:2048
    v_mfma_f32_16x16x32_bf16 v[252:255], a[196:199], a[188:191], v[252:255]
    ds_read_b64_tr_b16 a[218:219], v57 offset:2048
    v_mfma_f32_16x16x32_bf16 v[252:255], a[192:195], a[184:187], v[252:255]
    s_waitcnt lgkmcnt(10)
    ds_read_b128 a[144:147], v32 offset:4096
    v_mfma_f32_16x16x32_bf16 v[124:127], a[200:203], a[184:187], v[124:127]
    ds_read_b64_tr_b16 a[220:221], v57 offset:4096
    v_mfma_f32_16x16x32_bf16 v[124:127], a[204:207], a[188:191], v[124:127]
    ds_read_b128 a[148:151], v33 offset:4096
    v_mfma_f32_16x16x32_bf16 v[120:123], a[204:207], a[180:183], v[120:123]
    ds_read_b64_tr_b16 a[222:223], v57 offset:6144
    v_mfma_f32_16x16x32_bf16 v[120:123], a[200:203], a[176:179], v[120:123]
    ds_read_b128 a[152:155], v32 offset:6144
    v_mfma_f32_16x16x32_bf16 v[116:119], a[200:203], a[168:171], v[116:119]
    ds_read_b128 a[156:159], v33 offset:6144
    v_mfma_f32_16x16x32_bf16 v[116:119], a[204:207], a[172:175], v[116:119]
    buffer_load_dwordx4 v40, s[24:27], s40 offen offset:2048 lds
    v_mfma_f32_16x16x32_bf16 v[112:115], a[204:207], a[164:167], v[112:115]
    buffer_load_dwordx4 v41, s[24:27], s40 offen offset:3072 lds
    v_mfma_f32_16x16x32_bf16 v[112:115], a[200:203], a[160:163], v[112:115]
    s_waitcnt lgkmcnt(10)
    s_add_u32 m0, s68, 147456
    v_mfma_f32_16x16x32_bf16 v[128:131], a[208:211], a[160:163], v[128:131]
    s_xor_b32 s40, s42, 3
    s_mul_i32 s40, s40, 176128
    v_mfma_f32_16x16x32_bf16 v[128:131], a[212:215], a[164:167], v[128:131]
    buffer_load_dwordx4 v42, s[28:31], s40 offen offset:0 lds
    v_mfma_f32_16x16x32_bf16 v[132:135], a[212:215], a[172:175], v[132:135]
    buffer_load_dwordx4 v43, s[28:31], s40 offen offset:1024 lds
    v_mfma_f32_16x16x32_bf16 v[132:135], a[208:211], a[168:171], v[132:135]
    s_waitcnt vmcnt(14)
    v_mfma_f32_16x16x32_bf16 v[136:139], a[208:211], a[176:179], v[136:139]
    s_waitcnt lgkmcnt(2)
    s_barrier
    v_mfma_f32_16x16x32_bf16 v[136:139], a[212:215], a[180:183], v[136:139]
    ds_read_b64_tr_b16 a[224:225], v6 offset:16384
    v_mfma_f32_16x16x32_bf16 v[140:143], a[212:215], a[188:191], v[140:143]
    ds_read_b64_tr_b16 a[226:227], v6 offset:20480
    v_mfma_f32_16x16x32_bf16 v[140:143], a[208:211], a[184:187], v[140:143]
    ds_read_b64_tr_b16 a[228:229], v6 offset:24576
    v_mfma_f32_16x16x32_bf16 v[156:159], a[216:219], a[184:187], v[156:159]
    ds_read_b64_tr_b16 a[230:231], v6 offset:28672
    v_mfma_f32_16x16x32_bf16 v[156:159], a[220:223], a[188:191], v[156:159]
    ds_read_b64_tr_b16 a[192:193], v7 offset:16384
    v_mfma_f32_16x16x32_bf16 v[152:155], a[220:223], a[180:183], v[152:155]
    v_mfma_f32_16x16x32_bf16 v[152:155], a[216:219], a[176:179], v[152:155]
    ds_read_b64_tr_b16 a[194:195], v7 offset:20480
    v_mfma_f32_16x16x32_bf16 v[148:151], a[216:219], a[168:171], v[148:151]
    v_mfma_f32_16x16x32_bf16 v[148:151], a[220:223], a[172:175], v[148:151]
    ds_read_b64_tr_b16 a[196:197], v7 offset:24576
    v_mfma_f32_16x16x32_bf16 v[144:147], a[220:223], a[164:167], v[144:147]
    ds_read_b64_tr_b16 a[198:199], v7 offset:28672
    s_waitcnt lgkmcnt(8)
    v_mfma_f32_16x16x32_bf16 v[144:147], a[216:219], a[160:163], v[144:147]
    ds_read_b64_tr_b16 a[200:201], v8 offset:16384
    s_waitcnt lgkmcnt(5)
    v_mfma_f32_16x16x32_bf16 v[192:195], a[224:227], a[128:131], v[192:195]
    s_add_u32 m0, s47, 0
    s_xor_b32 s40, s78, 640
    v_mfma_f32_16x16x32_bf16 v[192:195], a[228:231], a[132:135], v[192:195]
    ds_read_b64_tr_b16 a[202:203], v8 offset:20480
    v_mfma_f32_16x16x32_bf16 v[196:199], a[228:231], a[140:143], v[196:199]
    buffer_load_dwordx4 v34, s[20:23], s40 offen offset:0 lds
    v_mfma_f32_16x16x32_bf16 v[196:199], a[224:227], a[136:139], v[196:199]
    ds_read_b64_tr_b16 a[204:205], v8 offset:24576
    v_mfma_f32_16x16x32_bf16 v[200:203], a[224:227], a[144:147], v[200:203]
    v_mfma_f32_16x16x32_bf16 v[200:203], a[228:231], a[148:151], v[200:203]
    ds_read_b64_tr_b16 a[206:207], v8 offset:28672
    v_mfma_f32_16x16x32_bf16 v[204:207], a[228:231], a[156:159], v[204:207]
    ds_read_b64_tr_b16 a[208:209], v9 offset:16384
    v_mfma_f32_16x16x32_bf16 v[204:207], a[224:227], a[152:155], v[204:207]
    s_waitcnt lgkmcnt(5)
    v_smfmac_f32_16x16x64_bf16 a[232:235], v[24:27], a[224:231], v20
    ds_read_b64_tr_b16 a[210:211], v9 offset:20480
    v_mfma_f32_16x16x32_bf16 v[76:79], a[192:195], a[152:155], v[76:79]
    buffer_load_dwordx4 v35, s[20:23], s40 offen offset:1024 lds
    v_mfma_f32_16x16x32_bf16 v[76:79], a[196:199], a[156:159], v[76:79]
    ds_read_b64_tr_b16 a[212:213], v9 offset:24576
    v_mfma_f32_16x16x32_bf16 v[72:75], a[196:199], a[148:151], v[72:75]
    buffer_load_dwordx4 v36, s[20:23], s40 offen offset:2048 lds
    v_mfma_f32_16x16x32_bf16 v[72:75], a[192:195], a[144:147], v[72:75]
    ds_read_b64_tr_b16 a[214:215], v9 offset:28672
    v_mfma_f32_16x16x32_bf16 v[68:71], a[192:195], a[136:139], v[68:71]
    v_mfma_f32_16x16x32_bf16 v[68:71], a[196:199], a[140:143], v[68:71]
    ds_read_b64_tr_b16 a[216:217], v10 offset:16384
    v_mfma_f32_16x16x32_bf16 v[64:67], a[196:199], a[132:135], v[64:67]
    v_mfma_f32_16x16x32_bf16 v[64:67], a[192:195], a[128:131], v[64:67]
    ds_read_b64_tr_b16 a[218:219], v10 offset:20480
    v_smfmac_f32_16x16x64_bf16 a[236:239], v[24:27], a[192:199], v20
    s_waitcnt lgkmcnt(6)
    v_mfma_f32_16x16x32_bf16 v[208:211], a[200:203], a[128:131], v[208:211]
    ds_read_b64_tr_b16 a[220:221], v10 offset:24576
    v_mfma_f32_16x16x32_bf16 v[208:211], a[204:207], a[132:135], v[208:211]
    buffer_load_dwordx4 v37, s[20:23], s40 offen offset:3072 lds
    v_mfma_f32_16x16x32_bf16 v[212:215], a[204:207], a[140:143], v[212:215]
    ds_read_b64_tr_b16 a[222:223], v10 offset:28672
    s_add_u32 m0, s47, 4096
    v_mfma_f32_16x16x32_bf16 v[212:215], a[200:203], a[136:139], v[212:215]
    s_xor_b32 s40, s78, 33408
    v_mfma_f32_16x16x32_bf16 v[216:219], a[200:203], a[144:147], v[216:219]
    ds_read_b64_tr_b16 a[224:225], v60 offset:8192
    v_mfma_f32_16x16x32_bf16 v[216:219], a[204:207], a[148:151], v[216:219]
    buffer_load_dwordx4 v34, s[20:23], s40 offen offset:0 lds
    v_mfma_f32_16x16x32_bf16 v[220:223], a[204:207], a[156:159], v[220:223]
    ds_read_b64_tr_b16 a[226:227], v60 offset:10240
    v_mfma_f32_16x16x32_bf16 v[220:223], a[200:203], a[152:155], v[220:223]
    s_waitcnt lgkmcnt(6)
    v_mfma_f32_16x16x32_bf16 v[92:95], a[208:211], a[152:155], v[92:95]
    ds_read_b64_tr_b16 a[228:229], v60 offset:12288
    v_mfma_f32_16x16x32_bf16 v[92:95], a[212:215], a[156:159], v[92:95]
    buffer_load_dwordx4 v35, s[20:23], s40 offen offset:1024 lds
    v_mfma_f32_16x16x32_bf16 v[88:91], a[212:215], a[148:151], v[88:91]
    ds_read_b64_tr_b16 a[230:231], v60 offset:14336
    v_mfma_f32_16x16x32_bf16 v[88:91], a[208:211], a[144:147], v[88:91]
    v_mfma_f32_16x16x32_bf16 v[84:87], a[208:211], a[136:139], v[84:87]
    ds_read_b64_tr_b16 a[192:193], v11 offset:16384
    v_mfma_f32_16x16x32_bf16 v[84:87], a[212:215], a[140:143], v[84:87]
    ds_read_b64_tr_b16 a[194:195], v11 offset:20480
    v_mfma_f32_16x16x32_bf16 v[80:83], a[212:215], a[132:135], v[80:83]
    ds_read_b64_tr_b16 a[196:197], v11 offset:24576
    v_mfma_f32_16x16x32_bf16 v[80:83], a[208:211], a[128:131], v[80:83]
    ds_read_b64_tr_b16 a[198:199], v11 offset:28672
    s_waitcnt lgkmcnt(8)
    v_mfma_f32_16x16x32_bf16 v[224:227], a[216:219], a[128:131], v[224:227]
    ds_read_b64_tr_b16 a[200:201], v12 offset:16384
    v_mfma_f32_16x16x32_bf16 v[224:227], a[220:223], a[132:135], v[224:227]
    buffer_load_dwordx4 v36, s[20:23], s40 offen offset:2048 lds
    v_mfma_f32_16x16x32_bf16 v[228:231], a[220:223], a[140:143], v[228:231]
    ds_read_b64_tr_b16 a[202:203], v12 offset:20480
    v_mfma_f32_16x16x32_bf16 v[228:231], a[216:219], a[136:139], v[228:231]
    buffer_load_dwordx4 v37, s[20:23], s40 offen offset:3072 lds
    v_mfma_f32_16x16x32_bf16 v[232:235], a[216:219], a[144:147], v[232:235]
    ds_read_b64_tr_b16 a[204:205], v12 offset:24576
    v_mfma_f32_16x16x32_bf16 v[232:235], a[220:223], a[148:151], v[232:235]
    ds_read_b64_tr_b16 a[206:207], v12 offset:28672
    v_mfma_f32_16x16x32_bf16 v[236:239], a[220:223], a[156:159], v[236:239]
    ds_read_b64_tr_b16 a[208:209], v13 offset:16384
    s_add_u32 m0, s41, 65536
    v_mfma_f32_16x16x32_bf16 v[236:239], a[216:219], a[152:155], v[236:239]
    s_waitcnt lgkmcnt(9)
    s_waitcnt lgkmcnt(5)
    v_smfmac_f32_16x16x64_bf16 a[240:243], v[24:27], a[224:231], v20
    ds_read_b64_tr_b16 a[210:211], v13 offset:20480
    v_mfma_f32_16x16x32_bf16 v[108:111], a[192:195], a[152:155], v[108:111]
    s_xor_b32 s40, s79, 2621440
    v_mfma_f32_16x16x32_bf16 v[108:111], a[196:199], a[156:159], v[108:111]
    ds_read_b64_tr_b16 a[212:213], v13 offset:24576
    v_mfma_f32_16x16x32_bf16 v[104:107], a[196:199], a[148:151], v[104:107]
    buffer_load_dwordx4 v38, s[24:27], s40 offen offset:0 lds
    v_mfma_f32_16x16x32_bf16 v[104:107], a[192:195], a[144:147], v[104:107]
    ds_read_b64_tr_b16 a[214:215], v13 offset:28672
    v_mfma_f32_16x16x32_bf16 v[100:103], a[192:195], a[136:139], v[100:103]
    ds_read_b64_tr_b16 a[216:217], v56 offset:8192
    v_mfma_f32_16x16x32_bf16 v[100:103], a[196:199], a[140:143], v[100:103]
    buffer_load_dwordx4 v39, s[24:27], s40 offen offset:1024 lds
    v_mfma_f32_16x16x32_bf16 v[96:99], a[196:199], a[132:135], v[96:99]
    ds_read_b64_tr_b16 a[218:219], v56 offset:10240
    s_waitcnt vmcnt(16)
    v_mfma_f32_16x16x32_bf16 v[96:99], a[192:195], a[128:131], v[96:99]
    s_waitcnt lgkmcnt(6)
    ds_read_b128 a[160:163], v32 offset:8192
    v_mfma_f32_16x16x32_bf16 v[240:243], a[200:203], a[128:131], v[240:243]
    ds_read_b64_tr_b16 a[220:221], v56 offset:12288
    v_mfma_f32_16x16x32_bf16 v[240:243], a[204:207], a[132:135], v[240:243]
    ds_read_b128 a[164:167], v33 offset:8192
    v_mfma_f32_16x16x32_bf16 v[244:247], a[204:207], a[140:143], v[244:247]
    ds_read_b64_tr_b16 a[222:223], v56 offset:14336
    v_mfma_f32_16x16x32_bf16 v[244:247], a[200:203], a[136:139], v[244:247]
    ds_read_b128 a[168:171], v32 offset:10240
    v_mfma_f32_16x16x32_bf16 v[248:251], a[200:203], a[144:147], v[248:251]
    ds_read_b64_tr_b16 a[224:225], v57 offset:8192
    v_mfma_f32_16x16x32_bf16 v[248:251], a[204:207], a[148:151], v[248:251]
    ds_read_b128 a[172:175], v33 offset:10240
    v_mfma_f32_16x16x32_bf16 v[252:255], a[204:207], a[156:159], v[252:255]
    ds_read_b64_tr_b16 a[226:227], v57 offset:10240
    v_mfma_f32_16x16x32_bf16 v[252:255], a[200:203], a[152:155], v[252:255]
    s_waitcnt lgkmcnt(10)
    ds_read_b128 a[176:179], v32 offset:12288
    v_mfma_f32_16x16x32_bf16 v[124:127], a[208:211], a[152:155], v[124:127]
    ds_read_b64_tr_b16 a[228:229], v57 offset:12288
    v_mfma_f32_16x16x32_bf16 v[124:127], a[212:215], a[156:159], v[124:127]
    ds_read_b128 a[180:183], v33 offset:12288
    v_mfma_f32_16x16x32_bf16 v[120:123], a[212:215], a[148:151], v[120:123]
    ds_read_b64_tr_b16 a[230:231], v57 offset:14336
    v_mfma_f32_16x16x32_bf16 v[120:123], a[208:211], a[144:147], v[120:123]
    ds_read_b128 a[184:187], v32 offset:14336
    v_mfma_f32_16x16x32_bf16 v[116:119], a[208:211], a[136:139], v[116:119]
    ds_read_b128 a[188:191], v33 offset:14336
    v_mfma_f32_16x16x32_bf16 v[116:119], a[212:215], a[140:143], v[116:119]
    buffer_load_dwordx4 v40, s[24:27], s40 offen offset:2048 lds
    v_mfma_f32_16x16x32_bf16 v[112:115], a[212:215], a[132:135], v[112:115]
    buffer_load_dwordx4 v41, s[24:27], s40 offen offset:3072 lds
    v_mfma_f32_16x16x32_bf16 v[112:115], a[208:211], a[128:131], v[112:115]
    s_waitcnt lgkmcnt(10)
    s_add_u32 m0, s68, 131072
    v_mfma_f32_16x16x32_bf16 v[128:131], a[216:219], a[128:131], v[128:131]
    s_xor_b32 s40, s42, 5
    s_mul_i32 s40, s40, 176128
    v_mfma_f32_16x16x32_bf16 v[128:131], a[220:223], a[132:135], v[128:131]
    buffer_load_dwordx4 v42, s[28:31], s40 offen offset:0 lds
    v_mfma_f32_16x16x32_bf16 v[132:135], a[220:223], a[140:143], v[132:135]
    buffer_load_dwordx4 v43, s[28:31], s40 offen offset:1024 lds
    v_mfma_f32_16x16x32_bf16 v[132:135], a[216:219], a[136:139], v[132:135]
    s_waitcnt vmcnt(14)
    v_mfma_f32_16x16x32_bf16 v[136:139], a[216:219], a[144:147], v[136:139]
    s_waitcnt lgkmcnt(2)
    s_barrier
    v_mfma_f32_16x16x32_bf16 v[136:139], a[220:223], a[148:151], v[136:139]
    ds_read_b64_tr_b16 a[192:193], v6 offset:32768
    v_mfma_f32_16x16x32_bf16 v[140:143], a[220:223], a[156:159], v[140:143]
    ds_read_b64_tr_b16 a[194:195], v6 offset:36864
    v_mfma_f32_16x16x32_bf16 v[140:143], a[216:219], a[152:155], v[140:143]
    ds_read_b64_tr_b16 a[196:197], v6 offset:40960
    v_mfma_f32_16x16x32_bf16 v[156:159], a[224:227], a[152:155], v[156:159]
    ds_read_b64_tr_b16 a[198:199], v6 offset:45056
    v_mfma_f32_16x16x32_bf16 v[156:159], a[228:231], a[156:159], v[156:159]
    ds_read_b64_tr_b16 a[200:201], v7 offset:32768
    v_mfma_f32_16x16x32_bf16 v[152:155], a[228:231], a[148:151], v[152:155]
    v_mfma_f32_16x16x32_bf16 v[152:155], a[224:227], a[144:147], v[152:155]
    ds_read_b64_tr_b16 a[202:203], v7 offset:36864
    v_mfma_f32_16x16x32_bf16 v[148:151], a[224:227], a[136:139], v[148:151]
    v_mfma_f32_16x16x32_bf16 v[148:151], a[228:231], a[140:143], v[148:151]
    ds_read_b64_tr_b16 a[204:205], v7 offset:40960
    v_mfma_f32_16x16x32_bf16 v[144:147], a[228:231], a[132:135], v[144:147]
    ds_read_b64_tr_b16 a[206:207], v7 offset:45056
    s_waitcnt lgkmcnt(8)
    v_mfma_f32_16x16x32_bf16 v[144:147], a[224:227], a[128:131], v[144:147]
    ds_read_b64_tr_b16 a[208:209], v8 offset:32768
    s_waitcnt lgkmcnt(5)
    v_mfma_f32_16x16x32_bf16 v[192:195], a[192:195], a[160:163], v[192:195]
    s_add_u32 m0, s47, 8192
    s_xor_b32 s40, s78, 896
L1_pb2:
    s_cbranch_execz L1_pc2
    v_mfma_f32_16x16x32_bf16 v[192:195], a[196:199], a[164:167], v[192:195]
    ds_read_b64_tr_b16 a[210:211], v8 offset:36864
    v_mfma_f32_16x16x32_bf16 v[196:199], a[196:199], a[172:175], v[196:199]
    buffer_load_dwordx4 v34, s[20:23], s40 offen offset:0 lds
    v_mfma_f32_16x16x32_bf16 v[196:199], a[192:195], a[168:171], v[196:199]
    ds_read_b64_tr_b16 a[212:213], v8 offset:40960
    v_mfma_f32_16x16x32_bf16 v[200:203], a[192:195], a[176:179], v[200:203]
    v_mfma_f32_16x16x32_bf16 v[200:203], a[196:199], a[180:183], v[200:203]
    ds_read_b64_tr_b16 a[214:215], v8 offset:45056
    v_mfma_f32_16x16x32_bf16 v[204:207], a[196:199], a[188:191], v[204:207]
    ds_read_b64_tr_b16 a[216:217], v9 offset:32768
    v_mfma_f32_16x16x32_bf16 v[204:207], a[192:195], a[184:187], v[204:207]
    s_waitcnt lgkmcnt(5)
    v_smfmac_f32_16x16x64_bf16 a[232:235], v[24:27], a[192:199], v20
    ds_read_b64_tr_b16 a[218:219], v9 offset:36864
    v_mfma_f32_16x16x32_bf16 v[76:79], a[200:203], a[184:187], v[76:79]
    buffer_load_dwordx4 v35, s[20:23], s40 offen offset:1024 lds
    v_mfma_f32_16x16x32_bf16 v[76:79], a[204:207], a[188:191], v[76:79]
    ds_read_b64_tr_b16 a[220:221], v9 offset:40960
    v_mfma_f32_16x16x32_bf16 v[72:75], a[204:207], a[180:183], v[72:75]
    buffer_load_dwordx4 v36, s[20:23], s40 offen offset:2048 lds
    v_mfma_f32_16x16x32_bf16 v[72:75], a[200:203], a[176:179], v[72:75]
    ds_read_b64_tr_b16 a[222:223], v9 offset:45056
    v_mfma_f32_16x16x32_bf16 v[68:71], a[200:203], a[168:171], v[68:71]
    v_mfma_f32_16x16x32_bf16 v[68:71], a[204:207], a[172:175], v[68:71]
    ds_read_b64_tr_b16 a[224:225], v10 offset:32768
    v_mfma_f32_16x16x32_bf16 v[64:67], a[204:207], a[164:167], v[64:67]
    v_mfma_f32_16x16x32_bf16 v[64:67], a[200:203], a[160:163], v[64:67]
    ds_read_b64_tr_b16 a[226:227], v10 offset:36864
    v_smfmac_f32_16x16x64_bf16 a[236:239], v[24:27], a[200:207], v20
    s_waitcnt lgkmcnt(6)
    v_mfma_f32_16x16x32_bf16 v[208:211], a[208:211], a[160:163], v[208:211]
    ds_read_b64_tr_b16 a[228:229], v10 offset:40960
    v_mfma_f32_16x16x32_bf16 v[208:211], a[212:215], a[164:167], v[208:211]
    buffer_load_dwordx4 v37, s[20:23], s40 offen offset:3072 lds
    v_mfma_f32_16x16x32_bf16 v[212:215], a[212:215], a[172:175], v[212:215]
    ds_read_b64_tr_b16 a[230:231], v10 offset:45056
    s_add_u32 m0, s47, 12288
    v_mfma_f32_16x16x32_bf16 v[212:215], a[208:211], a[168:171], v[212:215]
    s_xor_b32 s40, s78, 33664
    v_mfma_f32_16x16x32_bf16 v[216:219], a[208:211], a[176:179], v[216:219]
    ds_read_b64_tr_b16 a[192:193], v60 offset:16384
    v_mfma_f32_16x16x32_bf16 v[216:219], a[212:215], a[180:183], v[216:219]
    buffer_load_dwordx4 v34, s[20:23], s40 offen offset:0 lds
    v_mfma_f32_16x16x32_bf16 v[220:223], a[212:215], a[188:191], v[220:223]
    ds_read_b64_tr_b16 a[194:195], v60 offset:18432
    v_mfma_f32_16x16x32_bf16 v[220:223], a[208:211], a[184:187], v[220:223]
    s_waitcnt lgkmcnt(6)
    v_mfma_f32_16x16x32_bf16 v[92:95], a[216:219], a[184:187], v[92:95]
    ds_read_b64_tr_b16 a[196:197], v60 offset:20480
    v_mfma_f32_16x16x32_bf16 v[92:95], a[220:223], a[188:191], v[92:95]
    buffer_load_dwordx4 v35, s[20:23], s40 offen offset:1024 lds
    v_mfma_f32_16x16x32_bf16 v[88:91], a[220:223], a[180:183], v[88:91]
    ds_read_b64_tr_b16 a[198:199], v60 offset:22528
    v_mfma_f32_16x16x32_bf16 v[88:91], a[216:219], a[176:179], v[88:91]
    v_mfma_f32_16x16x32_bf16 v[84:87], a[216:219], a[168:171], v[84:87]
    ds_read_b64_tr_b16 a[200:201], v11 offset:32768
    v_mfma_f32_16x16x32_bf16 v[84:87], a[220:223], a[172:175], v[84:87]
    ds_read_b64_tr_b16 a[202:203], v11 offset:36864
    v_mfma_f32_16x16x32_bf16 v[80:83], a[220:223], a[164:167], v[80:83]
    ds_read_b64_tr_b16 a[204:205], v11 offset:40960
    v_mfma_f32_16x16x32_bf16 v[80:83], a[216:219], a[160:163], v[80:83]
    ds_read_b64_tr_b16 a[206:207], v11 offset:45056
    s_waitcnt lgkmcnt(8)
    v_mfma_f32_16x16x32_bf16 v[224:227], a[224:227], a[160:163], v[224:227]
    ds_read_b64_tr_b16 a[208:209], v12 offset:32768
    v_mfma_f32_16x16x32_bf16 v[224:227], a[228:231], a[164:167], v[224:227]
    buffer_load_dwordx4 v36, s[20:23], s40 offen offset:2048 lds
    v_mfma_f32_16x16x32_bf16 v[228:231], a[228:231], a[172:175], v[228:231]
    ds_read_b64_tr_b16 a[210:211], v12 offset:36864
    v_mfma_f32_16x16x32_bf16 v[228:231], a[224:227], a[168:171], v[228:231]
    buffer_load_dwordx4 v37, s[20:23], s40 offen offset:3072 lds
    v_mfma_f32_16x16x32_bf16 v[232:235], a[224:227], a[176:179], v[232:235]
    ds_read_b64_tr_b16 a[212:213], v12 offset:40960
    v_mfma_f32_16x16x32_bf16 v[232:235], a[228:231], a[180:183], v[232:235]
    ds_read_b64_tr_b16 a[214:215], v12 offset:45056
    v_mfma_f32_16x16x32_bf16 v[236:239], a[228:231], a[188:191], v[236:239]
    ds_read_b64_tr_b16 a[216:217], v13 offset:32768
    s_add_u32 m0, s41, 81920
    v_mfma_f32_16x16x32_bf16 v[236:239], a[224:227], a[184:187], v[236:239]
    s_waitcnt lgkmcnt(9)
    s_waitcnt lgkmcnt(5)
    v_smfmac_f32_16x16x64_bf16 a[240:243], v[24:27], a[192:199], v20
    ds_read_b64_tr_b16 a[218:219], v13 offset:36864
    v_mfma_f32_16x16x32_bf16 v[108:111], a[200:203], a[184:187], v[108:111]
    s_xor_b32 s40, s79, 3670016
    v_mfma_f32_16x16x32_bf16 v[108:111], a[204:207], a[188:191], v[108:111]
    ds_read_b64_tr_b16 a[220:221], v13 offset:40960
    v_mfma_f32_16x16x32_bf16 v[104:107], a[204:207], a[180:183], v[104:107]
    buffer_load_dwordx4 v38, s[24:27], s40 offen offset:0 lds
    v_mfma_f32_16x16x32_bf16 v[104:107], a[200:203], a[176:179], v[104:107]
    ds_read_b64_tr_b16 a[222:223], v13 offset:45056
    v_mfma_f32_16x16x32_bf16 v[100:103], a[200:203], a[168:171], v[100:103]
    ds_read_b64_tr_b16 a[224:225], v56 offset:16384
    v_mfma_f32_16x16x32_bf16 v[100:103], a[204:207], a[172:175], v[100:103]
    buffer_load_dwordx4 v39, s[24:27], s40 offen offset:1024 lds
    v_mfma_f32_16x16x32_bf16 v[96:99], a[204:207], a[164:167], v[96:99]
    ds_read_b64_tr_b16 a[226:227], v56 offset:18432
    s_waitcnt vmcnt(16)
    v_mfma_f32_16x16x32_bf16 v[96:99], a[200:203], a[160:163], v[96:99]
    s_waitcnt lgkmcnt(6)
    ds_read_b128 a[128:131], v32 offset:0
    v_mfma_f32_16x16x32_bf16 v[240:243], a[208:211], a[160:163], v[240:243]
    ds_read_b64_tr_b16 a[228:229], v56 offset:20480
    v_mfma_f32_16x16x32_bf16 v[240:243], a[212:215], a[164:167], v[240:243]
    ds_read_b128 a[132:135], v33 offset:0
    v_mfma_f32_16x16x32_bf16 v[244:247], a[212:215], a[172:175], v[244:247]
    ds_read_b64_tr_b16 a[230:231], v56 offset:22528
    v_mfma_f32_16x16x32_bf16 v[244:247], a[208:211], a[168:171], v[244:247]
    ds_read_b128 a[136:139], v32 offset:2048
    v_mfma_f32_16x16x32_bf16 v[248:251], a[208:211], a[176:179], v[248:251]
    ds_read_b64_tr_b16 a[192:193], v57 offset:16384
    v_mfma_f32_16x16x32_bf16 v[248:251], a[212:215], a[180:183], v[248:251]
    ds_read_b128 a[140:143], v33 offset:2048
    v_mfma_f32_16x16x32_bf16 v[252:255], a[212:215], a[188:191], v[252:255]
    ds_read_b64_tr_b16 a[194:195], v57 offset:18432
    v_mfma_f32_16x16x32_bf16 v[252:255], a[208:211], a[184:187], v[252:255]
    s_waitcnt lgkmcnt(10)
    ds_read_b128 a[144:147], v32 offset:4096
    v_mfma_f32_16x16x32_bf16 v[124:127], a[216:219], a[184:187], v[124:127]
    ds_read_b64_tr_b16 a[196:197], v57 offset:20480
    v_mfma_f32_16x16x32_bf16 v[124:127], a[220:223], a[188:191], v[124:127]
    ds_read_b128 a[148:151], v33 offset:4096
    v_mfma_f32_16x16x32_bf16 v[120:123], a[220:223], a[180:183], v[120:123]
    ds_read_b64_tr_b16 a[198:199], v57 offset:22528
    v_mfma_f32_16x16x32_bf16 v[120:123], a[216:219], a[176:179], v[120:123]
    ds_read_b128 a[152:155], v32 offset:6144
    v_mfma_f32_16x16x32_bf16 v[116:119], a[216:219], a[168:171], v[116:119]
    ds_read_b128 a[156:159], v33 offset:6144
    v_mfma_f32_16x16x32_bf16 v[116:119], a[220:223], a[172:175], v[116:119]
    buffer_load_dwordx4 v40, s[24:27], s40 offen offset:2048 lds
    v_mfma_f32_16x16x32_bf16 v[112:115], a[220:223], a[164:167], v[112:115]
    buffer_load_dwordx4 v41, s[24:27], s40 offen offset:3072 lds
    v_mfma_f32_16x16x32_bf16 v[112:115], a[216:219], a[160:163], v[112:115]
    s_waitcnt lgkmcnt(10)
    s_add_u32 m0, s68, 139264
    v_mfma_f32_16x16x32_bf16 v[128:131], a[224:227], a[160:163], v[128:131]
    s_xor_b32 s40, s42, 7
    s_mul_i32 s40, s40, 176128
    v_mfma_f32_16x16x32_bf16 v[128:131], a[228:231], a[164:167], v[128:131]
    buffer_load_dwordx4 v42, s[28:31], s40 offen offset:0 lds
    v_mfma_f32_16x16x32_bf16 v[132:135], a[228:231], a[172:175], v[132:135]
    buffer_load_dwordx4 v43, s[28:31], s40 offen offset:1024 lds
    v_mfma_f32_16x16x32_bf16 v[132:135], a[224:227], a[168:171], v[132:135]
    s_waitcnt vmcnt(14)
    v_mfma_f32_16x16x32_bf16 v[136:139], a[224:227], a[176:179], v[136:139]
    s_waitcnt lgkmcnt(2)
    s_barrier
    v_mfma_f32_16x16x32_bf16 v[136:139], a[228:231], a[180:183], v[136:139]
    ds_read_b64_tr_b16 a[200:201], v6 offset:0
    v_mfma_f32_16x16x32_bf16 v[140:143], a[228:231], a[188:191], v[140:143]
    ds_read_b64_tr_b16 a[202:203], v6 offset:4096
    v_mfma_f32_16x16x32_bf16 v[140:143], a[224:227], a[184:187], v[140:143]
    ds_read_b64_tr_b16 a[204:205], v6 offset:8192
    v_mfma_f32_16x16x32_bf16 v[156:159], a[192:195], a[184:187], v[156:159]
    ds_read_b64_tr_b16 a[206:207], v6 offset:12288
    v_mfma_f32_16x16x32_bf16 v[156:159], a[196:199], a[188:191], v[156:159]
    ds_read_b64_tr_b16 a[208:209], v7 offset:0
    v_mfma_f32_16x16x32_bf16 v[152:155], a[196:199], a[180:183], v[152:155]
    s_mov_b64 exec, 1
    buffer_load_dword v22, off, s[52:55], s65 sc1
    s_mov_b64 exec, -1
    v_mfma_f32_16x16x32_bf16 v[152:155], a[192:195], a[176:179], v[152:155]
    ds_read_b64_tr_b16 a[210:211], v7 offset:4096
    v_mfma_f32_16x16x32_bf16 v[148:151], a[192:195], a[168:171], v[148:151]
    buffer_load_dwordx2 v[48:49], v61, s[32:35], s80 offen offset:0
    v_mfma_f32_16x16x32_bf16 v[148:151], a[196:199], a[172:175], v[148:151]
    ds_read_b64_tr_b16 a[212:213], v7 offset:8192
    v_mfma_f32_16x16x32_bf16 v[144:147], a[196:199], a[164:167], v[144:147]
    ds_read_b64_tr_b16 a[214:215], v7 offset:12288
    s_waitcnt lgkmcnt(8)
    v_mfma_f32_16x16x32_bf16 v[144:147], a[192:195], a[160:163], v[144:147]
    ds_read_b64_tr_b16 a[216:217], v8 offset:0
    s_waitcnt lgkmcnt(5)
    v_mfma_f32_16x16x32_bf16 v[192:195], a[200:203], a[128:131], v[192:195]
    buffer_load_dwordx2 v[50:51], v61, s[32:35], s80 offen offset:32
    v_mfma_f32_16x16x32_bf16 v[192:195], a[204:207], a[132:135], v[192:195]
    ds_read_b64_tr_b16 a[218:219], v8 offset:4096
    v_mfma_f32_16x16x32_bf16 v[196:199], a[204:207], a[140:143], v[196:199]
    buffer_load_dwordx2 v[52:53], v61, s[32:35], s81 offen offset:0
    v_mfma_f32_16x16x32_bf16 v[196:199], a[200:203], a[136:139], v[196:199]
    ds_read_b64_tr_b16 a[220:221], v8 offset:8192
    v_mfma_f32_16x16x32_bf16 v[200:203], a[200:203], a[144:147], v[200:203]
    buffer_load_dwordx2 v[54:55], v61, s[32:35], s81 offen offset:32
    v_mfma_f32_16x16x32_bf16 v[200:203], a[204:207], a[148:151], v[200:203]
    ds_read_b64_tr_b16 a[222:223], v8 offset:12288
    v_mfma_f32_16x16x32_bf16 v[204:207], a[204:207], a[156:159], v[204:207]
    ds_read_b64_tr_b16 a[224:225], v9 offset:0
    v_mfma_f32_16x16x32_bf16 v[204:207], a[200:203], a[152:155], v[204:207]
    s_waitcnt lgkmcnt(5)
    v_smfmac_f32_16x16x64_bf16 a[232:235], v[24:27], a[200:207], v20
    ds_read_b64_tr_b16 a[226:227], v9 offset:4096
    v_mfma_f32_16x16x32_bf16 v[76:79], a[208:211], a[152:155], v[76:79]
    s_mov_b32 exec_hi, 0
    buffer_store_dwordx4 v[44:47], v1, s[84:87], s70 offen sc1
    s_mov_b64 exec, -1
    v_mfma_f32_16x16x32_bf16 v[76:79], a[212:215], a[156:159], v[76:79]
    ds_read_b64_tr_b16 a[228:229], v9 offset:8192
    s_mov_b32 s24, s82
    v_mfma_f32_16x16x32_bf16 v[72:75], a[212:215], a[148:151], v[72:75]
    s_mov_b32 s25, s83
    s_mov_b32 s26, 4194304
    v_mfma_f32_16x16x32_bf16 v[72:75], a[208:211], a[144:147], v[72:75]
    ds_read_b64_tr_b16 a[230:231], v9 offset:12288
    s_mov_b32 s27, 0x20000
    v_mfma_f32_16x16x32_bf16 v[68:71], a[208:211], a[136:139], v[68:71]
    s_mov_b32 s28, s88
    s_mov_b32 s29, s89
    v_mfma_f32_16x16x32_bf16 v[68:71], a[212:215], a[140:143], v[68:71]
    ds_read_b64_tr_b16 a[192:193], v10 offset:0
    s_mov_b32 s30, 1409024
    v_mfma_f32_16x16x32_bf16 v[64:67], a[212:215], a[132:135], v[64:67]
    s_mov_b32 s31, 0x20000
    s_mov_b32 s32, s90
    v_mfma_f32_16x16x32_bf16 v[64:67], a[208:211], a[128:131], v[64:67]
    ds_read_b64_tr_b16 a[194:195], v10 offset:4096
    s_mov_b32 s33, s91
    v_smfmac_f32_16x16x64_bf16 a[236:239], v[24:27], a[208:215], v20
    s_waitcnt lgkmcnt(6)
    v_mfma_f32_16x16x32_bf16 v[208:211], a[216:219], a[128:131], v[208:211]
    ds_read_b64_tr_b16 a[196:197], v10 offset:8192
    s_mov_b32 s34, 1024
    v_mfma_f32_16x16x32_bf16 v[208:211], a[220:223], a[132:135], v[208:211]
    s_mov_b32 s35, 0x20000
    s_mov_b32 s48, s92
    v_mfma_f32_16x16x32_bf16 v[212:215], a[220:223], a[140:143], v[212:215]
    ds_read_b64_tr_b16 a[198:199], v10 offset:12288
    s_mov_b32 s49, s93
    v_mfma_f32_16x16x32_bf16 v[212:215], a[216:219], a[136:139], v[212:215]
    s_mov_b32 s50, 2097152
    s_mov_b32 s51, 0x20000
    v_mfma_f32_16x16x32_bf16 v[216:219], a[216:219], a[144:147], v[216:219]
    ds_read_b64_tr_b16 a[200:201], v60 offset:0
    s_bfe_u32 s82, s2, 0x20001
    v_mfma_f32_16x16x32_bf16 v[216:219], a[220:223], a[148:151], v[216:219]
    s_and_b32 s3, s2, 1
    s_lshl_b32 s3, s3, 3
    v_mfma_f32_16x16x32_bf16 v[220:223], a[220:223], a[156:159], v[220:223]
    ds_read_b64_tr_b16 a[202:203], v60 offset:2048
    s_bfe_u32 s4, s2, 196611
    v_mfma_f32_16x16x32_bf16 v[220:223], a[216:219], a[152:155], v[220:223]
    s_waitcnt lgkmcnt(6)
    s_add_u32 s56, s3, s4
    v_mfma_f32_16x16x32_bf16 v[92:95], a[224:227], a[152:155], v[92:95]
    ds_read_b64_tr_b16 a[204:205], v60 offset:4096
    s_bfe_u32 s57, s2, 131078
    v_mfma_f32_16x16x32_bf16 v[92:95], a[228:231], a[156:159], v[92:95]
    s_lshl_b32 s3, s56, 3
    s_lshl_b32 s4, s45, 1
    v_mfma_f32_16x16x32_bf16 v[88:91], a[228:231], a[148:151], v[88:91]
    ds_read_b64_tr_b16 a[206:207], v60 offset:6144
    s_add_u32 s3, s3, s4
    v_mfma_f32_16x16x32_bf16 v[88:91], a[224:227], a[144:147], v[88:91]
    s_lshl_b32 s58, s3, 17
    s_lshl_b32 s4, s82, 15
    v_mfma_f32_16x16x32_bf16 v[84:87], a[224:227], a[136:139], v[84:87]
    ds_read_b64_tr_b16 a[208:209], v11 offset:0
    s_add_u32 s58, s58, s4
    v_mfma_f32_16x16x32_bf16 v[84:87], a[228:231], a[140:143], v[84:87]
    ds_read_b64_tr_b16 a[210:211], v11 offset:4096
    s_lshl_b32 s59, s3, 10
    v_mfma_f32_16x16x32_bf16 v[80:83], a[228:231], a[132:135], v[80:83]
    ds_read_b64_tr_b16 a[212:213], v11 offset:8192
    s_mul_i32 s4, s82, 1441792
    v_mfma_f32_16x16x32_bf16 v[80:83], a[224:227], a[128:131], v[80:83]
    ds_read_b64_tr_b16 a[214:215], v11 offset:12288
    s_waitcnt lgkmcnt(8)
    v_mfma_f32_16x16x32_bf16 v[224:227], a[192:195], a[128:131], v[224:227]
    ds_read_b64_tr_b16 a[216:217], v12 offset:0
    s_add_u32 s59, s59, s4
    v_mfma_f32_16x16x32_bf16 v[224:227], a[196:199], a[132:135], v[224:227]
    s_lshl_b32 s71, s82, 20
    s_mul_i32 s75, s82, 360448
    v_mfma_f32_16x16x32_bf16 v[228:231], a[196:199], a[140:143], v[228:231]
    ds_read_b64_tr_b16 a[218:219], v12 offset:4096
    s_mul_i32 s4, s57, 0
    v_mfma_f32_16x16x32_bf16 v[228:231], a[192:195], a[136:139], v[228:231]
    s_waitcnt vmcnt(12)
    s_add_u32 s71, s71, s4
    v_mfma_f32_16x16x32_bf16 v[232:235], a[192:195], a[144:147], v[232:235]
    ds_read_b64_tr_b16 a[220:221], v12 offset:8192
    s_mul_i32 s4, s57, 0
    v_mfma_f32_16x16x32_bf16 v[232:235], a[196:199], a[148:151], v[232:235]
    ds_read_b64_tr_b16 a[222:223], v12 offset:12288
    s_add_u32 s58, s58, s4
    v_mfma_f32_16x16x32_bf16 v[236:239], a[196:199], a[156:159], v[236:239]
    ds_read_b64_tr_b16 a[224:225], v13 offset:0
    s_mul_i32 s83, s2, 49152
    v_mfma_f32_16x16x32_bf16 v[236:239], a[192:195], a[152:155], v[236:239]
    s_waitcnt lgkmcnt(9)
    s_waitcnt lgkmcnt(5)
    v_smfmac_f32_16x16x64_bf16 a[240:243], v[24:27], a[200:207], v20
    ds_read_b64_tr_b16 a[226:227], v13 offset:4096
    v_mfma_f32_16x16x32_bf16 v[108:111], a[208:211], a[152:155], v[108:111]
    ds_read_b128 a[160:163], v32 offset:8192
    s_add_u32 s83, s83, s68
    v_mfma_f32_16x16x32_bf16 v[108:111], a[212:215], a[156:159], v[108:111]
    ds_read_b64_tr_b16 a[228:229], v13 offset:8192
    s_bfe_u32 s4, s58, 0x40014
    v_mfma_f32_16x16x32_bf16 v[104:107], a[212:215], a[148:151], v[104:107]
    ds_read_b128 a[164:167], v33 offset:8192
    s_lshl_b32 s4, s4, 11
    v_mfma_f32_16x16x32_bf16 v[104:107], a[208:211], a[144:147], v[104:107]
    ds_read_b64_tr_b16 a[230:231], v13 offset:12288
    s_xor_b32 s58, s58, s4
    v_mfma_f32_16x16x32_bf16 v[100:103], a[208:211], a[136:139], v[100:103]
    ds_read_b64_tr_b16 a[192:193], v56 offset:0
    s_xor_b32 s4, s2, 6
    v_mfma_f32_16x16x32_bf16 v[100:103], a[212:215], a[140:143], v[100:103]
    ds_read_b128 a[168:171], v32 offset:10240
    s_mul_i32 s4, s4, 49152
    v_mfma_f32_16x16x32_bf16 v[96:99], a[212:215], a[132:135], v[96:99]
    ds_read_b64_tr_b16 a[194:195], v56 offset:2048
    s_add_u32 s4, s4, 0
    v_mfma_f32_16x16x32_bf16 v[96:99], a[208:211], a[128:131], v[96:99]
    s_waitcnt lgkmcnt(9)
    ds_read_b128 a[172:175], v33 offset:10240
    v_mfma_f32_16x16x32_bf16 v[240:243], a[216:219], a[128:131], v[240:243]
    ds_read_b64_tr_b16 a[196:197], v56 offset:4096
    s_add_u32 s88, s4, s68
    v_mfma_f32_16x16x32_bf16 v[240:243], a[220:223], a[132:135], v[240:243]
    ds_read_b128 a[176:179], v32 offset:12288
    s_xor_b32 s4, s2, 4
    v_mfma_f32_16x16x32_bf16 v[244:247], a[220:223], a[140:143], v[244:247]
    ds_read_b64_tr_b16 a[198:199], v56 offset:6144
    s_waitcnt vmcnt(5)
    v_mfma_f32_16x16x32_bf16 v[244:247], a[216:219], a[136:139], v[244:247]
    ds_read_b128 a[180:183], v33 offset:12288
    v_cmp_ne_u32 vcc, 15, v22
    s_nop 0
    s_and_b32 s6, vcc_lo, 1
    s_cbranch_scc1 L1_ptb_spin
L1_ptb_ok:
    v_mfma_f32_16x16x32_bf16 v[248:251], a[216:219], a[144:147], v[248:251]
    ds_read_b64_tr_b16 a[200:201], v57 offset:0
    s_mul_i32 s4, s4, 49152
    v_mfma_f32_16x16x32_bf16 v[248:251], a[220:223], a[148:151], v[248:251]
    ds_read_b128 a[184:187], v32 offset:14336
    s_add_u32 s4, s4, 8192
    v_mfma_f32_16x16x32_bf16 v[252:255], a[220:223], a[156:159], v[252:255]
    ds_read_b64_tr_b16 a[202:203], v57 offset:2048
    s_add_u32 s89, s4, s68
    v_mfma_f32_16x16x32_bf16 v[252:255], a[216:219], a[152:155], v[252:255]
    s_waitcnt lgkmcnt(11)
    ds_read_b128 a[188:191], v33 offset:14336
    v_mfma_f32_16x16x32_bf16 v[124:127], a[224:227], a[152:155], v[124:127]
    ds_read_b64_tr_b16 a[204:205], v57 offset:4096
    s_xor_b32 s4, s2, 2
    v_mfma_f32_16x16x32_bf16 v[124:127], a[228:231], a[156:159], v[124:127]
    buffer_load_dwordx2 a[244:245], v62, s[84:87], s66 offen offset:0 sc1
    v_mfma_f32_16x16x32_bf16 v[120:123], a[228:231], a[148:151], v[120:123]
    ds_read_b64_tr_b16 a[206:207], v57 offset:6144
    s_mul_i32 s4, s4, 49152
    v_mfma_f32_16x16x32_bf16 v[120:123], a[224:227], a[144:147], v[120:123]
    buffer_load_dwordx2 a[246:247], v62, s[84:87], s66 offen offset:128 sc1
    v_mfma_f32_16x16x32_bf16 v[116:119], a[224:227], a[136:139], v[116:119]
    buffer_load_dwordx2 a[248:249], v62, s[84:87], s66 offen offset:256 sc1
    v_mfma_f32_16x16x32_bf16 v[116:119], a[228:231], a[140:143], v[116:119]
    buffer_load_dwordx2 a[250:251], v62, s[84:87], s66 offen offset:384 sc1
    v_mfma_f32_16x16x32_bf16 v[112:115], a[228:231], a[132:135], v[112:115]
    s_add_u32 s4, s4, 16384
    s_add_u32 s90, s4, s68
    v_mfma_f32_16x16x32_bf16 v[112:115], a[224:227], a[128:131], v[112:115]
    s_waitcnt lgkmcnt(7)
    s_lshl_b32 s92, s57, 8
    v_mfma_f32_16x16x32_bf16 v[128:131], a[192:195], a[128:131], v[128:131]
    s_add_u32 s92, s92, s47
    s_and_b32 s3, s3, 12
    v_mfma_f32_16x16x32_bf16 v[128:131], a[196:199], a[132:135], v[128:131]
    s_lshl_b32 s3, s3, 7
    s_lshr_b32 s4, s56, 1
    v_mfma_f32_16x16x32_bf16 v[132:135], a[196:199], a[140:143], v[132:135]
    s_lshl_b32 s4, s4, 16
    s_add_u32 s3, s3, s4
    v_mfma_f32_16x16x32_bf16 v[132:135], a[192:195], a[136:139], v[132:135]
    s_waitcnt vmcnt(10)
    s_lshl_b32 s4, s82, 12
    v_mfma_f32_16x16x32_bf16 v[136:139], a[192:195], a[144:147], v[136:139]
    s_waitcnt lgkmcnt(0)
    s_waitcnt lgkmcnt(2)
    s_barrier
    v_mfma_f32_16x16x32_bf16 v[136:139], a[196:199], a[148:151], v[136:139]
    ds_read_b64_tr_b16 a[208:209], v6 offset:16384
    s_add_u32 m0, s41, 0
    v_mfma_f32_16x16x32_bf16 v[140:143], a[196:199], a[156:159], v[140:143]
    ds_read_b64_tr_b16 a[210:211], v6 offset:20480
    s_mov_b32 s40, 0
    v_mfma_f32_16x16x32_bf16 v[140:143], a[192:195], a[152:155], v[140:143]
    ds_read_b64_tr_b16 a[212:213], v6 offset:24576
    s_add_u32 s3, s3, s4
    v_mfma_f32_16x16x32_bf16 v[156:159], a[200:203], a[152:155], v[156:159]
    ds_read_b64_tr_b16 a[214:215], v6 offset:28672
    s_add_u32 s93, s3, 12582912
    v_mfma_f32_16x16x32_bf16 v[156:159], a[204:207], a[156:159], v[156:159]
    ds_read_b64_tr_b16 a[216:217], v60 offset:8192
    s_xor_b32 s94, s70, 12288
    v_mfma_f32_16x16x32_bf16 v[152:155], a[204:207], a[148:151], v[152:155]
    buffer_load_dwordx4 v14, s[8:11], s40 offen offset:0 lds
    v_mfma_f32_16x16x32_bf16 v[152:155], a[200:203], a[144:147], v[152:155]
    ds_read_b64_tr_b16 a[218:219], v60 offset:10240
    s_xor_b32 s95, s82, 3
    v_mfma_f32_16x16x32_bf16 v[148:151], a[200:203], a[136:139], v[148:151]
    buffer_load_dwordx4 v15, s[8:11], s40 offen offset:1024 lds
    v_mfma_f32_16x16x32_bf16 v[148:151], a[204:207], a[140:143], v[148:151]
    ds_read_b64_tr_b16 a[220:221], v60 offset:12288
    s_lshl_b32 s95, s95, 6
    v_mfma_f32_16x16x32_bf16 v[144:147], a[204:207], a[132:135], v[144:147]
    ds_read_b64_tr_b16 a[222:223], v60 offset:14336
    s_lshl_b32 s91, s45, 6
    v_mfma_f32_16x16x32_bf16 v[144:147], a[200:203], a[128:131], v[144:147]
    ds_read_b64_tr_b16 a[224:225], v7 offset:16384
    s_waitcnt lgkmcnt(5)
    v_mfma_f32_16x16x32_bf16 v[192:195], a[208:211], a[160:163], v[192:195]
    ds_read_b64_tr_b16 a[226:227], v7 offset:20480
    v_lshrrev_b32 v21, 8, v1
    v_mfma_f32_16x16x32_bf16 v[192:195], a[212:215], a[164:167], v[192:195]
    ds_read_b64_tr_b16 a[228:229], v7 offset:24576
    v_xor_b32 v22, s45, v21
    v_mfma_f32_16x16x32_bf16 v[196:199], a[212:215], a[172:175], v[196:199]
    ds_read_b64_tr_b16 a[230:231], v7 offset:28672
    v_lshl_add_u32 v22, v21, 2, v22
    v_mfma_f32_16x16x32_bf16 v[196:199], a[208:211], a[168:171], v[196:199]
    ds_read_b64_tr_b16 a[192:193], v56 offset:8192
    v_bfe_u32 v0, v1, 4, 4
    v_mfma_f32_16x16x32_bf16 v[200:203], a[208:211], a[176:179], v[200:203]
    buffer_load_dwordx4 v16, s[8:11], s40 offen offset:2048 lds
    v_mfma_f32_16x16x32_bf16 v[200:203], a[212:215], a[180:183], v[200:203]
    ds_read_b64_tr_b16 a[194:195], v56 offset:10240
    v_lshlrev_b32 v0, 2, v0
    v_mfma_f32_16x16x32_bf16 v[204:207], a[212:215], a[188:191], v[204:207]
    buffer_load_dwordx4 v17, s[8:11], s40 offen offset:3072 lds
    v_lshl_add_u32 v22, v22, 7, v0
    v_mfma_f32_16x16x32_bf16 v[204:207], a[208:211], a[184:187], v[204:207]
    ds_read_b64_tr_b16 a[196:197], v56 offset:12288
    s_waitcnt lgkmcnt(7)
    s_lshl_b32 s4, s45, 6
    v_smfmac_f32_16x16x64_bf16 a[232:235], v[24:27], a[208:215], v20
    ds_read_b64_tr_b16 a[198:199], v56 offset:14336
    v_add_u32 v22, 155648, v22
    v_smfmac_f32_16x16x64_bf16 a[240:243], v[24:27], a[216:223], v20
    ds_read_b64_tr_b16 a[200:201], v57 offset:8192
    s_waitcnt lgkmcnt(5)
    v_mfma_f32_16x16x32_bf16 v[76:79], a[224:227], a[184:187], v[76:79]
    s_add_u32 m0, s41, 16384
    s_mov_b32 s40, 16384
    v_mfma_f32_16x16x32_bf16 v[76:79], a[228:231], a[188:191], v[76:79]
    ds_read_b64_tr_b16 a[202:203], v57 offset:10240
    s_add_u32 s4, s4, 157696
    v_mfma_f32_16x16x32_bf16 v[72:75], a[228:231], a[180:183], v[72:75]
    buffer_load_dwordx4 v14, s[8:11], s40 offen offset:0 lds
    v_mfma_f32_16x16x32_bf16 v[72:75], a[224:227], a[176:179], v[72:75]
    ds_read_b64_tr_b16 a[204:205], v57 offset:12288
    v_add_u32 v0, s4, v0
    v_mfma_f32_16x16x32_bf16 v[68:71], a[224:227], a[168:171], v[68:71]
    v_mfma_f32_16x16x32_bf16 v[68:71], a[228:231], a[172:175], v[68:71]
    ds_read_b64_tr_b16 a[206:207], v57 offset:14336
    v_mfma_f32_16x16x32_bf16 v[64:67], a[228:231], a[164:167], v[64:67]
    ds_read_b64_tr_b16 a[208:209], v8 offset:16384
    v_mfma_f32_16x16x32_bf16 v[64:67], a[224:227], a[160:163], v[64:67]
    s_waitcnt lgkmcnt(5)
    v_smfmac_f32_16x16x64_bf16 a[236:239], v[24:27], a[224:231], v20
    ds_read_b64_tr_b16 a[210:211], v8 offset:20480
    v_mfma_f32_16x16x32_bf16 v[128:131], a[192:195], a[160:163], v[128:131]
    buffer_load_dwordx4 v15, s[8:11], s40 offen offset:1024 lds
    v_mfma_f32_16x16x32_bf16 v[128:131], a[196:199], a[164:167], v[128:131]
    ds_read_b64_tr_b16 a[212:213], v8 offset:24576
    v_mfma_f32_16x16x32_bf16 v[132:135], a[196:199], a[172:175], v[132:135]
    buffer_load_dwordx4 v16, s[8:11], s40 offen offset:2048 lds
    v_mfma_f32_16x16x32_bf16 v[132:135], a[192:195], a[168:171], v[132:135]
    ds_read_b64_tr_b16 a[214:215], v8 offset:28672
    v_mfma_f32_16x16x32_bf16 v[136:139], a[192:195], a[176:179], v[136:139]
    ds_read_b64_tr_b16 a[216:217], v9 offset:16384
    v_mfma_f32_16x16x32_bf16 v[136:139], a[196:199], a[180:183], v[136:139]
    v_accvgpr_read_b32 v33, a232
    v_accvgpr_read_b32 v34, a233
    v_mfma_f32_16x16x32_bf16 v[140:143], a[196:199], a[188:191], v[140:143]
    ds_read_b64_tr_b16 a[218:219], v9 offset:20480
    v_accvgpr_read_b32 v37, a236
    v_mfma_f32_16x16x32_bf16 v[140:143], a[192:195], a[184:187], v[140:143]
    s_waitcnt lgkmcnt(6)
    v_accvgpr_read_b32 v38, a237
    v_mfma_f32_16x16x32_bf16 v[156:159], a[200:203], a[184:187], v[156:159]
    ds_read_b64_tr_b16 a[220:221], v9 offset:24576
    v_accvgpr_read_b32 v41, a240
    v_mfma_f32_16x16x32_bf16 v[156:159], a[204:207], a[188:191], v[156:159]
    buffer_load_dwordx4 v17, s[8:11], s40 offen offset:3072 lds
    v_mfma_f32_16x16x32_bf16 v[152:155], a[204:207], a[180:183], v[152:155]
    ds_read_b64_tr_b16 a[222:223], v9 offset:28672
    v_accvgpr_read_b32 v42, a241
    v_mfma_f32_16x16x32_bf16 v[152:155], a[200:203], a[176:179], v[152:155]
    s_add_u32 m0, s41, 32768
    s_mov_b32 s40, 32768
    v_mfma_f32_16x16x32_bf16 v[148:151], a[200:203], a[168:171], v[148:151]
    ds_read_b64_tr_b16 a[224:225], v10 offset:16384
    v_add_f32 v33, v33, v34
    v_mfma_f32_16x16x32_bf16 v[148:151], a[204:207], a[172:175], v[148:151]
    buffer_load_dwordx4 v14, s[8:11], s40 offen offset:0 lds
    v_mfma_f32_16x16x32_bf16 v[144:147], a[204:207], a[164:167], v[144:147]
    ds_read_b64_tr_b16 a[226:227], v10 offset:20480
    v_add_f32 v37, v37, v38
    v_mfma_f32_16x16x32_bf16 v[144:147], a[200:203], a[160:163], v[144:147]
    s_waitcnt lgkmcnt(6)
    v_add_f32 v41, v41, v42
    v_mfma_f32_16x16x32_bf16 v[208:211], a[208:211], a[160:163], v[208:211]
    ds_read_b64_tr_b16 a[228:229], v10 offset:24576
    v_mfma_f32_16x16x32_bf16 v[208:211], a[212:215], a[164:167], v[208:211]
    ds_write_b32 v22, v33 offset:0
    v_mfma_f32_16x16x32_bf16 v[212:215], a[212:215], a[172:175], v[212:215]
    ds_read_b64_tr_b16 a[230:231], v10 offset:28672
    ds_write_b32 v22, v37 offset:64
    v_mfma_f32_16x16x32_bf16 v[212:215], a[208:211], a[168:171], v[212:215]
    buffer_load_dwordx4 v15, s[8:11], s40 offen offset:1024 lds
    v_mfma_f32_16x16x32_bf16 v[216:219], a[208:211], a[176:179], v[216:219]
    ds_read_b64_tr_b16 a[192:193], v11 offset:16384
    v_mfma_f32_16x16x32_bf16 v[216:219], a[212:215], a[180:183], v[216:219]
    ds_write_b32 v0, v41
    s_lshl_b32 s3, s45, 9
    v_mfma_f32_16x16x32_bf16 v[220:223], a[212:215], a[188:191], v[220:223]
    ds_read_b64_tr_b16 a[194:195], v11 offset:20480
    v_lshlrev_b32 v21, 4, v21
    v_mfma_f32_16x16x32_bf16 v[220:223], a[208:211], a[184:187], v[220:223]
    s_waitcnt lgkmcnt(9)
    s_add_u32 s3, s3, 155648
    v_mfma_f32_16x16x32_bf16 v[92:95], a[216:219], a[184:187], v[92:95]
    ds_read_b64_tr_b16 a[196:197], v11 offset:24576
    v_add_u32 v22, 157696, v21
    v_mfma_f32_16x16x32_bf16 v[92:95], a[220:223], a[188:191], v[92:95]
    buffer_load_dwordx4 v16, s[8:11], s40 offen offset:2048 lds
    v_mfma_f32_16x16x32_bf16 v[88:91], a[220:223], a[180:183], v[88:91]
    ds_read_b64_tr_b16 a[198:199], v11 offset:28672
    v_add_u32 v21, s3, v21
    v_mfma_f32_16x16x32_bf16 v[88:91], a[216:219], a[176:179], v[88:91]
    s_waitcnt lgkmcnt(3)
    s_barrier
    v_mfma_f32_16x16x32_bf16 v[84:87], a[216:219], a[168:171], v[84:87]
    ds_read_b64_tr_b16 a[200:201], v12 offset:16384
    v_mfma_f32_16x16x32_bf16 v[84:87], a[220:223], a[172:175], v[84:87]
    buffer_load_dwordx4 v17, s[8:11], s40 offen offset:3072 lds
    v_mfma_f32_16x16x32_bf16 v[80:83], a[220:223], a[164:167], v[80:83]
    ds_read_b64_tr_b16 a[202:203], v12 offset:20480
    v_mfma_f32_16x16x32_bf16 v[80:83], a[216:219], a[160:163], v[80:83]
    s_waitcnt lgkmcnt(8)
    ds_read_b128 v[32:35], v21 offset:0
    v_mfma_f32_16x16x32_bf16 v[224:227], a[224:227], a[160:163], v[224:227]
    ds_read_b64_tr_b16 a[204:205], v12 offset:24576
    s_add_u32 m0, s41, 65536
    v_mfma_f32_16x16x32_bf16 v[224:227], a[228:231], a[164:167], v[224:227]
    s_mov_b32 s40, 0
    ds_read_b128 v[36:39], v21 offset:64
    v_mfma_f32_16x16x32_bf16 v[228:231], a[228:231], a[172:175], v[228:231]
    ds_read_b64_tr_b16 a[206:207], v12 offset:28672
    v_mfma_f32_16x16x32_bf16 v[228:231], a[224:227], a[168:171], v[228:231]
    buffer_load_dwordx4 v18, s[12:15], s40 offen offset:0 lds
    v_mfma_f32_16x16x32_bf16 v[232:235], a[224:227], a[176:179], v[232:235]
    ds_read_b64_tr_b16 a[208:209], v13 offset:16384
    v_mfma_f32_16x16x32_bf16 v[232:235], a[228:231], a[180:183], v[232:235]
    ds_read_b128 v[40:43], v21 offset:128
    v_mfma_f32_16x16x32_bf16 v[236:239], a[228:231], a[188:191], v[236:239]
    ds_read_b64_tr_b16 a[210:211], v13 offset:20480
    v_mfma_f32_16x16x32_bf16 v[236:239], a[224:227], a[184:187], v[236:239]
    s_waitcnt lgkmcnt(9)
    ds_read_b128 v[44:47], v21 offset:192
    v_mfma_f32_16x16x32_bf16 v[108:111], a[192:195], a[184:187], v[108:111]
    ds_read_b64_tr_b16 a[212:213], v13 offset:24576
    v_mfma_f32_16x16x32_bf16 v[108:111], a[196:199], a[188:191], v[108:111]
    buffer_load_dwordx4 v19, s[12:15], s40 offen offset:1024 lds
    v_mfma_f32_16x16x32_bf16 v[104:107], a[196:199], a[180:183], v[104:107]
L1_pb3:
    s_cbranch_execz L1_pc3
    ds_read_b64_tr_b16 a[214:215], v13 offset:28672
    v_mfma_f32_16x16x32_bf16 v[104:107], a[192:195], a[176:179], v[104:107]
    v_mfma_f32_16x16x32_bf16 v[100:103], a[192:195], a[168:171], v[100:103]
    s_waitcnt vmcnt(14)
    v_accvgpr_read_b32 v28, a245
    v_mfma_f32_16x16x32_bf16 v[100:103], a[196:199], a[172:175], v[100:103]
    buffer_load_dwordx4 v18, s[12:15], s40 offen offset:2048 lds
    v_mfma_f32_16x16x32_bf16 v[96:99], a[196:199], a[164:167], v[96:99]
    v_accvgpr_read_b32 v29, a247
    v_accvgpr_read_b32 v30, a249
    v_mfma_f32_16x16x32_bf16 v[96:99], a[192:195], a[160:163], v[96:99]
    s_waitcnt lgkmcnt(6)
    v_accvgpr_read_b32 v31, a251
    v_mfma_f32_16x16x32_bf16 v[240:243], a[200:203], a[160:163], v[240:243]
    v_accvgpr_read_b32 v56, a244
    v_accvgpr_read_b32 v58, a246
    v_mfma_f32_16x16x32_bf16 v[240:243], a[204:207], a[164:167], v[240:243]
    v_accvgpr_read_b32 v60, a248
    v_accvgpr_read_b32 v62, a250
    v_mfma_f32_16x16x32_bf16 v[244:247], a[204:207], a[172:175], v[244:247]
    buffer_load_dwordx4 v19, s[12:15], s40 offen offset:3072 lds
    v_mfma_f32_16x16x32_bf16 v[244:247], a[200:203], a[168:171], v[244:247]
    v_mul_f32 v57, 0x3e0293ee, v28
    v_mul_f32 v59, 0x3e0293ee, v29
    v_mfma_f32_16x16x32_bf16 v[248:251], a[200:203], a[176:179], v[248:251]
    v_mul_f32 v61, 0x3e0293ee, v30
    v_mul_f32 v63, 0x3e0293ee, v31
    v_mfma_f32_16x16x32_bf16 v[248:251], a[204:207], a[180:183], v[248:251]
    v_mfma_f32_16x16x32_bf16 v[252:255], a[204:207], a[188:191], v[252:255]
    v_mfma_f32_16x16x32_bf16 v[252:255], a[200:203], a[184:187], v[252:255]
    s_waitcnt lgkmcnt(0)
    v_mfma_f32_16x16x32_bf16 v[124:127], a[208:211], a[184:187], v[124:127]
    v_mfma_f32_16x16x32_bf16 v[124:127], a[212:215], a[188:191], v[124:127]
    v_mfma_f32_16x16x32_bf16 v[120:123], a[212:215], a[180:183], v[120:123]
    v_mfma_f32_16x16x32_bf16 v[120:123], a[208:211], a[176:179], v[120:123]
    v_mfma_f32_16x16x32_bf16 v[116:119], a[208:211], a[168:171], v[116:119]
    v_mfma_f32_16x16x32_bf16 v[116:119], a[212:215], a[172:175], v[116:119]
    v_mfma_f32_16x16x32_bf16 v[112:115], a[212:215], a[164:167], v[112:115]
    v_mfma_f32_16x16x32_bf16 v[112:115], a[208:211], a[160:163], v[112:115]
    s_waitcnt lgkmcnt(7)
    v_pk_fma_f32 v[192:193], v[32:33], v[56:57], v[192:193] op_sel_hi:[1,0,1]
    v_pk_fma_f32 v[194:195], v[34:35], v[56:57], v[194:195] op_sel_hi:[1,0,1]
    v_pk_fma_f32 v[64:65], v[36:37], v[56:57], v[64:65] op_sel_hi:[1,0,1]
    v_pk_fma_f32 v[66:67], v[38:39], v[56:57], v[66:67] op_sel_hi:[1,0,1]
    v_pk_mul_f32 v[192:193], v[192:193], v[56:57] op_sel:[0,1]
    v_pk_mul_f32 v[194:195], v[194:195], v[56:57] op_sel:[0,1]
    v_pk_mul_f32 v[64:65], v[64:65], v[56:57] op_sel:[0,1]
    v_pk_mul_f32 v[66:67], v[66:67], v[56:57] op_sel:[0,1]
    v_cvt_pk_bf16_f32 v192, v192, v193
    v_cvt_pk_bf16_f32 v193, v194, v195
    v_cvt_pk_bf16_f32 v194, v64, v65
    v_cvt_pk_bf16_f32 v195, v66, v67
    v_pk_fma_f32 v[196:197], v[32:33], v[58:59], v[196:197] op_sel_hi:[1,0,1]
    v_pk_fma_f32 v[198:199], v[34:35], v[58:59], v[198:199] op_sel_hi:[1,0,1]
    v_pk_fma_f32 v[68:69], v[36:37], v[58:59], v[68:69] op_sel_hi:[1,0,1]
    v_pk_fma_f32 v[70:71], v[38:39], v[58:59], v[70:71] op_sel_hi:[1,0,1]
    v_pk_mul_f32 v[196:197], v[196:197], v[58:59] op_sel:[0,1]
    v_pk_mul_f32 v[198:199], v[198:199], v[58:59] op_sel:[0,1]
    v_pk_mul_f32 v[68:69], v[68:69], v[58:59] op_sel:[0,1]
    v_pk_mul_f32 v[70:71], v[70:71], v[58:59] op_sel:[0,1]
    v_cvt_pk_bf16_f32 v196, v196, v197
    v_cvt_pk_bf16_f32 v197, v198, v199
    v_cvt_pk_bf16_f32 v198, v68, v69
    v_cvt_pk_bf16_f32 v199, v70, v71
    v_pk_fma_f32 v[200:201], v[32:33], v[60:61], v[200:201] op_sel_hi:[1,0,1]
    v_pk_fma_f32 v[202:203], v[34:35], v[60:61], v[202:203] op_sel_hi:[1,0,1]
    v_pk_fma_f32 v[72:73], v[36:37], v[60:61], v[72:73] op_sel_hi:[1,0,1]
    v_pk_fma_f32 v[74:75], v[38:39], v[60:61], v[74:75] op_sel_hi:[1,0,1]
    v_pk_mul_f32 v[200:201], v[200:201], v[60:61] op_sel:[0,1]
    v_pk_mul_f32 v[202:203], v[202:203], v[60:61] op_sel:[0,1]
    v_pk_mul_f32 v[72:73], v[72:73], v[60:61] op_sel:[0,1]
    v_pk_mul_f32 v[74:75], v[74:75], v[60:61] op_sel:[0,1]
    v_cvt_pk_bf16_f32 v200, v200, v201
    v_cvt_pk_bf16_f32 v201, v202, v203
    v_cvt_pk_bf16_f32 v202, v72, v73
    v_cvt_pk_bf16_f32 v203, v74, v75
    v_pk_fma_f32 v[204:205], v[32:33], v[62:63], v[204:205] op_sel_hi:[1,0,1]
    v_pk_fma_f32 v[206:207], v[34:35], v[62:63], v[206:207] op_sel_hi:[1,0,1]
    v_pk_fma_f32 v[76:77], v[36:37], v[62:63], v[76:77] op_sel_hi:[1,0,1]
    v_pk_fma_f32 v[78:79], v[38:39], v[62:63], v[78:79] op_sel_hi:[1,0,1]
    v_pk_mul_f32 v[204:205], v[204:205], v[62:63] op_sel:[0,1]
    v_pk_mul_f32 v[206:207], v[206:207], v[62:63] op_sel:[0,1]
    v_pk_mul_f32 v[76:77], v[76:77], v[62:63] op_sel:[0,1]
    v_pk_mul_f32 v[78:79], v[78:79], v[62:63] op_sel:[0,1]
    v_cvt_pk_bf16_f32 v204, v204, v205
    v_cvt_pk_bf16_f32 v205, v206, v207
    v_cvt_pk_bf16_f32 v206, v76, v77
    v_cvt_pk_bf16_f32 v207, v78, v79
    ds_read_b128 v[64:67], v21 offset:256
    ds_read_b128 v[68:71], v21 offset:320
    ds_read_b128 v[72:75], v21 offset:384
    ds_read_b128 v[76:79], v21 offset:448
    s_waitcnt lgkmcnt(6)
    v_pk_fma_f32 v[208:209], v[40:41], v[56:57], v[208:209] op_sel_hi:[1,0,1]
    v_pk_fma_f32 v[210:211], v[42:43], v[56:57], v[210:211] op_sel_hi:[1,0,1]
    v_pk_fma_f32 v[80:81], v[44:45], v[56:57], v[80:81] op_sel_hi:[1,0,1]
    v_pk_fma_f32 v[82:83], v[46:47], v[56:57], v[82:83] op_sel_hi:[1,0,1]
    v_pk_mul_f32 v[208:209], v[208:209], v[56:57] op_sel:[0,1]
    v_pk_mul_f32 v[210:211], v[210:211], v[56:57] op_sel:[0,1]
    v_pk_mul_f32 v[80:81], v[80:81], v[56:57] op_sel:[0,1]
    v_pk_mul_f32 v[82:83], v[82:83], v[56:57] op_sel:[0,1]
    v_cvt_pk_bf16_f32 v208, v208, v209
    v_cvt_pk_bf16_f32 v209, v210, v211
    v_cvt_pk_bf16_f32 v210, v80, v81
    v_cvt_pk_bf16_f32 v211, v82, v83
    v_pk_fma_f32 v[212:213], v[40:41], v[58:59], v[212:213] op_sel_hi:[1,0,1]
    v_pk_fma_f32 v[214:215], v[42:43], v[58:59], v[214:215] op_sel_hi:[1,0,1]
    v_pk_fma_f32 v[84:85], v[44:45], v[58:59], v[84:85] op_sel_hi:[1,0,1]
    v_pk_fma_f32 v[86:87], v[46:47], v[58:59], v[86:87] op_sel_hi:[1,0,1]
    v_pk_mul_f32 v[212:213], v[212:213], v[58:59] op_sel:[0,1]
    v_pk_mul_f32 v[214:215], v[214:215], v[58:59] op_sel:[0,1]
    v_pk_mul_f32 v[84:85], v[84:85], v[58:59] op_sel:[0,1]
    v_pk_mul_f32 v[86:87], v[86:87], v[58:59] op_sel:[0,1]
    v_cvt_pk_bf16_f32 v212, v212, v213
    v_cvt_pk_bf16_f32 v213, v214, v215
    v_cvt_pk_bf16_f32 v214, v84, v85
    v_cvt_pk_bf16_f32 v215, v86, v87
    v_pk_fma_f32 v[216:217], v[40:41], v[60:61], v[216:217] op_sel_hi:[1,0,1]
    v_pk_fma_f32 v[218:219], v[42:43], v[60:61], v[218:219] op_sel_hi:[1,0,1]
    v_pk_fma_f32 v[88:89], v[44:45], v[60:61], v[88:89] op_sel_hi:[1,0,1]
    v_pk_fma_f32 v[90:91], v[46:47], v[60:61], v[90:91] op_sel_hi:[1,0,1]
    v_pk_mul_f32 v[216:217], v[216:217], v[60:61] op_sel:[0,1]
    v_pk_mul_f32 v[218:219], v[218:219], v[60:61] op_sel:[0,1]
    v_pk_mul_f32 v[88:89], v[88:89], v[60:61] op_sel:[0,1]
    v_pk_mul_f32 v[90:91], v[90:91], v[60:61] op_sel:[0,1]
    v_cvt_pk_bf16_f32 v216, v216, v217
    v_cvt_pk_bf16_f32 v217, v218, v219
    v_cvt_pk_bf16_f32 v218, v88, v89
    v_cvt_pk_bf16_f32 v219, v90, v91
    v_pk_fma_f32 v[220:221], v[40:41], v[62:63], v[220:221] op_sel_hi:[1,0,1]
    v_pk_fma_f32 v[222:223], v[42:43], v[62:63], v[222:223] op_sel_hi:[1,0,1]
    v_pk_fma_f32 v[92:93], v[44:45], v[62:63], v[92:93] op_sel_hi:[1,0,1]
    v_pk_fma_f32 v[94:95], v[46:47], v[62:63], v[94:95] op_sel_hi:[1,0,1]
    v_pk_mul_f32 v[220:221], v[220:221], v[62:63] op_sel:[0,1]
    v_pk_mul_f32 v[222:223], v[222:223], v[62:63] op_sel:[0,1]
    v_pk_mul_f32 v[92:93], v[92:93], v[62:63] op_sel:[0,1]
    v_pk_mul_f32 v[94:95], v[94:95], v[62:63] op_sel:[0,1]
    v_cvt_pk_bf16_f32 v220, v220, v221
    v_cvt_pk_bf16_f32 v221, v222, v223
    v_cvt_pk_bf16_f32 v222, v92, v93
    v_cvt_pk_bf16_f32 v223, v94, v95
    ds_read_b128 v[32:35], v22 offset:0
    ds_read_b128 v[36:39], v22 offset:64
    ds_read_b128 v[40:43], v22 offset:128
    ds_read_b128 v[44:47], v22 offset:192
    s_waitcnt lgkmcnt(6)
    v_pk_fma_f32 v[224:225], v[64:65], v[56:57], v[224:225] op_sel_hi:[1,0,1]
    v_pk_fma_f32 v[226:227], v[66:67], v[56:57], v[226:227] op_sel_hi:[1,0,1]
    v_pk_fma_f32 v[96:97], v[68:69], v[56:57], v[96:97] op_sel_hi:[1,0,1]
    v_pk_fma_f32 v[98:99], v[70:71], v[56:57], v[98:99] op_sel_hi:[1,0,1]
    v_pk_mul_f32 v[224:225], v[224:225], v[56:57] op_sel:[0,1]
    v_pk_mul_f32 v[226:227], v[226:227], v[56:57] op_sel:[0,1]
    v_pk_mul_f32 v[96:97], v[96:97], v[56:57] op_sel:[0,1]
    v_pk_mul_f32 v[98:99], v[98:99], v[56:57] op_sel:[0,1]
    v_cvt_pk_bf16_f32 v224, v224, v225
    v_cvt_pk_bf16_f32 v225, v226, v227
    v_cvt_pk_bf16_f32 v226, v96, v97
    v_cvt_pk_bf16_f32 v227, v98, v99
    v_pk_fma_f32 v[228:229], v[64:65], v[58:59], v[228:229] op_sel_hi:[1,0,1]
    v_pk_fma_f32 v[230:231], v[66:67], v[58:59], v[230:231] op_sel_hi:[1,0,1]
    v_pk_fma_f32 v[100:101], v[68:69], v[58:59], v[100:101] op_sel_hi:[1,0,1]
    v_pk_fma_f32 v[102:103], v[70:71], v[58:59], v[102:103] op_sel_hi:[1,0,1]
    v_pk_mul_f32 v[228:229], v[228:229], v[58:59] op_sel:[0,1]
    v_pk_mul_f32 v[230:231], v[230:231], v[58:59] op_sel:[0,1]
    v_pk_mul_f32 v[100:101], v[100:101], v[58:59] op_sel:[0,1]
    v_pk_mul_f32 v[102:103], v[102:103], v[58:59] op_sel:[0,1]
    v_cvt_pk_bf16_f32 v228, v228, v229
    v_cvt_pk_bf16_f32 v229, v230, v231
    v_cvt_pk_bf16_f32 v230, v100, v101
    v_cvt_pk_bf16_f32 v231, v102, v103
    v_pk_fma_f32 v[232:233], v[64:65], v[60:61], v[232:233] op_sel_hi:[1,0,1]
    v_pk_fma_f32 v[234:235], v[66:67], v[60:61], v[234:235] op_sel_hi:[1,0,1]
    v_pk_fma_f32 v[104:105], v[68:69], v[60:61], v[104:105] op_sel_hi:[1,0,1]
    v_pk_fma_f32 v[106:107], v[70:71], v[60:61], v[106:107] op_sel_hi:[1,0,1]
    v_pk_mul_f32 v[232:233], v[232:233], v[60:61] op_sel:[0,1]
    v_pk_mul_f32 v[234:235], v[234:235], v[60:61] op_sel:[0,1]
    v_pk_mul_f32 v[104:105], v[104:105], v[60:61] op_sel:[0,1]
    v_pk_mul_f32 v[106:107], v[106:107], v[60:61] op_sel:[0,1]
    v_cvt_pk_bf16_f32 v232, v232, v233
    v_cvt_pk_bf16_f32 v233, v234, v235
    v_cvt_pk_bf16_f32 v234, v104, v105
    v_cvt_pk_bf16_f32 v235, v106, v107
    v_pk_fma_f32 v[236:237], v[64:65], v[62:63], v[236:237] op_sel_hi:[1,0,1]
    v_pk_fma_f32 v[238:239], v[66:67], v[62:63], v[238:239] op_sel_hi:[1,0,1]
    v_pk_fma_f32 v[108:109], v[68:69], v[62:63], v[108:109] op_sel_hi:[1,0,1]
    v_pk_fma_f32 v[110:111], v[70:71], v[62:63], v[110:111] op_sel_hi:[1,0,1]
    v_pk_mul_f32 v[236:237], v[236:237], v[62:63] op_sel:[0,1]
    v_pk_mul_f32 v[238:239], v[238:239], v[62:63] op_sel:[0,1]
    v_pk_mul_f32 v[108:109], v[108:109], v[62:63] op_sel:[0,1]
    v_pk_mul_f32 v[110:111], v[110:111], v[62:63] op_sel:[0,1]
    v_cvt_pk_bf16_f32 v236, v236, v237
    v_cvt_pk_bf16_f32 v237, v238, v239
    v_cvt_pk_bf16_f32 v238, v108, v109
    v_cvt_pk_bf16_f32 v239, v110, v111
    s_waitcnt lgkmcnt(4)
    v_pk_fma_f32 v[240:241], v[72:73], v[56:57], v[240:241] op_sel_hi:[1,0,1]
    v_pk_fma_f32 v[242:243], v[74:75], v[56:57], v[242:243] op_sel_hi:[1,0,1]
    v_pk_fma_f32 v[112:113], v[76:77], v[56:57], v[112:113] op_sel_hi:[1,0,1]
    v_pk_fma_f32 v[114:115], v[78:79], v[56:57], v[114:115] op_sel_hi:[1,0,1]
    v_pk_mul_f32 v[240:241], v[240:241], v[56:57] op_sel:[0,1]
    v_pk_mul_f32 v[242:243], v[242:243], v[56:57] op_sel:[0,1]
    v_pk_mul_f32 v[112:113], v[112:113], v[56:57] op_sel:[0,1]
    v_pk_mul_f32 v[114:115], v[114:115], v[56:57] op_sel:[0,1]
    v_cvt_pk_bf16_f32 v240, v240, v241
    v_cvt_pk_bf16_f32 v241, v242, v243
    v_cvt_pk_bf16_f32 v242, v112, v113
    v_cvt_pk_bf16_f32 v243, v114, v115
    v_pk_fma_f32 v[244:245], v[72:73], v[58:59], v[244:245] op_sel_hi:[1,0,1]
    v_pk_fma_f32 v[246:247], v[74:75], v[58:59], v[246:247] op_sel_hi:[1,0,1]
    v_pk_fma_f32 v[116:117], v[76:77], v[58:59], v[116:117] op_sel_hi:[1,0,1]
    v_pk_fma_f32 v[118:119], v[78:79], v[58:59], v[118:119] op_sel_hi:[1,0,1]
    v_pk_mul_f32 v[244:245], v[244:245], v[58:59] op_sel:[0,1]
    v_pk_mul_f32 v[246:247], v[246:247], v[58:59] op_sel:[0,1]
    v_pk_mul_f32 v[116:117], v[116:117], v[58:59] op_sel:[0,1]
    v_pk_mul_f32 v[118:119], v[118:119], v[58:59] op_sel:[0,1]
    v_cvt_pk_bf16_f32 v244, v244, v245
    v_cvt_pk_bf16_f32 v245, v246, v247
    v_cvt_pk_bf16_f32 v246, v116, v117
    v_cvt_pk_bf16_f32 v247, v118, v119
    v_pk_fma_f32 v[248:249], v[72:73], v[60:61], v[248:249] op_sel_hi:[1,0,1]
    v_pk_fma_f32 v[250:251], v[74:75], v[60:61], v[250:251] op_sel_hi:[1,0,1]
    v_pk_fma_f32 v[120:121], v[76:77], v[60:61], v[120:121] op_sel_hi:[1,0,1]
    v_pk_fma_f32 v[122:123], v[78:79], v[60:61], v[122:123] op_sel_hi:[1,0,1]
    v_pk_mul_f32 v[248:249], v[248:249], v[60:61] op_sel:[0,1]
    v_pk_mul_f32 v[250:251], v[250:251], v[60:61] op_sel:[0,1]
    v_pk_mul_f32 v[120:121], v[120:121], v[60:61] op_sel:[0,1]
    v_pk_mul_f32 v[122:123], v[122:123], v[60:61] op_sel:[0,1]
    v_cvt_pk_bf16_f32 v248, v248, v249
    v_cvt_pk_bf16_f32 v249, v250, v251
    v_cvt_pk_bf16_f32 v250, v120, v121
    v_cvt_pk_bf16_f32 v251, v122, v123
    v_pk_fma_f32 v[252:253], v[72:73], v[62:63], v[252:253] op_sel_hi:[1,0,1]
    v_pk_fma_f32 v[254:255], v[74:75], v[62:63], v[254:255] op_sel_hi:[1,0,1]
    v_pk_fma_f32 v[124:125], v[76:77], v[62:63], v[124:125] op_sel_hi:[1,0,1]
    v_pk_fma_f32 v[126:127], v[78:79], v[62:63], v[126:127] op_sel_hi:[1,0,1]
    v_pk_mul_f32 v[252:253], v[252:253], v[62:63] op_sel:[0,1]
    v_pk_mul_f32 v[254:255], v[254:255], v[62:63] op_sel:[0,1]
    v_pk_mul_f32 v[124:125], v[124:125], v[62:63] op_sel:[0,1]
    v_pk_mul_f32 v[126:127], v[126:127], v[62:63] op_sel:[0,1]
    v_cvt_pk_bf16_f32 v252, v252, v253
    v_cvt_pk_bf16_f32 v253, v254, v255
    v_cvt_pk_bf16_f32 v254, v124, v125
    v_cvt_pk_bf16_f32 v255, v126, v127
    s_waitcnt vmcnt(8)
    s_barrier
    ds_read_b128 a[192:195], v2 offset:0
    ds_read_b128 a[196:199], v3 offset:0
    ds_read_b128 a[200:203], v4 offset:0
    ds_read_b128 a[204:207], v5 offset:0
    v_lshlrev_b32 v112, 16, v48
    v_and_b32 v113, 0xffff0000, v48
    v_lshlrev_b32 v114, 16, v49
    v_and_b32 v115, 0xffff0000, v49
    v_lshlrev_b32 v116, 16, v50
    v_and_b32 v117, 0xffff0000, v50
    v_lshlrev_b32 v118, 16, v51
    v_and_b32 v119, 0xffff0000, v51
    v_mov_b32 v48, 0xbdd2d3e8
    v_mov_b32 v49, 0xc0135761
    s_waitcnt lgkmcnt(4)
    v_pk_fma_f32 v[128:129], v[32:33], v[56:57], v[128:129] op_sel_hi:[1,0,1]
    v_pk_fma_f32 v[130:131], v[34:35], v[56:57], v[130:131] op_sel_hi:[1,0,1]
    v_pk_fma_f32 v[144:145], v[36:37], v[56:57], v[144:145] op_sel_hi:[1,0,1]
    v_pk_fma_f32 v[146:147], v[38:39], v[56:57], v[146:147] op_sel_hi:[1,0,1]
    v_pk_fma_f32 v[132:133], v[32:33], v[58:59], v[132:133] op_sel_hi:[1,0,1]
    v_pk_fma_f32 v[134:135], v[34:35], v[58:59], v[134:135] op_sel_hi:[1,0,1]
    v_pk_fma_f32 v[148:149], v[36:37], v[58:59], v[148:149] op_sel_hi:[1,0,1]
    v_pk_fma_f32 v[150:151], v[38:39], v[58:59], v[150:151] op_sel_hi:[1,0,1]
    v_pk_fma_f32 v[128:129], v[128:129], v[28:29], v[112:113] op_sel:[0,0,0] op_sel_hi:[1,0,1]
    v_pk_fma_f32 v[130:131], v[130:131], v[28:29], v[114:115] op_sel:[0,0,0] op_sel_hi:[1,0,1]
    v_pk_fma_f32 v[144:145], v[144:145], v[28:29], v[116:117] op_sel:[0,0,0] op_sel_hi:[1,0,1]
    v_pk_fma_f32 v[146:147], v[146:147], v[28:29], v[118:119] op_sel:[0,0,0] op_sel_hi:[1,0,1]
    v_pk_fma_f32 v[132:133], v[132:133], v[28:29], v[112:113] op_sel:[0,1,0] op_sel_hi:[1,1,1]
    v_pk_fma_f32 v[134:135], v[134:135], v[28:29], v[114:115] op_sel:[0,1,0] op_sel_hi:[1,1,1]
    v_pk_fma_f32 v[148:149], v[148:149], v[28:29], v[116:117] op_sel:[0,1,0] op_sel_hi:[1,1,1]
    v_pk_fma_f32 v[150:151], v[150:151], v[28:29], v[118:119] op_sel:[0,1,0] op_sel_hi:[1,1,1]
    v_pk_mul_f32 v[64:65], v[128:129], v[128:129]
    v_pk_mul_f32 v[66:67], v[130:131], v[130:131]
    v_pk_mul_f32 v[68:69], v[144:145], v[144:145]
    v_pk_mul_f32 v[70:71], v[146:147], v[146:147]
    v_pk_mul_f32 v[72:73], v[132:133], v[132:133]
    v_pk_mul_f32 v[74:75], v[134:135], v[134:135]
    v_pk_mul_f32 v[76:77], v[148:149], v[148:149]
    v_pk_mul_f32 v[78:79], v[150:151], v[150:151]
    v_pk_fma_f32 v[64:65], v[64:65], v[48:49], v[48:49] op_sel:[0,0,1] op_sel_hi:[1,0,1]
    v_pk_fma_f32 v[66:67], v[66:67], v[48:49], v[48:49] op_sel:[0,0,1] op_sel_hi:[1,0,1]
    v_pk_fma_f32 v[68:69], v[68:69], v[48:49], v[48:49] op_sel:[0,0,1] op_sel_hi:[1,0,1]
    v_pk_fma_f32 v[70:71], v[70:71], v[48:49], v[48:49] op_sel:[0,0,1] op_sel_hi:[1,0,1]
    v_pk_fma_f32 v[72:73], v[72:73], v[48:49], v[48:49] op_sel:[0,0,1] op_sel_hi:[1,0,1]
    v_pk_fma_f32 v[74:75], v[74:75], v[48:49], v[48:49] op_sel:[0,0,1] op_sel_hi:[1,0,1]
    v_pk_fma_f32 v[76:77], v[76:77], v[48:49], v[48:49] op_sel:[0,0,1] op_sel_hi:[1,0,1]
    v_pk_fma_f32 v[78:79], v[78:79], v[48:49], v[48:49] op_sel:[0,0,1] op_sel_hi:[1,0,1]
    v_pk_mul_f32 v[64:65], v[64:65], v[128:129]
    v_pk_mul_f32 v[66:67], v[66:67], v[130:131]
    v_pk_mul_f32 v[68:69], v[68:69], v[144:145]
    v_pk_mul_f32 v[70:71], v[70:71], v[146:147]
    v_pk_mul_f32 v[72:73], v[72:73], v[132:133]
    v_pk_mul_f32 v[74:75], v[74:75], v[134:135]
    v_pk_mul_f32 v[76:77], v[76:77], v[148:149]
    v_pk_mul_f32 v[78:79], v[78:79], v[150:151]
    v_exp_f32 v64, v64
    v_exp_f32 v65, v65
    v_exp_f32 v66, v66
    v_exp_f32 v67, v67
    v_exp_f32 v68, v68
    v_exp_f32 v69, v69
    v_exp_f32 v70, v70
    v_exp_f32 v71, v71
    v_exp_f32 v72, v72
    v_exp_f32 v73, v73
    v_exp_f32 v74, v74
    v_exp_f32 v75, v75
    v_exp_f32 v76, v76
    v_exp_f32 v77, v77
    v_exp_f32 v78, v78
    v_exp_f32 v79, v79
    v_pk_add_f32 v[64:65], v[64:65], 1.0 op_sel_hi:[1,0]
    v_pk_add_f32 v[66:67], v[66:67], 1.0 op_sel_hi:[1,0]
    v_pk_add_f32 v[68:69], v[68:69], 1.0 op_sel_hi:[1,0]
    v_pk_add_f32 v[70:71], v[70:71], 1.0 op_sel_hi:[1,0]
    v_pk_add_f32 v[72:73], v[72:73], 1.0 op_sel_hi:[1,0]
    v_pk_add_f32 v[74:75], v[74:75], 1.0 op_sel_hi:[1,0]
    v_pk_add_f32 v[76:77], v[76:77], 1.0 op_sel_hi:[1,0]
    v_pk_add_f32 v[78:79], v[78:79], 1.0 op_sel_hi:[1,0]
    v_rcp_f32 v64, v64
    v_rcp_f32 v65, v65
    v_rcp_f32 v66, v66
    v_rcp_f32 v67, v67
    v_rcp_f32 v68, v68
    v_rcp_f32 v69, v69
    v_rcp_f32 v70, v70
    v_rcp_f32 v71, v71
    v_rcp_f32 v72, v72
    v_rcp_f32 v73, v73
    v_rcp_f32 v74, v74
    v_rcp_f32 v75, v75
    v_rcp_f32 v76, v76
    v_rcp_f32 v77, v77
    v_rcp_f32 v78, v78
    v_rcp_f32 v79, v79
    v_pk_mul_f32 v[64:65], v[64:65], v[128:129]
    v_pk_mul_f32 v[66:67], v[66:67], v[130:131]
    v_pk_mul_f32 v[68:69], v[68:69], v[144:145]
    v_pk_mul_f32 v[70:71], v[70:71], v[146:147]
    v_pk_mul_f32 v[72:73], v[72:73], v[132:133]
    v_pk_mul_f32 v[74:75], v[74:75], v[134:135]
    v_pk_mul_f32 v[76:77], v[76:77], v[148:149]
    v_pk_mul_f32 v[78:79], v[78:79], v[150:151]
    v_cvt_pk_bf16_f32 v128, v64, v65
    v_cvt_pk_bf16_f32 v129, v66, v67
    v_cvt_pk_bf16_f32 v130, v68, v69
    v_cvt_pk_bf16_f32 v131, v70, v71
    buffer_store_dwordx4 v[128:131], v1, s[36:39], s72 offen offset:0 sc1
    v_cvt_pk_bf16_f32 v132, v72, v73
    v_cvt_pk_bf16_f32 v133, v74, v75
    v_cvt_pk_bf16_f32 v134, v76, v77
    v_cvt_pk_bf16_f32 v135, v78, v79
    buffer_store_dwordx4 v[132:135], v1, s[36:39], s72 offen offset:1024 sc1
    v_pk_fma_f32 v[136:137], v[32:33], v[60:61], v[136:137] op_sel_hi:[1,0,1]
    v_pk_fma_f32 v[138:139], v[34:35], v[60:61], v[138:139] op_sel_hi:[1,0,1]
    v_pk_fma_f32 v[152:153], v[36:37], v[60:61], v[152:153] op_sel_hi:[1,0,1]
    v_pk_fma_f32 v[154:155], v[38:39], v[60:61], v[154:155] op_sel_hi:[1,0,1]
    v_pk_fma_f32 v[140:141], v[32:33], v[62:63], v[140:141] op_sel_hi:[1,0,1]
    v_pk_fma_f32 v[142:143], v[34:35], v[62:63], v[142:143] op_sel_hi:[1,0,1]
    v_pk_fma_f32 v[156:157], v[36:37], v[62:63], v[156:157] op_sel_hi:[1,0,1]
    v_pk_fma_f32 v[158:159], v[38:39], v[62:63], v[158:159] op_sel_hi:[1,0,1]
    v_pk_fma_f32 v[136:137], v[136:137], v[30:31], v[112:113] op_sel:[0,0,0] op_sel_hi:[1,0,1]
    v_pk_fma_f32 v[138:139], v[138:139], v[30:31], v[114:115] op_sel:[0,0,0] op_sel_hi:[1,0,1]
    v_pk_fma_f32 v[152:153], v[152:153], v[30:31], v[116:117] op_sel:[0,0,0] op_sel_hi:[1,0,1]
    v_pk_fma_f32 v[154:155], v[154:155], v[30:31], v[118:119] op_sel:[0,0,0] op_sel_hi:[1,0,1]
    v_pk_fma_f32 v[140:141], v[140:141], v[30:31], v[112:113] op_sel:[0,1,0] op_sel_hi:[1,1,1]
    v_pk_fma_f32 v[142:143], v[142:143], v[30:31], v[114:115] op_sel:[0,1,0] op_sel_hi:[1,1,1]
    v_pk_fma_f32 v[156:157], v[156:157], v[30:31], v[116:117] op_sel:[0,1,0] op_sel_hi:[1,1,1]
    v_pk_fma_f32 v[158:159], v[158:159], v[30:31], v[118:119] op_sel:[0,1,0] op_sel_hi:[1,1,1]
    v_pk_mul_f32 v[80:81], v[136:137], v[136:137]
    v_pk_mul_f32 v[82:83], v[138:139], v[138:139]
    v_pk_mul_f32 v[84:85], v[152:153], v[152:153]
    v_pk_mul_f32 v[86:87], v[154:155], v[154:155]
    v_pk_mul_f32 v[88:89], v[140:141], v[140:141]
    v_pk_mul_f32 v[90:91], v[142:143], v[142:143]
    v_pk_mul_f32 v[92:93], v[156:157], v[156:157]
    v_pk_mul_f32 v[94:95], v[158:159], v[158:159]
    v_pk_fma_f32 v[80:81], v[80:81], v[48:49], v[48:49] op_sel:[0,0,1] op_sel_hi:[1,0,1]
    v_pk_fma_f32 v[82:83], v[82:83], v[48:49], v[48:49] op_sel:[0,0,1] op_sel_hi:[1,0,1]
    v_pk_fma_f32 v[84:85], v[84:85], v[48:49], v[48:49] op_sel:[0,0,1] op_sel_hi:[1,0,1]
    v_pk_fma_f32 v[86:87], v[86:87], v[48:49], v[48:49] op_sel:[0,0,1] op_sel_hi:[1,0,1]
    v_pk_fma_f32 v[88:89], v[88:89], v[48:49], v[48:49] op_sel:[0,0,1] op_sel_hi:[1,0,1]
    v_pk_fma_f32 v[90:91], v[90:91], v[48:49], v[48:49] op_sel:[0,0,1] op_sel_hi:[1,0,1]
    v_pk_fma_f32 v[92:93], v[92:93], v[48:49], v[48:49] op_sel:[0,0,1] op_sel_hi:[1,0,1]
    v_pk_fma_f32 v[94:95], v[94:95], v[48:49], v[48:49] op_sel:[0,0,1] op_sel_hi:[1,0,1]
    v_pk_mul_f32 v[80:81], v[80:81], v[136:137]
    v_pk_mul_f32 v[82:83], v[82:83], v[138:139]
    v_pk_mul_f32 v[84:85], v[84:85], v[152:153]
    v_pk_mul_f32 v[86:87], v[86:87], v[154:155]
    v_pk_mul_f32 v[88:89], v[88:89], v[140:141]
    v_pk_mul_f32 v[90:91], v[90:91], v[142:143]
    v_pk_mul_f32 v[92:93], v[92:93], v[156:157]
    v_pk_mul_f32 v[94:95], v[94:95], v[158:159]
    v_exp_f32 v80, v80
    v_exp_f32 v81, v81
    v_exp_f32 v82, v82
    v_exp_f32 v83, v83
    v_exp_f32 v84, v84
    v_exp_f32 v85, v85
    v_exp_f32 v86, v86
    v_exp_f32 v87, v87
    v_exp_f32 v88, v88
    v_exp_f32 v89, v89
    v_exp_f32 v90, v90
    v_exp_f32 v91, v91
    v_exp_f32 v92, v92
    v_exp_f32 v93, v93
    v_exp_f32 v94, v94
    v_exp_f32 v95, v95
    v_pk_add_f32 v[80:81], v[80:81], 1.0 op_sel_hi:[1,0]
    v_pk_add_f32 v[82:83], v[82:83], 1.0 op_sel_hi:[1,0]
    v_pk_add_f32 v[84:85], v[84:85], 1.0 op_sel_hi:[1,0]
    v_pk_add_f32 v[86:87], v[86:87], 1.0 op_sel_hi:[1,0]
    v_pk_add_f32 v[88:89], v[88:89], 1.0 op_sel_hi:[1,0]
    v_pk_add_f32 v[90:91], v[90:91], 1.0 op_sel_hi:[1,0]
    v_pk_add_f32 v[92:93], v[92:93], 1.0 op_sel_hi:[1,0]
    v_pk_add_f32 v[94:95], v[94:95], 1.0 op_sel_hi:[1,0]
    v_rcp_f32 v80, v80
    v_rcp_f32 v81, v81
    v_rcp_f32 v82, v82
    v_rcp_f32 v83, v83
    v_rcp_f32 v84, v84
    v_rcp_f32 v85, v85
    v_rcp_f32 v86, v86
    v_rcp_f32 v87, v87
    v_rcp_f32 v88, v88
    v_rcp_f32 v89, v89
    v_rcp_f32 v90, v90
    v_rcp_f32 v91, v91
    v_rcp_f32 v92, v92
    v_rcp_f32 v93, v93
    v_rcp_f32 v94, v94
    v_rcp_f32 v95, v95
    v_pk_mul_f32 v[80:81], v[80:81], v[136:137]
    v_pk_mul_f32 v[82:83], v[82:83], v[138:139]
    v_pk_mul_f32 v[84:85], v[84:85], v[152:153]
    v_pk_mul_f32 v[86:87], v[86:87], v[154:155]
    v_pk_mul_f32 v[88:89], v[88:89], v[140:141]
    v_pk_mul_f32 v[90:91], v[90:91], v[142:143]
    v_pk_mul_f32 v[92:93], v[92:93], v[156:157]
    v_pk_mul_f32 v[94:95], v[94:95], v[158:159]
    v_cvt_pk_bf16_f32 v136, v80, v81
    v_cvt_pk_bf16_f32 v137, v82, v83
    v_cvt_pk_bf16_f32 v138, v84, v85
    v_cvt_pk_bf16_f32 v139, v86, v87
    buffer_store_dwordx4 v[136:139], v1, s[36:39], s72 offen offset:2048 sc1
    v_cvt_pk_bf16_f32 v140, v88, v89
    v_cvt_pk_bf16_f32 v141, v90, v91
    v_cvt_pk_bf16_f32 v142, v92, v93
    v_cvt_pk_bf16_f32 v143, v94, v95
    buffer_store_dwordx4 v[140:143], v1, s[36:39], s72 offen offset:3072 sc1
L1_join:
L1_pa5:
    s_cbranch_execz L1_pc3
    s_cmp_lg_u32 s46, 0
    s_cbranch_scc1 L1_maxpass
L1_attn:
    s_mov_b32 s40, 16384
    s_waitcnt lgkmcnt(0)
    v_mfma_f32_16x16x32_bf16 v[128:131], a[192:195], v[192:195], 0
    ds_read_b128 a[208:211], v2 offset:4096
    v_add_u32 v14, 32768, v14
    v_mfma_f32_16x16x32_bf16 v[128:131], a[196:199], v[208:211], v[128:131]
    v_add_u32 v15, 32768, v15
    v_add_u32 v16, 32768, v16
    v_mfma_f32_16x16x32_bf16 v[128:131], a[200:203], v[224:227], v[128:131]
    ds_read_b128 a[212:215], v3 offset:4096
    v_add_u32 v17, 32768, v17
    v_mfma_f32_16x16x32_bf16 v[128:131], a[204:207], v[240:243], v[128:131]
    v_and_b32 v22, 0x30, v1
    v_xor_b32 v6, s91, v6
    v_mfma_f32_16x16x32_bf16 v[144:147], a[204:207], v[244:247], 0
    ds_read_b128 a[216:219], v4 offset:4096
    v_xor_b32 v6, v22, v6
    v_mfma_f32_16x16x32_bf16 v[144:147], a[200:203], v[228:231], v[144:147]
    v_lshrrev_b32 v22, 1, v22
    v_xor_b32 v6, v22, v6
    v_mfma_f32_16x16x32_bf16 v[144:147], a[196:199], v[212:215], v[144:147]
    ds_read_b128 a[220:223], v5 offset:4096
    s_add_u32 m0, s41, 49152
    v_mfma_f32_16x16x32_bf16 v[144:147], a[192:195], v[196:199], v[144:147]
    v_xor_b32 v7, 32, v6
    v_xor_b32 v8, 64, v6
    v_mfma_f32_16x16x32_bf16 v[160:163], a[192:195], v[200:203], 0
    buffer_load_dwordx4 v14, s[8:11], s40 offen offset:0 lds
    v_mfma_f32_16x16x32_bf16 v[160:163], a[196:199], v[216:219], v[160:163]
    v_max3_f32 v48, v128, v129, v130
    v_max_f32 v48, v48, v131
    v_mfma_f32_16x16x32_bf16 v[160:163], a[200:203], v[232:235], v[160:163]
    buffer_load_dwordx4 v15, s[8:11], s40 offen offset:1024 lds
    v_mfma_f32_16x16x32_bf16 v[160:163], a[204:207], v[248:251], v[160:163]
    v_xor_b32 v9, 96, v6
    v_xor_b32 v10, 128, v6
    v_mfma_f32_16x16x32_bf16 v[176:179], a[204:207], v[252:255], 0
    buffer_load_dwordx4 v16, s[8:11], s40 offen offset:2048 lds
    v_mfma_f32_16x16x32_bf16 v[176:179], a[200:203], v[236:239], v[176:179]
    v_max3_f32 v52, v144, v145, v146
    v_max_f32 v52, v52, v147
    v_mfma_f32_16x16x32_bf16 v[176:179], a[196:199], v[220:223], v[176:179]
    s_waitcnt lgkmcnt(0)
    v_xor_b32 v11, 160, v6
    v_mfma_f32_16x16x32_bf16 v[176:179], a[192:195], v[204:207], v[176:179]
    v_xor_b32 v12, 192, v6
    v_xor_b32 v13, 224, v6
    v_mfma_f32_16x16x32_bf16 v[64:67], a[208:211], v[192:195], 0
    ds_read_b128 a[224:227], v2 offset:8192
    v_lshrrev_b32 v21, 8, v1
    v_mfma_f32_16x16x32_bf16 v[64:67], a[212:215], v[208:211], v[64:67]
    v_max3_f32 v56, v160, v161, v162
    v_max_f32 v56, v56, v163
    v_mfma_f32_16x16x32_bf16 v[64:67], a[216:219], v[224:227], v[64:67]
    ds_read_b128 a[228:231], v3 offset:8192
    v_lshlrev_b32 v22, 5, v21
    v_mfma_f32_16x16x32_bf16 v[64:67], a[220:223], v[240:243], v[64:67]
    v_and_b32 v28, 0xf0, v1
    v_xor_b32 v22, v22, v28
    v_mfma_f32_16x16x32_bf16 v[68:71], a[220:223], v[244:247], 0
    ds_read_b128 a[232:235], v4 offset:8192
    v_lshl_add_u32 v21, v21, 10, v22
    v_mfma_f32_16x16x32_bf16 v[68:71], a[216:219], v[228:231], v[68:71]
    v_max3_f32 v60, v176, v177, v178
    v_max_f32 v60, v60, v179
    v_mfma_f32_16x16x32_bf16 v[68:71], a[212:215], v[212:215], v[68:71]
    ds_read_b128 a[236:239], v5 offset:8192
    v_add_u32 v21, s92, v21
    v_mfma_f32_16x16x32_bf16 v[68:71], a[208:211], v[196:199], v[68:71]
    v_add_u32 v28, 131072, v1
    v_bfe_u32 v22, v1, 4, 2
    v_mfma_f32_16x16x32_bf16 v[72:75], a[208:211], v[200:203], 0
    buffer_load_dwordx4 v17, s[8:11], s40 offen offset:3072 lds
    v_mfma_f32_16x16x32_bf16 v[72:75], a[212:215], v[216:219], v[72:75]
    v_max3_f32 v48, v48, v64, v65
    v_max3_f32 v48, v48, v66, v67
    v_mfma_f32_16x16x32_bf16 v[72:75], a[216:219], v[232:235], v[72:75]
    s_add_u32 m0, s41, 81920
    v_bfe_u32 v29, v1, 6, 1
    v_mfma_f32_16x16x32_bf16 v[72:75], a[220:223], v[248:251], v[72:75]
    v_lshl_add_u32 v29, v22, 3, v29
    v_lshl_add_u32 v29, v29, 11, s93
    v_mfma_f32_16x16x32_bf16 v[76:79], a[220:223], v[252:255], 0
    buffer_load_dwordx4 v18, s[12:15], s40 offen offset:0 lds
    v_mfma_f32_16x16x32_bf16 v[76:79], a[216:219], v[236:239], v[76:79]
    v_max3_f32 v52, v52, v68, v69
    v_max3_f32 v52, v52, v70, v71
    v_mfma_f32_16x16x32_bf16 v[76:79], a[212:215], v[220:223], v[76:79]
    s_waitcnt lgkmcnt(0)
    v_lshlrev_b32 v22, 12, v22
    v_mfma_f32_16x16x32_bf16 v[76:79], a[208:211], v[204:207], v[76:79]
    v_xor_b32 v30, s94, v22
    v_xor_b32 v31, s95, v6
    v_mfma_f32_16x16x32_bf16 v[132:135], a[224:227], v[192:195], 0
    ds_read_b128 a[240:243], v2 offset:12288
    v_xor_b32 v31, 65536, v31
    v_mfma_f32_16x16x32_bf16 v[132:135], a[228:231], v[208:211], v[132:135]
    v_max3_f32 v56, v56, v72, v73
    v_max3_f32 v56, v56, v74, v75
    v_mfma_f32_16x16x32_bf16 v[132:135], a[232:235], v[224:227], v[132:135]
    ds_read_b128 a[244:247], v3 offset:12288
    v_accvgpr_write_b32 a128, v192
    v_mfma_f32_16x16x32_bf16 v[132:135], a[236:239], v[240:243], v[132:135]
    v_accvgpr_write_b32 a129, v193
L1_pc0:
    s_cbranch_execz L1_pc4
    v_accvgpr_write_b32 a130, v194
    v_mfma_f32_16x16x32_bf16 v[148:151], a[236:239], v[244:247], 0
    ds_read_b128 a[248:251], v4 offset:12288
    v_accvgpr_write_b32 a131, v195
    v_mfma_f32_16x16x32_bf16 v[148:151], a[232:235], v[228:231], v[148:151]
    v_max3_f32 v60, v60, v76, v77
    v_max3_f32 v60, v60, v78, v79
    v_mfma_f32_16x16x32_bf16 v[148:151], a[228:231], v[212:215], v[148:151]
    ds_read_b128 a[252:255], v5 offset:12288
    v_accvgpr_write_b32 a132, v196
    v_mfma_f32_16x16x32_bf16 v[148:151], a[224:227], v[196:199], v[148:151]
    v_accvgpr_write_b32 a133, v197
    v_accvgpr_write_b32 a134, v198
    v_mfma_f32_16x16x32_bf16 v[164:167], a[224:227], v[200:203], 0
    buffer_load_dwordx4 v19, s[12:15], s40 offen offset:1024 lds
    v_mfma_f32_16x16x32_bf16 v[164:167], a[228:231], v[216:219], v[164:167]
    v_max3_f32 v48, v48, v132, v133
    v_max3_f32 v48, v48, v134, v135
    v_mfma_f32_16x16x32_bf16 v[164:167], a[232:235], v[232:235], v[164:167]
    buffer_load_dwordx4 v18, s[12:15], s40 offen offset:2048 lds
    v_mfma_f32_16x16x32_bf16 v[164:167], a[236:239], v[248:251], v[164:167]
    v_accvgpr_write_b32 a135, v199
    v_accvgpr_write_b32 a136, v200
    v_mfma_f32_16x16x32_bf16 v[180:183], a[236:239], v[252:255], 0
    buffer_load_dwordx4 v19, s[12:15], s40 offen offset:3072 lds
    v_mfma_f32_16x16x32_bf16 v[180:183], a[232:235], v[236:239], v[180:183]
    v_lshlrev_b32 v0, 3, v1
    s_lshl_b32 s5, s2, 2
    v_mfma_f32_16x16x32_bf16 v[180:183], a[228:231], v[220:223], v[180:183]
    s_waitcnt lgkmcnt(0)
    s_mov_b32 s40, 32768
    v_mfma_f32_16x16x32_bf16 v[180:183], a[224:227], v[204:207], v[180:183]
    s_mov_b32 s77, 49152
    s_add_u32 s5, s5, s45
    v_mfma_f32_16x16x32_bf16 v[80:83], a[240:243], v[192:195], 0
    ds_read_b128 a[192:195], v2 offset:16384
    s_lshl_b32 s6, s44, 2
    v_mfma_f32_16x16x32_bf16 v[80:83], a[244:247], v[208:211], v[80:83]
    s_add_u32 s6, s6, s45
    v_max3_f32 v52, v52, v148, v149
    v_mfma_f32_16x16x32_bf16 v[80:83], a[248:251], v[224:227], v[80:83]
    ds_read_b128 a[196:199], v3 offset:16384
    v_max3_f32 v52, v52, v150, v151
    v_mfma_f32_16x16x32_bf16 v[80:83], a[252:255], v[240:243], v[80:83]
    v_max3_f32 v56, v56, v164, v165
    v_max3_f32 v56, v56, v166, v167
    v_mfma_f32_16x16x32_bf16 v[84:87], a[252:255], v[244:247], 0
    ds_read_b128 a[200:203], v4 offset:16384
    v_accvgpr_write_b32 a137, v201
    v_mfma_f32_16x16x32_bf16 v[84:87], a[248:251], v[228:231], v[84:87]
    v_max3_f32 v60, v60, v180, v181
    v_max3_f32 v60, v60, v182, v183
    v_mfma_f32_16x16x32_bf16 v[84:87], a[244:247], v[212:215], v[84:87]
    ds_read_b128 a[204:207], v5 offset:16384
    v_accvgpr_write_b32 a138, v202
    v_mfma_f32_16x16x32_bf16 v[84:87], a[240:243], v[196:199], v[84:87]
    v_accvgpr_write_b32 a139, v203
    v_accvgpr_write_b32 a140, v204
    v_mfma_f32_16x16x32_bf16 v[88:91], a[240:243], v[200:203], 0
    s_lshl_b32 s7, s6, 11
    s_add_u32 s7, s7, 458752
    s_mov_b64 exec, 65535
    buffer_load_dword v22, v0, s[12:15], s7 offen
    s_mov_b64 exec, -1
    v_mfma_f32_16x16x32_bf16 v[88:91], a[244:247], v[216:219], v[88:91]
    v_max3_f32 v48, v48, v80, v81
    v_max3_f32 v48, v48, v82, v83
    v_mfma_f32_16x16x32_bf16 v[88:91], a[248:251], v[232:235], v[88:91]
    s_lshl_b32 s7, s6, 10
    s_add_u32 s7, s7, 491520
    s_mov_b64 exec, 255
    buffer_load_dword v22, v0, s[8:11], s7 offen
    s_mov_b64 exec, -1
    v_mfma_f32_16x16x32_bf16 v[88:91], a[252:255], v[248:251], v[88:91]
    v_accvgpr_write_b32 a141, v205
    v_accvgpr_write_b32 a142, v206
    v_mfma_f32_16x16x32_bf16 v[92:95], a[252:255], v[252:255], 0
    s_lshl_b32 s7, s5, 11
    s_mov_b64 exec, 65535
    buffer_load_dword v22, v0, s[28:31], s7 offen
    s_mov_b64 exec, -1
    v_mfma_f32_16x16x32_bf16 v[92:95], a[248:251], v[236:239], v[92:95]
    v_max3_f32 v52, v52, v84, v85
    v_max3_f32 v52, v52, v86, v87
    v_mfma_f32_16x16x32_bf16 v[92:95], a[244:247], v[220:223], v[92:95]
    s_waitcnt lgkmcnt(0)
    v_accvgpr_write_b32 a143, v207
    v_mfma_f32_16x16x32_bf16 v[92:95], a[240:243], v[204:207], v[92:95]
    v_accvgpr_write_b32 a144, v208
    v_accvgpr_write_b32 a145, v209
    v_mfma_f32_16x16x32_bf16 v[136:139], a[192:195], v[192:195], 0
    ds_read_b128 a[208:211], v2 offset:20480
    v_accvgpr_write_b32 a146, v210
    v_mfma_f32_16x16x32_bf16 v[136:139], a[196:199], v[208:211], v[136:139]
    v_max3_f32 v56, v56, v88, v89
    v_max3_f32 v56, v56, v90, v91
    v_mfma_f32_16x16x32_bf16 v[136:139], a[200:203], v[224:227], v[136:139]
    ds_read_b128 a[212:215], v3 offset:20480
    v_accvgpr_write_b32 a147, v211
    v_mfma_f32_16x16x32_bf16 v[136:139], a[204:207], v[240:243], v[136:139]
    v_accvgpr_write_b32 a148, v212
    v_accvgpr_write_b32 a149, v213
    v_mfma_f32_16x16x32_bf16 v[152:155], a[204:207], v[244:247], 0
    ds_read_b128 a[216:219], v4 offset:20480
    v_accvgpr_write_b32 a150, v214
    v_mfma_f32_16x16x32_bf16 v[152:155], a[200:203], v[228:231], v[152:155]
    v_max3_f32 v60, v60, v92, v93
    v_max3_f32 v60, v60, v94, v95
    v_mfma_f32_16x16x32_bf16 v[152:155], a[196:199], v[212:215], v[152:155]
    ds_read_b128 a[220:223], v5 offset:20480
    v_accvgpr_write_b32 a151, v215
    v_mfma_f32_16x16x32_bf16 v[152:155], a[192:195], v[196:199], v[152:155]
    v_accvgpr_write_b32 a152, v216
    v_accvgpr_write_b32 a153, v217
    v_mfma_f32_16x16x32_bf16 v[168:171], a[192:195], v[200:203], 0
    s_lshl_b32 s7, s5, 12
    s_mov_b32 exec_hi, 0
    buffer_load_dword v22, v0, s[24:27], s7 offen
    s_mov_b64 exec, -1
    v_mfma_f32_16x16x32_bf16 v[168:171], a[196:199], v[216:219], v[168:171]
    v_max3_f32 v48, v48, v136, v137
    v_max3_f32 v48, v48, v138, v139
    v_mfma_f32_16x16x32_bf16 v[168:171], a[200:203], v[232:235], v[168:171]
    v_accvgpr_write_b32 a154, v218
    v_accvgpr_write_b32 a155, v219
    v_mfma_f32_16x16x32_bf16 v[168:171], a[204:207], v[248:251], v[168:171]
    v_accvgpr_write_b32 a156, v220
    v_accvgpr_write_b32 a157, v221
    v_mfma_f32_16x16x32_bf16 v[184:187], a[204:207], v[252:255], 0
    v_accvgpr_write_b32 a158, v222
    v_accvgpr_write_b32 a159, v223
    v_mfma_f32_16x16x32_bf16 v[184:187], a[200:203], v[236:239], v[184:187]
    v_max3_f32 v52, v52, v152, v153
    v_max3_f32 v52, v52, v154, v155
    v_mfma_f32_16x16x32_bf16 v[184:187], a[196:199], v[220:223], v[184:187]
    s_waitcnt lgkmcnt(0)
    v_accvgpr_write_b32 a160, v224
    v_mfma_f32_16x16x32_bf16 v[184:187], a[192:195], v[204:207], v[184:187]
    v_accvgpr_write_b32 a161, v225
    v_accvgpr_write_b32 a162, v226
    v_mfma_f32_16x16x32_bf16 v[96:99], a[208:211], v[192:195], 0
    ds_read_b128 a[224:227], v2 offset:24576
    v_accvgpr_write_b32 a163, v227
    v_mfma_f32_16x16x32_bf16 v[96:99], a[212:215], v[208:211], v[96:99]
    v_max3_f32 v56, v56, v168, v169
    v_max3_f32 v56, v56, v170, v171
    v_mfma_f32_16x16x32_bf16 v[96:99], a[216:219], v[224:227], v[96:99]
    ds_read_b128 a[228:231], v3 offset:24576
    v_accvgpr_write_b32 a164, v228
    v_mfma_f32_16x16x32_bf16 v[96:99], a[220:223], v[240:243], v[96:99]
    v_accvgpr_write_b32 a165, v229
    v_accvgpr_write_b32 a166, v230
    v_mfma_f32_16x16x32_bf16 v[100:103], a[220:223], v[244:247], 0
    ds_read_b128 a[232:235], v4 offset:24576
    v_accvgpr_write_b32 a167, v231
    v_mfma_f32_16x16x32_bf16 v[100:103], a[216:219], v[228:231], v[100:103]
    v_max3_f32 v60, v60, v184, v185
    v_max3_f32 v60, v60, v186, v187
    v_mfma_f32_16x16x32_bf16 v[100:103], a[212:215], v[212:215], v[100:103]
    ds_read_b128 a[236:239], v5 offset:24576
    v_accvgpr_write_b32 a168, v232
    v_mfma_f32_16x16x32_bf16 v[100:103], a[208:211], v[196:199], v[100:103]
    v_accvgpr_write_b32 a169, v233
    v_accvgpr_write_b32 a170, v234
    v_mfma_f32_16x16x32_bf16 v[104:107], a[208:211], v[200:203], 0
    v_accvgpr_write_b32 a171, v235
    v_accvgpr_write_b32 a172, v236
    v_mfma_f32_16x16x32_bf16 v[104:107], a[212:215], v[216:219], v[104:107]
    v_max3_f32 v48, v48, v96, v97
    v_max3_f32 v48, v48, v98, v99
    v_mfma_f32_16x16x32_bf16 v[104:107], a[216:219], v[232:235], v[104:107]
    v_accvgpr_write_b32 a173, v237
    v_accvgpr_write_b32 a174, v238
    v_mfma_f32_16x16x32_bf16 v[104:107], a[220:223], v[248:251], v[104:107]
    v_accvgpr_write_b32 a175, v239
    v_accvgpr_write_b32 a176, v240
    v_mfma_f32_16x16x32_bf16 v[108:111], a[220:223], v[252:255], 0
    v_accvgpr_write_b32 a177, v241
    v_accvgpr_write_b32 a178, v242
    v_mfma_f32_16x16x32_bf16 v[108:111], a[216:219], v[236:239], v[108:111]
    v_max3_f32 v52, v52, v100, v101
    v_max3_f32 v52, v52, v102, v103
    v_mfma_f32_16x16x32_bf16 v[108:111], a[212:215], v[220:223], v[108:111]
    s_waitcnt lgkmcnt(0)
    v_accvgpr_write_b32 a179, v243
    v_mfma_f32_16x16x32_bf16 v[108:111], a[208:211], v[204:207], v[108:111]
    v_accvgpr_write_b32 a180, v244
    v_accvgpr_write_b32 a181, v245
    v_mfma_f32_16x16x32_bf16 v[140:143], a[224:227], v[192:195], 0
    ds_read_b128 a[240:243], v2 offset:28672
    v_accvgpr_write_b32 a182, v246
    v_mfma_f32_16x16x32_bf16 v[140:143], a[228:231], v[208:211], v[140:143]
    v_max3_f32 v56, v56, v104, v105
    v_max3_f32 v56, v56, v106, v107
    v_mfma_f32_16x16x32_bf16 v[140:143], a[232:235], v[224:227], v[140:143]
    ds_read_b128 a[244:247], v3 offset:28672
    v_accvgpr_write_b32 a183, v247
    v_mfma_f32_16x16x32_bf16 v[140:143], a[236:239], v[240:243], v[140:143]
    v_accvgpr_write_b32 a184, v248
    v_accvgpr_write_b32 a185, v249
    v_mfma_f32_16x16x32_bf16 v[156:159], a[236:239], v[244:247], 0
    ds_read_b128 a[248:251], v4 offset:28672
    v_accvgpr_write_b32 a186, v250
    v_mfma_f32_16x16x32_bf16 v[156:159], a[232:235], v[228:231], v[156:159]
    v_max3_f32 v60, v60, v108, v109
    v_max3_f32 v60, v60, v110, v111
    v_mfma_f32_16x16x32_bf16 v[156:159], a[228:231], v[212:215], v[156:159]
    ds_read_b128 a[252:255], v5 offset:28672
    v_accvgpr_write_b32 a187, v251
    v_mfma_f32_16x16x32_bf16 v[156:159], a[224:227], v[196:199], v[156:159]
    v_accvgpr_write_b32 a188, v252
    v_accvgpr_write_b32 a189, v253
    v_mfma_f32_16x16x32_bf16 v[172:175], a[224:227], v[200:203], 0
    v_accvgpr_write_b32 a190, v254
    v_accvgpr_write_b32 a191, v255
    v_mfma_f32_16x16x32_bf16 v[172:175], a[228:231], v[216:219], v[172:175]
    v_max3_f32 v48, v48, v140, v141
    v_max3_f32 v48, v48, v142, v143
    v_mfma_f32_16x16x32_bf16 v[172:175], a[232:235], v[232:235], v[172:175]
    v_mov_b32 v50, 0
    v_mov_b32 v51, 0
    v_mfma_f32_16x16x32_bf16 v[172:175], a[236:239], v[248:251], v[172:175]
    v_mov_b32 v54, 0
    v_mov_b32 v55, 0
    v_mfma_f32_16x16x32_bf16 v[188:191], a[236:239], v[252:255], 0
    v_mov_b32 v58, 0
    v_mov_b32 v59, 0
    v_mfma_f32_16x16x32_bf16 v[188:191], a[232:235], v[236:239], v[188:191]
    v_max3_f32 v52, v52, v156, v157
    v_max3_f32 v52, v52, v158, v159
    v_mfma_f32_16x16x32_bf16 v[188:191], a[228:231], v[220:223], v[188:191]
    s_waitcnt lgkmcnt(0)
    v_mov_b32 v62, 0
    v_mfma_f32_16x16x32_bf16 v[188:191], a[224:227], v[204:207], v[188:191]
    v_mov_b32 v63, 0
    v_mfma_f32_16x16x32_bf16 v[112:115], a[240:243], v[192:195], 0
    v_mfma_f32_16x16x32_bf16 v[112:115], a[244:247], v[208:211], v[112:115]
    v_max3_f32 v56, v56, v172, v173
    v_max3_f32 v56, v56, v174, v175
    v_mfma_f32_16x16x32_bf16 v[112:115], a[248:251], v[224:227], v[112:115]
    v_mfma_f32_16x16x32_bf16 v[112:115], a[252:255], v[240:243], v[112:115]
    v_mfma_f32_16x16x32_bf16 v[116:119], a[252:255], v[244:247], 0
    v_mfma_f32_16x16x32_bf16 v[116:119], a[248:251], v[228:231], v[116:119]
    v_max3_f32 v60, v60, v188, v189
    v_max3_f32 v60, v60, v190, v191
    v_mfma_f32_16x16x32_bf16 v[116:119], a[244:247], v[212:215], v[116:119]
    v_mfma_f32_16x16x32_bf16 v[116:119], a[240:243], v[196:199], v[116:119]
    v_mfma_f32_16x16x32_bf16 v[120:123], a[240:243], v[200:203], 0
    v_mfma_f32_16x16x32_bf16 v[120:123], a[244:247], v[216:219], v[120:123]
    v_max3_f32 v48, v48, v112, v113
    v_max3_f32 v48, v48, v114, v115
    v_mfma_f32_16x16x32_bf16 v[120:123], a[248:251], v[232:235], v[120:123]
    v_mfma_f32_16x16x32_bf16 v[120:123], a[252:255], v[248:251], v[120:123]
    v_mfma_f32_16x16x32_bf16 v[124:127], a[252:255], v[252:255], 0
    v_mfma_f32_16x16x32_bf16 v[124:127], a[248:251], v[236:239], v[124:127]
    v_max3_f32 v52, v52, v116, v117
    v_max3_f32 v52, v52, v118, v119
    v_mfma_f32_16x16x32_bf16 v[124:127], a[244:247], v[220:223], v[124:127]
    v_mfma_f32_16x16x32_bf16 v[124:127], a[240:243], v[204:207], v[124:127]
    s_cmp_lg_u32 s46, 0
    s_cbranch_scc1 L1_havemax
    v_max3_f32 v56, v56, v120, v121
    v_max3_f32 v56, v56, v122, v123
    s_nop 3
    v_max3_f32 v60, v60, v124, v125
    v_max3_f32 v60, v60, v126, v127
    v_mov_b32 v49, v48
    v_mov_b32 v53, v52
    v_mov_b32 v57, v56
    v_mov_b32 v61, v60
    v_permlane32_swap_b32 v48, v49
    v_permlane32_swap_b32 v52, v53
    v_permlane32_swap_b32 v56, v57
    v_permlane32_swap_b32 v60, v61
    v_max_f32 v48, v48, v49
    v_max_f32 v52, v52, v53
    v_max_f32 v56, v56, v57
    v_max_f32 v60, v60, v61
    v_mov_b32 v49, v48
    v_mov_b32 v53, v52
    v_mov_b32 v57, v56
    v_mov_b32 v61, v60
    v_permlane16_swap_b32 v48, v49
    v_permlane16_swap_b32 v52, v53
    v_permlane16_swap_b32 v56, v57
    v_permlane16_swap_b32 v60, v61
    v_max_f32 v48, v48, v49
    v_max_f32 v52, v52, v53
    v_max_f32 v56, v56, v57
    v_max_f32 v60, v60, v61
    v_sub_f32 v32, 0xc2cc0000, v48
    v_sub_f32 v33, 0xc2cc0000, v48
    v_sub_f32 v34, 0xc2cc0000, v48
    v_sub_f32 v35, 0xc2cc0000, v48
    v_sub_f32 v36, 0xc2cc0000, v52
    v_sub_f32 v37, 0xc2cc0000, v52
    v_sub_f32 v38, 0xc2cc0000, v52
    v_sub_f32 v39, 0xc2cc0000, v52
    v_sub_f32 v40, 0xc2cc0000, v56
    v_sub_f32 v41, 0xc2cc0000, v56
    v_sub_f32 v42, 0xc2cc0000, v56
    v_sub_f32 v43, 0xc2cc0000, v56
    v_sub_f32 v44, 0xc2cc0000, v60
    v_sub_f32 v45, 0xc2cc0000, v60
    v_sub_f32 v46, 0xc2cc0000, v60
    v_sub_f32 v47, 0xc2cc0000, v60
L1_havemax:
    v_mov_b32 v48, 0
    v_mov_b32 v49, 0
    v_mov_b32 v52, 0
    v_mov_b32 v53, 0
    v_mov_b32 v56, 0
    v_mov_b32 v57, 0
    v_mov_b32 v60, 0
    v_mov_b32 v61, 0
    v_pk_add_f32 v[128:129], v[128:129], v[32:33]
    v_pk_add_f32 v[130:131], v[130:131], v[32:33]
    v_pk_add_f32 v[144:145], v[144:145], v[36:37]
    v_pk_add_f32 v[146:147], v[146:147], v[36:37]
    v_pk_add_f32 v[160:161], v[160:161], v[40:41]
    v_pk_add_f32 v[162:163], v[162:163], v[40:41]
    v_pk_add_f32 v[176:177], v[176:177], v[44:45]
    v_pk_add_f32 v[178:179], v[178:179], v[44:45]
    v_pk_add_f32 v[64:65], v[64:65], v[32:33]
    v_pk_add_f32 v[66:67], v[66:67], v[32:33]
    v_pk_add_f32 v[68:69], v[68:69], v[36:37]
    v_pk_add_f32 v[70:71], v[70:71], v[36:37]
    v_pk_add_f32 v[72:73], v[72:73], v[40:41]
    v_pk_add_f32 v[74:75], v[74:75], v[40:41]
    v_pk_add_f32 v[76:77], v[76:77], v[44:45]
    v_pk_add_f32 v[78:79], v[78:79], v[44:45]
    v_pk_add_f32 v[132:133], v[132:133], v[32:33]
    v_pk_add_f32 v[134:135], v[134:135], v[32:33]
    v_pk_add_f32 v[148:149], v[148:149], v[36:37]
    v_pk_add_f32 v[150:151], v[150:151], v[36:37]
    v_pk_add_f32 v[164:165], v[164:165], v[40:41]
    v_pk_add_f32 v[166:167], v[166:167], v[40:41]
    v_pk_add_f32 v[180:181], v[180:181], v[44:45]
    v_pk_add_f32 v[182:183], v[182:183], v[44:45]
    v_pk_add_f32 v[80:81], v[80:81], v[32:33]
    v_pk_add_f32 v[82:83], v[82:83], v[32:33]
    v_pk_add_f32 v[84:85], v[84:85], v[36:37]
    v_pk_add_f32 v[86:87], v[86:87], v[36:37]
    v_pk_add_f32 v[88:89], v[88:89], v[40:41]
    v_pk_add_f32 v[90:91], v[90:91], v[40:41]
    v_pk_add_f32 v[92:93], v[92:93], v[44:45]
    v_pk_add_f32 v[94:95], v[94:95], v[44:45]
    v_pk_add_f32 v[136:137], v[136:137], v[32:33]
    v_pk_add_f32 v[138:139], v[138:139], v[32:33]
    v_pk_add_f32 v[152:153], v[152:153], v[36:37]
    v_pk_add_f32 v[154:155], v[154:155], v[36:37]
    v_pk_add_f32 v[168:169], v[168:169], v[40:41]
    v_pk_add_f32 v[170:171], v[170:171], v[40:41]
    v_pk_add_f32 v[184:185], v[184:185], v[44:45]
    v_pk_add_f32 v[186:187], v[186:187], v[44:45]
    v_pk_add_f32 v[96:97], v[96:97], v[32:33]
    v_pk_add_f32 v[98:99], v[98:99], v[32:33]
    v_pk_add_f32 v[100:101], v[100:101], v[36:37]
    v_pk_add_f32 v[102:103], v[102:103], v[36:37]
    v_pk_add_f32 v[104:105], v[104:105], v[40:41]
    v_pk_add_f32 v[106:107], v[106:107], v[40:41]
    v_pk_add_f32 v[108:109], v[108:109], v[44:45]
    v_pk_add_f32 v[110:111], v[110:111], v[44:45]
    v_pk_add_f32 v[140:141], v[140:141], v[32:33]
    v_pk_add_f32 v[142:143], v[142:143], v[32:33]
    v_pk_add_f32 v[156:157], v[156:157], v[36:37]
    v_pk_add_f32 v[158:159], v[158:159], v[36:37]
    v_pk_add_f32 v[172:173], v[172:173], v[40:41]
    v_pk_add_f32 v[174:175], v[174:175], v[40:41]
    v_pk_add_f32 v[188:189], v[188:189], v[44:45]
    v_pk_add_f32 v[190:191], v[190:191], v[44:45]
    v_pk_add_f32 v[112:113], v[112:113], v[32:33]
    v_pk_add_f32 v[114:115], v[114:115], v[32:33]
    v_pk_add_f32 v[116:117], v[116:117], v[36:37]
    v_pk_add_f32 v[118:119], v[118:119], v[36:37]
    v_pk_add_f32 v[120:121], v[120:121], v[40:41]
    v_pk_add_f32 v[122:123], v[122:123], v[40:41]
    v_pk_add_f32 v[124:125], v[124:125], v[44:45]
    v_pk_add_f32 v[126:127], v[126:127], v[44:45]
    v_exp_f32 v128, v128
    v_exp_f32 v129, v129
    v_exp_f32 v130, v130
    v_cvt_pk_bf16_f32 v128, v128, v129
    v_exp_f32 v131, v131
    v_exp_f32 v144, v144
    v_cvt_pk_bf16_f32 v129, v130, v131
    v_exp_f32 v145, v145
    v_exp_f32 v146, v146
    v_cvt_pk_bf16_f32 v144, v144, v145
    v_exp_f32 v147, v147
    v_exp_f32 v160, v160
    v_cvt_pk_bf16_f32 v145, v146, v147
    v_exp_f32 v161, v161
    v_exp_f32 v162, v162
    v_cvt_pk_bf16_f32 v160, v160, v161
    v_exp_f32 v163, v163
    v_exp_f32 v176, v176
    v_cvt_pk_bf16_f32 v161, v162, v163
    v_exp_f32 v177, v177
    v_exp_f32 v178, v178
    v_cvt_pk_bf16_f32 v176, v176, v177
    v_exp_f32 v179, v179
    v_exp_f32 v64, v64
    v_cvt_pk_bf16_f32 v177, v178, v179
    v_exp_f32 v65, v65
    v_exp_f32 v66, v66
    v_cvt_pk_bf16_f32 v130, v64, v65
    v_exp_f32 v67, v67
    v_exp_f32 v68, v68
    v_cvt_pk_bf16_f32 v131, v66, v67
    v_exp_f32 v69, v69
    v_exp_f32 v70, v70
    v_cvt_pk_bf16_f32 v146, v68, v69
    v_exp_f32 v71, v71
    v_exp_f32 v72, v72
    v_cvt_pk_bf16_f32 v147, v70, v71
    v_exp_f32 v73, v73
    v_exp_f32 v74, v74
    v_cvt_pk_bf16_f32 v162, v72, v73
    v_exp_f32 v75, v75
    v_exp_f32 v76, v76
    v_cvt_pk_bf16_f32 v163, v74, v75
    v_exp_f32 v77, v77
    v_exp_f32 v78, v78
    v_cvt_pk_bf16_f32 v178, v76, v77
    v_exp_f32 v79, v79
    v_exp_f32 v132, v132
    v_cvt_pk_bf16_f32 v179, v78, v79
    v_exp_f32 v133, v133
    v_exp_f32 v134, v134
    v_cvt_pk_bf16_f32 v132, v132, v133
    v_exp_f32 v135, v135
    v_exp_f32 v148, v148
    v_cvt_pk_bf16_f32 v133, v134, v135
    v_exp_f32 v149, v149
    v_exp_f32 v150, v150
    v_cvt_pk_bf16_f32 v148, v148, v149
    v_exp_f32 v151, v151
    v_exp_f32 v164, v164
    v_cvt_pk_bf16_f32 v149, v150, v151
    v_exp_f32 v165, v165
    v_exp_f32 v166, v166
    v_cvt_pk_bf16_f32 v164, v164, v165
    v_exp_f32 v167, v167
    v_exp_f32 v180, v180
    v_cvt_pk_bf16_f32 v165, v166, v167
    v_exp_f32 v181, v181
    v_exp_f32 v182, v182
    v_cvt_pk_bf16_f32 v180, v180, v181
    v_exp_f32 v183, v183
    v_exp_f32 v80, v80
    v_cvt_pk_bf16_f32 v181, v182, v183
    v_exp_f32 v81, v81
    v_exp_f32 v82, v82
    v_cvt_pk_bf16_f32 v134, v80, v81
    v_exp_f32 v83, v83
    v_exp_f32 v84, v84
    v_cvt_pk_bf16_f32 v135, v82, v83
    v_exp_f32 v85, v85
    v_exp_f32 v86, v86
    v_cvt_pk_bf16_f32 v150, v84, v85
    v_exp_f32 v87, v87
    v_exp_f32 v88, v88
    v_cvt_pk_bf16_f32 v151, v86, v87
    v_exp_f32 v89, v89
    v_exp_f32 v90, v90
    v_cvt_pk_bf16_f32 v166, v88, v89
    v_exp_f32 v91, v91
    v_exp_f32 v92, v92
    v_cvt_pk_bf16_f32 v167, v90, v91
    v_exp_f32 v93, v93
    v_exp_f32 v94, v94
    v_cvt_pk_bf16_f32 v182, v92, v93
    v_exp_f32 v95, v95
    v_exp_f32 v136, v136
    v_cvt_pk_bf16_f32 v183, v94, v95
    v_exp_f32 v137, v137
    v_exp_f32 v138, v138
    v_cvt_pk_bf16_f32 v136, v136, v137
    v_exp_f32 v139, v139
    v_exp_f32 v152, v152
    v_cvt_pk_bf16_f32 v137, v138, v139
    v_exp_f32 v153, v153
    v_exp_f32 v154, v154
    v_cvt_pk_bf16_f32 v152, v152, v153
    v_exp_f32 v155, v155
    v_exp_f32 v168, v168
    v_cvt_pk_bf16_f32 v153, v154, v155
    v_exp_f32 v169, v169
    v_exp_f32 v170, v170
    v_cvt_pk_bf16_f32 v168, v168, v169
    v_exp_f32 v171, v171
    v_exp_f32 v184, v184
    v_cvt_pk_bf16_f32 v169, v170, v171
    v_exp_f32 v185, v185
    v_exp_f32 v186, v186
    v_cvt_pk_bf16_f32 v184, v184, v185
    v_exp_f32 v187, v187
    v_exp_f32 v96, v96
    v_cvt_pk_bf16_f32 v185, v186, v187
    v_exp_f32 v97, v97
    v_exp_f32 v98, v98
    v_cvt_pk_bf16_f32 v138, v96, v97
    v_exp_f32 v99, v99
    v_exp_f32 v100, v100
    v_cvt_pk_bf16_f32 v139, v98, v99
    v_exp_f32 v101, v101
    v_exp_f32 v102, v102
    v_cvt_pk_bf16_f32 v154, v100, v101
    v_exp_f32 v103, v103
    v_exp_f32 v104, v104
    v_cvt_pk_bf16_f32 v155, v102, v103
    v_exp_f32 v105, v105
    v_exp_f32 v106, v106
    v_cvt_pk_bf16_f32 v170, v104, v105
    v_exp_f32 v107, v107
    v_exp_f32 v108, v108
    v_cvt_pk_bf16_f32 v171, v106, v107
    v_exp_f32 v109, v109
    v_exp_f32 v110, v110
    v_cvt_pk_bf16_f32 v186, v108, v109
    v_exp_f32 v111, v111
    v_exp_f32 v140, v140
    v_cvt_pk_bf16_f32 v187, v110, v111
    v_exp_f32 v141, v141
    v_exp_f32 v142, v142
    v_cvt_pk_bf16_f32 v140, v140, v141
    v_exp_f32 v143, v143
    v_exp_f32 v156, v156
    v_cvt_pk_bf16_f32 v141, v142, v143
    s_waitcnt vmcnt(4)
    s_barrier
    ds_read_b128 a[192:195], v2 offset:32768
    ds_read_b128 a[196:199], v3 offset:32768
    ds_read_b128 a[200:203], v4 offset:32768
    ds_read_b128 a[204:207], v5 offset:32768
    s_cmp_lg_u32 s45, 0
    s_cbranch_scc1 L1_sig1
    s_lshl_b32 s3, 1, s43
    s_lshl_b32 s4, s44, 5
    v_mov_b32 v192, s3
    s_mov_b64 exec, 1
    buffer_atomic_or v192, off, s[52:55], s4
    s_mov_b64 exec, -1
L1_sig1:
    v_exp_f32 v157, v157
    v_exp_f32 v158, v158
    v_cvt_pk_bf16_f32 v156, v156, v157
    v_exp_f32 v159, v159
    v_exp_f32 v172, v172
    v_cvt_pk_bf16_f32 v157, v158, v159
    v_exp_f32 v173, v173
    v_exp_f32 v174, v174
    v_cvt_pk_bf16_f32 v172, v172, v173
    v_exp_f32 v175, v175
    v_exp_f32 v188, v188
    v_cvt_pk_bf16_f32 v173, v174, v175
    v_exp_f32 v189, v189
    v_exp_f32 v190, v190
    v_cvt_pk_bf16_f32 v188, v188, v189
    v_exp_f32 v191, v191
    v_exp_f32 v112, v112
    v_cvt_pk_bf16_f32 v189, v190, v191
    v_exp_f32 v113, v113
    v_exp_f32 v114, v114
    v_cvt_pk_bf16_f32 v142, v112, v113
    v_exp_f32 v115, v115
    v_exp_f32 v116, v116
    v_cvt_pk_bf16_f32 v143, v114, v115
    v_exp_f32 v117, v117
    v_exp_f32 v118, v118
    v_cvt_pk_bf16_f32 v158, v116, v117
    v_exp_f32 v119, v119
    v_exp_f32 v120, v120
    v_cvt_pk_bf16_f32 v159, v118, v119
    v_exp_f32 v121, v121
    v_exp_f32 v122, v122
    v_cvt_pk_bf16_f32 v174, v120, v121
    v_exp_f32 v123, v123
    s_waitcnt lgkmcnt(0)
    s_mov_b32 s42, 7
    s_branch L1_u1
.p2align 6
L1_loop:
    v_mfma_f32_16x16x32_bf16 v[128:131], a[192:195], a[128:131], v[32:35]
    ds_read_b128 a[208:211], v2 offset:4096
    v_cvt_pk_bf16_f32 v239, v122, v123
    v_mfma_f32_16x16x32_bf16 v[128:131], a[196:199], a[144:147], v[128:131]
    v_exp_f32 v124, v124
    v_mfma_f32_16x16x32_bf16 v[128:131], a[200:203], a[160:163], v[128:131]
    ds_read_b128 a[212:215], v3 offset:4096
    v_mfma_f32_16x16x32_bf16 v[128:131], a[204:207], a[176:179], v[128:131]
    v_exp_f32 v125, v125
    v_mfma_f32_16x16x32_bf16 v[144:147], a[204:207], a[180:183], v[36:39]
    ds_read_b128 a[216:219], v4 offset:4096
    v_cvt_pk_bf16_f32 v254, v124, v125
    v_mfma_f32_16x16x32_bf16 v[144:147], a[200:203], a[164:167], v[144:147]
    v_exp_f32 v126, v126
    v_mfma_f32_16x16x32_bf16 v[144:147], a[196:199], a[148:151], v[144:147]
    ds_read_b128 a[220:223], v5 offset:4096
    s_add_u32 m0, s41, 32768
    v_mfma_f32_16x16x32_bf16 v[144:147], a[192:195], a[132:135], v[144:147]
    v_exp_f32 v127, v127
    v_mfma_f32_16x16x32_bf16 v[160:163], a[192:195], a[136:139], v[40:43]
    buffer_load_dwordx4 v14, s[8:11], s40 offen offset:0 lds
    v_mfma_f32_16x16x32_bf16 v[160:163], a[196:199], a[152:155], v[160:163]
    v_exp_f32 v128, v128
    v_mfma_f32_16x16x32_bf16 v[160:163], a[200:203], a[168:171], v[160:163]
    buffer_load_dwordx4 v15, s[8:11], s40 offen offset:1024 lds
    v_mfma_f32_16x16x32_bf16 v[160:163], a[204:207], a[184:187], v[160:163]
    v_exp_f32 v129, v129
L1_pc1:
    s_cbranch_execz L1_pc5
    v_mfma_f32_16x16x32_bf16 v[176:179], a[204:207], a[188:191], v[44:47]
    buffer_load_dwordx4 v16, s[8:11], s40 offen offset:2048 lds
    v_mfma_f32_16x16x32_bf16 v[176:179], a[200:203], a[172:175], v[176:179]
    v_exp_f32 v130, v130
    v_mfma_f32_16x16x32_bf16 v[176:179], a[196:199], a[156:159], v[176:179]
    s_waitcnt lgkmcnt(0)
    v_cvt_pk_bf16_f32 v255, v126, v127
    v_mfma_f32_16x16x32_bf16 v[176:179], a[192:195], a[140:143], v[176:179]
    v_exp_f32 v131, v131
    v_mfma_f32_16x16x32_bf16 v[64:67], a[208:211], a[128:131], v[32:35]
    ds_read_b128 a[224:227], v2 offset:8192
    v_cvt_pk_bf16_f32 v128, v128, v129
    v_mfma_f32_16x16x32_bf16 v[64:67], a[212:215], a[144:147], v[64:67]
    v_exp_f32 v144, v144
    v_mfma_f32_16x16x32_bf16 v[64:67], a[216:219], a[160:163], v[64:67]
    ds_read_b128 a[228:231], v3 offset:8192
    v_cvt_pk_bf16_f32 v129, v130, v131
    v_mfma_f32_16x16x32_bf16 v[64:67], a[220:223], a[176:179], v[64:67]
    v_exp_f32 v145, v145
    v_mfma_f32_16x16x32_bf16 v[68:71], a[220:223], a[180:183], v[36:39]
    ds_read_b128 a[232:235], v4 offset:8192
    v_cvt_pk_bf16_f32 v144, v144, v145
    v_mfma_f32_16x16x32_bf16 v[68:71], a[216:219], a[164:167], v[68:71]
    v_exp_f32 v146, v146
    v_mfma_f32_16x16x32_bf16 v[68:71], a[212:215], a[148:151], v[68:71]
    ds_read_b128 a[236:239], v5 offset:8192
    v_mfma_f32_16x16x32_bf16 v[68:71], a[208:211], a[132:135], v[68:71]
    v_exp_f32 v147, v147
    v_smfmac_f32_16x16x64_bf16 v[48:51], v[24:27], v[192:199], v20
    v_mfma_f32_16x16x32_bf16 v[72:75], a[208:211], a[136:139], v[40:43]
    buffer_load_dwordx4 v17, s[8:11], s40 offen offset:3072 lds
    v_mfma_f32_16x16x32_bf16 v[72:75], a[212:215], a[152:155], v[72:75]
    v_exp_f32 v160, v160
    v_mfma_f32_16x16x32_bf16 v[72:75], a[216:219], a[168:171], v[72:75]
    s_add_u32 m0, s41, 49152
    v_cvt_pk_bf16_f32 v145, v146, v147
    v_mfma_f32_16x16x32_bf16 v[72:75], a[220:223], a[184:187], v[72:75]
    v_exp_f32 v161, v161
    v_mfma_f32_16x16x32_bf16 v[76:79], a[220:223], a[188:191], v[44:47]
    buffer_load_dwordx4 v14, s[8:11], s77 offen offset:0 lds
    v_mfma_f32_16x16x32_bf16 v[76:79], a[216:219], a[172:175], v[76:79]
    v_exp_f32 v162, v162
    v_mfma_f32_16x16x32_bf16 v[76:79], a[212:215], a[156:159], v[76:79]
    s_waitcnt lgkmcnt(0)
    v_cvt_pk_bf16_f32 v160, v160, v161
    v_mfma_f32_16x16x32_bf16 v[76:79], a[208:211], a[140:143], v[76:79]
    v_exp_f32 v163, v163
    v_mfma_f32_16x16x32_bf16 v[132:135], a[224:227], a[128:131], v[32:35]
    ds_read_b128 a[240:243], v2 offset:12288
    v_cvt_pk_bf16_f32 v161, v162, v163
    v_mfma_f32_16x16x32_bf16 v[132:135], a[228:231], a[144:147], v[132:135]
    v_exp_f32 v176, v176
    v_mfma_f32_16x16x32_bf16 v[132:135], a[232:235], a[160:163], v[132:135]
    ds_read_b128 a[244:247], v3 offset:12288
    v_mfma_f32_16x16x32_bf16 v[132:135], a[236:239], a[176:179], v[132:135]
    v_exp_f32 v177, v177
    v_mfma_f32_16x16x32_bf16 v[148:151], a[236:239], a[180:183], v[36:39]
    ds_read_b128 a[248:251], v4 offset:12288
    v_cvt_pk_bf16_f32 v176, v176, v177
    v_mfma_f32_16x16x32_bf16 v[148:151], a[232:235], a[164:167], v[148:151]
    v_exp_f32 v178, v178
    v_mfma_f32_16x16x32_bf16 v[148:151], a[228:231], a[148:151], v[148:151]
    ds_read_b128 a[252:255], v5 offset:12288
    v_mfma_f32_16x16x32_bf16 v[148:151], a[224:227], a[132:135], v[148:151]
    v_exp_f32 v179, v179
    v_smfmac_f32_16x16x64_bf16 v[52:55], v[24:27], v[208:215], v20
    v_mfma_f32_16x16x32_bf16 v[164:167], a[224:227], a[136:139], v[40:43]
    buffer_load_dwordx4 v15, s[8:11], s77 offen offset:1024 lds
    v_mfma_f32_16x16x32_bf16 v[164:167], a[228:231], a[152:155], v[164:167]
    v_exp_f32 v64, v64
    v_mfma_f32_16x16x32_bf16 v[164:167], a[232:235], a[168:171], v[164:167]
    buffer_load_dwordx4 v16, s[8:11], s77 offen offset:2048 lds
    v_mfma_f32_16x16x32_bf16 v[164:167], a[236:239], a[184:187], v[164:167]
    v_exp_f32 v65, v65
    v_mfma_f32_16x16x32_bf16 v[180:183], a[236:239], a[188:191], v[44:47]
    buffer_load_dwordx4 v17, s[8:11], s77 offen offset:3072 lds
    v_mfma_f32_16x16x32_bf16 v[180:183], a[232:235], a[172:175], v[180:183]
    v_exp_f32 v66, v66
    v_mfma_f32_16x16x32_bf16 v[180:183], a[228:231], a[156:159], v[180:183]
    s_waitcnt lgkmcnt(0)
    v_cvt_pk_bf16_f32 v177, v178, v179
    v_mfma_f32_16x16x32_bf16 v[180:183], a[224:227], a[140:143], v[180:183]
    v_exp_f32 v67, v67
    v_mfma_f32_16x16x32_bf16 v[80:83], a[240:243], a[128:131], v[32:35]
    ds_read_b128 a[192:195], v2 offset:16384
    v_cvt_pk_bf16_f32 v130, v64, v65
    v_mfma_f32_16x16x32_bf16 v[80:83], a[244:247], a[144:147], v[80:83]
    v_exp_f32 v68, v68
    v_mfma_f32_16x16x32_bf16 v[80:83], a[248:251], a[160:163], v[80:83]
    ds_read_b128 a[196:199], v3 offset:16384
    v_cvt_pk_bf16_f32 v131, v66, v67
    v_mfma_f32_16x16x32_bf16 v[80:83], a[252:255], a[176:179], v[80:83]
    v_exp_f32 v69, v69
    v_mfma_f32_16x16x32_bf16 v[84:87], a[252:255], a[180:183], v[36:39]
    ds_read_b128 a[200:203], v4 offset:16384
    v_cvt_pk_bf16_f32 v146, v68, v69
    v_mfma_f32_16x16x32_bf16 v[84:87], a[248:251], a[164:167], v[84:87]
    v_exp_f32 v70, v70
    v_mfma_f32_16x16x32_bf16 v[84:87], a[244:247], a[148:151], v[84:87]
    ds_read_b128 a[204:207], v5 offset:16384
    s_add_u32 m0, s41, 65536
    v_mfma_f32_16x16x32_bf16 v[84:87], a[240:243], a[132:135], v[84:87]
    v_exp_f32 v71, v71
    v_smfmac_f32_16x16x64_bf16 v[56:59], v[24:27], v[224:231], v20
    v_mfma_f32_16x16x32_bf16 v[88:91], a[240:243], a[136:139], v[40:43]
    buffer_load_dwordx4 v18, s[12:15], s40 offen offset:0 lds
    v_mfma_f32_16x16x32_bf16 v[88:91], a[244:247], a[152:155], v[88:91]
    v_exp_f32 v72, v72
    v_mfma_f32_16x16x32_bf16 v[88:91], a[248:251], a[168:171], v[88:91]
    buffer_load_dwordx4 v19, s[12:15], s40 offen offset:1024 lds
    v_mfma_f32_16x16x32_bf16 v[88:91], a[252:255], a[184:187], v[88:91]
    v_exp_f32 v73, v73
    v_mfma_f32_16x16x32_bf16 v[92:95], a[252:255], a[188:191], v[44:47]
    buffer_load_dwordx4 v18, s[12:15], s40 offen offset:2048 lds
    v_mfma_f32_16x16x32_bf16 v[92:95], a[248:251], a[172:175], v[92:95]
    v_exp_f32 v74, v74
    v_mfma_f32_16x16x32_bf16 v[92:95], a[244:247], a[156:159], v[92:95]
    s_waitcnt lgkmcnt(0)
    v_cvt_pk_bf16_f32 v147, v70, v71
    v_mfma_f32_16x16x32_bf16 v[92:95], a[240:243], a[140:143], v[92:95]
    v_exp_f32 v75, v75
    v_mfma_f32_16x16x32_bf16 v[136:139], a[192:195], a[128:131], v[32:35]
    ds_read_b128 a[208:211], v2 offset:20480
    v_cvt_pk_bf16_f32 v162, v72, v73
    v_mfma_f32_16x16x32_bf16 v[136:139], a[196:199], a[144:147], v[136:139]
    v_exp_f32 v76, v76
    v_mfma_f32_16x16x32_bf16 v[136:139], a[200:203], a[160:163], v[136:139]
    ds_read_b128 a[212:215], v3 offset:20480
    v_cvt_pk_bf16_f32 v163, v74, v75
    v_mfma_f32_16x16x32_bf16 v[136:139], a[204:207], a[176:179], v[136:139]
    v_exp_f32 v77, v77
    v_mfma_f32_16x16x32_bf16 v[152:155], a[204:207], a[180:183], v[36:39]
    ds_read_b128 a[216:219], v4 offset:20480
    v_cvt_pk_bf16_f32 v178, v76, v77
    v_mfma_f32_16x16x32_bf16 v[152:155], a[200:203], a[164:167], v[152:155]
    v_exp_f32 v78, v78
    v_mfma_f32_16x16x32_bf16 v[152:155], a[196:199], a[148:151], v[152:155]
    ds_read_b128 a[220:223], v5 offset:20480
    v_mfma_f32_16x16x32_bf16 v[152:155], a[192:195], a[132:135], v[152:155]
    v_exp_f32 v79, v79
    v_smfmac_f32_16x16x64_bf16 v[60:63], v[24:27], v[240:247], v20
    v_mfma_f32_16x16x32_bf16 v[168:171], a[192:195], a[136:139], v[40:43]
    buffer_load_dwordx4 v19, s[12:15], s40 offen offset:3072 lds
    v_mfma_f32_16x16x32_bf16 v[168:171], a[196:199], a[152:155], v[168:171]
    v_exp_f32 v132, v132
    v_mfma_f32_16x16x32_bf16 v[168:171], a[200:203], a[168:171], v[168:171]
    s_add_u32 m0, s41, 81920
    v_cvt_pk_bf16_f32 v179, v78, v79
    v_mfma_f32_16x16x32_bf16 v[168:171], a[204:207], a[184:187], v[168:171]
    v_exp_f32 v133, v133
    v_mfma_f32_16x16x32_bf16 v[184:187], a[204:207], a[188:191], v[44:47]
    buffer_load_dwordx4 v18, s[12:15], s77 offen offset:0 lds
    v_mfma_f32_16x16x32_bf16 v[184:187], a[200:203], a[172:175], v[184:187]
    v_exp_f32 v134, v134
    v_mfma_f32_16x16x32_bf16 v[184:187], a[196:199], a[156:159], v[184:187]
    s_waitcnt lgkmcnt(0)
    v_cvt_pk_bf16_f32 v132, v132, v133
    v_mfma_f32_16x16x32_bf16 v[184:187], a[192:195], a[140:143], v[184:187]
    v_exp_f32 v135, v135
    v_mfma_f32_16x16x32_bf16 v[96:99], a[208:211], a[128:131], v[32:35]
    ds_read_b128 a[224:227], v2 offset:24576
    v_cvt_pk_bf16_f32 v133, v134, v135
    v_mfma_f32_16x16x32_bf16 v[96:99], a[212:215], a[144:147], v[96:99]
    v_exp_f32 v148, v148
    v_mfma_f32_16x16x32_bf16 v[96:99], a[216:219], a[160:163], v[96:99]
    ds_read_b128 a[228:231], v3 offset:24576
    v_mfma_f32_16x16x32_bf16 v[96:99], a[220:223], a[176:179], v[96:99]
    v_exp_f32 v149, v149
    v_mfma_f32_16x16x32_bf16 v[100:103], a[220:223], a[180:183], v[36:39]
    ds_read_b128 a[232:235], v4 offset:24576
    v_cvt_pk_bf16_f32 v148, v148, v149
    v_mfma_f32_16x16x32_bf16 v[100:103], a[216:219], a[164:167], v[100:103]
    v_exp_f32 v150, v150
    v_mfma_f32_16x16x32_bf16 v[100:103], a[212:215], a[148:151], v[100:103]
    ds_read_b128 a[236:239], v5 offset:24576
    v_mfma_f32_16x16x32_bf16 v[100:103], a[208:211], a[132:135], v[100:103]
    v_exp_f32 v151, v151
    v_smfmac_f32_16x16x64_bf16 v[48:51], v[24:27], v[200:207], v20
    v_mfma_f32_16x16x32_bf16 v[104:107], a[208:211], a[136:139], v[40:43]
    buffer_load_dwordx4 v19, s[12:15], s77 offen offset:1024 lds
    v_mfma_f32_16x16x32_bf16 v[104:107], a[212:215], a[152:155], v[104:107]
    v_exp_f32 v164, v164
    v_mfma_f32_16x16x32_bf16 v[104:107], a[216:219], a[168:171], v[104:107]
    buffer_load_dwordx4 v18, s[12:15], s77 offen offset:2048 lds
    v_mfma_f32_16x16x32_bf16 v[104:107], a[220:223], a[184:187], v[104:107]
    v_exp_f32 v165, v165
    v_mfma_f32_16x16x32_bf16 v[108:111], a[220:223], a[188:191], v[44:47]
    buffer_load_dwordx4 v19, s[12:15], s77 offen offset:3072 lds
    v_mfma_f32_16x16x32_bf16 v[108:111], a[216:219], a[172:175], v[108:111]
    v_exp_f32 v166, v166
    v_mfma_f32_16x16x32_bf16 v[108:111], a[212:215], a[156:159], v[108:111]
    s_waitcnt lgkmcnt(0)
    v_cvt_pk_bf16_f32 v149, v150, v151
    v_mfma_f32_16x16x32_bf16 v[108:111], a[208:211], a[140:143], v[108:111]
    v_exp_f32 v167, v167
    v_mfma_f32_16x16x32_bf16 v[140:143], a[224:227], a[128:131], v[32:35]
    ds_read_b128 a[240:243], v2 offset:28672
    v_cvt_pk_bf16_f32 v164, v164, v165
    v_mfma_f32_16x16x32_bf16 v[140:143], a[228:231], a[144:147], v[140:143]
    v_exp_f32 v180, v180
    v_mfma_f32_16x16x32_bf16 v[140:143], a[232:235], a[160:163], v[140:143]
    ds_read_b128 a[244:247], v3 offset:28672
    v_cvt_pk_bf16_f32 v165, v166, v167
    v_mfma_f32_16x16x32_bf16 v[140:143], a[236:239], a[176:179], v[140:143]
    v_exp_f32 v181, v181
    v_mfma_f32_16x16x32_bf16 v[156:159], a[236:239], a[180:183], v[36:39]
    ds_read_b128 a[248:251], v4 offset:28672
    v_cvt_pk_bf16_f32 v180, v180, v181
    v_mfma_f32_16x16x32_bf16 v[156:159], a[232:235], a[164:167], v[156:159]
    v_exp_f32 v182, v182
    v_mfma_f32_16x16x32_bf16 v[156:159], a[228:231], a[148:151], v[156:159]
    ds_read_b128 a[252:255], v5 offset:28672
    v_mfma_f32_16x16x32_bf16 v[156:159], a[224:227], a[132:135], v[156:159]
    v_exp_f32 v183, v183
    v_smfmac_f32_16x16x64_bf16 v[52:55], v[24:27], v[216:223], v20
    v_mfma_f32_16x16x32_bf16 v[172:175], a[224:227], a[136:139], v[40:43]
    ds_read_b64_tr_b16 a[192:193], v6 offset:32768
    v_cvt_pk_bf16_f32 v181, v182, v183
    v_mfma_f32_16x16x32_bf16 v[172:175], a[228:231], a[152:155], v[172:175]
    v_exp_f32 v80, v80
    v_mfma_f32_16x16x32_bf16 v[172:175], a[232:235], a[168:171], v[172:175]
    ds_read_b64_tr_b16 a[194:195], v6 offset:36864
    v_mfma_f32_16x16x32_bf16 v[172:175], a[236:239], a[184:187], v[172:175]
    v_exp_f32 v81, v81
    v_mfma_f32_16x16x32_bf16 v[188:191], a[236:239], a[188:191], v[44:47]
    ds_read_b64_tr_b16 a[196:197], v6 offset:40960
    v_cvt_pk_bf16_f32 v134, v80, v81
    v_mfma_f32_16x16x32_bf16 v[188:191], a[232:235], a[172:175], v[188:191]
    v_exp_f32 v82, v82
    v_mfma_f32_16x16x32_bf16 v[188:191], a[228:231], a[156:159], v[188:191]
    ds_read_b64_tr_b16 a[198:199], v6 offset:45056
    s_waitcnt lgkmcnt(4)
    v_mfma_f32_16x16x32_bf16 v[188:191], a[224:227], a[140:143], v[188:191]
    v_exp_f32 v83, v83
    v_mfma_f32_16x16x32_bf16 v[112:115], a[240:243], a[128:131], v[32:35]
    ds_read_b64_tr_b16 a[200:201], v6 offset:49152
    v_cvt_pk_bf16_f32 v135, v82, v83
    v_mfma_f32_16x16x32_bf16 v[112:115], a[244:247], a[144:147], v[112:115]
    v_exp_f32 v84, v84
    v_mfma_f32_16x16x32_bf16 v[112:115], a[248:251], a[160:163], v[112:115]
    ds_read_b64_tr_b16 a[202:203], v6 offset:53248
    v_mfma_f32_16x16x32_bf16 v[112:115], a[252:255], a[176:179], v[112:115]
    v_exp_f32 v85, v85
    v_mfma_f32_16x16x32_bf16 v[116:119], a[252:255], a[180:183], v[36:39]
    ds_read_b64_tr_b16 a[204:205], v6 offset:57344
    v_cvt_pk_bf16_f32 v150, v84, v85
    v_mfma_f32_16x16x32_bf16 v[116:119], a[248:251], a[164:167], v[116:119]
    v_exp_f32 v86, v86
    v_mfma_f32_16x16x32_bf16 v[116:119], a[244:247], a[148:151], v[116:119]
    ds_read_b64_tr_b16 a[206:207], v6 offset:61440
    v_mfma_f32_16x16x32_bf16 v[116:119], a[240:243], a[132:135], v[116:119]
    v_exp_f32 v87, v87
    v_smfmac_f32_16x16x64_bf16 v[56:59], v[24:27], v[232:239], v20
    v_mfma_f32_16x16x32_bf16 v[120:123], a[240:243], a[136:139], v[40:43]
    ds_read_b64_tr_b16 a[208:209], v7 offset:32768
    v_cvt_pk_bf16_f32 v151, v86, v87
    v_mfma_f32_16x16x32_bf16 v[120:123], a[244:247], a[152:155], v[120:123]
    v_exp_f32 v88, v88
    v_mfma_f32_16x16x32_bf16 v[120:123], a[248:251], a[168:171], v[120:123]
    ds_read_b64_tr_b16 a[210:211], v7 offset:36864
    v_mfma_f32_16x16x32_bf16 v[120:123], a[252:255], a[184:187], v[120:123]
    v_exp_f32 v89, v89
    v_mfma_f32_16x16x32_bf16 v[124:127], a[252:255], a[188:191], v[44:47]
    ds_read_b64_tr_b16 a[212:213], v7 offset:40960
    v_cvt_pk_bf16_f32 v166, v88, v89
    v_mfma_f32_16x16x32_bf16 v[124:127], a[248:251], a[172:175], v[124:127]
    v_exp_f32 v90, v90
    v_mfma_f32_16x16x32_bf16 v[124:127], a[244:247], a[156:159], v[124:127]
    ds_read_b64_tr_b16 a[214:215], v7 offset:45056
    s_waitcnt lgkmcnt(4)
    v_mfma_f32_16x16x32_bf16 v[124:127], a[240:243], a[140:143], v[124:127]
    v_exp_f32 v91, v91
    v_mfma_f32_16x16x32_bf16 a[0:3], a[192:195], v[192:195], a[0:3]
    ds_read_b64_tr_b16 a[216:217], v7 offset:49152
    v_cvt_pk_bf16_f32 v167, v90, v91
    v_mfma_f32_16x16x32_bf16 a[0:3], a[196:199], v[196:199], a[0:3]
    v_exp_f32 v92, v92
    v_mfma_f32_16x16x32_bf16 a[0:3], a[200:203], v[200:203], a[0:3]
    ds_read_b64_tr_b16 a[218:219], v7 offset:53248
    v_mfma_f32_16x16x32_bf16 a[0:3], a[204:207], v[204:207], a[0:3]
    v_exp_f32 v93, v93
    v_mfma_f32_16x16x32_bf16 a[4:7], a[204:207], v[220:223], a[4:7]
    ds_read_b64_tr_b16 a[220:221], v7 offset:57344
    v_cvt_pk_bf16_f32 v182, v92, v93
    v_mfma_f32_16x16x32_bf16 a[4:7], a[200:203], v[216:219], a[4:7]
    v_exp_f32 v94, v94
    v_mfma_f32_16x16x32_bf16 a[4:7], a[196:199], v[212:215], a[4:7]
    ds_read_b64_tr_b16 a[222:223], v7 offset:61440
    v_mfma_f32_16x16x32_bf16 a[4:7], a[192:195], v[208:211], a[4:7]
    v_exp_f32 v95, v95
    v_smfmac_f32_16x16x64_bf16 v[60:63], v[24:27], v[248:255], v20
    v_mfma_f32_16x16x32_bf16 a[8:11], a[192:195], v[224:227], a[8:11]
    ds_read_b64_tr_b16 a[224:225], v8 offset:32768
    v_cvt_pk_bf16_f32 v183, v94, v95
    v_mfma_f32_16x16x32_bf16 a[8:11], a[196:199], v[228:231], a[8:11]
    v_exp_f32 v136, v136
    v_mfma_f32_16x16x32_bf16 a[8:11], a[200:203], v[232:235], a[8:11]
    ds_read_b64_tr_b16 a[226:227], v8 offset:36864
    v_mfma_f32_16x16x32_bf16 a[8:11], a[204:207], v[236:239], a[8:11]
    v_exp_f32 v137, v137
    v_mfma_f32_16x16x32_bf16 a[12:15], a[204:207], v[252:255], a[12:15]
    ds_read_b64_tr_b16 a[228:229], v8 offset:40960
    v_cvt_pk_bf16_f32 v136, v136, v137
    v_mfma_f32_16x16x32_bf16 a[12:15], a[200:203], v[248:251], a[12:15]
    v_exp_f32 v138, v138
    v_mfma_f32_16x16x32_bf16 a[12:15], a[196:199], v[244:247], a[12:15]
    ds_read_b64_tr_b16 a[230:231], v8 offset:45056
    s_waitcnt lgkmcnt(4)
    v_mfma_f32_16x16x32_bf16 a[12:15], a[192:195], v[240:243], a[12:15]
    v_exp_f32 v139, v139
    v_mfma_f32_16x16x32_bf16 a[28:31], a[208:211], v[240:243], a[28:31]
    ds_read_b64_tr_b16 a[232:233], v8 offset:49152
    v_cvt_pk_bf16_f32 v137, v138, v139
    v_mfma_f32_16x16x32_bf16 a[28:31], a[212:215], v[244:247], a[28:31]
    v_exp_f32 v152, v152
    v_mfma_f32_16x16x32_bf16 a[28:31], a[216:219], v[248:251], a[28:31]
    ds_read_b64_tr_b16 a[234:235], v8 offset:53248
    v_mfma_f32_16x16x32_bf16 a[28:31], a[220:223], v[252:255], a[28:31]
    v_exp_f32 v153, v153
    v_mfma_f32_16x16x32_bf16 a[24:27], a[220:223], v[236:239], a[24:27]
    ds_read_b64_tr_b16 a[236:237], v8 offset:57344
    v_cvt_pk_bf16_f32 v152, v152, v153
    v_mfma_f32_16x16x32_bf16 a[24:27], a[216:219], v[232:235], a[24:27]
    v_exp_f32 v154, v154
    v_mfma_f32_16x16x32_bf16 a[24:27], a[212:215], v[228:231], a[24:27]
    ds_read_b64_tr_b16 a[238:239], v8 offset:61440
    v_mfma_f32_16x16x32_bf16 a[24:27], a[208:211], v[224:227], a[24:27]
    v_exp_f32 v155, v155
    v_mfma_f32_16x16x32_bf16 a[20:23], a[208:211], v[208:211], a[20:23]
    ds_read_b64_tr_b16 a[240:241], v9 offset:32768
    v_cvt_pk_bf16_f32 v153, v154, v155
    v_mfma_f32_16x16x32_bf16 a[20:23], a[212:215], v[212:215], a[20:23]
    v_exp_f32 v168, v168
    v_mfma_f32_16x16x32_bf16 a[20:23], a[216:219], v[216:219], a[20:23]
    ds_read_b64_tr_b16 a[242:243], v9 offset:36864
    v_mfma_f32_16x16x32_bf16 a[20:23], a[220:223], v[220:223], a[20:23]
    v_exp_f32 v169, v169
    v_mfma_f32_16x16x32_bf16 a[16:19], a[220:223], v[204:207], a[16:19]
    ds_read_b64_tr_b16 a[244:245], v9 offset:40960
    v_cvt_pk_bf16_f32 v168, v168, v169
    v_mfma_f32_16x16x32_bf16 a[16:19], a[216:219], v[200:203], a[16:19]
    v_exp_f32 v170, v170
    v_mfma_f32_16x16x32_bf16 a[16:19], a[212:215], v[196:199], a[16:19]
    ds_read_b64_tr_b16 a[246:247], v9 offset:45056
    s_waitcnt lgkmcnt(4)
    v_mfma_f32_16x16x32_bf16 a[16:19], a[208:211], v[192:195], a[16:19]
    v_exp_f32 v171, v171
    v_mfma_f32_16x16x32_bf16 a[32:35], a[224:227], v[192:195], a[32:35]
    ds_read_b64_tr_b16 a[248:249], v9 offset:49152
    v_cvt_pk_bf16_f32 v169, v170, v171
    v_mfma_f32_16x16x32_bf16 a[32:35], a[228:231], v[196:199], a[32:35]
    v_exp_f32 v184, v184
    v_mfma_f32_16x16x32_bf16 a[32:35], a[232:235], v[200:203], a[32:35]
    ds_read_b64_tr_b16 a[250:251], v9 offset:53248
    v_mfma_f32_16x16x32_bf16 a[32:35], a[236:239], v[204:207], a[32:35]
    v_exp_f32 v185, v185
    v_mfma_f32_16x16x32_bf16 a[36:39], a[236:239], v[220:223], a[36:39]
    ds_read_b64_tr_b16 a[252:253], v9 offset:57344
    v_cvt_pk_bf16_f32 v184, v184, v185
    v_mfma_f32_16x16x32_bf16 a[36:39], a[232:235], v[216:219], a[36:39]
    v_exp_f32 v186, v186
    v_mfma_f32_16x16x32_bf16 a[36:39], a[228:231], v[212:215], a[36:39]
    ds_read_b64_tr_b16 a[254:255], v9 offset:61440
    v_mfma_f32_16x16x32_bf16 a[36:39], a[224:227], v[208:211], a[36:39]
    v_exp_f32 v187, v187
    v_mfma_f32_16x16x32_bf16 a[40:43], a[224:227], v[224:227], a[40:43]
    ds_read_b64_tr_b16 a[192:193], v10 offset:32768
    v_cvt_pk_bf16_f32 v185, v186, v187
    v_mfma_f32_16x16x32_bf16 a[40:43], a[228:231], v[228:231], a[40:43]
    v_exp_f32 v96, v96
    v_mfma_f32_16x16x32_bf16 a[40:43], a[232:235], v[232:235], a[40:43]
    ds_read_b64_tr_b16 a[194:195], v10 offset:36864
    v_mfma_f32_16x16x32_bf16 a[40:43], a[236:239], v[236:239], a[40:43]
    v_exp_f32 v97, v97
    v_mfma_f32_16x16x32_bf16 a[44:47], a[236:239], v[252:255], a[44:47]
    ds_read_b64_tr_b16 a[196:197], v10 offset:40960
    v_cvt_pk_bf16_f32 v138, v96, v97
    v_mfma_f32_16x16x32_bf16 a[44:47], a[232:235], v[248:251], a[44:47]
    v_exp_f32 v98, v98
    v_mfma_f32_16x16x32_bf16 a[44:47], a[228:231], v[244:247], a[44:47]
    ds_read_b64_tr_b16 a[198:199], v10 offset:45056
    s_waitcnt lgkmcnt(4)
    v_mfma_f32_16x16x32_bf16 a[44:47], a[224:227], v[240:243], a[44:47]
    v_exp_f32 v99, v99
    v_mfma_f32_16x16x32_bf16 a[60:63], a[240:243], v[240:243], a[60:63]
    ds_read_b64_tr_b16 a[200:201], v10 offset:49152
    v_cvt_pk_bf16_f32 v139, v98, v99
    v_mfma_f32_16x16x32_bf16 a[60:63], a[244:247], v[244:247], a[60:63]
    v_exp_f32 v100, v100
    v_mfma_f32_16x16x32_bf16 a[60:63], a[248:251], v[248:251], a[60:63]
    ds_read_b64_tr_b16 a[202:203], v10 offset:53248
    v_mfma_f32_16x16x32_bf16 a[60:63], a[252:255], v[252:255], a[60:63]
    v_exp_f32 v101, v101
    v_mfma_f32_16x16x32_bf16 a[56:59], a[252:255], v[236:239], a[56:59]
    ds_read_b64_tr_b16 a[204:205], v10 offset:57344
    v_cvt_pk_bf16_f32 v154, v100, v101
    v_mfma_f32_16x16x32_bf16 a[56:59], a[248:251], v[232:235], a[56:59]
    v_exp_f32 v102, v102
    v_mfma_f32_16x16x32_bf16 a[56:59], a[244:247], v[228:231], a[56:59]
    ds_read_b64_tr_b16 a[206:207], v10 offset:61440
    v_mfma_f32_16x16x32_bf16 a[56:59], a[240:243], v[224:227], a[56:59]
    v_exp_f32 v103, v103
    v_mfma_f32_16x16x32_bf16 a[52:55], a[240:243], v[208:211], a[52:55]
    ds_read_b64_tr_b16 a[208:209], v11 offset:32768
    v_cvt_pk_bf16_f32 v155, v102, v103
    v_mfma_f32_16x16x32_bf16 a[52:55], a[244:247], v[212:215], a[52:55]
    v_exp_f32 v104, v104
    v_mfma_f32_16x16x32_bf16 a[52:55], a[248:251], v[216:219], a[52:55]
    ds_read_b64_tr_b16 a[210:211], v11 offset:36864
    v_mfma_f32_16x16x32_bf16 a[52:55], a[252:255], v[220:223], a[52:55]
    v_exp_f32 v105, v105
    v_mfma_f32_16x16x32_bf16 a[48:51], a[252:255], v[204:207], a[48:51]
    ds_read_b64_tr_b16 a[212:213], v11 offset:40960
    v_cvt_pk_bf16_f32 v170, v104, v105
    v_mfma_f32_16x16x32_bf16 a[48:51], a[248:251], v[200:203], a[48:51]
    v_exp_f32 v106, v106
    v_mfma_f32_16x16x32_bf16 a[48:51], a[244:247], v[196:199], a[48:51]
    ds_read_b64_tr_b16 a[214:215], v11 offset:45056
    s_waitcnt lgkmcnt(4)
    v_mfma_f32_16x16x32_bf16 a[48:51], a[240:243], v[192:195], a[48:51]
    v_exp_f32 v107, v107
    v_mfma_f32_16x16x32_bf16 a[64:67], a[192:195], v[192:195], a[64:67]
    ds_read_b64_tr_b16 a[216:217], v11 offset:49152
    v_cvt_pk_bf16_f32 v171, v106, v107
    v_mfma_f32_16x16x32_bf16 a[64:67], a[196:199], v[196:199], a[64:67]
    v_exp_f32 v108, v108
    v_mfma_f32_16x16x32_bf16 a[64:67], a[200:203], v[200:203], a[64:67]
    ds_read_b64_tr_b16 a[218:219], v11 offset:53248
    v_mfma_f32_16x16x32_bf16 a[64:67], a[204:207], v[204:207], a[64:67]
    v_exp_f32 v109, v109
    v_mfma_f32_16x16x32_bf16 a[68:71], a[204:207], v[220:223], a[68:71]
    ds_read_b64_tr_b16 a[220:221], v11 offset:57344
    v_cvt_pk_bf16_f32 v186, v108, v109
    v_mfma_f32_16x16x32_bf16 a[68:71], a[200:203], v[216:219], a[68:71]
    v_exp_f32 v110, v110
    v_mfma_f32_16x16x32_bf16 a[68:71], a[196:199], v[212:215], a[68:71]
    ds_read_b64_tr_b16 a[222:223], v11 offset:61440
    v_mfma_f32_16x16x32_bf16 a[68:71], a[192:195], v[208:211], a[68:71]
    v_exp_f32 v111, v111
    v_mfma_f32_16x16x32_bf16 a[72:75], a[192:195], v[224:227], a[72:75]
    ds_read_b64_tr_b16 a[224:225], v12 offset:32768
    v_cvt_pk_bf16_f32 v187, v110, v111
    v_mfma_f32_16x16x32_bf16 a[72:75], a[196:199], v[228:231], a[72:75]
    v_exp_f32 v140, v140
    v_mfma_f32_16x16x32_bf16 a[72:75], a[200:203], v[232:235], a[72:75]
    ds_read_b64_tr_b16 a[226:227], v12 offset:36864
    v_mfma_f32_16x16x32_bf16 a[72:75], a[204:207], v[236:239], a[72:75]
    v_exp_f32 v141, v141
    v_mfma_f32_16x16x32_bf16 a[76:79], a[204:207], v[252:255], a[76:79]
    ds_read_b64_tr_b16 a[228:229], v12 offset:40960
    v_cvt_pk_bf16_f32 v140, v140, v141
    v_mfma_f32_16x16x32_bf16 a[76:79], a[200:203], v[248:251], a[76:79]
    v_exp_f32 v142, v142
    v_mfma_f32_16x16x32_bf16 a[76:79], a[196:199], v[244:247], a[76:79]
    ds_read_b64_tr_b16 a[230:231], v12 offset:45056
    s_waitcnt lgkmcnt(4)
    v_mfma_f32_16x16x32_bf16 a[76:79], a[192:195], v[240:243], a[76:79]
    v_exp_f32 v143, v143
    v_mfma_f32_16x16x32_bf16 a[92:95], a[208:211], v[240:243], a[92:95]
    ds_read_b64_tr_b16 a[232:233], v12 offset:49152
    v_cvt_pk_bf16_f32 v141, v142, v143
    v_mfma_f32_16x16x32_bf16 a[92:95], a[212:215], v[244:247], a[92:95]
    v_exp_f32 v156, v156
    v_mfma_f32_16x16x32_bf16 a[92:95], a[216:219], v[248:251], a[92:95]
    ds_read_b64_tr_b16 a[234:235], v12 offset:53248
    v_mfma_f32_16x16x32_bf16 a[92:95], a[220:223], v[252:255], a[92:95]
    v_exp_f32 v157, v157
    v_mfma_f32_16x16x32_bf16 a[88:91], a[220:223], v[236:239], a[88:91]
    ds_read_b64_tr_b16 a[236:237], v12 offset:57344
    v_cvt_pk_bf16_f32 v156, v156, v157
    v_mfma_f32_16x16x32_bf16 a[88:91], a[216:219], v[232:235], a[88:91]
    v_exp_f32 v158, v158
    v_mfma_f32_16x16x32_bf16 a[88:91], a[212:215], v[228:231], a[88:91]
    ds_read_b64_tr_b16 a[238:239], v12 offset:61440
    v_mfma_f32_16x16x32_bf16 a[88:91], a[208:211], v[224:227], a[88:91]
    v_exp_f32 v159, v159
    v_mfma_f32_16x16x32_bf16 a[84:87], a[208:211], v[208:211], a[84:87]
    ds_read_b64_tr_b16 a[240:241], v13 offset:32768
    v_cvt_pk_bf16_f32 v157, v158, v159
    v_mfma_f32_16x16x32_bf16 a[84:87], a[212:215], v[212:215], a[84:87]
    v_exp_f32 v172, v172
    v_mfma_f32_16x16x32_bf16 a[84:87], a[216:219], v[216:219], a[84:87]
    ds_read_b64_tr_b16 a[242:243], v13 offset:36864
    v_mfma_f32_16x16x32_bf16 a[84:87], a[220:223], v[220:223], a[84:87]
    v_exp_f32 v173, v173
    v_mfma_f32_16x16x32_bf16 a[80:83], a[220:223], v[204:207], a[80:83]
    ds_read_b64_tr_b16 a[244:245], v13 offset:40960
    v_cvt_pk_bf16_f32 v172, v172, v173
    v_mfma_f32_16x16x32_bf16 a[80:83], a[216:219], v[200:203], a[80:83]
    v_exp_f32 v174, v174
    v_mfma_f32_16x16x32_bf16 a[80:83], a[212:215], v[196:199], a[80:83]
    ds_read_b64_tr_b16 a[246:247], v13 offset:45056
    s_waitcnt lgkmcnt(4)
    v_mfma_f32_16x16x32_bf16 a[80:83], a[208:211], v[192:195], a[80:83]
    v_exp_f32 v175, v175
    v_mfma_f32_16x16x32_bf16 a[96:99], a[224:227], v[192:195], a[96:99]
    ds_read_b64_tr_b16 a[248:249], v13 offset:49152
    v_cvt_pk_bf16_f32 v173, v174, v175
    v_mfma_f32_16x16x32_bf16 a[96:99], a[228:231], v[196:199], a[96:99]
    v_exp_f32 v188, v188
    v_mfma_f32_16x16x32_bf16 a[96:99], a[232:235], v[200:203], a[96:99]
    ds_read_b64_tr_b16 a[250:251], v13 offset:53248
    v_mfma_f32_16x16x32_bf16 a[96:99], a[236:239], v[204:207], a[96:99]
    v_exp_f32 v189, v189
    v_mfma_f32_16x16x32_bf16 a[100:103], a[236:239], v[220:223], a[100:103]
    ds_read_b64_tr_b16 a[252:253], v13 offset:57344
    v_cvt_pk_bf16_f32 v188, v188, v189
    v_mfma_f32_16x16x32_bf16 a[100:103], a[232:235], v[216:219], a[100:103]
    v_exp_f32 v190, v190
    v_mfma_f32_16x16x32_bf16 a[100:103], a[228:231], v[212:215], a[100:103]
    ds_read_b64_tr_b16 a[254:255], v13 offset:61440
    v_mfma_f32_16x16x32_bf16 a[100:103], a[224:227], v[208:211], a[100:103]
    v_exp_f32 v191, v191
    v_mfma_f32_16x16x32_bf16 a[104:107], a[224:227], v[224:227], a[104:107]
    s_add_u32 s40, s40, 32768
    v_cvt_pk_bf16_f32 v189, v190, v191
    v_mfma_f32_16x16x32_bf16 a[104:107], a[228:231], v[228:231], a[104:107]
    v_exp_f32 v112, v112
    v_mfma_f32_16x16x32_bf16 a[104:107], a[232:235], v[232:235], a[104:107]
    s_add_u32 s77, s77, 32768
    v_mfma_f32_16x16x32_bf16 a[104:107], a[236:239], v[236:239], a[104:107]
    v_exp_f32 v113, v113
    v_mfma_f32_16x16x32_bf16 a[108:111], a[236:239], v[252:255], a[108:111]
    s_waitcnt lgkmcnt(0)
    v_cvt_pk_bf16_f32 v142, v112, v113
    v_mfma_f32_16x16x32_bf16 a[108:111], a[232:235], v[248:251], a[108:111]
    v_exp_f32 v114, v114
    v_mfma_f32_16x16x32_bf16 a[108:111], a[228:231], v[244:247], a[108:111]
    s_waitcnt vmcnt(0)
    s_barrier
    v_mfma_f32_16x16x32_bf16 a[108:111], a[224:227], v[240:243], a[108:111]
    v_exp_f32 v115, v115
    v_mfma_f32_16x16x32_bf16 a[124:127], a[240:243], v[240:243], a[124:127]
    ds_read_b128 a[192:195], v2 offset:32768
    v_cvt_pk_bf16_f32 v143, v114, v115
    v_mfma_f32_16x16x32_bf16 a[124:127], a[244:247], v[244:247], a[124:127]
    v_exp_f32 v116, v116
    v_mfma_f32_16x16x32_bf16 a[124:127], a[248:251], v[248:251], a[124:127]
    ds_read_b128 a[196:199], v3 offset:32768
    v_mfma_f32_16x16x32_bf16 a[124:127], a[252:255], v[252:255], a[124:127]
    v_exp_f32 v117, v117
    v_mfma_f32_16x16x32_bf16 a[120:123], a[252:255], v[236:239], a[120:123]
    ds_read_b128 a[200:203], v4 offset:32768
    v_cvt_pk_bf16_f32 v158, v116, v117
    v_mfma_f32_16x16x32_bf16 a[120:123], a[248:251], v[232:235], a[120:123]
    v_exp_f32 v118, v118
    v_mfma_f32_16x16x32_bf16 a[120:123], a[244:247], v[228:231], a[120:123]
    ds_read_b128 a[204:207], v5 offset:32768
    v_mfma_f32_16x16x32_bf16 a[120:123], a[240:243], v[224:227], a[120:123]
    v_exp_f32 v119, v119
    v_mfma_f32_16x16x32_bf16 a[116:119], a[240:243], v[208:211], a[116:119]
    v_cvt_pk_bf16_f32 v159, v118, v119
    v_mfma_f32_16x16x32_bf16 a[116:119], a[244:247], v[212:215], a[116:119]
    v_exp_f32 v120, v120
    v_mfma_f32_16x16x32_bf16 a[116:119], a[248:251], v[216:219], a[116:119]
    v_mfma_f32_16x16x32_bf16 a[116:119], a[252:255], v[220:223], a[116:119]
    v_exp_f32 v121, v121
    v_mfma_f32_16x16x32_bf16 a[112:115], a[252:255], v[204:207], a[112:115]
    v_cvt_pk_bf16_f32 v174, v120, v121
    v_mfma_f32_16x16x32_bf16 a[112:115], a[248:251], v[200:203], a[112:115]
    v_exp_f32 v122, v122
    v_mfma_f32_16x16x32_bf16 a[112:115], a[244:247], v[196:199], a[112:115]
    s_waitcnt lgkmcnt(0)
    v_mfma_f32_16x16x32_bf16 a[112:115], a[240:243], v[192:195], a[112:115]
    v_exp_f32 v123, v123
L1_u1:
L1_pc2:
    s_cbranch_execz L1_pc6
    v_mfma_f32_16x16x32_bf16 v[192:195], a[192:195], a[128:131], v[32:35]
    ds_read_b128 a[208:211], v2 offset:36864
    v_cvt_pk_bf16_f32 v175, v122, v123
    v_mfma_f32_16x16x32_bf16 v[192:195], a[196:199], a[144:147], v[192:195]
    v_exp_f32 v124, v124
    v_mfma_f32_16x16x32_bf16 v[192:195], a[200:203], a[160:163], v[192:195]
    ds_read_b128 a[212:215], v3 offset:36864
    v_mfma_f32_16x16x32_bf16 v[192:195], a[204:207], a[176:179], v[192:195]
    v_exp_f32 v125, v125
    v_mfma_f32_16x16x32_bf16 v[208:211], a[204:207], a[180:183], v[36:39]
    ds_read_b128 a[216:219], v4 offset:36864
    v_cvt_pk_bf16_f32 v190, v124, v125
    v_mfma_f32_16x16x32_bf16 v[208:211], a[200:203], a[164:167], v[208:211]
    v_exp_f32 v126, v126
    v_mfma_f32_16x16x32_bf16 v[208:211], a[196:199], a[148:151], v[208:211]
    ds_read_b128 a[220:223], v5 offset:36864
    s_add_u32 m0, s41, 0
    v_mfma_f32_16x16x32_bf16 v[208:211], a[192:195], a[132:135], v[208:211]
L1_pc3:
    s_cbranch_execz L1_pc7
    v_exp_f32 v127, v127
    v_mfma_f32_16x16x32_bf16 v[224:227], a[192:195], a[136:139], v[40:43]
    buffer_load_dwordx4 v14, s[8:11], s40 offen offset:0 lds
    v_mfma_f32_16x16x32_bf16 v[224:227], a[196:199], a[152:155], v[224:227]
    v_exp_f32 v192, v192
    v_mfma_f32_16x16x32_bf16 v[224:227], a[200:203], a[168:171], v[224:227]
    buffer_load_dwordx4 v15, s[8:11], s40 offen offset:1024 lds
    v_mfma_f32_16x16x32_bf16 v[224:227], a[204:207], a[184:187], v[224:227]
    v_exp_f32 v193, v193
    v_mfma_f32_16x16x32_bf16 v[240:243], a[204:207], a[188:191], v[44:47]
    buffer_load_dwordx4 v16, s[8:11], s40 offen offset:2048 lds
    v_mfma_f32_16x16x32_bf16 v[240:243], a[200:203], a[172:175], v[240:243]
    v_exp_f32 v194, v194
    v_mfma_f32_16x16x32_bf16 v[240:243], a[196:199], a[156:159], v[240:243]
    s_waitcnt lgkmcnt(0)
    v_cvt_pk_bf16_f32 v191, v126, v127
    v_mfma_f32_16x16x32_bf16 v[240:243], a[192:195], a[140:143], v[240:243]
    v_exp_f32 v195, v195
    v_mfma_f32_16x16x32_bf16 v[64:67], a[208:211], a[128:131], v[32:35]
    ds_read_b128 a[224:227], v2 offset:40960
    v_cvt_pk_bf16_f32 v192, v192, v193
    v_mfma_f32_16x16x32_bf16 v[64:67], a[212:215], a[144:147], v[64:67]
    v_exp_f32 v208, v208
    v_mfma_f32_16x16x32_bf16 v[64:67], a[216:219], a[160:163], v[64:67]
    ds_read_b128 a[228:231], v3 offset:40960
    v_cvt_pk_bf16_f32 v193, v194, v195
    v_mfma_f32_16x16x32_bf16 v[64:67], a[220:223], a[176:179], v[64:67]
    v_exp_f32 v209, v209
    v_mfma_f32_16x16x32_bf16 v[68:71], a[220:223], a[180:183], v[36:39]
    ds_read_b128 a[232:235], v4 offset:40960
    v_cvt_pk_bf16_f32 v208, v208, v209
    v_mfma_f32_16x16x32_bf16 v[68:71], a[216:219], a[164:167], v[68:71]
    v_exp_f32 v210, v210
    v_mfma_f32_16x16x32_bf16 v[68:71], a[212:215], a[148:151], v[68:71]
    ds_read_b128 a[236:239], v5 offset:40960
    v_mfma_f32_16x16x32_bf16 v[68:71], a[208:211], a[132:135], v[68:71]
    v_exp_f32 v211, v211
    v_smfmac_f32_16x16x64_bf16 v[48:51], v[24:27], v[128:135], v20
    v_mfma_f32_16x16x32_bf16 v[72:75], a[208:211], a[136:139], v[40:43]
    buffer_load_dwordx4 v17, s[8:11], s40 offen offset:3072 lds
    v_mfma_f32_16x16x32_bf16 v[72:75], a[212:215], a[152:155], v[72:75]
    v_exp_f32 v224, v224
    v_mfma_f32_16x16x32_bf16 v[72:75], a[216:219], a[168:171], v[72:75]
    s_add_u32 m0, s41, 16384
    v_cvt_pk_bf16_f32 v209, v210, v211
    v_mfma_f32_16x16x32_bf16 v[72:75], a[220:223], a[184:187], v[72:75]
    v_exp_f32 v225, v225
    v_mfma_f32_16x16x32_bf16 v[76:79], a[220:223], a[188:191], v[44:47]
    buffer_load_dwordx4 v14, s[8:11], s77 offen offset:0 lds
    v_mfma_f32_16x16x32_bf16 v[76:79], a[216:219], a[172:175], v[76:79]
    v_exp_f32 v226, v226
    v_mfma_f32_16x16x32_bf16 v[76:79], a[212:215], a[156:159], v[76:79]
    s_waitcnt lgkmcnt(0)
    v_cvt_pk_bf16_f32 v224, v224, v225
    v_mfma_f32_16x16x32_bf16 v[76:79], a[208:211], a[140:143], v[76:79]
    v_exp_f32 v227, v227
    v_mfma_f32_16x16x32_bf16 v[196:199], a[224:227], a[128:131], v[32:35]
    ds_read_b128 a[240:243], v2 offset:45056
    v_cvt_pk_bf16_f32 v225, v226, v227
    v_mfma_f32_16x16x32_bf16 v[196:199], a[228:231], a[144:147], v[196:199]
    v_exp_f32 v240, v240
    v_mfma_f32_16x16x32_bf16 v[196:199], a[232:235], a[160:163], v[196:199]
    ds_read_b128 a[244:247], v3 offset:45056
    v_mfma_f32_16x16x32_bf16 v[196:199], a[236:239], a[176:179], v[196:199]
    v_exp_f32 v241, v241
    v_mfma_f32_16x16x32_bf16 v[212:215], a[236:239], a[180:183], v[36:39]
    ds_read_b128 a[248:251], v4 offset:45056
    v_cvt_pk_bf16_f32 v240, v240, v241
    v_mfma_f32_16x16x32_bf16 v[212:215], a[232:235], a[164:167], v[212:215]
    v_exp_f32 v242, v242
    v_mfma_f32_16x16x32_bf16 v[212:215], a[228:231], a[148:151], v[212:215]
    ds_read_b128 a[252:255], v5 offset:45056
    v_mfma_f32_16x16x32_bf16 v[212:215], a[224:227], a[132:135], v[212:215]
    v_exp_f32 v243, v243
    v_smfmac_f32_16x16x64_bf16 v[52:55], v[24:27], v[144:151], v20
    v_mfma_f32_16x16x32_bf16 v[228:231], a[224:227], a[136:139], v[40:43]
    buffer_load_dwordx4 v15, s[8:11], s77 offen offset:1024 lds
    v_mfma_f32_16x16x32_bf16 v[228:231], a[228:231], a[152:155], v[228:231]
    v_exp_f32 v64, v64
    v_mfma_f32_16x16x32_bf16 v[228:231], a[232:235], a[168:171], v[228:231]
    buffer_load_dwordx4 v16, s[8:11], s77 offen offset:2048 lds
    v_mfma_f32_16x16x32_bf16 v[228:231], a[236:239], a[184:187], v[228:231]
    v_exp_f32 v65, v65
    v_mfma_f32_16x16x32_bf16 v[244:247], a[236:239], a[188:191], v[44:47]
    buffer_load_dwordx4 v17, s[8:11], s77 offen offset:3072 lds
    v_mfma_f32_16x16x32_bf16 v[244:247], a[232:235], a[172:175], v[244:247]
    v_exp_f32 v66, v66
    v_mfma_f32_16x16x32_bf16 v[244:247], a[228:231], a[156:159], v[244:247]
    s_waitcnt lgkmcnt(0)
    v_cvt_pk_bf16_f32 v241, v242, v243
    v_mfma_f32_16x16x32_bf16 v[244:247], a[224:227], a[140:143], v[244:247]
    v_exp_f32 v67, v67
    v_mfma_f32_16x16x32_bf16 v[80:83], a[240:243], a[128:131], v[32:35]
    ds_read_b128 a[192:195], v2 offset:49152
    v_cvt_pk_bf16_f32 v194, v64, v65
    v_mfma_f32_16x16x32_bf16 v[80:83], a[244:247], a[144:147], v[80:83]
    v_exp_f32 v68, v68
    v_mfma_f32_16x16x32_bf16 v[80:83], a[248:251], a[160:163], v[80:83]
    ds_read_b128 a[196:199], v3 offset:49152
    v_cvt_pk_bf16_f32 v195, v66, v67
    v_mfma_f32_16x16x32_bf16 v[80:83], a[252:255], a[176:179], v[80:83]
    v_exp_f32 v69, v69
    v_mfma_f32_16x16x32_bf16 v[84:87], a[252:255], a[180:183], v[36:39]
    ds_read_b128 a[200:203], v4 offset:49152
    v_cvt_pk_bf16_f32 v210, v68, v69
    v_mfma_f32_16x16x32_bf16 v[84:87], a[248:251], a[164:167], v[84:87]
    v_exp_f32 v70, v70
    v_mfma_f32_16x16x32_bf16 v[84:87], a[244:247], a[148:151], v[84:87]
    ds_read_b128 a[204:207], v5 offset:49152
    s_add_u32 m0, s41, 98304
    v_mfma_f32_16x16x32_bf16 v[84:87], a[240:243], a[132:135], v[84:87]
    v_exp_f32 v71, v71
    v_smfmac_f32_16x16x64_bf16 v[56:59], v[24:27], v[160:167], v20
    v_mfma_f32_16x16x32_bf16 v[88:91], a[240:243], a[136:139], v[40:43]
    buffer_load_dwordx4 v18, s[12:15], s40 offen offset:0 lds
    v_mfma_f32_16x16x32_bf16 v[88:91], a[244:247], a[152:155], v[88:91]
    v_exp_f32 v72, v72
    v_mfma_f32_16x16x32_bf16 v[88:91], a[248:251], a[168:171], v[88:91]
    buffer_load_dwordx4 v19, s[12:15], s40 offen offset:1024 lds
    v_mfma_f32_16x16x32_bf16 v[88:91], a[252:255], a[184:187], v[88:91]
    v_exp_f32 v73, v73
    v_mfma_f32_16x16x32_bf16 v[92:95], a[252:255], a[188:191], v[44:47]
    buffer_load_dwordx4 v18, s[12:15], s40 offen offset:2048 lds
    v_mfma_f32_16x16x32_bf16 v[92:95], a[248:251], a[172:175], v[92:95]
    v_exp_f32 v74, v74
    v_mfma_f32_16x16x32_bf16 v[92:95], a[244:247], a[156:159], v[92:95]
    s_waitcnt lgkmcnt(0)
    v_cvt_pk_bf16_f32 v211, v70, v71
    v_mfma_f32_16x16x32_bf16 v[92:95], a[240:243], a[140:143], v[92:95]
    v_exp_f32 v75, v75
    v_mfma_f32_16x16x32_bf16 v[200:203], a[192:195], a[128:131], v[32:35]
    ds_read_b128 a[208:211], v2 offset:53248
    v_cvt_pk_bf16_f32 v226, v72, v73
    v_mfma_f32_16x16x32_bf16 v[200:203], a[196:199], a[144:147], v[200:203]
    v_exp_f32 v76, v76
    v_mfma_f32_16x16x32_bf16 v[200:203], a[200:203], a[160:163], v[200:203]
    ds_read_b128 a[212:215], v3 offset:53248
    v_cvt_pk_bf16_f32 v227, v74, v75
    v_mfma_f32_16x16x32_bf16 v[200:203], a[204:207], a[176:179], v[200:203]
    v_exp_f32 v77, v77
    v_mfma_f32_16x16x32_bf16 v[216:219], a[204:207], a[180:183], v[36:39]
    ds_read_b128 a[216:219], v4 offset:53248
    v_cvt_pk_bf16_f32 v242, v76, v77
    v_mfma_f32_16x16x32_bf16 v[216:219], a[200:203], a[164:167], v[216:219]
    v_exp_f32 v78, v78
    v_mfma_f32_16x16x32_bf16 v[216:219], a[196:199], a[148:151], v[216:219]
    ds_read_b128 a[220:223], v5 offset:53248
    v_mfma_f32_16x16x32_bf16 v[216:219], a[192:195], a[132:135], v[216:219]
    v_exp_f32 v79, v79
    v_smfmac_f32_16x16x64_bf16 v[60:63], v[24:27], v[176:183], v20
    v_mfma_f32_16x16x32_bf16 v[232:235], a[192:195], a[136:139], v[40:43]
    buffer_load_dwordx4 v19, s[12:15], s40 offen offset:3072 lds
    v_mfma_f32_16x16x32_bf16 v[232:235], a[196:199], a[152:155], v[232:235]
    v_exp_f32 v196, v196
    v_mfma_f32_16x16x32_bf16 v[232:235], a[200:203], a[168:171], v[232:235]
    s_add_u32 m0, s41, 114688
    v_cvt_pk_bf16_f32 v243, v78, v79
    v_mfma_f32_16x16x32_bf16 v[232:235], a[204:207], a[184:187], v[232:235]
    v_exp_f32 v197, v197
    v_mfma_f32_16x16x32_bf16 v[248:251], a[204:207], a[188:191], v[44:47]
    buffer_load_dwordx4 v18, s[12:15], s77 offen offset:0 lds
    v_mfma_f32_16x16x32_bf16 v[248:251], a[200:203], a[172:175], v[248:251]
    v_exp_f32 v198, v198
    v_mfma_f32_16x16x32_bf16 v[248:251], a[196:199], a[156:159], v[248:251]
    s_waitcnt lgkmcnt(0)
    v_cvt_pk_bf16_f32 v196, v196, v197
    v_mfma_f32_16x16x32_bf16 v[248:251], a[192:195], a[140:143], v[248:251]
    v_exp_f32 v199, v199
    v_mfma_f32_16x16x32_bf16 v[96:99], a[208:211], a[128:131], v[32:35]
    ds_read_b128 a[224:227], v2 offset:57344
    v_cvt_pk_bf16_f32 v197, v198, v199
    v_mfma_f32_16x16x32_bf16 v[96:99], a[212:215], a[144:147], v[96:99]
    v_exp_f32 v212, v212
    v_mfma_f32_16x16x32_bf16 v[96:99], a[216:219], a[160:163], v[96:99]
    ds_read_b128 a[228:231], v3 offset:57344
    v_mfma_f32_16x16x32_bf16 v[96:99], a[220:223], a[176:179], v[96:99]
    v_exp_f32 v213, v213
    v_mfma_f32_16x16x32_bf16 v[100:103], a[220:223], a[180:183], v[36:39]
    ds_read_b128 a[232:235], v4 offset:57344
    v_cvt_pk_bf16_f32 v212, v212, v213
    v_mfma_f32_16x16x32_bf16 v[100:103], a[216:219], a[164:167], v[100:103]
    v_exp_f32 v214, v214
    v_mfma_f32_16x16x32_bf16 v[100:103], a[212:215], a[148:151], v[100:103]
    ds_read_b128 a[236:239], v5 offset:57344
    v_mfma_f32_16x16x32_bf16 v[100:103], a[208:211], a[132:135], v[100:103]
    v_exp_f32 v215, v215
    v_smfmac_f32_16x16x64_bf16 v[48:51], v[24:27], v[136:143], v20
    v_mfma_f32_16x16x32_bf16 v[104:107], a[208:211], a[136:139], v[40:43]
    buffer_load_dwordx4 v19, s[12:15], s77 offen offset:1024 lds
    v_mfma_f32_16x16x32_bf16 v[104:107], a[212:215], a[152:155], v[104:107]
    v_exp_f32 v228, v228
    v_mfma_f32_16x16x32_bf16 v[104:107], a[216:219], a[168:171], v[104:107]
    buffer_load_dwordx4 v18, s[12:15], s77 offen offset:2048 lds
    v_mfma_f32_16x16x32_bf16 v[104:107], a[220:223], a[184:187], v[104:107]
    v_exp_f32 v229, v229
    v_mfma_f32_16x16x32_bf16 v[108:111], a[220:223], a[188:191], v[44:47]
    buffer_load_dwordx4 v19, s[12:15], s77 offen offset:3072 lds
    v_mfma_f32_16x16x32_bf16 v[108:111], a[216:219], a[172:175], v[108:111]
    v_exp_f32 v230, v230
    v_mfma_f32_16x16x32_bf16 v[108:111], a[212:215], a[156:159], v[108:111]
    s_waitcnt lgkmcnt(0)
    v_cvt_pk_bf16_f32 v213, v214, v215
    v_mfma_f32_16x16x32_bf16 v[108:111], a[208:211], a[140:143], v[108:111]
    v_exp_f32 v231, v231
    v_mfma_f32_16x16x32_bf16 v[204:207], a[224:227], a[128:131], v[32:35]
    ds_read_b128 a[240:243], v2 offset:61440
    v_cvt_pk_bf16_f32 v228, v228, v229
    v_mfma_f32_16x16x32_bf16 v[204:207], a[228:231], a[144:147], v[204:207]
    v_exp_f32 v244, v244
    v_mfma_f32_16x16x32_bf16 v[204:207], a[232:235], a[160:163], v[204:207]
    ds_read_b128 a[244:247], v3 offset:61440
    v_cvt_pk_bf16_f32 v229, v230, v231
    v_mfma_f32_16x16x32_bf16 v[204:207], a[236:239], a[176:179], v[204:207]
    v_exp_f32 v245, v245
    v_mfma_f32_16x16x32_bf16 v[220:223], a[236:239], a[180:183], v[36:39]
    ds_read_b128 a[248:251], v4 offset:61440
    v_cvt_pk_bf16_f32 v244, v244, v245
    v_mfma_f32_16x16x32_bf16 v[220:223], a[232:235], a[164:167], v[220:223]
    v_exp_f32 v246, v246
    v_mfma_f32_16x16x32_bf16 v[220:223], a[228:231], a[148:151], v[220:223]
    ds_read_b128 a[252:255], v5 offset:61440
    v_mfma_f32_16x16x32_bf16 v[220:223], a[224:227], a[132:135], v[220:223]
    v_exp_f32 v247, v247
    v_smfmac_f32_16x16x64_bf16 v[52:55], v[24:27], v[152:159], v20
    v_mfma_f32_16x16x32_bf16 v[236:239], a[224:227], a[136:139], v[40:43]
    ds_read_b64_tr_b16 a[192:193], v6 offset:0
    v_cvt_pk_bf16_f32 v245, v246, v247
    v_mfma_f32_16x16x32_bf16 v[236:239], a[228:231], a[152:155], v[236:239]
    v_exp_f32 v80, v80
    v_mfma_f32_16x16x32_bf16 v[236:239], a[232:235], a[168:171], v[236:239]
    ds_read_b64_tr_b16 a[194:195], v6 offset:4096
    v_mfma_f32_16x16x32_bf16 v[236:239], a[236:239], a[184:187], v[236:239]
    v_exp_f32 v81, v81
    v_mfma_f32_16x16x32_bf16 v[252:255], a[236:239], a[188:191], v[44:47]
    ds_read_b64_tr_b16 a[196:197], v6 offset:8192
    v_cvt_pk_bf16_f32 v198, v80, v81
    v_mfma_f32_16x16x32_bf16 v[252:255], a[232:235], a[172:175], v[252:255]
    v_exp_f32 v82, v82
    v_mfma_f32_16x16x32_bf16 v[252:255], a[228:231], a[156:159], v[252:255]
    ds_read_b64_tr_b16 a[198:199], v6 offset:12288
    s_waitcnt lgkmcnt(4)
    v_mfma_f32_16x16x32_bf16 v[252:255], a[224:227], a[140:143], v[252:255]
    v_exp_f32 v83, v83
    v_mfma_f32_16x16x32_bf16 v[112:115], a[240:243], a[128:131], v[32:35]
    ds_read_b64_tr_b16 a[200:201], v6 offset:16384
    v_cvt_pk_bf16_f32 v199, v82, v83
    v_mfma_f32_16x16x32_bf16 v[112:115], a[244:247], a[144:147], v[112:115]
    v_exp_f32 v84, v84
    v_mfma_f32_16x16x32_bf16 v[112:115], a[248:251], a[160:163], v[112:115]
    ds_read_b64_tr_b16 a[202:203], v6 offset:20480
    v_mfma_f32_16x16x32_bf16 v[112:115], a[252:255], a[176:179], v[112:115]
    v_exp_f32 v85, v85
    v_mfma_f32_16x16x32_bf16 v[116:119], a[252:255], a[180:183], v[36:39]
    ds_read_b64_tr_b16 a[204:205], v6 offset:24576
    v_cvt_pk_bf16_f32 v214, v84, v85
    v_mfma_f32_16x16x32_bf16 v[116:119], a[248:251], a[164:167], v[116:119]
    v_exp_f32 v86, v86
    v_mfma_f32_16x16x32_bf16 v[116:119], a[244:247], a[148:151], v[116:119]
    ds_read_b64_tr_b16 a[206:207], v6 offset:28672
    v_mfma_f32_16x16x32_bf16 v[116:119], a[240:243], a[132:135], v[116:119]
    v_exp_f32 v87, v87
    v_smfmac_f32_16x16x64_bf16 v[56:59], v[24:27], v[168:175], v20
    v_mfma_f32_16x16x32_bf16 v[120:123], a[240:243], a[136:139], v[40:43]
    ds_read_b64_tr_b16 a[208:209], v7 offset:0
    v_cvt_pk_bf16_f32 v215, v86, v87
    v_mfma_f32_16x16x32_bf16 v[120:123], a[244:247], a[152:155], v[120:123]
    v_exp_f32 v88, v88
    v_mfma_f32_16x16x32_bf16 v[120:123], a[248:251], a[168:171], v[120:123]
    ds_read_b64_tr_b16 a[210:211], v7 offset:4096
    v_mfma_f32_16x16x32_bf16 v[120:123], a[252:255], a[184:187], v[120:123]
    v_exp_f32 v89, v89
    v_mfma_f32_16x16x32_bf16 v[124:127], a[252:255], a[188:191], v[44:47]
    ds_read_b64_tr_b16 a[212:213], v7 offset:8192
    v_cvt_pk_bf16_f32 v230, v88, v89
    v_mfma_f32_16x16x32_bf16 v[124:127], a[248:251], a[172:175], v[124:127]
    v_exp_f32 v90, v90
    v_mfma_f32_16x16x32_bf16 v[124:127], a[244:247], a[156:159], v[124:127]
    ds_read_b64_tr_b16 a[214:215], v7 offset:12288
    s_waitcnt lgkmcnt(4)
    v_mfma_f32_16x16x32_bf16 v[124:127], a[240:243], a[140:143], v[124:127]
    v_exp_f32 v91, v91
    v_mfma_f32_16x16x32_bf16 a[0:3], a[192:195], v[128:131], a[0:3]
    ds_read_b64_tr_b16 a[216:217], v7 offset:16384
    v_cvt_pk_bf16_f32 v231, v90, v91
    v_mfma_f32_16x16x32_bf16 a[0:3], a[196:199], v[132:135], a[0:3]
    v_exp_f32 v92, v92
    v_mfma_f32_16x16x32_bf16 a[0:3], a[200:203], v[136:139], a[0:3]
    ds_read_b64_tr_b16 a[218:219], v7 offset:20480
    v_mfma_f32_16x16x32_bf16 a[0:3], a[204:207], v[140:143], a[0:3]
    v_exp_f32 v93, v93
    v_mfma_f32_16x16x32_bf16 a[4:7], a[204:207], v[156:159], a[4:7]
    ds_read_b64_tr_b16 a[220:221], v7 offset:24576
    v_cvt_pk_bf16_f32 v246, v92, v93
    v_mfma_f32_16x16x32_bf16 a[4:7], a[200:203], v[152:155], a[4:7]
    v_exp_f32 v94, v94
    v_mfma_f32_16x16x32_bf16 a[4:7], a[196:199], v[148:151], a[4:7]
    ds_read_b64_tr_b16 a[222:223], v7 offset:28672
    v_mfma_f32_16x16x32_bf16 a[4:7], a[192:195], v[144:147], a[4:7]
    v_exp_f32 v95, v95
    v_smfmac_f32_16x16x64_bf16 v[60:63], v[24:27], v[184:191], v20
    v_mfma_f32_16x16x32_bf16 a[8:11], a[192:195], v[160:163], a[8:11]
    ds_read_b64_tr_b16 a[224:225], v8 offset:0
    v_cvt_pk_bf16_f32 v247, v94, v95
    v_mfma_f32_16x16x32_bf16 a[8:11], a[196:199], v[164:167], a[8:11]
    v_exp_f32 v200, v200
    v_mfma_f32_16x16x32_bf16 a[8:11], a[200:203], v[168:171], a[8:11]
    ds_read_b64_tr_b16 a[226:227], v8 offset:4096
    v_mfma_f32_16x16x32_bf16 a[8:11], a[204:207], v[172:175], a[8:11]
    v_exp_f32 v201, v201
    v_mfma_f32_16x16x32_bf16 a[12:15], a[204:207], v[188:191], a[12:15]
    ds_read_b64_tr_b16 a[228:229], v8 offset:8192
    v_cvt_pk_bf16_f32 v200, v200, v201
    v_mfma_f32_16x16x32_bf16 a[12:15], a[200:203], v[184:187], a[12:15]
    v_exp_f32 v202, v202
    v_mfma_f32_16x16x32_bf16 a[12:15], a[196:199], v[180:183], a[12:15]
    ds_read_b64_tr_b16 a[230:231], v8 offset:12288
    s_waitcnt lgkmcnt(4)
    v_mfma_f32_16x16x32_bf16 a[12:15], a[192:195], v[176:179], a[12:15]
    v_exp_f32 v203, v203
    v_mfma_f32_16x16x32_bf16 a[28:31], a[208:211], v[176:179], a[28:31]
    ds_read_b64_tr_b16 a[232:233], v8 offset:16384
    v_cvt_pk_bf16_f32 v201, v202, v203
    v_mfma_f32_16x16x32_bf16 a[28:31], a[212:215], v[180:183], a[28:31]
    v_exp_f32 v216, v216
    v_mfma_f32_16x16x32_bf16 a[28:31], a[216:219], v[184:187], a[28:31]
    ds_read_b64_tr_b16 a[234:235], v8 offset:20480
    v_mfma_f32_16x16x32_bf16 a[28:31], a[220:223], v[188:191], a[28:31]
    v_exp_f32 v217, v217
    v_mfma_f32_16x16x32_bf16 a[24:27], a[220:223], v[172:175], a[24:27]
    ds_read_b64_tr_b16 a[236:237], v8 offset:24576
    v_cvt_pk_bf16_f32 v216, v216, v217
    v_mfma_f32_16x16x32_bf16 a[24:27], a[216:219], v[168:171], a[24:27]
    v_exp_f32 v218, v218
    v_mfma_f32_16x16x32_bf16 a[24:27], a[212:215], v[164:167], a[24:27]
    ds_read_b64_tr_b16 a[238:239], v8 offset:28672
    v_mfma_f32_16x16x32_bf16 a[24:27], a[208:211], v[160:163], a[24:27]
    v_exp_f32 v219, v219
    v_mfma_f32_16x16x32_bf16 a[20:23], a[208:211], v[144:147], a[20:23]
    ds_read_b64_tr_b16 a[240:241], v9 offset:0
    v_cvt_pk_bf16_f32 v217, v218, v219
    v_mfma_f32_16x16x32_bf16 a[20:23], a[212:215], v[148:151], a[20:23]
    v_exp_f32 v232, v232
    v_mfma_f32_16x16x32_bf16 a[20:23], a[216:219], v[152:155], a[20:23]
    ds_read_b64_tr_b16 a[242:243], v9 offset:4096
    v_mfma_f32_16x16x32_bf16 a[20:23], a[220:223], v[156:159], a[20:23]
    v_exp_f32 v233, v233
    v_mfma_f32_16x16x32_bf16 a[16:19], a[220:223], v[140:143], a[16:19]
    ds_read_b64_tr_b16 a[244:245], v9 offset:8192
    v_cvt_pk_bf16_f32 v232, v232, v233
    v_mfma_f32_16x16x32_bf16 a[16:19], a[216:219], v[136:139], a[16:19]
    v_exp_f32 v234, v234
    v_mfma_f32_16x16x32_bf16 a[16:19], a[212:215], v[132:135], a[16:19]
    ds_read_b64_tr_b16 a[246:247], v9 offset:12288
    s_waitcnt lgkmcnt(4)
    v_mfma_f32_16x16x32_bf16 a[16:19], a[208:211], v[128:131], a[16:19]
    v_exp_f32 v235, v235
    v_mfma_f32_16x16x32_bf16 a[32:35], a[224:227], v[128:131], a[32:35]
    ds_read_b64_tr_b16 a[248:249], v9 offset:16384
    v_cvt_pk_bf16_f32 v233, v234, v235
    v_mfma_f32_16x16x32_bf16 a[32:35], a[228:231], v[132:135], a[32:35]
    v_exp_f32 v248, v248
    v_mfma_f32_16x16x32_bf16 a[32:35], a[232:235], v[136:139], a[32:35]
    ds_read_b64_tr_b16 a[250:251], v9 offset:20480
    v_mfma_f32_16x16x32_bf16 a[32:35], a[236:239], v[140:143], a[32:35]
    v_exp_f32 v249, v249
    v_mfma_f32_16x16x32_bf16 a[36:39], a[236:239], v[156:159], a[36:39]
    ds_read_b64_tr_b16 a[252:253], v9 offset:24576
    v_cvt_pk_bf16_f32 v248, v248, v249
    v_mfma_f32_16x16x32_bf16 a[36:39], a[232:235], v[152:155], a[36:39]
    v_exp_f32 v250, v250
    v_mfma_f32_16x16x32_bf16 a[36:39], a[228:231], v[148:151], a[36:39]
    ds_read_b64_tr_b16 a[254:255], v9 offset:28672
    v_mfma_f32_16x16x32_bf16 a[36:39], a[224:227], v[144:147], a[36:39]
    v_exp_f32 v251, v251
    v_mfma_f32_16x16x32_bf16 a[40:43], a[224:227], v[160:163], a[40:43]
    ds_read_b64_tr_b16 a[192:193], v10 offset:0
    v_cvt_pk_bf16_f32 v249, v250, v251
    v_mfma_f32_16x16x32_bf16 a[40:43], a[228:231], v[164:167], a[40:43]
    v_exp_f32 v96, v96
    v_mfma_f32_16x16x32_bf16 a[40:43], a[232:235], v[168:171], a[40:43]
    ds_read_b64_tr_b16 a[194:195], v10 offset:4096
    v_mfma_f32_16x16x32_bf16 a[40:43], a[236:239], v[172:175], a[40:43]
    v_exp_f32 v97, v97
    v_mfma_f32_16x16x32_bf16 a[44:47], a[236:239], v[188:191], a[44:47]
    ds_read_b64_tr_b16 a[196:197], v10 offset:8192
    v_cvt_pk_bf16_f32 v202, v96, v97
    v_mfma_f32_16x16x32_bf16 a[44:47], a[232:235], v[184:187], a[44:47]
    v_exp_f32 v98, v98
    v_mfma_f32_16x16x32_bf16 a[44:47], a[228:231], v[180:183], a[44:47]
    ds_read_b64_tr_b16 a[198:199], v10 offset:12288
    s_waitcnt lgkmcnt(4)
    v_mfma_f32_16x16x32_bf16 a[44:47], a[224:227], v[176:179], a[44:47]
    v_exp_f32 v99, v99
    v_mfma_f32_16x16x32_bf16 a[60:63], a[240:243], v[176:179], a[60:63]
    ds_read_b64_tr_b16 a[200:201], v10 offset:16384
    v_cvt_pk_bf16_f32 v203, v98, v99
    v_mfma_f32_16x16x32_bf16 a[60:63], a[244:247], v[180:183], a[60:63]
    v_exp_f32 v100, v100
    v_mfma_f32_16x16x32_bf16 a[60:63], a[248:251], v[184:187], a[60:63]
    ds_read_b64_tr_b16 a[202:203], v10 offset:20480
    v_mfma_f32_16x16x32_bf16 a[60:63], a[252:255], v[188:191], a[60:63]
    v_exp_f32 v101, v101
    v_mfma_f32_16x16x32_bf16 a[56:59], a[252:255], v[172:175], a[56:59]
    ds_read_b64_tr_b16 a[204:205], v10 offset:24576
    v_cvt_pk_bf16_f32 v218, v100, v101
    v_mfma_f32_16x16x32_bf16 a[56:59], a[248:251], v[168:171], a[56:59]
    v_exp_f32 v102, v102
    v_mfma_f32_16x16x32_bf16 a[56:59], a[244:247], v[164:167], a[56:59]
    ds_read_b64_tr_b16 a[206:207], v10 offset:28672
    v_mfma_f32_16x16x32_bf16 a[56:59], a[240:243], v[160:163], a[56:59]
    v_exp_f32 v103, v103
    v_mfma_f32_16x16x32_bf16 a[52:55], a[240:243], v[144:147], a[52:55]
    ds_read_b64_tr_b16 a[208:209], v11 offset:0
    v_cvt_pk_bf16_f32 v219, v102, v103
    v_mfma_f32_16x16x32_bf16 a[52:55], a[244:247], v[148:151], a[52:55]
    v_exp_f32 v104, v104
    v_mfma_f32_16x16x32_bf16 a[52:55], a[248:251], v[152:155], a[52:55]
    ds_read_b64_tr_b16 a[210:211], v11 offset:4096
    v_mfma_f32_16x16x32_bf16 a[52:55], a[252:255], v[156:159], a[52:55]
    v_exp_f32 v105, v105
    v_mfma_f32_16x16x32_bf16 a[48:51], a[252:255], v[140:143], a[48:51]
    ds_read_b64_tr_b16 a[212:213], v11 offset:8192
    v_cvt_pk_bf16_f32 v234, v104, v105
    v_mfma_f32_16x16x32_bf16 a[48:51], a[248:251], v[136:139], a[48:51]
    v_exp_f32 v106, v106
    v_mfma_f32_16x16x32_bf16 a[48:51], a[244:247], v[132:135], a[48:51]
    ds_read_b64_tr_b16 a[214:215], v11 offset:12288
    s_waitcnt lgkmcnt(4)
    v_mfma_f32_16x16x32_bf16 a[48:51], a[240:243], v[128:131], a[48:51]
    v_exp_f32 v107, v107
    v_mfma_f32_16x16x32_bf16 a[64:67], a[192:195], v[128:131], a[64:67]
    ds_read_b64_tr_b16 a[216:217], v11 offset:16384
    v_cvt_pk_bf16_f32 v235, v106, v107
    v_mfma_f32_16x16x32_bf16 a[64:67], a[196:199], v[132:135], a[64:67]
    v_exp_f32 v108, v108
    v_mfma_f32_16x16x32_bf16 a[64:67], a[200:203], v[136:139], a[64:67]
    ds_read_b64_tr_b16 a[218:219], v11 offset:20480
    v_mfma_f32_16x16x32_bf16 a[64:67], a[204:207], v[140:143], a[64:67]
    v_exp_f32 v109, v109
    v_mfma_f32_16x16x32_bf16 a[68:71], a[204:207], v[156:159], a[68:71]
    ds_read_b64_tr_b16 a[220:221], v11 offset:24576
    v_cvt_pk_bf16_f32 v250, v108, v109
    v_mfma_f32_16x16x32_bf16 a[68:71], a[200:203], v[152:155], a[68:71]
    v_exp_f32 v110, v110
    v_mfma_f32_16x16x32_bf16 a[68:71], a[196:199], v[148:151], a[68:71]
    ds_read_b64_tr_b16 a[222:223], v11 offset:28672
    v_mfma_f32_16x16x32_bf16 a[68:71], a[192:195], v[144:147], a[68:71]
    v_exp_f32 v111, v111
    v_mfma_f32_16x16x32_bf16 a[72:75], a[192:195], v[160:163], a[72:75]
    ds_read_b64_tr_b16 a[224:225], v12 offset:0
    v_cvt_pk_bf16_f32 v251, v110, v111
    v_mfma_f32_16x16x32_bf16 a[72:75], a[196:199], v[164:167], a[72:75]
    v_exp_f32 v204, v204
    v_mfma_f32_16x16x32_bf16 a[72:75], a[200:203], v[168:171], a[72:75]
    ds_read_b64_tr_b16 a[226:227], v12 offset:4096
    v_mfma_f32_16x16x32_bf16 a[72:75], a[204:207], v[172:175], a[72:75]
    v_exp_f32 v205, v205
    v_mfma_f32_16x16x32_bf16 a[76:79], a[204:207], v[188:191], a[76:79]
    ds_read_b64_tr_b16 a[228:229], v12 offset:8192
    v_cvt_pk_bf16_f32 v204, v204, v205
    v_mfma_f32_16x16x32_bf16 a[76:79], a[200:203], v[184:187], a[76:79]
    v_exp_f32 v206, v206
    v_mfma_f32_16x16x32_bf16 a[76:79], a[196:199], v[180:183], a[76:79]
    ds_read_b64_tr_b16 a[230:231], v12 offset:12288
    s_waitcnt lgkmcnt(4)
    v_mfma_f32_16x16x32_bf16 a[76:79], a[192:195], v[176:179], a[76:79]
    v_exp_f32 v207, v207
    v_mfma_f32_16x16x32_bf16 a[92:95], a[208:211], v[176:179], a[92:95]
    ds_read_b64_tr_b16 a[232:233], v12 offset:16384
    v_cvt_pk_bf16_f32 v205, v206, v207
    v_mfma_f32_16x16x32_bf16 a[92:95], a[212:215], v[180:183], a[92:95]
    v_exp_f32 v220, v220
    v_mfma_f32_16x16x32_bf16 a[92:95], a[216:219], v[184:187], a[92:95]
    ds_read_b64_tr_b16 a[234:235], v12 offset:20480
    v_mfma_f32_16x16x32_bf16 a[92:95], a[220:223], v[188:191], a[92:95]
    v_exp_f32 v221, v221
    v_mfma_f32_16x16x32_bf16 a[88:91], a[220:223], v[172:175], a[88:91]
    ds_read_b64_tr_b16 a[236:237], v12 offset:24576
    v_cvt_pk_bf16_f32 v220, v220, v221
    v_mfma_f32_16x16x32_bf16 a[88:91], a[216:219], v[168:171], a[88:91]
    v_exp_f32 v222, v222
    v_mfma_f32_16x16x32_bf16 a[88:91], a[212:215], v[164:167], a[88:91]
    ds_read_b64_tr_b16 a[238:239], v12 offset:28672
    v_mfma_f32_16x16x32_bf16 a[88:91], a[208:211], v[160:163], a[88:91]
    v_exp_f32 v223, v223
    v_mfma_f32_16x16x32_bf16 a[84:87], a[208:211], v[144:147], a[84:87]
    ds_read_b64_tr_b16 a[240:241], v13 offset:0
    v_cvt_pk_bf16_f32 v221, v222, v223
    v_mfma_f32_16x16x32_bf16 a[84:87], a[212:215], v[148:151], a[84:87]
    v_exp_f32 v236, v236
    v_mfma_f32_16x16x32_bf16 a[84:87], a[216:219], v[152:155], a[84:87]
    ds_read_b64_tr_b16 a[242:243], v13 offset:4096
    v_mfma_f32_16x16x32_bf16 a[84:87], a[220:223], v[156:159], a[84:87]
    v_exp_f32 v237, v237
    v_mfma_f32_16x16x32_bf16 a[80:83], a[220:223], v[140:143], a[80:83]
    ds_read_b64_tr_b16 a[244:245], v13 offset:8192
    v_cvt_pk_bf16_f32 v236, v236, v237
    v_mfma_f32_16x16x32_bf16 a[80:83], a[216:219], v[136:139], a[80:83]
    v_exp_f32 v238, v238
    v_mfma_f32_16x16x32_bf16 a[80:83], a[212:215], v[132:135], a[80:83]
    ds_read_b64_tr_b16 a[246:247], v13 offset:12288
    s_waitcnt lgkmcnt(4)
    v_mfma_f32_16x16x32_bf16 a[80:83], a[208:211], v[128:131], a[80:83]
    v_exp_f32 v239, v239
    v_mfma_f32_16x16x32_bf16 a[96:99], a[224:227], v[128:131], a[96:99]
    ds_read_b64_tr_b16 a[248:249], v13 offset:16384
    v_cvt_pk_bf16_f32 v237, v238, v239
    v_mfma_f32_16x16x32_bf16 a[96:99], a[228:231], v[132:135], a[96:99]
    v_exp_f32 v252, v252
    v_mfma_f32_16x16x32_bf16 a[96:99], a[232:235], v[136:139], a[96:99]
    ds_read_b64_tr_b16 a[250:251], v13 offset:20480
    v_mfma_f32_16x16x32_bf16 a[96:99], a[236:239], v[140:143], a[96:99]
    v_exp_f32 v253, v253
    v_mfma_f32_16x16x32_bf16 a[100:103], a[236:239], v[156:159], a[100:103]
    ds_read_b64_tr_b16 a[252:253], v13 offset:24576
    v_cvt_pk_bf16_f32 v252, v252, v253
    v_mfma_f32_16x16x32_bf16 a[100:103], a[232:235], v[152:155], a[100:103]
    v_exp_f32 v254, v254
    v_mfma_f32_16x16x32_bf16 a[100:103], a[228:231], v[148:151], a[100:103]
    ds_read_b64_tr_b16 a[254:255], v13 offset:28672
    v_mfma_f32_16x16x32_bf16 a[100:103], a[224:227], v[144:147], a[100:103]
    v_exp_f32 v255, v255
    v_mfma_f32_16x16x32_bf16 a[104:107], a[224:227], v[160:163], a[104:107]
    s_add_u32 s40, s40, 32768
    v_cvt_pk_bf16_f32 v253, v254, v255
    v_mfma_f32_16x16x32_bf16 a[104:107], a[228:231], v[164:167], a[104:107]
    v_exp_f32 v112, v112
    v_mfma_f32_16x16x32_bf16 a[104:107], a[232:235], v[168:171], a[104:107]
    s_add_u32 s77, s77, 32768
    v_mfma_f32_16x16x32_bf16 a[104:107], a[236:239], v[172:175], a[104:107]
    v_exp_f32 v113, v113
    v_mfma_f32_16x16x32_bf16 a[108:111], a[236:239], v[188:191], a[108:111]
    s_waitcnt lgkmcnt(0)
    v_cvt_pk_bf16_f32 v206, v112, v113
    v_mfma_f32_16x16x32_bf16 a[108:111], a[232:235], v[184:187], a[108:111]
    v_exp_f32 v114, v114
    v_mfma_f32_16x16x32_bf16 a[108:111], a[228:231], v[180:183], a[108:111]
    s_waitcnt vmcnt(0)
    s_barrier
    v_mfma_f32_16x16x32_bf16 a[108:111], a[224:227], v[176:179], a[108:111]
    v_exp_f32 v115, v115
    v_mfma_f32_16x16x32_bf16 a[124:127], a[240:243], v[176:179], a[124:127]
    ds_read_b128 a[192:195], v2 offset:0
    v_cvt_pk_bf16_f32 v207, v114, v115
    v_mfma_f32_16x16x32_bf16 a[124:127], a[244:247], v[180:183], a[124:127]
    v_exp_f32 v116, v116
    v_mfma_f32_16x16x32_bf16 a[124:127], a[248:251], v[184:187], a[124:127]
    ds_read_b128 a[196:199], v3 offset:0
    v_mfma_f32_16x16x32_bf16 a[124:127], a[252:255], v[188:191], a[124:127]
    v_exp_f32 v117, v117
    v_mfma_f32_16x16x32_bf16 a[120:123], a[252:255], v[172:175], a[120:123]
    ds_read_b128 a[200:203], v4 offset:0
    v_cvt_pk_bf16_f32 v222, v116, v117
    v_mfma_f32_16x16x32_bf16 a[120:123], a[248:251], v[168:171], a[120:123]
    v_exp_f32 v118, v118
    v_mfma_f32_16x16x32_bf16 a[120:123], a[244:247], v[164:167], a[120:123]
    ds_read_b128 a[204:207], v5 offset:0
    v_mfma_f32_16x16x32_bf16 a[120:123], a[240:243], v[160:163], a[120:123]
    v_exp_f32 v119, v119
    v_mfma_f32_16x16x32_bf16 a[116:119], a[240:243], v[144:147], a[116:119]
    v_cvt_pk_bf16_f32 v223, v118, v119
    v_mfma_f32_16x16x32_bf16 a[116:119], a[244:247], v[148:151], a[116:119]
    v_exp_f32 v120, v120
    v_mfma_f32_16x16x32_bf16 a[116:119], a[248:251], v[152:155], a[116:119]
    s_sub_u32 s42, s42, 1
    s_cmp_lg_u32 s42, 0
    v_mfma_f32_16x16x32_bf16 a[116:119], a[252:255], v[156:159], a[116:119]
    v_exp_f32 v121, v121
    v_mfma_f32_16x16x32_bf16 a[112:115], a[252:255], v[140:143], a[112:115]
    v_cvt_pk_bf16_f32 v238, v120, v121
    v_mfma_f32_16x16x32_bf16 a[112:115], a[248:251], v[136:139], a[112:115]
    v_exp_f32 v122, v122
    v_mfma_f32_16x16x32_bf16 a[112:115], a[244:247], v[132:135], a[112:115]
    s_waitcnt lgkmcnt(0)
    v_mfma_f32_16x16x32_bf16 a[112:115], a[240:243], v[128:131], a[112:115]
    v_exp_f32 v123, v123
    s_cbranch_scc1 L1_loop
    v_mfma_f32_16x16x32_bf16 v[128:131], a[192:195], a[128:131], v[32:35]
    ds_read_b128 a[208:211], v2 offset:4096
    v_cvt_pk_bf16_f32 v239, v122, v123
    v_mfma_f32_16x16x32_bf16 v[128:131], a[196:199], a[144:147], v[128:131]
    s_mov_b64 exec, 255
    v_lshlrev_b32 v22, 1, v1
    buffer_load_dword v22, v22, s[52:55], 0 offen offset:0 sc1
    s_mov_b64 exec, -1
    v_exp_f32 v124, v124
L1_pc4:
    s_cbranch_execz L1_pc8
    v_mfma_f32_16x16x32_bf16 v[128:131], a[200:203], a[160:163], v[128:131]
    ds_read_b128 a[212:215], v3 offset:4096
    v_mfma_f32_16x16x32_bf16 v[128:131], a[204:207], a[176:179], v[128:131]
    v_exp_f32 v125, v125
    v_mfma_f32_16x16x32_bf16 v[144:147], a[204:207], a[180:183], v[36:39]
    ds_read_b128 a[216:219], v4 offset:4096
    v_cvt_pk_bf16_f32 v254, v124, v125
    v_mfma_f32_16x16x32_bf16 v[144:147], a[200:203], a[164:167], v[144:147]
    v_exp_f32 v126, v126
    v_mfma_f32_16x16x32_bf16 v[144:147], a[196:199], a[148:151], v[144:147]
    ds_read_b128 a[220:223], v5 offset:4096
    s_add_u32 m0, s41, 32768
    v_mfma_f32_16x16x32_bf16 v[144:147], a[192:195], a[132:135], v[144:147]
    v_exp_f32 v127, v127
    v_mfma_f32_16x16x32_bf16 v[160:163], a[192:195], a[136:139], v[40:43]
    buffer_load_dwordx4 v14, s[8:11], s40 offen offset:0 lds
    v_mfma_f32_16x16x32_bf16 v[160:163], a[196:199], a[152:155], v[160:163]
    v_exp_f32 v128, v128
    v_mfma_f32_16x16x32_bf16 v[160:163], a[200:203], a[168:171], v[160:163]
    buffer_load_dwordx4 v15, s[8:11], s40 offen offset:1024 lds
    v_mfma_f32_16x16x32_bf16 v[160:163], a[204:207], a[184:187], v[160:163]
    v_exp_f32 v129, v129
    v_mfma_f32_16x16x32_bf16 v[176:179], a[204:207], a[188:191], v[44:47]
    buffer_load_dwordx4 v16, s[8:11], s40 offen offset:2048 lds
    v_mfma_f32_16x16x32_bf16 v[176:179], a[200:203], a[172:175], v[176:179]
    v_exp_f32 v130, v130
    v_mfma_f32_16x16x32_bf16 v[176:179], a[196:199], a[156:159], v[176:179]
    s_waitcnt lgkmcnt(0)
    v_cvt_pk_bf16_f32 v255, v126, v127
    v_mfma_f32_16x16x32_bf16 v[176:179], a[192:195], a[140:143], v[176:179]
    v_exp_f32 v131, v131
    v_mfma_f32_16x16x32_bf16 v[64:67], a[208:211], a[128:131], v[32:35]
    ds_read_b128 a[224:227], v2 offset:8192
    v_cvt_pk_bf16_f32 v128, v128, v129
    v_mfma_f32_16x16x32_bf16 v[64:67], a[212:215], a[144:147], v[64:67]
    v_exp_f32 v144, v144
    v_mfma_f32_16x16x32_bf16 v[64:67], a[216:219], a[160:163], v[64:67]
    ds_read_b128 a[228:231], v3 offset:8192
    v_cvt_pk_bf16_f32 v129, v130, v131
    v_mfma_f32_16x16x32_bf16 v[64:67], a[220:223], a[176:179], v[64:67]
    v_exp_f32 v145, v145
    v_mfma_f32_16x16x32_bf16 v[68:71], a[220:223], a[180:183], v[36:39]
    ds_read_b128 a[232:235], v4 offset:8192
    v_cvt_pk_bf16_f32 v144, v144, v145
    v_mfma_f32_16x16x32_bf16 v[68:71], a[216:219], a[164:167], v[68:71]
    v_exp_f32 v146, v146
    v_mfma_f32_16x16x32_bf16 v[68:71], a[212:215], a[148:151], v[68:71]
    ds_read_b128 a[236:239], v5 offset:8192
    v_mfma_f32_16x16x32_bf16 v[68:71], a[208:211], a[132:135], v[68:71]
    v_exp_f32 v147, v147
    v_smfmac_f32_16x16x64_bf16 v[48:51], v[24:27], v[192:199], v20
    v_mfma_f32_16x16x32_bf16 v[72:75], a[208:211], a[136:139], v[40:43]
    buffer_load_dwordx4 v17, s[8:11], s40 offen offset:3072 lds
    v_mfma_f32_16x16x32_bf16 v[72:75], a[212:215], a[152:155], v[72:75]
    v_exp_f32 v160, v160
    v_mfma_f32_16x16x32_bf16 v[72:75], a[216:219], a[168:171], v[72:75]
    s_add_u32 m0, s41, 49152
    v_cvt_pk_bf16_f32 v145, v146, v147
    v_mfma_f32_16x16x32_bf16 v[72:75], a[220:223], a[184:187], v[72:75]
    v_exp_f32 v161, v161
    v_mfma_f32_16x16x32_bf16 v[76:79], a[220:223], a[188:191], v[44:47]
    buffer_load_dwordx4 v14, s[8:11], s77 offen offset:0 lds
    v_mfma_f32_16x16x32_bf16 v[76:79], a[216:219], a[172:175], v[76:79]
    v_exp_f32 v162, v162
    v_mfma_f32_16x16x32_bf16 v[76:79], a[212:215], a[156:159], v[76:79]
    s_waitcnt lgkmcnt(0)
    v_cvt_pk_bf16_f32 v160, v160, v161
    v_mfma_f32_16x16x32_bf16 v[76:79], a[208:211], a[140:143], v[76:79]
    v_exp_f32 v163, v163
    v_mfma_f32_16x16x32_bf16 v[132:135], a[224:227], a[128:131], v[32:35]
    ds_read_b128 a[240:243], v2 offset:12288
    v_cvt_pk_bf16_f32 v161, v162, v163
    v_mfma_f32_16x16x32_bf16 v[132:135], a[228:231], a[144:147], v[132:135]
    v_exp_f32 v176, v176
    v_mfma_f32_16x16x32_bf16 v[132:135], a[232:235], a[160:163], v[132:135]
    ds_read_b128 a[244:247], v3 offset:12288
    v_mfma_f32_16x16x32_bf16 v[132:135], a[236:239], a[176:179], v[132:135]
    v_exp_f32 v177, v177
    v_mfma_f32_16x16x32_bf16 v[148:151], a[236:239], a[180:183], v[36:39]
    ds_read_b128 a[248:251], v4 offset:12288
    v_cvt_pk_bf16_f32 v176, v176, v177
    v_mfma_f32_16x16x32_bf16 v[148:151], a[232:235], a[164:167], v[148:151]
    v_exp_f32 v178, v178
    v_mfma_f32_16x16x32_bf16 v[148:151], a[228:231], a[148:151], v[148:151]
    ds_read_b128 a[252:255], v5 offset:12288
    v_mfma_f32_16x16x32_bf16 v[148:151], a[224:227], a[132:135], v[148:151]
    v_exp_f32 v179, v179
    v_smfmac_f32_16x16x64_bf16 v[52:55], v[24:27], v[208:215], v20
    v_mfma_f32_16x16x32_bf16 v[164:167], a[224:227], a[136:139], v[40:43]
    buffer_load_dwordx4 v15, s[8:11], s77 offen offset:1024 lds
    v_mfma_f32_16x16x32_bf16 v[164:167], a[228:231], a[152:155], v[164:167]
    v_exp_f32 v64, v64
    v_mfma_f32_16x16x32_bf16 v[164:167], a[232:235], a[168:171], v[164:167]
    buffer_load_dwordx4 v16, s[8:11], s77 offen offset:2048 lds
    v_mfma_f32_16x16x32_bf16 v[164:167], a[236:239], a[184:187], v[164:167]
    v_exp_f32 v65, v65
    v_mfma_f32_16x16x32_bf16 v[180:183], a[236:239], a[188:191], v[44:47]
    buffer_load_dwordx4 v17, s[8:11], s77 offen offset:3072 lds
    v_mfma_f32_16x16x32_bf16 v[180:183], a[232:235], a[172:175], v[180:183]
    v_exp_f32 v66, v66
    v_mfma_f32_16x16x32_bf16 v[180:183], a[228:231], a[156:159], v[180:183]
    s_waitcnt lgkmcnt(0)
    v_cvt_pk_bf16_f32 v177, v178, v179
    v_mfma_f32_16x16x32_bf16 v[180:183], a[224:227], a[140:143], v[180:183]
    v_exp_f32 v67, v67
    v_mfma_f32_16x16x32_bf16 v[80:83], a[240:243], a[128:131], v[32:35]
    ds_read_b128 a[192:195], v2 offset:16384
    v_cvt_pk_bf16_f32 v130, v64, v65
    v_mfma_f32_16x16x32_bf16 v[80:83], a[244:247], a[144:147], v[80:83]
    v_exp_f32 v68, v68
    v_mfma_f32_16x16x32_bf16 v[80:83], a[248:251], a[160:163], v[80:83]
    ds_read_b128 a[196:199], v3 offset:16384
    v_cvt_pk_bf16_f32 v131, v66, v67
    v_mfma_f32_16x16x32_bf16 v[80:83], a[252:255], a[176:179], v[80:83]
    v_exp_f32 v69, v69
    v_mov_b32 v14, v21
    v_mfma_f32_16x16x32_bf16 v[84:87], a[252:255], a[180:183], v[36:39]
    ds_read_b128 a[200:203], v4 offset:16384
    v_cvt_pk_bf16_f32 v146, v68, v69
    v_mfma_f32_16x16x32_bf16 v[84:87], a[248:251], a[164:167], v[84:87]
    v_exp_f32 v70, v70
    v_xor_b32 v15, 0x80, v21
    v_mfma_f32_16x16x32_bf16 v[84:87], a[244:247], a[148:151], v[84:87]
    ds_read_b128 a[204:207], v5 offset:16384
    s_add_u32 m0, s41, 65536
    v_mfma_f32_16x16x32_bf16 v[84:87], a[240:243], a[132:135], v[84:87]
    v_exp_f32 v71, v71
    v_add_u32 v16, 6144, v21
    v_smfmac_f32_16x16x64_bf16 v[56:59], v[24:27], v[224:231], v20
    v_mfma_f32_16x16x32_bf16 v[88:91], a[240:243], a[136:139], v[40:43]
    buffer_load_dwordx4 v18, s[12:15], s40 offen offset:0 lds
    v_mfma_f32_16x16x32_bf16 v[88:91], a[244:247], a[152:155], v[88:91]
    v_exp_f32 v72, v72
    v_add_u32 v15, 3072, v15
    v_mfma_f32_16x16x32_bf16 v[88:91], a[248:251], a[168:171], v[88:91]
    buffer_load_dwordx4 v19, s[12:15], s40 offen offset:1024 lds
    v_mfma_f32_16x16x32_bf16 v[88:91], a[252:255], a[184:187], v[88:91]
    v_exp_f32 v73, v73
    v_add_u32 v17, 6144, v15
    v_mfma_f32_16x16x32_bf16 v[92:95], a[252:255], a[188:191], v[44:47]
    buffer_load_dwordx4 v18, s[12:15], s40 offen offset:2048 lds
    v_mfma_f32_16x16x32_bf16 v[92:95], a[248:251], a[172:175], v[92:95]
    v_exp_f32 v74, v74
    v_mfma_f32_16x16x32_bf16 v[92:95], a[244:247], a[156:159], v[92:95]
    s_waitcnt lgkmcnt(0)
    v_cvt_pk_bf16_f32 v147, v70, v71
    v_mfma_f32_16x16x32_bf16 v[92:95], a[240:243], a[140:143], v[92:95]
    v_exp_f32 v75, v75
    v_mfma_f32_16x16x32_bf16 v[136:139], a[192:195], a[128:131], v[32:35]
    ds_read_b128 a[208:211], v2 offset:20480
    v_cvt_pk_bf16_f32 v162, v72, v73
    v_mfma_f32_16x16x32_bf16 v[136:139], a[196:199], a[144:147], v[136:139]
    v_exp_f32 v76, v76
    v_mfma_f32_16x16x32_bf16 v[136:139], a[200:203], a[160:163], v[136:139]
    ds_read_b128 a[212:215], v3 offset:20480
    v_cvt_pk_bf16_f32 v163, v74, v75
    v_mfma_f32_16x16x32_bf16 v[136:139], a[204:207], a[176:179], v[136:139]
    v_exp_f32 v77, v77
    v_mfma_f32_16x16x32_bf16 v[152:155], a[204:207], a[180:183], v[36:39]
    ds_read_b128 a[216:219], v4 offset:20480
    v_cvt_pk_bf16_f32 v178, v76, v77
    v_mfma_f32_16x16x32_bf16 v[152:155], a[200:203], a[164:167], v[152:155]
    v_exp_f32 v78, v78
    v_mfma_f32_16x16x32_bf16 v[152:155], a[196:199], a[148:151], v[152:155]
    ds_read_b128 a[220:223], v5 offset:20480
    v_mfma_f32_16x16x32_bf16 v[152:155], a[192:195], a[132:135], v[152:155]
    v_exp_f32 v79, v79
    v_smfmac_f32_16x16x64_bf16 v[60:63], v[24:27], v[240:247], v20
    v_mfma_f32_16x16x32_bf16 v[168:171], a[192:195], a[136:139], v[40:43]
    buffer_load_dwordx4 v19, s[12:15], s40 offen offset:3072 lds
    v_mfma_f32_16x16x32_bf16 v[168:171], a[196:199], a[152:155], v[168:171]
    v_exp_f32 v132, v132
    v_mfma_f32_16x16x32_bf16 v[168:171], a[200:203], a[168:171], v[168:171]
    s_add_u32 m0, s41, 81920
    v_cvt_pk_bf16_f32 v179, v78, v79
    v_mfma_f32_16x16x32_bf16 v[168:171], a[204:207], a[184:187], v[168:171]
    v_exp_f32 v133, v133
    v_mfma_f32_16x16x32_bf16 v[184:187], a[204:207], a[188:191], v[44:47]
    buffer_load_dwordx4 v18, s[12:15], s77 offen offset:0 lds
    v_mfma_f32_16x16x32_bf16 v[184:187], a[200:203], a[172:175], v[184:187]
    v_exp_f32 v134, v134
    v_mfma_f32_16x16x32_bf16 v[184:187], a[196:199], a[156:159], v[184:187]
    s_waitcnt lgkmcnt(0)
    v_cvt_pk_bf16_f32 v132, v132, v133
    v_mfma_f32_16x16x32_bf16 v[184:187], a[192:195], a[140:143], v[184:187]
    v_exp_f32 v135, v135
    v_mfma_f32_16x16x32_bf16 v[96:99], a[208:211], a[128:131], v[32:35]
    ds_read_b128 a[224:227], v2 offset:24576
    v_cvt_pk_bf16_f32 v133, v134, v135
    v_mfma_f32_16x16x32_bf16 v[96:99], a[212:215], a[144:147], v[96:99]
    v_exp_f32 v148, v148
    v_mfma_f32_16x16x32_bf16 v[96:99], a[216:219], a[160:163], v[96:99]
    ds_read_b128 a[228:231], v3 offset:24576
    v_mfma_f32_16x16x32_bf16 v[96:99], a[220:223], a[176:179], v[96:99]
    v_exp_f32 v149, v149
    v_mfma_f32_16x16x32_bf16 v[100:103], a[220:223], a[180:183], v[36:39]
    ds_read_b128 a[232:235], v4 offset:24576
    v_cvt_pk_bf16_f32 v148, v148, v149
    v_mfma_f32_16x16x32_bf16 v[100:103], a[216:219], a[164:167], v[100:103]
    v_exp_f32 v150, v150
    v_mfma_f32_16x16x32_bf16 v[100:103], a[212:215], a[148:151], v[100:103]
    ds_read_b128 a[236:239], v5 offset:24576
    v_mfma_f32_16x16x32_bf16 v[100:103], a[208:211], a[132:135], v[100:103]
    v_exp_f32 v151, v151
    v_smfmac_f32_16x16x64_bf16 v[48:51], v[24:27], v[200:207], v20
    v_mfma_f32_16x16x32_bf16 v[104:107], a[208:211], a[136:139], v[40:43]
    buffer_load_dwordx4 v19, s[12:15], s77 offen offset:1024 lds
    v_mfma_f32_16x16x32_bf16 v[104:107], a[212:215], a[152:155], v[104:107]
    v_exp_f32 v164, v164
    v_mfma_f32_16x16x32_bf16 v[104:107], a[216:219], a[168:171], v[104:107]
    buffer_load_dwordx4 v18, s[12:15], s77 offen offset:2048 lds
    v_mfma_f32_16x16x32_bf16 v[104:107], a[220:223], a[184:187], v[104:107]
    v_exp_f32 v165, v165
    v_mfma_f32_16x16x32_bf16 v[108:111], a[220:223], a[188:191], v[44:47]
    buffer_load_dwordx4 v19, s[12:15], s77 offen offset:3072 lds
    v_mfma_f32_16x16x32_bf16 v[108:111], a[216:219], a[172:175], v[108:111]
    v_exp_f32 v166, v166
    v_mfma_f32_16x16x32_bf16 v[108:111], a[212:215], a[156:159], v[108:111]
    s_waitcnt lgkmcnt(0)
    v_cvt_pk_bf16_f32 v149, v150, v151
    v_mfma_f32_16x16x32_bf16 v[108:111], a[208:211], a[140:143], v[108:111]
    v_exp_f32 v167, v167
    v_mfma_f32_16x16x32_bf16 v[140:143], a[224:227], a[128:131], v[32:35]
    ds_read_b128 a[240:243], v2 offset:28672
    v_cvt_pk_bf16_f32 v164, v164, v165
    v_mfma_f32_16x16x32_bf16 v[140:143], a[228:231], a[144:147], v[140:143]
    v_exp_f32 v180, v180
    v_mfma_f32_16x16x32_bf16 v[140:143], a[232:235], a[160:163], v[140:143]
    ds_read_b128 a[244:247], v3 offset:28672
    v_cvt_pk_bf16_f32 v165, v166, v167
    v_mfma_f32_16x16x32_bf16 v[140:143], a[236:239], a[176:179], v[140:143]
    v_exp_f32 v181, v181
    v_mfma_f32_16x16x32_bf16 v[156:159], a[236:239], a[180:183], v[36:39]
    ds_read_b128 a[248:251], v4 offset:28672
    v_cvt_pk_bf16_f32 v180, v180, v181
    v_mfma_f32_16x16x32_bf16 v[156:159], a[232:235], a[164:167], v[156:159]
    v_exp_f32 v182, v182
    v_mfma_f32_16x16x32_bf16 v[156:159], a[228:231], a[148:151], v[156:159]
    ds_read_b128 a[252:255], v5 offset:28672
    v_mfma_f32_16x16x32_bf16 v[156:159], a[224:227], a[132:135], v[156:159]
    v_exp_f32 v183, v183
    v_smfmac_f32_16x16x64_bf16 v[52:55], v[24:27], v[216:223], v20
    v_mfma_f32_16x16x32_bf16 v[172:175], a[224:227], a[136:139], v[40:43]
    ds_read_b64_tr_b16 a[192:193], v6 offset:32768
    v_cvt_pk_bf16_f32 v181, v182, v183
    v_mfma_f32_16x16x32_bf16 v[172:175], a[228:231], a[152:155], v[172:175]
    v_exp_f32 v80, v80
    v_mfma_f32_16x16x32_bf16 v[172:175], a[232:235], a[168:171], v[172:175]
    ds_read_b64_tr_b16 a[194:195], v6 offset:36864
    v_mfma_f32_16x16x32_bf16 v[172:175], a[236:239], a[184:187], v[172:175]
    v_exp_f32 v81, v81
    v_mfma_f32_16x16x32_bf16 v[188:191], a[236:239], a[188:191], v[44:47]
    ds_read_b64_tr_b16 a[196:197], v6 offset:40960
    v_cvt_pk_bf16_f32 v134, v80, v81
    v_mfma_f32_16x16x32_bf16 v[188:191], a[232:235], a[172:175], v[188:191]
    v_exp_f32 v82, v82
    v_mfma_f32_16x16x32_bf16 v[188:191], a[228:231], a[156:159], v[188:191]
    ds_read_b64_tr_b16 a[198:199], v6 offset:45056
    s_waitcnt lgkmcnt(4)
    s_add_u32 m0, s41, 131072
    s_add_u32 s80, s75, 0
    v_mfma_f32_16x16x32_bf16 v[188:191], a[224:227], a[140:143], v[188:191]
    buffer_load_dwordx4 v14, s[28:31], s80 offen offset:0 lds
    v_exp_f32 v83, v83
    v_mfma_f32_16x16x32_bf16 v[112:115], a[240:243], a[128:131], v[32:35]
    ds_read_b64_tr_b16 a[200:201], v6 offset:49152
    v_cvt_pk_bf16_f32 v135, v82, v83
    v_mfma_f32_16x16x32_bf16 v[112:115], a[244:247], a[144:147], v[112:115]
    v_exp_f32 v84, v84
    v_mfma_f32_16x16x32_bf16 v[112:115], a[248:251], a[160:163], v[112:115]
    ds_read_b64_tr_b16 a[202:203], v6 offset:53248
    v_mfma_f32_16x16x32_bf16 v[112:115], a[252:255], a[176:179], v[112:115]
    v_exp_f32 v85, v85
    v_mfma_f32_16x16x32_bf16 v[116:119], a[252:255], a[180:183], v[36:39]
    ds_read_b64_tr_b16 a[204:205], v6 offset:57344
    v_cvt_pk_bf16_f32 v150, v84, v85
    v_mfma_f32_16x16x32_bf16 v[116:119], a[248:251], a[164:167], v[116:119]
    v_exp_f32 v86, v86
    v_mfma_f32_16x16x32_bf16 v[116:119], a[244:247], a[148:151], v[116:119]
    ds_read_b64_tr_b16 a[206:207], v6 offset:61440
    v_mfma_f32_16x16x32_bf16 v[116:119], a[240:243], a[132:135], v[116:119]
    v_exp_f32 v87, v87
    v_smfmac_f32_16x16x64_bf16 v[56:59], v[24:27], v[232:239], v20
    v_mfma_f32_16x16x32_bf16 v[120:123], a[240:243], a[136:139], v[40:43]
    ds_read_b64_tr_b16 a[208:209], v7 offset:32768
    v_cvt_pk_bf16_f32 v151, v86, v87
    v_mfma_f32_16x16x32_bf16 v[120:123], a[244:247], a[152:155], v[120:123]
    buffer_load_dwordx4 v15, s[28:31], s80 offen offset:1024 lds
    v_exp_f32 v88, v88
    v_mfma_f32_16x16x32_bf16 v[120:123], a[248:251], a[168:171], v[120:123]
    ds_read_b64_tr_b16 a[210:211], v7 offset:36864
    v_mfma_f32_16x16x32_bf16 v[120:123], a[252:255], a[184:187], v[120:123]
    v_exp_f32 v89, v89
    v_mfma_f32_16x16x32_bf16 v[124:127], a[252:255], a[188:191], v[44:47]
    ds_read_b64_tr_b16 a[212:213], v7 offset:40960
    v_cvt_pk_bf16_f32 v166, v88, v89
    v_mfma_f32_16x16x32_bf16 v[124:127], a[248:251], a[172:175], v[124:127]
    v_exp_f32 v90, v90
    v_mfma_f32_16x16x32_bf16 v[124:127], a[244:247], a[156:159], v[124:127]
    ds_read_b64_tr_b16 a[214:215], v7 offset:45056
    s_waitcnt lgkmcnt(4)
    v_mfma_f32_16x16x32_bf16 v[124:127], a[240:243], a[140:143], v[124:127]
    v_exp_f32 v91, v91
    v_mfma_f32_16x16x32_bf16 a[0:3], a[192:195], v[192:195], a[0:3]
    ds_read_b64_tr_b16 a[216:217], v7 offset:49152
    v_cvt_pk_bf16_f32 v167, v90, v91
    v_mfma_f32_16x16x32_bf16 a[0:3], a[196:199], v[196:199], a[0:3]
    v_exp_f32 v92, v92
    v_mfma_f32_16x16x32_bf16 a[0:3], a[200:203], v[200:203], a[0:3]
    ds_read_b64_tr_b16 a[218:219], v7 offset:53248
    v_mfma_f32_16x16x32_bf16 a[0:3], a[204:207], v[204:207], a[0:3]
    buffer_load_dwordx4 v16, s[28:31], s80 offen offset:2048 lds
    v_exp_f32 v93, v93
    v_mfma_f32_16x16x32_bf16 a[4:7], a[204:207], v[220:223], a[4:7]
    ds_read_b64_tr_b16 a[220:221], v7 offset:57344
    v_cvt_pk_bf16_f32 v182, v92, v93
    v_mfma_f32_16x16x32_bf16 a[4:7], a[200:203], v[216:219], a[4:7]
    v_exp_f32 v94, v94
    v_mfma_f32_16x16x32_bf16 a[4:7], a[196:199], v[212:215], a[4:7]
    ds_read_b64_tr_b16 a[222:223], v7 offset:61440
    v_mfma_f32_16x16x32_bf16 a[4:7], a[192:195], v[208:211], a[4:7]
    v_exp_f32 v95, v95
    v_smfmac_f32_16x16x64_bf16 v[60:63], v[24:27], v[248:255], v20
    v_mfma_f32_16x16x32_bf16 a[8:11], a[192:195], v[224:227], a[8:11]
    ds_read_b64_tr_b16 a[224:225], v8 offset:32768
    v_cvt_pk_bf16_f32 v183, v94, v95
    v_mfma_f32_16x16x32_bf16 a[8:11], a[196:199], v[228:231], a[8:11]
    v_exp_f32 v136, v136
    v_mfma_f32_16x16x32_bf16 a[8:11], a[200:203], v[232:235], a[8:11]
    ds_read_b64_tr_b16 a[226:227], v8 offset:36864
    v_mfma_f32_16x16x32_bf16 a[8:11], a[204:207], v[236:239], a[8:11]
    v_exp_f32 v137, v137
    v_mfma_f32_16x16x32_bf16 a[12:15], a[204:207], v[252:255], a[12:15]
    ds_read_b64_tr_b16 a[228:229], v8 offset:40960
    v_cvt_pk_bf16_f32 v136, v136, v137
    v_mfma_f32_16x16x32_bf16 a[12:15], a[200:203], v[248:251], a[12:15]
    buffer_load_dwordx4 v17, s[28:31], s80 offen offset:3072 lds
    v_exp_f32 v138, v138
    v_mfma_f32_16x16x32_bf16 a[12:15], a[196:199], v[244:247], a[12:15]
    ds_read_b64_tr_b16 a[230:231], v8 offset:45056
    s_waitcnt lgkmcnt(4)
    v_mfma_f32_16x16x32_bf16 a[12:15], a[192:195], v[240:243], a[12:15]
    v_exp_f32 v139, v139
    v_mfma_f32_16x16x32_bf16 a[28:31], a[208:211], v[240:243], a[28:31]
    ds_read_b64_tr_b16 a[232:233], v8 offset:49152
    v_cvt_pk_bf16_f32 v137, v138, v139
    v_mfma_f32_16x16x32_bf16 a[28:31], a[212:215], v[244:247], a[28:31]
    v_exp_f32 v152, v152
    v_mfma_f32_16x16x32_bf16 a[28:31], a[216:219], v[248:251], a[28:31]
    ds_read_b64_tr_b16 a[234:235], v8 offset:53248
    v_mfma_f32_16x16x32_bf16 a[28:31], a[220:223], v[252:255], a[28:31]
    v_exp_f32 v153, v153
    v_mfma_f32_16x16x32_bf16 a[24:27], a[220:223], v[236:239], a[24:27]
    ds_read_b64_tr_b16 a[236:237], v8 offset:57344
    v_cvt_pk_bf16_f32 v152, v152, v153
    v_mfma_f32_16x16x32_bf16 a[24:27], a[216:219], v[232:235], a[24:27]
    v_exp_f32 v154, v154
    v_mfma_f32_16x16x32_bf16 a[24:27], a[212:215], v[228:231], a[24:27]
    ds_read_b64_tr_b16 a[238:239], v8 offset:61440
    v_mfma_f32_16x16x32_bf16 a[24:27], a[208:211], v[224:227], a[24:27]
    v_exp_f32 v155, v155
    v_mfma_f32_16x16x32_bf16 a[20:23], a[208:211], v[208:211], a[20:23]
    ds_read_b64_tr_b16 a[240:241], v9 offset:32768
    v_cvt_pk_bf16_f32 v153, v154, v155
    s_add_u32 m0, s41, 147456
    s_add_u32 s80, s75, 65536
    v_mfma_f32_16x16x32_bf16 a[20:23], a[212:215], v[212:215], a[20:23]
    buffer_load_dwordx4 v14, s[28:31], s80 offen offset:0 lds
    v_exp_f32 v168, v168
    v_mfma_f32_16x16x32_bf16 a[20:23], a[216:219], v[216:219], a[20:23]
    ds_read_b64_tr_b16 a[242:243], v9 offset:36864
    v_mfma_f32_16x16x32_bf16 a[20:23], a[220:223], v[220:223], a[20:23]
    v_exp_f32 v169, v169
    v_mfma_f32_16x16x32_bf16 a[16:19], a[220:223], v[204:207], a[16:19]
    ds_read_b64_tr_b16 a[244:245], v9 offset:40960
    v_cvt_pk_bf16_f32 v168, v168, v169
    v_mfma_f32_16x16x32_bf16 a[16:19], a[216:219], v[200:203], a[16:19]
    v_exp_f32 v170, v170
    v_mfma_f32_16x16x32_bf16 a[16:19], a[212:215], v[196:199], a[16:19]
    ds_read_b64_tr_b16 a[246:247], v9 offset:45056
    s_waitcnt lgkmcnt(4)
    v_mfma_f32_16x16x32_bf16 a[16:19], a[208:211], v[192:195], a[16:19]
    v_exp_f32 v171, v171
    v_mfma_f32_16x16x32_bf16 a[32:35], a[224:227], v[192:195], a[32:35]
    ds_read_b64_tr_b16 a[248:249], v9 offset:49152
    v_cvt_pk_bf16_f32 v169, v170, v171
    v_mfma_f32_16x16x32_bf16 a[32:35], a[228:231], v[196:199], a[32:35]
    v_exp_f32 v184, v184
    v_mfma_f32_16x16x32_bf16 a[32:35], a[232:235], v[200:203], a[32:35]
    ds_read_b64_tr_b16 a[250:251], v9 offset:53248
    v_mfma_f32_16x16x32_bf16 a[32:35], a[236:239], v[204:207], a[32:35]
    buffer_load_dwordx4 v15, s[28:31], s80 offen offset:1024 lds
    v_exp_f32 v185, v185
    v_mfma_f32_16x16x32_bf16 a[36:39], a[236:239], v[220:223], a[36:39]
    ds_read_b64_tr_b16 a[252:253], v9 offset:57344
    v_cvt_pk_bf16_f32 v184, v184, v185
    v_mfma_f32_16x16x32_bf16 a[36:39], a[232:235], v[216:219], a[36:39]
    v_exp_f32 v186, v186
    v_mfma_f32_16x16x32_bf16 a[36:39], a[228:231], v[212:215], a[36:39]
    ds_read_b64_tr_b16 a[254:255], v9 offset:61440
    v_mfma_f32_16x16x32_bf16 a[36:39], a[224:227], v[208:211], a[36:39]
    v_exp_f32 v187, v187
    v_mfma_f32_16x16x32_bf16 a[40:43], a[224:227], v[224:227], a[40:43]
    ds_read_b64_tr_b16 a[192:193], v10 offset:32768
    v_cvt_pk_bf16_f32 v185, v186, v187
    v_mfma_f32_16x16x32_bf16 a[40:43], a[228:231], v[228:231], a[40:43]
    v_exp_f32 v96, v96
    v_mfma_f32_16x16x32_bf16 a[40:43], a[232:235], v[232:235], a[40:43]
    ds_read_b64_tr_b16 a[194:195], v10 offset:36864
    v_mfma_f32_16x16x32_bf16 a[40:43], a[236:239], v[236:239], a[40:43]
    v_exp_f32 v97, v97
    v_mfma_f32_16x16x32_bf16 a[44:47], a[236:239], v[252:255], a[44:47]
    ds_read_b64_tr_b16 a[196:197], v10 offset:40960
    v_cvt_pk_bf16_f32 v138, v96, v97
    v_mfma_f32_16x16x32_bf16 a[44:47], a[232:235], v[248:251], a[44:47]
    buffer_load_dwordx4 v16, s[28:31], s80 offen offset:2048 lds
    v_exp_f32 v98, v98
    v_mfma_f32_16x16x32_bf16 a[44:47], a[228:231], v[244:247], a[44:47]
    ds_read_b64_tr_b16 a[198:199], v10 offset:45056
    s_waitcnt lgkmcnt(4)
    v_mfma_f32_16x16x32_bf16 a[44:47], a[224:227], v[240:243], a[44:47]
    v_exp_f32 v99, v99
    v_mfma_f32_16x16x32_bf16 a[60:63], a[240:243], v[240:243], a[60:63]
    ds_read_b64_tr_b16 a[200:201], v10 offset:49152
    v_cvt_pk_bf16_f32 v139, v98, v99
    v_mfma_f32_16x16x32_bf16 a[60:63], a[244:247], v[244:247], a[60:63]
    v_exp_f32 v100, v100
    s_lshr_b32 s5, s2, 3
    v_mfma_f32_16x16x32_bf16 a[60:63], a[248:251], v[248:251], a[60:63]
    ds_read_b64_tr_b16 a[202:203], v10 offset:53248
    v_mfma_f32_16x16x32_bf16 a[60:63], a[252:255], v[252:255], a[60:63]
    v_exp_f32 v101, v101
    s_lshl_b32 s5, s5, 2
    v_mfma_f32_16x16x32_bf16 a[56:59], a[252:255], v[236:239], a[56:59]
    ds_read_b64_tr_b16 a[204:205], v10 offset:57344
    v_cvt_pk_bf16_f32 v154, v100, v101
    v_mfma_f32_16x16x32_bf16 a[56:59], a[248:251], v[232:235], a[56:59]
    v_exp_f32 v102, v102
    s_add_u32 s5, s5, s45
    v_mfma_f32_16x16x32_bf16 a[56:59], a[244:247], v[228:231], a[56:59]
    ds_read_b64_tr_b16 a[206:207], v10 offset:61440
    v_mfma_f32_16x16x32_bf16 a[56:59], a[240:243], v[224:227], a[56:59]
    v_exp_f32 v103, v103
    s_lshl_b32 s5, s5, 13
    v_mfma_f32_16x16x32_bf16 a[52:55], a[240:243], v[208:211], a[52:55]
    ds_read_b64_tr_b16 a[208:209], v11 offset:32768
    v_cvt_pk_bf16_f32 v155, v102, v103
    v_mfma_f32_16x16x32_bf16 a[52:55], a[244:247], v[212:215], a[52:55]
    buffer_load_dwordx4 v17, s[28:31], s80 offen offset:3072 lds
    v_exp_f32 v104, v104
    s_lshl_b32 s6, s82, 20
    v_mfma_f32_16x16x32_bf16 a[52:55], a[248:251], v[216:219], a[52:55]
    ds_read_b64_tr_b16 a[210:211], v11 offset:36864
    v_mfma_f32_16x16x32_bf16 a[52:55], a[252:255], v[220:223], a[52:55]
    v_exp_f32 v105, v105
    s_add_u32 s7, s5, s6
    v_mfma_f32_16x16x32_bf16 a[48:51], a[252:255], v[204:207], a[48:51]
    ds_read_b64_tr_b16 a[212:213], v11 offset:40960
    v_cvt_pk_bf16_f32 v170, v104, v105
    v_mfma_f32_16x16x32_bf16 a[48:51], a[248:251], v[200:203], a[48:51]
    v_exp_f32 v106, v106
    v_lshlrev_b32 v0, 3, v1
    v_mfma_f32_16x16x32_bf16 a[48:51], a[244:247], v[196:199], a[48:51]
    ds_read_b64_tr_b16 a[214:215], v11 offset:45056
    s_waitcnt lgkmcnt(4)
    v_mfma_f32_16x16x32_bf16 a[48:51], a[240:243], v[192:195], a[48:51]
    v_exp_f32 v107, v107
    v_mfma_f32_16x16x32_bf16 a[64:67], a[192:195], v[192:195], a[64:67]
    ds_read_b64_tr_b16 a[216:217], v11 offset:49152
    v_cvt_pk_bf16_f32 v171, v106, v107
    v_mfma_f32_16x16x32_bf16 a[64:67], a[196:199], v[196:199], a[64:67]
    buffer_load_dword v21, v0, s[24:27], s7 offen
    v_exp_f32 v108, v108
    v_mfma_f32_16x16x32_bf16 a[64:67], a[200:203], v[200:203], a[64:67]
    ds_read_b64_tr_b16 a[218:219], v11 offset:53248
    v_mfma_f32_16x16x32_bf16 a[64:67], a[204:207], v[204:207], a[64:67]
    v_exp_f32 v109, v109
    v_mfma_f32_16x16x32_bf16 a[68:71], a[204:207], v[220:223], a[68:71]
    ds_read_b64_tr_b16 a[220:221], v11 offset:57344
    v_cvt_pk_bf16_f32 v186, v108, v109
    v_mfma_f32_16x16x32_bf16 a[68:71], a[200:203], v[216:219], a[68:71]
    v_exp_f32 v110, v110
    v_mfma_f32_16x16x32_bf16 a[68:71], a[196:199], v[212:215], a[68:71]
    ds_read_b64_tr_b16 a[222:223], v11 offset:61440
    v_mfma_f32_16x16x32_bf16 a[68:71], a[192:195], v[208:211], a[68:71]
    v_exp_f32 v111, v111
    v_mfma_f32_16x16x32_bf16 a[72:75], a[192:195], v[224:227], a[72:75]
    ds_read_b64_tr_b16 a[224:225], v12 offset:32768
    v_cvt_pk_bf16_f32 v187, v110, v111
    s_waitcnt vmcnt(25)
    v_cmp_ne_u32 vcc, -1, v22
    s_nop 0
    s_and_b32 s3, vcc_lo, 255
    s_cbranch_scc1 L1_ph_spin
L1_ph_ok:
    v_mfma_f32_16x16x32_bf16 a[72:75], a[196:199], v[228:231], a[72:75]
    v_exp_f32 v140, v140
    v_mfma_f32_16x16x32_bf16 a[72:75], a[200:203], v[232:235], a[72:75]
    ds_read_b64_tr_b16 a[226:227], v12 offset:36864
    v_mfma_f32_16x16x32_bf16 a[72:75], a[204:207], v[236:239], a[72:75]
    v_exp_f32 v141, v141
    v_mfma_f32_16x16x32_bf16 a[76:79], a[204:207], v[252:255], a[76:79]
    ds_read_b64_tr_b16 a[228:229], v12 offset:40960
    v_cvt_pk_bf16_f32 v140, v140, v141
    v_mfma_f32_16x16x32_bf16 a[76:79], a[200:203], v[248:251], a[76:79]
    v_exp_f32 v142, v142
    v_mfma_f32_16x16x32_bf16 a[76:79], a[196:199], v[244:247], a[76:79]
    ds_read_b64_tr_b16 a[230:231], v12 offset:45056
    s_waitcnt lgkmcnt(4)
    v_mfma_f32_16x16x32_bf16 a[76:79], a[192:195], v[240:243], a[76:79]
    v_exp_f32 v143, v143
    v_mfma_f32_16x16x32_bf16 a[92:95], a[208:211], v[240:243], a[92:95]
    ds_read_b64_tr_b16 a[232:233], v12 offset:49152
    v_cvt_pk_bf16_f32 v141, v142, v143
    v_mfma_f32_16x16x32_bf16 a[92:95], a[212:215], v[244:247], a[92:95]
    v_exp_f32 v156, v156
    v_mfma_f32_16x16x32_bf16 a[92:95], a[216:219], v[248:251], a[92:95]
    ds_read_b64_tr_b16 a[234:235], v12 offset:53248
    v_mfma_f32_16x16x32_bf16 a[92:95], a[220:223], v[252:255], a[92:95]
    v_exp_f32 v157, v157
    v_mfma_f32_16x16x32_bf16 a[88:91], a[220:223], v[236:239], a[88:91]
    ds_read_b64_tr_b16 a[236:237], v12 offset:57344
    v_cvt_pk_bf16_f32 v156, v156, v157
    v_mfma_f32_16x16x32_bf16 a[88:91], a[216:219], v[232:235], a[88:91]
    v_exp_f32 v158, v158
    v_mfma_f32_16x16x32_bf16 a[88:91], a[212:215], v[228:231], a[88:91]
    ds_read_b64_tr_b16 a[238:239], v12 offset:61440
    v_mfma_f32_16x16x32_bf16 a[88:91], a[208:211], v[224:227], a[88:91]
    v_exp_f32 v159, v159
    v_mfma_f32_16x16x32_bf16 a[84:87], a[208:211], v[208:211], a[84:87]
    ds_read_b64_tr_b16 a[240:241], v13 offset:32768
    v_cvt_pk_bf16_f32 v157, v158, v159
    v_mfma_f32_16x16x32_bf16 a[84:87], a[212:215], v[212:215], a[84:87]
    v_exp_f32 v172, v172
    v_mfma_f32_16x16x32_bf16 a[84:87], a[216:219], v[216:219], a[84:87]
    ds_read_b64_tr_b16 a[242:243], v13 offset:36864
    v_mfma_f32_16x16x32_bf16 a[84:87], a[220:223], v[220:223], a[84:87]
    v_exp_f32 v173, v173
    v_mfma_f32_16x16x32_bf16 a[80:83], a[220:223], v[204:207], a[80:83]
    ds_read_b64_tr_b16 a[244:245], v13 offset:40960
    v_cvt_pk_bf16_f32 v172, v172, v173
    v_mfma_f32_16x16x32_bf16 a[80:83], a[216:219], v[200:203], a[80:83]
    v_exp_f32 v174, v174
    v_mfma_f32_16x16x32_bf16 a[80:83], a[212:215], v[196:199], a[80:83]
    ds_read_b64_tr_b16 a[246:247], v13 offset:45056
    s_waitcnt lgkmcnt(4)
    v_mfma_f32_16x16x32_bf16 a[80:83], a[208:211], v[192:195], a[80:83]
    v_exp_f32 v175, v175
    v_mfma_f32_16x16x32_bf16 a[96:99], a[224:227], v[192:195], a[96:99]
    ds_read_b64_tr_b16 a[248:249], v13 offset:49152
    v_cvt_pk_bf16_f32 v173, v174, v175
    v_mfma_f32_16x16x32_bf16 a[96:99], a[228:231], v[196:199], a[96:99]
    v_exp_f32 v188, v188
    v_mfma_f32_16x16x32_bf16 a[96:99], a[232:235], v[200:203], a[96:99]
    ds_read_b64_tr_b16 a[250:251], v13 offset:53248
    v_mfma_f32_16x16x32_bf16 a[96:99], a[236:239], v[204:207], a[96:99]
    v_exp_f32 v189, v189
    v_mfma_f32_16x16x32_bf16 a[100:103], a[236:239], v[220:223], a[100:103]
    ds_read_b64_tr_b16 a[252:253], v13 offset:57344
    v_cvt_pk_bf16_f32 v188, v188, v189
    v_mfma_f32_16x16x32_bf16 a[100:103], a[232:235], v[216:219], a[100:103]
    v_exp_f32 v190, v190
    v_mfma_f32_16x16x32_bf16 a[100:103], a[228:231], v[212:215], a[100:103]
    ds_read_b64_tr_b16 a[254:255], v13 offset:61440
    v_mfma_f32_16x16x32_bf16 a[100:103], a[224:227], v[208:211], a[100:103]
    v_exp_f32 v191, v191
    v_mfma_f32_16x16x32_bf16 a[104:107], a[224:227], v[224:227], a[104:107]
    s_add_u32 s40, s40, 32768
    v_cvt_pk_bf16_f32 v189, v190, v191
    v_mfma_f32_16x16x32_bf16 a[104:107], a[228:231], v[228:231], a[104:107]
    v_exp_f32 v112, v112
    v_mfma_f32_16x16x32_bf16 a[104:107], a[232:235], v[232:235], a[104:107]
    s_add_u32 s77, s77, 32768
    v_mfma_f32_16x16x32_bf16 a[104:107], a[236:239], v[236:239], a[104:107]
    v_exp_f32 v113, v113
    v_mfma_f32_16x16x32_bf16 a[108:111], a[236:239], v[252:255], a[108:111]
    s_waitcnt lgkmcnt(0)
    v_cvt_pk_bf16_f32 v142, v112, v113
    v_mfma_f32_16x16x32_bf16 a[108:111], a[232:235], v[248:251], a[108:111]
    v_exp_f32 v114, v114
    v_mfma_f32_16x16x32_bf16 a[108:111], a[228:231], v[244:247], a[108:111]
    s_waitcnt vmcnt(9)
    s_barrier
    v_mfma_f32_16x16x32_bf16 a[108:111], a[224:227], v[240:243], a[108:111]
    v_exp_f32 v115, v115
    v_mfma_f32_16x16x32_bf16 a[124:127], a[240:243], v[240:243], a[124:127]
    ds_read_b128 a[192:195], v2 offset:32768
L1_pc5:
    s_cbranch_execz L1_pc9
    v_cvt_pk_bf16_f32 v143, v114, v115
    v_mfma_f32_16x16x32_bf16 a[124:127], a[244:247], v[244:247], a[124:127]
    v_exp_f32 v116, v116
    v_mfma_f32_16x16x32_bf16 a[124:127], a[248:251], v[248:251], a[124:127]
    ds_read_b128 a[196:199], v3 offset:32768
    v_mfma_f32_16x16x32_bf16 a[124:127], a[252:255], v[252:255], a[124:127]
    v_exp_f32 v117, v117
    v_mfma_f32_16x16x32_bf16 a[120:123], a[252:255], v[236:239], a[120:123]
    ds_read_b128 a[200:203], v4 offset:32768
    v_cvt_pk_bf16_f32 v158, v116, v117
    v_mfma_f32_16x16x32_bf16 a[120:123], a[248:251], v[232:235], a[120:123]
    v_exp_f32 v118, v118
    v_mfma_f32_16x16x32_bf16 a[120:123], a[244:247], v[228:231], a[120:123]
    ds_read_b128 a[204:207], v5 offset:32768
    v_mfma_f32_16x16x32_bf16 a[120:123], a[240:243], v[224:227], a[120:123]
    v_exp_f32 v119, v119
    v_mfma_f32_16x16x32_bf16 a[116:119], a[240:243], v[208:211], a[116:119]
    v_cvt_pk_bf16_f32 v159, v118, v119
    v_mfma_f32_16x16x32_bf16 a[116:119], a[244:247], v[212:215], a[116:119]
    v_exp_f32 v120, v120
    v_mfma_f32_16x16x32_bf16 a[116:119], a[248:251], v[216:219], a[116:119]
    v_mfma_f32_16x16x32_bf16 a[116:119], a[252:255], v[220:223], a[116:119]
    v_exp_f32 v121, v121
    v_mfma_f32_16x16x32_bf16 a[112:115], a[252:255], v[204:207], a[112:115]
    v_cvt_pk_bf16_f32 v174, v120, v121
    v_mfma_f32_16x16x32_bf16 a[112:115], a[248:251], v[200:203], a[112:115]
    v_exp_f32 v122, v122
    v_mfma_f32_16x16x32_bf16 a[112:115], a[244:247], v[196:199], a[112:115]
    s_waitcnt lgkmcnt(0)
    v_mfma_f32_16x16x32_bf16 a[112:115], a[240:243], v[192:195], a[112:115]
    v_exp_f32 v123, v123
    v_mfma_f32_16x16x32_bf16 v[192:195], a[192:195], a[128:131], v[32:35]
    ds_read_b128 a[208:211], v2 offset:36864
    v_cvt_pk_bf16_f32 v175, v122, v123
    v_mfma_f32_16x16x32_bf16 v[192:195], a[196:199], a[144:147], v[192:195]
    v_exp_f32 v124, v124
    v_mfma_f32_16x16x32_bf16 v[192:195], a[200:203], a[160:163], v[192:195]
    ds_read_b128 a[212:215], v3 offset:36864
    v_mfma_f32_16x16x32_bf16 v[192:195], a[204:207], a[176:179], v[192:195]
    v_exp_f32 v125, v125
    v_mfma_f32_16x16x32_bf16 v[208:211], a[204:207], a[180:183], v[36:39]
    ds_read_b128 a[216:219], v4 offset:36864
    v_cvt_pk_bf16_f32 v190, v124, v125
    v_mfma_f32_16x16x32_bf16 v[208:211], a[200:203], a[164:167], v[208:211]
    v_exp_f32 v126, v126
    v_mfma_f32_16x16x32_bf16 v[208:211], a[196:199], a[148:151], v[208:211]
    ds_read_b128 a[220:223], v5 offset:36864
    s_add_u32 m0, s41, 0
    s_add_u32 s80, s75, 131072
    v_mfma_f32_16x16x32_bf16 v[208:211], a[192:195], a[132:135], v[208:211]
    v_exp_f32 v127, v127
    v_mfma_f32_16x16x32_bf16 v[224:227], a[192:195], a[136:139], v[40:43]
    buffer_load_dwordx4 v14, s[28:31], s80 offen offset:0 lds
    v_mfma_f32_16x16x32_bf16 v[224:227], a[196:199], a[152:155], v[224:227]
    v_exp_f32 v192, v192
    v_mfma_f32_16x16x32_bf16 v[224:227], a[200:203], a[168:171], v[224:227]
    buffer_load_dwordx4 v15, s[28:31], s80 offen offset:1024 lds
    v_mfma_f32_16x16x32_bf16 v[224:227], a[204:207], a[184:187], v[224:227]
    v_exp_f32 v193, v193
    v_mfma_f32_16x16x32_bf16 v[240:243], a[204:207], a[188:191], v[44:47]
    buffer_load_dwordx4 v16, s[28:31], s80 offen offset:2048 lds
    v_mfma_f32_16x16x32_bf16 v[240:243], a[200:203], a[172:175], v[240:243]
    v_exp_f32 v194, v194
    v_mfma_f32_16x16x32_bf16 v[240:243], a[196:199], a[156:159], v[240:243]
    s_waitcnt lgkmcnt(0)
    v_cvt_pk_bf16_f32 v191, v126, v127
    v_mfma_f32_16x16x32_bf16 v[240:243], a[192:195], a[140:143], v[240:243]
    v_exp_f32 v195, v195
    v_mfma_f32_16x16x32_bf16 v[64:67], a[208:211], a[128:131], v[32:35]
    ds_read_b128 a[224:227], v2 offset:40960
    v_cvt_pk_bf16_f32 v192, v192, v193
    v_mfma_f32_16x16x32_bf16 v[64:67], a[212:215], a[144:147], v[64:67]
    v_exp_f32 v208, v208
    v_mfma_f32_16x16x32_bf16 v[64:67], a[216:219], a[160:163], v[64:67]
    ds_read_b128 a[228:231], v3 offset:40960
    v_cvt_pk_bf16_f32 v193, v194, v195
    v_mfma_f32_16x16x32_bf16 v[64:67], a[220:223], a[176:179], v[64:67]
    v_exp_f32 v209, v209
    v_mfma_f32_16x16x32_bf16 v[68:71], a[220:223], a[180:183], v[36:39]
    ds_read_b128 a[232:235], v4 offset:40960
    v_cvt_pk_bf16_f32 v208, v208, v209
    v_mfma_f32_16x16x32_bf16 v[68:71], a[216:219], a[164:167], v[68:71]
    v_exp_f32 v210, v210
    v_mfma_f32_16x16x32_bf16 v[68:71], a[212:215], a[148:151], v[68:71]
    ds_read_b128 a[236:239], v5 offset:40960
    v_mfma_f32_16x16x32_bf16 v[68:71], a[208:211], a[132:135], v[68:71]
    v_exp_f32 v211, v211
    v_smfmac_f32_16x16x64_bf16 v[48:51], v[24:27], v[128:135], v20
    v_mfma_f32_16x16x32_bf16 v[72:75], a[208:211], a[136:139], v[40:43]
    buffer_load_dwordx4 v17, s[28:31], s80 offen offset:3072 lds
    v_mfma_f32_16x16x32_bf16 v[72:75], a[212:215], a[152:155], v[72:75]
    v_exp_f32 v224, v224
    v_mfma_f32_16x16x32_bf16 v[72:75], a[216:219], a[168:171], v[72:75]
    s_add_u32 m0, s41, 16384
    s_add_u32 s80, s75, 196608
    v_cvt_pk_bf16_f32 v209, v210, v211
    v_mfma_f32_16x16x32_bf16 v[72:75], a[220:223], a[184:187], v[72:75]
    v_exp_f32 v225, v225
    v_mfma_f32_16x16x32_bf16 v[76:79], a[220:223], a[188:191], v[44:47]
    buffer_load_dwordx4 v14, s[28:31], s80 offen offset:0 lds
    v_mfma_f32_16x16x32_bf16 v[76:79], a[216:219], a[172:175], v[76:79]
    v_exp_f32 v226, v226
    v_mfma_f32_16x16x32_bf16 v[76:79], a[212:215], a[156:159], v[76:79]
    s_waitcnt lgkmcnt(0)
    v_cvt_pk_bf16_f32 v224, v224, v225
    v_mfma_f32_16x16x32_bf16 v[76:79], a[208:211], a[140:143], v[76:79]
    v_exp_f32 v227, v227
    v_mfma_f32_16x16x32_bf16 v[196:199], a[224:227], a[128:131], v[32:35]
    ds_read_b128 a[240:243], v2 offset:45056
    v_cvt_pk_bf16_f32 v225, v226, v227
    v_mfma_f32_16x16x32_bf16 v[196:199], a[228:231], a[144:147], v[196:199]
    v_exp_f32 v240, v240
    v_mfma_f32_16x16x32_bf16 v[196:199], a[232:235], a[160:163], v[196:199]
    ds_read_b128 a[244:247], v3 offset:45056
    v_mfma_f32_16x16x32_bf16 v[196:199], a[236:239], a[176:179], v[196:199]
    v_exp_f32 v241, v241
    v_mfma_f32_16x16x32_bf16 v[212:215], a[236:239], a[180:183], v[36:39]
    ds_read_b128 a[248:251], v4 offset:45056
    v_cvt_pk_bf16_f32 v240, v240, v241
    v_mfma_f32_16x16x32_bf16 v[212:215], a[232:235], a[164:167], v[212:215]
    v_exp_f32 v242, v242
    v_mfma_f32_16x16x32_bf16 v[212:215], a[228:231], a[148:151], v[212:215]
    ds_read_b128 a[252:255], v5 offset:45056
    v_mfma_f32_16x16x32_bf16 v[212:215], a[224:227], a[132:135], v[212:215]
    v_exp_f32 v243, v243
    v_smfmac_f32_16x16x64_bf16 v[52:55], v[24:27], v[144:151], v20
    v_mfma_f32_16x16x32_bf16 v[228:231], a[224:227], a[136:139], v[40:43]
    buffer_load_dwordx4 v15, s[28:31], s80 offen offset:1024 lds
    v_mfma_f32_16x16x32_bf16 v[228:231], a[228:231], a[152:155], v[228:231]
    v_exp_f32 v64, v64
    v_mfma_f32_16x16x32_bf16 v[228:231], a[232:235], a[168:171], v[228:231]
    buffer_load_dwordx4 v16, s[28:31], s80 offen offset:2048 lds
    v_mfma_f32_16x16x32_bf16 v[228:231], a[236:239], a[184:187], v[228:231]
    v_exp_f32 v65, v65
    v_mfma_f32_16x16x32_bf16 v[244:247], a[236:239], a[188:191], v[44:47]
    buffer_load_dwordx4 v17, s[28:31], s80 offen offset:3072 lds
    v_mfma_f32_16x16x32_bf16 v[244:247], a[232:235], a[172:175], v[244:247]
    v_exp_f32 v66, v66
    v_mfma_f32_16x16x32_bf16 v[244:247], a[228:231], a[156:159], v[244:247]
    s_waitcnt lgkmcnt(0)
    v_cvt_pk_bf16_f32 v241, v242, v243
    v_mfma_f32_16x16x32_bf16 v[244:247], a[224:227], a[140:143], v[244:247]
    v_exp_f32 v67, v67
    v_mfma_f32_16x16x32_bf16 v[80:83], a[240:243], a[128:131], v[32:35]
    ds_read_b128 a[192:195], v2 offset:49152
    v_cvt_pk_bf16_f32 v194, v64, v65
    v_mfma_f32_16x16x32_bf16 v[80:83], a[244:247], a[144:147], v[80:83]
    v_exp_f32 v68, v68
    v_mfma_f32_16x16x32_bf16 v[80:83], a[248:251], a[160:163], v[80:83]
    ds_read_b128 a[196:199], v3 offset:49152
    v_cvt_pk_bf16_f32 v195, v66, v67
    v_mfma_f32_16x16x32_bf16 v[80:83], a[252:255], a[176:179], v[80:83]
    v_exp_f32 v69, v69
    v_mfma_f32_16x16x32_bf16 v[84:87], a[252:255], a[180:183], v[36:39]
    ds_read_b128 a[200:203], v4 offset:49152
    v_cvt_pk_bf16_f32 v210, v68, v69
    v_mfma_f32_16x16x32_bf16 v[84:87], a[248:251], a[164:167], v[84:87]
    v_exp_f32 v70, v70
    v_mfma_f32_16x16x32_bf16 v[84:87], a[244:247], a[148:151], v[84:87]
    ds_read_b128 a[204:207], v5 offset:49152
    s_add_u32 m0, s41, 98304
    v_mfma_f32_16x16x32_bf16 v[84:87], a[240:243], a[132:135], v[84:87]
    v_exp_f32 v71, v71
    v_smfmac_f32_16x16x64_bf16 v[56:59], v[24:27], v[160:167], v20
    v_mfma_f32_16x16x32_bf16 v[88:91], a[240:243], a[136:139], v[40:43]
    buffer_load_dwordx4 v18, s[12:15], s40 offen offset:0 lds
    v_mfma_f32_16x16x32_bf16 v[88:91], a[244:247], a[152:155], v[88:91]
    v_exp_f32 v72, v72
    v_mfma_f32_16x16x32_bf16 v[88:91], a[248:251], a[168:171], v[88:91]
    buffer_load_dwordx4 v19, s[12:15], s40 offen offset:1024 lds
    v_mfma_f32_16x16x32_bf16 v[88:91], a[252:255], a[184:187], v[88:91]
    v_exp_f32 v73, v73
    v_mfma_f32_16x16x32_bf16 v[92:95], a[252:255], a[188:191], v[44:47]
    buffer_load_dwordx4 v18, s[12:15], s40 offen offset:2048 lds
    v_mfma_f32_16x16x32_bf16 v[92:95], a[248:251], a[172:175], v[92:95]
    v_exp_f32 v74, v74
    v_mfma_f32_16x16x32_bf16 v[92:95], a[244:247], a[156:159], v[92:95]
    s_waitcnt lgkmcnt(0)
    v_cvt_pk_bf16_f32 v211, v70, v71
    v_mfma_f32_16x16x32_bf16 v[92:95], a[240:243], a[140:143], v[92:95]
    v_exp_f32 v75, v75
    v_mfma_f32_16x16x32_bf16 v[200:203], a[192:195], a[128:131], v[32:35]
    ds_read_b128 a[208:211], v2 offset:53248
    v_cvt_pk_bf16_f32 v226, v72, v73
    v_mfma_f32_16x16x32_bf16 v[200:203], a[196:199], a[144:147], v[200:203]
    v_exp_f32 v76, v76
    v_mfma_f32_16x16x32_bf16 v[200:203], a[200:203], a[160:163], v[200:203]
    ds_read_b128 a[212:215], v3 offset:53248
    v_cvt_pk_bf16_f32 v227, v74, v75
    v_mfma_f32_16x16x32_bf16 v[200:203], a[204:207], a[176:179], v[200:203]
    v_exp_f32 v77, v77
    v_mfma_f32_16x16x32_bf16 v[216:219], a[204:207], a[180:183], v[36:39]
    ds_read_b128 a[216:219], v4 offset:53248
    v_cvt_pk_bf16_f32 v242, v76, v77
    v_mfma_f32_16x16x32_bf16 v[216:219], a[200:203], a[164:167], v[216:219]
    v_exp_f32 v78, v78
    v_mfma_f32_16x16x32_bf16 v[216:219], a[196:199], a[148:151], v[216:219]
    ds_read_b128 a[220:223], v5 offset:53248
    v_mfma_f32_16x16x32_bf16 v[216:219], a[192:195], a[132:135], v[216:219]
    v_exp_f32 v79, v79
    v_smfmac_f32_16x16x64_bf16 v[60:63], v[24:27], v[176:183], v20
    v_mfma_f32_16x16x32_bf16 v[232:235], a[192:195], a[136:139], v[40:43]
    buffer_load_dwordx4 v19, s[12:15], s40 offen offset:3072 lds
    v_mfma_f32_16x16x32_bf16 v[232:235], a[196:199], a[152:155], v[232:235]
    v_exp_f32 v196, v196
    v_mfma_f32_16x16x32_bf16 v[232:235], a[200:203], a[168:171], v[232:235]
    s_add_u32 m0, s41, 114688
    v_cvt_pk_bf16_f32 v243, v78, v79
    v_mfma_f32_16x16x32_bf16 v[232:235], a[204:207], a[184:187], v[232:235]
    v_exp_f32 v197, v197
    v_mfma_f32_16x16x32_bf16 v[248:251], a[204:207], a[188:191], v[44:47]
    buffer_load_dwordx4 v18, s[12:15], s77 offen offset:0 lds
    v_mfma_f32_16x16x32_bf16 v[248:251], a[200:203], a[172:175], v[248:251]
    v_exp_f32 v198, v198
    v_mfma_f32_16x16x32_bf16 v[248:251], a[196:199], a[156:159], v[248:251]
    s_waitcnt lgkmcnt(0)
    v_cvt_pk_bf16_f32 v196, v196, v197
    v_mfma_f32_16x16x32_bf16 v[248:251], a[192:195], a[140:143], v[248:251]
    v_exp_f32 v199, v199
    v_mfma_f32_16x16x32_bf16 v[96:99], a[208:211], a[128:131], v[32:35]
    ds_read_b128 a[224:227], v2 offset:57344
    v_cvt_pk_bf16_f32 v197, v198, v199
    v_mfma_f32_16x16x32_bf16 v[96:99], a[212:215], a[144:147], v[96:99]
    v_exp_f32 v212, v212
    v_mfma_f32_16x16x32_bf16 v[96:99], a[216:219], a[160:163], v[96:99]
    ds_read_b128 a[228:231], v3 offset:57344
    v_mfma_f32_16x16x32_bf16 v[96:99], a[220:223], a[176:179], v[96:99]
    v_exp_f32 v213, v213
    v_mfma_f32_16x16x32_bf16 v[100:103], a[220:223], a[180:183], v[36:39]
    ds_read_b128 a[232:235], v4 offset:57344
    v_cvt_pk_bf16_f32 v212, v212, v213
    v_mfma_f32_16x16x32_bf16 v[100:103], a[216:219], a[164:167], v[100:103]
    v_exp_f32 v214, v214
    v_mfma_f32_16x16x32_bf16 v[100:103], a[212:215], a[148:151], v[100:103]
    ds_read_b128 a[236:239], v5 offset:57344
    v_mfma_f32_16x16x32_bf16 v[100:103], a[208:211], a[132:135], v[100:103]
    v_exp_f32 v215, v215
    v_smfmac_f32_16x16x64_bf16 v[48:51], v[24:27], v[136:143], v20
    v_mfma_f32_16x16x32_bf16 v[104:107], a[208:211], a[136:139], v[40:43]
    buffer_load_dwordx4 v19, s[12:15], s77 offen offset:1024 lds
    v_mfma_f32_16x16x32_bf16 v[104:107], a[212:215], a[152:155], v[104:107]
    v_exp_f32 v228, v228
    v_mfma_f32_16x16x32_bf16 v[104:107], a[216:219], a[168:171], v[104:107]
    buffer_load_dwordx4 v18, s[12:15], s77 offen offset:2048 lds
    v_mfma_f32_16x16x32_bf16 v[104:107], a[220:223], a[184:187], v[104:107]
    v_exp_f32 v229, v229
    v_mfma_f32_16x16x32_bf16 v[108:111], a[220:223], a[188:191], v[44:47]
    buffer_load_dwordx4 v19, s[12:15], s77 offen offset:3072 lds
    v_mfma_f32_16x16x32_bf16 v[108:111], a[216:219], a[172:175], v[108:111]
    v_exp_f32 v230, v230
    v_mfma_f32_16x16x32_bf16 v[108:111], a[212:215], a[156:159], v[108:111]
    s_waitcnt lgkmcnt(0)
    v_cvt_pk_bf16_f32 v213, v214, v215
    s_add_u32 s81, s59, 1048576
    v_mfma_f32_16x16x32_bf16 v[108:111], a[208:211], a[140:143], v[108:111]
    buffer_load_dwordx4 v[64:67], v1, s[36:39], s81 offen offset:0 sc1
    v_exp_f32 v231, v231
    v_mfma_f32_16x16x32_bf16 v[204:207], a[224:227], a[128:131], v[32:35]
    ds_read_b128 a[240:243], v2 offset:61440
    v_cvt_pk_bf16_f32 v228, v228, v229
    v_mfma_f32_16x16x32_bf16 v[204:207], a[228:231], a[144:147], v[204:207]
    v_exp_f32 v244, v244
    v_mfma_f32_16x16x32_bf16 v[204:207], a[232:235], a[160:163], v[204:207]
    ds_read_b128 a[244:247], v3 offset:61440
    v_cvt_pk_bf16_f32 v229, v230, v231
    v_mfma_f32_16x16x32_bf16 v[204:207], a[236:239], a[176:179], v[204:207]
    buffer_load_dwordx4 v[68:71], v28, s[36:39], s81 offen offset:0 sc1
    v_exp_f32 v245, v245
    v_mfma_f32_16x16x32_bf16 v[220:223], a[236:239], a[180:183], v[36:39]
    ds_read_b128 a[248:251], v4 offset:61440
    v_cvt_pk_bf16_f32 v244, v244, v245
    v_mfma_f32_16x16x32_bf16 v[220:223], a[232:235], a[164:167], v[220:223]
    v_exp_f32 v246, v246
    v_mfma_f32_16x16x32_bf16 v[220:223], a[228:231], a[148:151], v[220:223]
    ds_read_b128 a[252:255], v5 offset:61440
    v_mfma_f32_16x16x32_bf16 v[220:223], a[224:227], a[132:135], v[220:223]
    buffer_load_dwordx4 v[72:75], v1, s[36:39], s81 offen offset:1024 sc1
    v_exp_f32 v247, v247
    v_smfmac_f32_16x16x64_bf16 v[52:55], v[24:27], v[152:159], v20
    v_mfma_f32_16x16x32_bf16 v[236:239], a[224:227], a[136:139], v[40:43]
    ds_read_b64_tr_b16 a[192:193], v6 offset:0
    v_cvt_pk_bf16_f32 v245, v246, v247
    v_mfma_f32_16x16x32_bf16 v[236:239], a[228:231], a[152:155], v[236:239]
    v_exp_f32 v80, v80
    v_mfma_f32_16x16x32_bf16 v[236:239], a[232:235], a[168:171], v[236:239]
    ds_read_b64_tr_b16 a[194:195], v6 offset:4096
    v_mfma_f32_16x16x32_bf16 v[236:239], a[236:239], a[184:187], v[236:239]
    buffer_load_dwordx4 v[76:79], v28, s[36:39], s81 offen offset:1024 sc1
    v_exp_f32 v81, v81
    v_mfma_f32_16x16x32_bf16 v[252:255], a[236:239], a[188:191], v[44:47]
    ds_read_b64_tr_b16 a[196:197], v6 offset:8192
    v_cvt_pk_bf16_f32 v198, v80, v81
    v_mfma_f32_16x16x32_bf16 v[252:255], a[232:235], a[172:175], v[252:255]
    v_exp_f32 v82, v82
    v_mfma_f32_16x16x32_bf16 v[252:255], a[228:231], a[156:159], v[252:255]
    ds_read_b64_tr_b16 a[198:199], v6 offset:12288
    s_waitcnt lgkmcnt(4)
    v_mfma_f32_16x16x32_bf16 v[252:255], a[224:227], a[140:143], v[252:255]
    v_exp_f32 v83, v83
    v_mfma_f32_16x16x32_bf16 v[112:115], a[240:243], a[128:131], v[32:35]
    ds_read_b64_tr_b16 a[200:201], v6 offset:16384
    v_cvt_pk_bf16_f32 v199, v82, v83
    s_barrier
    v_mfma_f32_16x16x32_bf16 v[112:115], a[244:247], a[144:147], v[112:115]
    v_exp_f32 v84, v84
    v_mfma_f32_16x16x32_bf16 v[112:115], a[248:251], a[160:163], v[112:115]
    ds_read_b64_tr_b16 a[202:203], v6 offset:20480
    s_add_u32 m0, s41, 32768
    s_add_u32 s80, s75, 262144
    v_mfma_f32_16x16x32_bf16 v[112:115], a[252:255], a[176:179], v[112:115]
    buffer_load_dwordx4 v14, s[28:31], s80 offen offset:0 lds
    v_exp_f32 v85, v85
    v_mfma_f32_16x16x32_bf16 v[116:119], a[252:255], a[180:183], v[36:39]
    ds_read_b64_tr_b16 a[204:205], v6 offset:24576
    v_cvt_pk_bf16_f32 v214, v84, v85
    v_mfma_f32_16x16x32_bf16 v[116:119], a[248:251], a[164:167], v[116:119]
    v_exp_f32 v86, v86
    v_mfma_f32_16x16x32_bf16 v[116:119], a[244:247], a[148:151], v[116:119]
    ds_read_b64_tr_b16 a[206:207], v6 offset:28672
    v_mfma_f32_16x16x32_bf16 v[116:119], a[240:243], a[132:135], v[116:119]
    buffer_load_dwordx4 v15, s[28:31], s80 offen offset:1024 lds
    v_exp_f32 v87, v87
    v_smfmac_f32_16x16x64_bf16 v[56:59], v[24:27], v[168:175], v20
    v_mfma_f32_16x16x32_bf16 v[120:123], a[240:243], a[136:139], v[40:43]
    ds_read_b64_tr_b16 a[208:209], v7 offset:0
    v_cvt_pk_bf16_f32 v215, v86, v87
    v_mfma_f32_16x16x32_bf16 v[120:123], a[244:247], a[152:155], v[120:123]
    v_exp_f32 v88, v88
    v_mfma_f32_16x16x32_bf16 v[120:123], a[248:251], a[168:171], v[120:123]
    ds_read_b64_tr_b16 a[210:211], v7 offset:4096
    v_mfma_f32_16x16x32_bf16 v[120:123], a[252:255], a[184:187], v[120:123]
    buffer_load_dwordx4 v16, s[28:31], s80 offen offset:2048 lds
    v_exp_f32 v89, v89
    v_mfma_f32_16x16x32_bf16 v[124:127], a[252:255], a[188:191], v[44:47]
    ds_read_b64_tr_b16 a[212:213], v7 offset:8192
    v_cvt_pk_bf16_f32 v230, v88, v89
    v_mfma_f32_16x16x32_bf16 v[124:127], a[248:251], a[172:175], v[124:127]
    v_exp_f32 v90, v90
    v_mfma_f32_16x16x32_bf16 v[124:127], a[244:247], a[156:159], v[124:127]
    ds_read_b64_tr_b16 a[214:215], v7 offset:12288
    s_waitcnt lgkmcnt(4)
    v_mfma_f32_16x16x32_bf16 v[124:127], a[240:243], a[140:143], v[124:127]
    buffer_load_dwordx4 v17, s[28:31], s80 offen offset:3072 lds
    v_exp_f32 v91, v91
    v_mfma_f32_16x16x32_bf16 a[0:3], a[192:195], v[128:131], a[0:3]
    ds_read_b64_tr_b16 a[216:217], v7 offset:16384
    v_cvt_pk_bf16_f32 v231, v90, v91
    v_mfma_f32_16x16x32_bf16 a[0:3], a[196:199], v[132:135], a[0:3]
    v_exp_f32 v92, v92
    v_mfma_f32_16x16x32_bf16 a[0:3], a[200:203], v[136:139], a[0:3]
    ds_read_b64_tr_b16 a[218:219], v7 offset:20480
    s_add_u32 m0, s41, 49152
    s_add_u32 s80, s75, 327680
    v_mfma_f32_16x16x32_bf16 a[0:3], a[204:207], v[140:143], a[0:3]
    buffer_load_dwordx4 v14, s[28:31], s80 offen offset:0 lds
    v_exp_f32 v93, v93
    v_mfma_f32_16x16x32_bf16 a[4:7], a[204:207], v[156:159], a[4:7]
    ds_read_b64_tr_b16 a[220:221], v7 offset:24576
    v_cvt_pk_bf16_f32 v246, v92, v93
    v_mfma_f32_16x16x32_bf16 a[4:7], a[200:203], v[152:155], a[4:7]
    v_exp_f32 v94, v94
    v_mfma_f32_16x16x32_bf16 a[4:7], a[196:199], v[148:151], a[4:7]
    ds_read_b64_tr_b16 a[222:223], v7 offset:28672
    v_mfma_f32_16x16x32_bf16 a[4:7], a[192:195], v[144:147], a[4:7]
    v_exp_f32 v95, v95
    v_smfmac_f32_16x16x64_bf16 v[60:63], v[24:27], v[184:191], v20
    v_mfma_f32_16x16x32_bf16 a[8:11], a[192:195], v[160:163], a[8:11]
    ds_read_b64_tr_b16 a[224:225], v8 offset:0
    v_cvt_pk_bf16_f32 v247, v94, v95
    v_mfma_f32_16x16x32_bf16 a[8:11], a[196:199], v[164:167], a[8:11]
    buffer_load_dwordx4 v15, s[28:31], s80 offen offset:1024 lds
    v_exp_f32 v200, v200
    v_mfma_f32_16x16x32_bf16 a[8:11], a[200:203], v[168:171], a[8:11]
    ds_read_b64_tr_b16 a[226:227], v8 offset:4096
    v_mfma_f32_16x16x32_bf16 a[8:11], a[204:207], v[172:175], a[8:11]
    v_exp_f32 v201, v201
    v_mfma_f32_16x16x32_bf16 a[12:15], a[204:207], v[188:191], a[12:15]
    ds_read_b64_tr_b16 a[228:229], v8 offset:8192
    v_cvt_pk_bf16_f32 v200, v200, v201
    v_mfma_f32_16x16x32_bf16 a[12:15], a[200:203], v[184:187], a[12:15]
    buffer_load_dwordx4 v16, s[28:31], s80 offen offset:2048 lds
    v_exp_f32 v202, v202
    v_mfma_f32_16x16x32_bf16 a[12:15], a[196:199], v[180:183], a[12:15]
    ds_read_b64_tr_b16 a[230:231], v8 offset:12288
    s_waitcnt lgkmcnt(4)
    v_mfma_f32_16x16x32_bf16 a[12:15], a[192:195], v[176:179], a[12:15]
    v_exp_f32 v203, v203
    v_mfma_f32_16x16x32_bf16 a[28:31], a[208:211], v[176:179], a[28:31]
    ds_read_b64_tr_b16 a[232:233], v8 offset:16384
    v_cvt_pk_bf16_f32 v201, v202, v203
    v_mfma_f32_16x16x32_bf16 a[28:31], a[212:215], v[180:183], a[28:31]
    buffer_load_dwordx4 v17, s[28:31], s80 offen offset:3072 lds
    v_exp_f32 v216, v216
    v_mfma_f32_16x16x32_bf16 a[28:31], a[216:219], v[184:187], a[28:31]
    ds_read_b64_tr_b16 a[234:235], v8 offset:20480
    v_mfma_f32_16x16x32_bf16 a[28:31], a[220:223], v[188:191], a[28:31]
    v_exp_f32 v217, v217
    v_mfma_f32_16x16x32_bf16 a[24:27], a[220:223], v[172:175], a[24:27]
    ds_read_b64_tr_b16 a[236:237], v8 offset:24576
    v_cvt_pk_bf16_f32 v216, v216, v217
    s_add_u32 s81, s59, 0
    v_mfma_f32_16x16x32_bf16 a[24:27], a[216:219], v[168:171], a[24:27]
    buffer_load_dwordx4 a[128:131], v1, s[36:39], s81 offen offset:0 sc1
    v_exp_f32 v218, v218
    v_mfma_f32_16x16x32_bf16 a[24:27], a[212:215], v[164:167], a[24:27]
    ds_read_b64_tr_b16 a[238:239], v8 offset:28672
    v_mfma_f32_16x16x32_bf16 a[24:27], a[208:211], v[160:163], a[24:27]
    v_exp_f32 v219, v219
    v_mfma_f32_16x16x32_bf16 a[20:23], a[208:211], v[144:147], a[20:23]
    ds_read_b64_tr_b16 a[240:241], v9 offset:0
    v_cvt_pk_bf16_f32 v217, v218, v219
    v_mfma_f32_16x16x32_bf16 a[20:23], a[212:215], v[148:151], a[20:23]
    buffer_load_dwordx4 a[132:135], v28, s[36:39], s81 offen offset:0 sc1
    v_exp_f32 v232, v232
    v_mfma_f32_16x16x32_bf16 a[20:23], a[216:219], v[152:155], a[20:23]
    ds_read_b64_tr_b16 a[242:243], v9 offset:4096
    v_mfma_f32_16x16x32_bf16 a[20:23], a[220:223], v[156:159], a[20:23]
    v_exp_f32 v233, v233
    v_mfma_f32_16x16x32_bf16 a[16:19], a[220:223], v[140:143], a[16:19]
    ds_read_b64_tr_b16 a[244:245], v9 offset:8192
    v_cvt_pk_bf16_f32 v232, v232, v233
    v_mfma_f32_16x16x32_bf16 a[16:19], a[216:219], v[136:139], a[16:19]
    buffer_load_dwordx4 a[136:139], v1, s[36:39], s81 offen offset:1024 sc1
    v_exp_f32 v234, v234
    v_mfma_f32_16x16x32_bf16 a[16:19], a[212:215], v[132:135], a[16:19]
    ds_read_b64_tr_b16 a[246:247], v9 offset:12288
    s_waitcnt lgkmcnt(4)
    v_mfma_f32_16x16x32_bf16 a[16:19], a[208:211], v[128:131], a[16:19]
    v_exp_f32 v235, v235
    v_mfma_f32_16x16x32_bf16 a[32:35], a[224:227], v[128:131], a[32:35]
    ds_read_b64_tr_b16 a[248:249], v9 offset:16384
    v_cvt_pk_bf16_f32 v233, v234, v235
    v_mfma_f32_16x16x32_bf16 a[32:35], a[228:231], v[132:135], a[32:35]
    buffer_load_dwordx4 a[140:143], v28, s[36:39], s81 offen offset:1024 sc1
    v_exp_f32 v248, v248
    v_mfma_f32_16x16x32_bf16 a[32:35], a[232:235], v[136:139], a[32:35]
    ds_read_b64_tr_b16 a[250:251], v9 offset:20480
    v_mfma_f32_16x16x32_bf16 a[32:35], a[236:239], v[140:143], a[32:35]
    v_exp_f32 v249, v249
    v_mfma_f32_16x16x32_bf16 a[36:39], a[236:239], v[156:159], a[36:39]
    ds_read_b64_tr_b16 a[252:253], v9 offset:24576
    v_cvt_pk_bf16_f32 v248, v248, v249
    s_add_u32 s81, s59, 262144
    v_mfma_f32_16x16x32_bf16 a[36:39], a[232:235], v[152:155], a[36:39]
    buffer_load_dwordx4 a[144:147], v1, s[36:39], s81 offen offset:0 sc1
    v_exp_f32 v250, v250
    v_mfma_f32_16x16x32_bf16 a[36:39], a[228:231], v[148:151], a[36:39]
    ds_read_b64_tr_b16 a[254:255], v9 offset:28672
    v_mfma_f32_16x16x32_bf16 a[36:39], a[224:227], v[144:147], a[36:39]
    v_exp_f32 v251, v251
    v_mfma_f32_16x16x32_bf16 a[40:43], a[224:227], v[160:163], a[40:43]
    ds_read_b64_tr_b16 a[192:193], v10 offset:0
    v_cvt_pk_bf16_f32 v249, v250, v251
    v_mfma_f32_16x16x32_bf16 a[40:43], a[228:231], v[164:167], a[40:43]
    buffer_load_dwordx4 a[148:151], v28, s[36:39], s81 offen offset:0 sc1
    v_exp_f32 v96, v96
    v_mfma_f32_16x16x32_bf16 a[40:43], a[232:235], v[168:171], a[40:43]
    ds_read_b64_tr_b16 a[194:195], v10 offset:4096
    v_mfma_f32_16x16x32_bf16 a[40:43], a[236:239], v[172:175], a[40:43]
    v_exp_f32 v97, v97
    v_mfma_f32_16x16x32_bf16 a[44:47], a[236:239], v[188:191], a[44:47]
    ds_read_b64_tr_b16 a[196:197], v10 offset:8192
    v_cvt_pk_bf16_f32 v202, v96, v97
    v_mfma_f32_16x16x32_bf16 a[44:47], a[232:235], v[184:187], a[44:47]
    buffer_load_dwordx4 a[152:155], v1, s[36:39], s81 offen offset:1024 sc1
    v_exp_f32 v98, v98
    v_mfma_f32_16x16x32_bf16 a[44:47], a[228:231], v[180:183], a[44:47]
    ds_read_b64_tr_b16 a[198:199], v10 offset:12288
    s_waitcnt lgkmcnt(4)
    v_mfma_f32_16x16x32_bf16 a[44:47], a[224:227], v[176:179], a[44:47]
    v_exp_f32 v99, v99
    v_mfma_f32_16x16x32_bf16 a[60:63], a[240:243], v[176:179], a[60:63]
    ds_read_b64_tr_b16 a[200:201], v10 offset:16384
    v_cvt_pk_bf16_f32 v203, v98, v99
    v_mfma_f32_16x16x32_bf16 a[60:63], a[244:247], v[180:183], a[60:63]
    buffer_load_dwordx4 a[156:159], v28, s[36:39], s81 offen offset:1024 sc1
    v_exp_f32 v100, v100
    v_mfma_f32_16x16x32_bf16 a[60:63], a[248:251], v[184:187], a[60:63]
    ds_read_b64_tr_b16 a[202:203], v10 offset:20480
    s_lshl_b32 s6, s56, 17
    v_mfma_f32_16x16x32_bf16 a[60:63], a[252:255], v[188:191], a[60:63]
    v_exp_f32 v101, v101
    v_mfma_f32_16x16x32_bf16 a[56:59], a[252:255], v[172:175], a[56:59]
    ds_read_b64_tr_b16 a[204:205], v10 offset:24576
    v_cvt_pk_bf16_f32 v218, v100, v101
    s_add_u32 s81, s59, 524288
    v_mfma_f32_16x16x32_bf16 a[56:59], a[248:251], v[168:171], a[56:59]
    buffer_load_dwordx4 a[160:163], v1, s[36:39], s81 offen offset:0 sc1
    v_exp_f32 v102, v102
    v_mfma_f32_16x16x32_bf16 a[56:59], a[244:247], v[164:167], a[56:59]
    ds_read_b64_tr_b16 a[206:207], v10 offset:28672
    s_lshl_b32 s7, s45, 15
    v_mfma_f32_16x16x32_bf16 a[56:59], a[240:243], v[160:163], a[56:59]
    v_exp_f32 v103, v103
    v_mfma_f32_16x16x32_bf16 a[52:55], a[240:243], v[144:147], a[52:55]
    ds_read_b64_tr_b16 a[208:209], v11 offset:0
    v_cvt_pk_bf16_f32 v219, v102, v103
    v_mfma_f32_16x16x32_bf16 a[52:55], a[244:247], v[148:151], a[52:55]
    buffer_load_dwordx4 a[164:167], v28, s[36:39], s81 offen offset:0 sc1
    v_exp_f32 v104, v104
    v_mfma_f32_16x16x32_bf16 a[52:55], a[248:251], v[152:155], a[52:55]
    ds_read_b64_tr_b16 a[210:211], v11 offset:4096
    s_add_u32 s6, s6, s7
    v_mfma_f32_16x16x32_bf16 a[52:55], a[252:255], v[156:159], a[52:55]
    v_exp_f32 v105, v105
    v_mfma_f32_16x16x32_bf16 a[48:51], a[252:255], v[140:143], a[48:51]
    ds_read_b64_tr_b16 a[212:213], v11 offset:8192
    v_cvt_pk_bf16_f32 v234, v104, v105
    v_mfma_f32_16x16x32_bf16 a[48:51], a[248:251], v[136:139], a[48:51]
    buffer_load_dwordx4 a[168:171], v1, s[36:39], s81 offen offset:1024 sc1
    v_exp_f32 v106, v106
    v_mfma_f32_16x16x32_bf16 a[48:51], a[244:247], v[132:135], a[48:51]
    ds_read_b64_tr_b16 a[214:215], v11 offset:12288
    s_waitcnt lgkmcnt(4)
    s_lshl_b32 s7, s57, 8
    v_mfma_f32_16x16x32_bf16 a[48:51], a[240:243], v[128:131], a[48:51]
    v_exp_f32 v107, v107
    v_mfma_f32_16x16x32_bf16 a[64:67], a[192:195], v[128:131], a[64:67]
    ds_read_b64_tr_b16 a[216:217], v11 offset:16384
    v_cvt_pk_bf16_f32 v235, v106, v107
    v_mfma_f32_16x16x32_bf16 a[64:67], a[196:199], v[132:135], a[64:67]
    buffer_load_dwordx4 a[172:175], v28, s[36:39], s81 offen offset:1024 sc1
    v_exp_f32 v108, v108
    v_mfma_f32_16x16x32_bf16 a[64:67], a[200:203], v[136:139], a[64:67]
    ds_read_b64_tr_b16 a[218:219], v11 offset:20480
    s_lshl_b32 s5, s82, 6
    v_mfma_f32_16x16x32_bf16 a[64:67], a[204:207], v[140:143], a[64:67]
    v_exp_f32 v109, v109
    v_mfma_f32_16x16x32_bf16 a[68:71], a[204:207], v[156:159], a[68:71]
    ds_read_b64_tr_b16 a[220:221], v11 offset:24576
    v_cvt_pk_bf16_f32 v250, v108, v109
    s_add_u32 s81, s59, 786432
    v_mfma_f32_16x16x32_bf16 a[68:71], a[200:203], v[152:155], a[68:71]
    buffer_load_dwordx4 a[176:179], v1, s[36:39], s81 offen offset:0 sc1
    v_exp_f32 v110, v110
    v_mfma_f32_16x16x32_bf16 a[68:71], a[196:199], v[148:151], a[68:71]
    ds_read_b64_tr_b16 a[222:223], v11 offset:28672
    s_add_u32 s7, s7, s5
    v_mfma_f32_16x16x32_bf16 a[68:71], a[192:195], v[144:147], a[68:71]
    v_exp_f32 v111, v111
    v_mfma_f32_16x16x32_bf16 a[72:75], a[192:195], v[160:163], a[72:75]
    ds_read_b64_tr_b16 a[224:225], v12 offset:0
    v_cvt_pk_bf16_f32 v251, v110, v111
    v_mfma_f32_16x16x32_bf16 a[72:75], a[196:199], v[164:167], a[72:75]
    buffer_load_dwordx4 a[180:183], v28, s[36:39], s81 offen offset:0 sc1
    v_exp_f32 v204, v204
    v_mfma_f32_16x16x32_bf16 a[72:75], a[200:203], v[168:171], a[72:75]
    ds_read_b64_tr_b16 a[226:227], v12 offset:4096
    v_lshrrev_b32 v0, 8, v1
    v_mfma_f32_16x16x32_bf16 a[72:75], a[204:207], v[172:175], a[72:75]
    v_exp_f32 v205, v205
    v_mfma_f32_16x16x32_bf16 a[76:79], a[204:207], v[188:191], a[76:79]
    ds_read_b64_tr_b16 a[228:229], v12 offset:8192
    v_cvt_pk_bf16_f32 v204, v204, v205
    v_mfma_f32_16x16x32_bf16 a[76:79], a[200:203], v[184:187], a[76:79]
    buffer_load_dwordx4 a[184:187], v1, s[36:39], s81 offen offset:1024 sc1
    v_exp_f32 v206, v206
    v_mfma_f32_16x16x32_bf16 a[76:79], a[196:199], v[180:183], a[76:79]
    ds_read_b64_tr_b16 a[230:231], v12 offset:12288
    s_waitcnt lgkmcnt(4)
    v_bfe_u32 v18, v1, 4, 4
    v_mfma_f32_16x16x32_bf16 a[76:79], a[192:195], v[176:179], a[76:79]
    v_exp_f32 v207, v207
    v_mfma_f32_16x16x32_bf16 a[92:95], a[208:211], v[176:179], a[92:95]
    ds_read_b64_tr_b16 a[232:233], v12 offset:16384
    v_cvt_pk_bf16_f32 v205, v206, v207
    v_mfma_f32_16x16x32_bf16 a[92:95], a[212:215], v[180:183], a[92:95]
    buffer_load_dwordx4 a[188:191], v28, s[36:39], s81 offen offset:1024 sc1
    v_exp_f32 v220, v220
    v_mfma_f32_16x16x32_bf16 a[92:95], a[216:219], v[184:187], a[92:95]
    ds_read_b64_tr_b16 a[234:235], v12 offset:20480
    v_lshl_add_u32 v22, v0, 3, s7
    v_mfma_f32_16x16x32_bf16 a[92:95], a[220:223], v[188:191], a[92:95]
    v_exp_f32 v221, v221
    v_mfma_f32_16x16x32_bf16 a[88:91], a[220:223], v[172:175], a[88:91]
    ds_read_b64_tr_b16 a[236:237], v12 offset:24576
    v_cvt_pk_bf16_f32 v220, v220, v221
    s_add_u32 s81, s59, 1310720
    v_mfma_f32_16x16x32_bf16 a[88:91], a[216:219], v[168:171], a[88:91]
    buffer_load_dwordx4 v[80:83], v1, s[36:39], s81 offen offset:0 sc1
    v_exp_f32 v222, v222
L1_pc6:
    s_cbranch_execz L1_pc10
    v_mfma_f32_16x16x32_bf16 a[88:91], a[212:215], v[164:167], a[88:91]
    ds_read_b64_tr_b16 a[238:239], v12 offset:28672
    v_lshl_add_u32 v18, v18, 10, v22
    v_mfma_f32_16x16x32_bf16 a[88:91], a[208:211], v[160:163], a[88:91]
    v_exp_f32 v223, v223
    v_mfma_f32_16x16x32_bf16 a[84:87], a[208:211], v[144:147], a[84:87]
    ds_read_b64_tr_b16 a[240:241], v13 offset:0
    v_cvt_pk_bf16_f32 v221, v222, v223
    v_mfma_f32_16x16x32_bf16 a[84:87], a[212:215], v[148:151], a[84:87]
    buffer_load_dwordx4 v[84:87], v1, s[36:39], s81 offen offset:1024 sc1
    v_exp_f32 v236, v236
    v_mfma_f32_16x16x32_bf16 a[84:87], a[216:219], v[152:155], a[84:87]
    ds_read_b64_tr_b16 a[242:243], v13 offset:4096
    v_add_u32 v18, s6, v18
    v_mfma_f32_16x16x32_bf16 a[84:87], a[220:223], v[156:159], a[84:87]
    v_exp_f32 v237, v237
    v_mfma_f32_16x16x32_bf16 a[80:83], a[220:223], v[140:143], a[80:83]
    ds_read_b64_tr_b16 a[244:245], v13 offset:8192
    v_cvt_pk_bf16_f32 v236, v236, v237
    v_mfma_f32_16x16x32_bf16 a[80:83], a[216:219], v[136:139], a[80:83]
    v_exp_f32 v238, v238
    v_mfma_f32_16x16x32_bf16 a[80:83], a[212:215], v[132:135], a[80:83]
    ds_read_b64_tr_b16 a[246:247], v13 offset:12288
    s_waitcnt lgkmcnt(4)
    v_add_u32 v19, 16384, v18
    v_mfma_f32_16x16x32_bf16 a[80:83], a[208:211], v[128:131], a[80:83]
    v_exp_f32 v239, v239
    v_mfma_f32_16x16x32_bf16 a[96:99], a[224:227], v[128:131], a[96:99]
    ds_read_b64_tr_b16 a[248:249], v13 offset:16384
    v_cvt_pk_bf16_f32 v237, v238, v239
    v_mfma_f32_16x16x32_bf16 a[96:99], a[228:231], v[132:135], a[96:99]
    buffer_load_dwordx2 v[88:89], v18, s[20:23], 0 offen offset:0
    v_exp_f32 v252, v252
    v_mfma_f32_16x16x32_bf16 a[96:99], a[232:235], v[136:139], a[96:99]
    ds_read_b64_tr_b16 a[250:251], v13 offset:20480
    v_mfma_f32_16x16x32_bf16 a[96:99], a[236:239], v[140:143], a[96:99]
    v_exp_f32 v253, v253
    v_mfma_f32_16x16x32_bf16 a[100:103], a[236:239], v[156:159], a[100:103]
    ds_read_b64_tr_b16 a[252:253], v13 offset:24576
    v_cvt_pk_bf16_f32 v252, v252, v253
    v_mfma_f32_16x16x32_bf16 a[100:103], a[232:235], v[152:155], a[100:103]
    buffer_load_dwordx2 v[90:91], v18, s[20:23], 0 offen offset:32
    v_exp_f32 v254, v254
    v_mfma_f32_16x16x32_bf16 a[100:103], a[228:231], v[148:151], a[100:103]
    ds_read_b64_tr_b16 a[254:255], v13 offset:28672
    v_mfma_f32_16x16x32_bf16 a[100:103], a[224:227], v[144:147], a[100:103]
    v_exp_f32 v255, v255
    v_mfma_f32_16x16x32_bf16 a[104:107], a[224:227], v[160:163], a[104:107]
    s_add_u32 s40, s40, 32768
    v_cvt_pk_bf16_f32 v253, v254, v255
    v_mfma_f32_16x16x32_bf16 a[104:107], a[228:231], v[164:167], a[104:107]
    buffer_load_dwordx2 v[92:93], v19, s[20:23], 0 offen offset:0
    v_exp_f32 v112, v112
    v_mfma_f32_16x16x32_bf16 a[104:107], a[232:235], v[168:171], a[104:107]
    s_add_u32 s77, s77, 32768
    v_mfma_f32_16x16x32_bf16 a[104:107], a[236:239], v[172:175], a[104:107]
    v_exp_f32 v113, v113
    v_mfma_f32_16x16x32_bf16 a[108:111], a[236:239], v[188:191], a[108:111]
    s_waitcnt lgkmcnt(0)
    v_cvt_pk_bf16_f32 v206, v112, v113
    v_mfma_f32_16x16x32_bf16 a[108:111], a[232:235], v[184:187], a[108:111]
    buffer_load_dwordx2 v[94:95], v19, s[20:23], 0 offen offset:32
    v_exp_f32 v114, v114
    v_mfma_f32_16x16x32_bf16 a[108:111], a[228:231], v[180:183], a[108:111]
    s_waitcnt vmcnt(22)
    s_barrier
    v_mfma_f32_16x16x32_bf16 a[108:111], a[224:227], v[176:179], a[108:111]
    v_exp_f32 v115, v115
    v_mfma_f32_16x16x32_bf16 a[124:127], a[240:243], v[176:179], a[124:127]
    v_cvt_pk_bf16_f32 v207, v114, v115
    ds_read_b64_tr_b16 a[192:193], v6 offset:32768
    v_mfma_f32_16x16x32_bf16 a[124:127], a[244:247], v[180:183], a[124:127]
    v_exp_f32 v116, v116
    v_mfma_f32_16x16x32_bf16 a[124:127], a[248:251], v[184:187], a[124:127]
    ds_read_b64_tr_b16 a[194:195], v6 offset:36864
    v_mfma_f32_16x16x32_bf16 a[124:127], a[252:255], v[188:191], a[124:127]
    v_exp_f32 v117, v117
    v_mfma_f32_16x16x32_bf16 a[120:123], a[252:255], v[172:175], a[120:123]
    v_cvt_pk_bf16_f32 v222, v116, v117
    ds_read_b64_tr_b16 a[196:197], v6 offset:40960
    v_mfma_f32_16x16x32_bf16 a[120:123], a[248:251], v[168:171], a[120:123]
    v_exp_f32 v118, v118
    v_mfma_f32_16x16x32_bf16 a[120:123], a[244:247], v[164:167], a[120:123]
    ds_read_b64_tr_b16 a[198:199], v6 offset:45056
    v_mfma_f32_16x16x32_bf16 a[120:123], a[240:243], v[160:163], a[120:123]
    v_exp_f32 v119, v119
    v_mfma_f32_16x16x32_bf16 a[116:119], a[240:243], v[144:147], a[116:119]
    v_cvt_pk_bf16_f32 v223, v118, v119
    ds_read_b64_tr_b16 a[200:201], v6 offset:49152
    v_mfma_f32_16x16x32_bf16 a[116:119], a[244:247], v[148:151], a[116:119]
    v_exp_f32 v120, v120
    v_mfma_f32_16x16x32_bf16 a[116:119], a[248:251], v[152:155], a[116:119]
    buffer_load_dwordx2 v[44:45], v22, s[32:35], 0 offen offset:0
    v_mfma_f32_16x16x32_bf16 a[116:119], a[252:255], v[156:159], a[116:119]
    v_exp_f32 v121, v121
    v_mfma_f32_16x16x32_bf16 a[112:115], a[252:255], v[140:143], a[112:115]
    v_cvt_pk_bf16_f32 v238, v120, v121
    v_mfma_f32_16x16x32_bf16 a[112:115], a[248:251], v[136:139], a[112:115]
    v_exp_f32 v122, v122
    v_mfma_f32_16x16x32_bf16 a[112:115], a[244:247], v[132:135], a[112:115]
    buffer_load_dwordx2 v[46:47], v22, s[32:35], 0 offen offset:32
    v_mfma_f32_16x16x32_bf16 a[112:115], a[240:243], v[128:131], a[112:115]
    v_exp_f32 v123, v123
    ds_read_b64_tr_b16 a[202:203], v6 offset:53248
    ds_read_b64_tr_b16 a[204:205], v6 offset:57344
    ds_read_b64_tr_b16 a[206:207], v6 offset:61440
    v_smfmac_f32_16x16x64_bf16 v[48:51], v[24:27], v[192:199], v20
    v_exp_f32 v124, v124
    v_smfmac_f32_16x16x64_bf16 v[52:55], v[24:27], v[208:215], v20
    v_exp_f32 v125, v125
    v_smfmac_f32_16x16x64_bf16 v[56:59], v[24:27], v[224:231], v20
    v_cvt_pk_bf16_f32 v239, v122, v123
    v_exp_f32 v126, v126
    v_smfmac_f32_16x16x64_bf16 v[60:63], v[24:27], v[240:247], v20
    v_exp_f32 v127, v127
    v_smfmac_f32_16x16x64_bf16 v[48:51], v[24:27], v[200:207], v20
    v_cvt_pk_bf16_f32 v254, v124, v125
    v_cvt_pk_bf16_f32 v255, v126, v127
    v_smfmac_f32_16x16x64_bf16 v[52:55], v[24:27], v[216:223], v20
    ds_read_b64_tr_b16 a[208:209], v7 offset:32768
    v_smfmac_f32_16x16x64_bf16 v[56:59], v[24:27], v[232:239], v20
    ds_read_b64_tr_b16 a[210:211], v7 offset:36864
    s_lshl_b32 s3, s69, 3
    s_add_u32 s3, s3, s76
    v_smfmac_f32_16x16x64_bf16 v[60:63], v[24:27], v[248:255], v20
    ds_read_b64_tr_b16 a[212:213], v7 offset:40960
    s_waitcnt lgkmcnt(3)
    s_bfe_u32 s4, s3, 0x40014
    v_mfma_f32_16x16x32_bf16 a[0:3], a[192:195], v[192:195], a[0:3]
    ds_read_b64_tr_b16 a[214:215], v7 offset:45056
    s_lshl_b32 s4, s4, 11
    s_xor_b32 s4, s4, s3
    v_mfma_f32_16x16x32_bf16 a[0:3], a[196:199], v[196:199], a[0:3]
    ds_read_b64_tr_b16 a[216:217], v7 offset:49152
    s_add_u32 m0, s41, 65536
    s_xor_b32 s80, s71, 0
    buffer_load_dwordx4 v14, s[24:27], s80 offen offset:0 lds
    v_add_u32 v32, s4, v1
    v_mfma_f32_16x16x32_bf16 a[0:3], a[200:203], v[200:203], a[0:3]
    ds_read_b64_tr_b16 a[218:219], v7 offset:53248
    v_xor_b32 v33, 0x20000, v32
    s_xor_b32 s3, s3, 0x40000
    v_mfma_f32_16x16x32_bf16 a[0:3], a[204:207], v[204:207], a[0:3]
    s_bfe_u32 s4, s3, 0x40014
    s_lshl_b32 s4, s4, 11
    v_mfma_f32_16x16x32_bf16 a[4:7], a[204:207], v[220:223], a[4:7]
    ds_read_b64_tr_b16 a[220:221], v7 offset:57344
    s_xor_b32 s4, s4, s3
    v_mfma_f32_16x16x32_bf16 a[4:7], a[200:203], v[216:219], a[4:7]
    buffer_load_dwordx4 v15, s[24:27], s80 offen offset:1024 lds
    v_add_u32 v34, s4, v1
    v_mfma_f32_16x16x32_bf16 a[4:7], a[196:199], v[212:215], a[4:7]
    ds_read_b64_tr_b16 a[222:223], v7 offset:61440
    v_xor_b32 v35, 0x20000, v34
    v_mfma_f32_16x16x32_bf16 a[4:7], a[192:195], v[208:211], a[4:7]
    v_xor_b32 v96, 131072, v31
    v_xor_b32 v97, 131104, v31
    v_mfma_f32_16x16x32_bf16 a[8:11], a[192:195], v[224:227], a[8:11]
    ds_read_b64_tr_b16 a[224:225], v8 offset:32768
    v_add_f32 v48, v48, v49
    v_mfma_f32_16x16x32_bf16 a[8:11], a[196:199], v[228:231], a[8:11]
    buffer_load_dwordx4 v16, s[24:27], s80 offen offset:2048 lds
    v_add_f32 v52, v52, v53
    v_mfma_f32_16x16x32_bf16 a[8:11], a[200:203], v[232:235], a[8:11]
    ds_read_b64_tr_b16 a[226:227], v8 offset:36864
    v_add_f32 v56, v56, v57
    v_mfma_f32_16x16x32_bf16 a[8:11], a[204:207], v[236:239], a[8:11]
    v_xor_b32 v98, 131136, v31
    v_xor_b32 v99, 131168, v31
    v_mfma_f32_16x16x32_bf16 a[12:15], a[204:207], v[252:255], a[12:15]
    ds_read_b64_tr_b16 a[228:229], v8 offset:40960
    v_add_f32 v60, v60, v61
    v_mfma_f32_16x16x32_bf16 a[12:15], a[200:203], v[248:251], a[12:15]
    buffer_load_dwordx4 v17, s[24:27], s80 offen offset:3072 lds
    v_rcp_f32 v62, v60
    v_mfma_f32_16x16x32_bf16 a[12:15], a[196:199], v[244:247], a[12:15]
    ds_read_b64_tr_b16 a[230:231], v8 offset:45056
    v_rcp_f32 v58, v56
    v_mfma_f32_16x16x32_bf16 a[12:15], a[192:195], v[240:243], a[12:15]
    s_waitcnt lgkmcnt(4)
    v_xor_b32 v100, 131200, v31
    v_mfma_f32_16x16x32_bf16 a[28:31], a[208:211], v[240:243], a[28:31]
    ds_read_b64_tr_b16 a[232:233], v8 offset:49152
    v_rcp_f32 v54, v52
    v_mfma_f32_16x16x32_bf16 a[28:31], a[212:215], v[244:247], a[28:31]
    s_add_u32 m0, s41, 81920
    s_xor_b32 s80, s71, 131072
    buffer_load_dwordx4 v14, s[24:27], s80 offen offset:0 lds
    v_rcp_f32 v50, v48
    v_mfma_f32_16x16x32_bf16 a[28:31], a[216:219], v[248:251], a[28:31]
    ds_read_b64_tr_b16 a[234:235], v8 offset:53248
    v_xor_b32 v101, 131232, v31
    v_mfma_f32_16x16x32_bf16 a[28:31], a[220:223], v[252:255], a[28:31]
    v_maximum3_f32 v36, v48, v52, v56
    v_xor_b32 v102, 131264, v31
    v_mfma_f32_16x16x32_bf16 a[24:27], a[220:223], v[236:239], a[24:27]
    ds_read_b64_tr_b16 a[236:237], v8 offset:57344
    v_maximum3_f32 v36, v36, v60, v60
    v_mfma_f32_16x16x32_bf16 a[24:27], a[216:219], v[232:235], a[24:27]
    buffer_load_dwordx4 v15, s[24:27], s80 offen offset:1024 lds
    v_cmp_nge_f32 vcc, 0x45000000, v36
    v_mfma_f32_16x16x32_bf16 a[24:27], a[212:215], v[228:231], a[24:27]
    ds_read_b64_tr_b16 a[238:239], v8 offset:61440
    v_xor_b32 v103, 131296, v31
    v_mfma_f32_16x16x32_bf16 a[24:27], a[208:211], v[224:227], a[24:27]
    s_mov_b32 s3, 0x1000000
    v_mfma_f32_16x16x32_bf16 a[20:23], a[208:211], v[208:211], a[20:23]
    ds_read_b64_tr_b16 a[240:241], v9 offset:32768
    s_mov_b64 s[4:5], vcc
    v_mfma_f32_16x16x32_bf16 a[20:23], a[212:215], v[212:215], a[20:23]
    buffer_load_dwordx4 v16, s[24:27], s80 offen offset:2048 lds
    v_mfma_f32_16x16x32_bf16 a[20:23], a[216:219], v[216:219], a[20:23]
    ds_read_b64_tr_b16 a[242:243], v9 offset:36864
    v_mfma_f32_16x16x32_bf16 a[20:23], a[220:223], v[220:223], a[20:23]
    v_mfma_f32_16x16x32_bf16 a[16:19], a[220:223], v[204:207], a[16:19]
    ds_read_b64_tr_b16 a[244:245], v9 offset:40960
    v_accvgpr_read_b32 v128, a12
    v_accvgpr_read_b32 v129, a13
    v_accvgpr_read_b32 v130, a14
    v_accvgpr_read_b32 v131, a15
    v_mfma_f32_16x16x32_bf16 a[16:19], a[216:219], v[200:203], a[16:19]
    buffer_load_dwordx4 v17, s[24:27], s80 offen offset:3072 lds
    v_accvgpr_read_b32 v132, a28
    v_accvgpr_read_b32 v133, a29
    v_accvgpr_read_b32 v134, a30
    v_mfma_f32_16x16x32_bf16 a[16:19], a[212:215], v[196:199], a[16:19]
    ds_read_b64_tr_b16 a[246:247], v9 offset:45056
    v_accvgpr_read_b32 v135, a31
    v_max3_f32 v36, abs(v128), abs(v129), abs(v130)
    v_max3_f32 v36, v36, abs(v131), abs(v132)
    v_max3_f32 v36, v36, abs(v133), abs(v134)
    v_mfma_f32_16x16x32_bf16 a[16:19], a[208:211], v[192:195], a[16:19]
    s_waitcnt lgkmcnt(4)
    v_cmp_gt_f32 vcc, s3, v36
    v_mul_f32 v128, v128, v62
    v_mul_f32 v129, v129, v62
    v_mfma_f32_16x16x32_bf16 a[32:35], a[224:227], v[192:195], a[32:35]
    ds_read_b64_tr_b16 a[248:249], v9 offset:49152
    v_mul_f32 v130, v130, v62
    v_mul_f32 v131, v131, v62
    v_mul_f32 v132, v132, v62
    v_mul_f32 v133, v133, v62
    v_mfma_f32_16x16x32_bf16 a[32:35], a[228:231], v[196:199], a[32:35]
    v_mul_f32 v134, v134, v62
    v_mul_f32 v135, v135, v62
    s_or_b64 s[4:5], s[4:5], vcc
    v_mfma_f32_16x16x32_bf16 a[32:35], a[232:235], v[200:203], a[32:35]
    ds_read_b64_tr_b16 a[250:251], v9 offset:53248
    v_cvt_pk_bf16_f32 v136, v128, v129
    v_cvt_pk_bf16_f32 v137, v130, v131
    v_cvt_pk_bf16_f32 v138, v132, v133
    v_cvt_pk_bf16_f32 v139, v134, v135
    v_mfma_f32_16x16x32_bf16 a[32:35], a[236:239], v[204:207], a[32:35]
    buffer_store_dwordx4 v[136:139], v35, s[16:19], 0 offen sc1
    v_accvgpr_read_b32 v144, a8
    v_accvgpr_read_b32 v145, a9
    v_mfma_f32_16x16x32_bf16 a[36:39], a[236:239], v[220:223], a[36:39]
    ds_read_b64_tr_b16 a[252:253], v9 offset:57344
    v_accvgpr_read_b32 v146, a10
    v_accvgpr_read_b32 v147, a11
    v_accvgpr_read_b32 v148, a24
    v_accvgpr_read_b32 v149, a25
    v_mfma_f32_16x16x32_bf16 a[36:39], a[232:235], v[216:219], a[36:39]
    v_accvgpr_read_b32 v150, a26
    v_accvgpr_read_b32 v151, a27
    v_max3_f32 v36, abs(v144), abs(v145), abs(v146)
    v_mfma_f32_16x16x32_bf16 a[36:39], a[228:231], v[212:215], a[36:39]
    ds_read_b64_tr_b16 a[254:255], v9 offset:61440
    v_max3_f32 v36, v36, abs(v147), abs(v148)
    v_max3_f32 v36, v36, abs(v149), abs(v150)
    v_cmp_gt_f32 vcc, s3, v36
    v_mul_f32 v144, v144, v58
    v_mfma_f32_16x16x32_bf16 a[36:39], a[224:227], v[208:211], a[36:39]
    v_mul_f32 v145, v145, v58
    v_mul_f32 v146, v146, v58
    v_mul_f32 v147, v147, v58
    v_mfma_f32_16x16x32_bf16 a[40:43], a[224:227], v[224:227], a[40:43]
    ds_read_b64_tr_b16 a[192:193], v10 offset:32768
    v_mul_f32 v148, v148, v58
    v_mul_f32 v149, v149, v58
    v_mul_f32 v150, v150, v58
    v_mul_f32 v151, v151, v58
    v_mfma_f32_16x16x32_bf16 a[40:43], a[228:231], v[228:231], a[40:43]
    s_or_b64 s[4:5], s[4:5], vcc
    v_cvt_pk_bf16_f32 v152, v144, v145
    v_cvt_pk_bf16_f32 v153, v146, v147
    v_mfma_f32_16x16x32_bf16 a[40:43], a[232:235], v[232:235], a[40:43]
    ds_read_b64_tr_b16 a[194:195], v10 offset:36864
    v_cvt_pk_bf16_f32 v154, v148, v149
    v_cvt_pk_bf16_f32 v155, v150, v151
    buffer_store_dwordx4 v[152:155], v34, s[16:19], 0 offen sc1
    v_accvgpr_read_b32 v160, a4
    v_mfma_f32_16x16x32_bf16 a[40:43], a[236:239], v[236:239], a[40:43]
    v_accvgpr_read_b32 v161, a5
    v_accvgpr_read_b32 v162, a6
    v_accvgpr_read_b32 v163, a7
    v_mfma_f32_16x16x32_bf16 a[44:47], a[236:239], v[252:255], a[44:47]
    ds_read_b64_tr_b16 a[196:197], v10 offset:40960
    v_accvgpr_read_b32 v164, a20
    v_accvgpr_read_b32 v165, a21
    v_accvgpr_read_b32 v166, a22
    v_accvgpr_read_b32 v167, a23
    v_mfma_f32_16x16x32_bf16 a[44:47], a[232:235], v[248:251], a[44:47]
    v_max3_f32 v36, abs(v160), abs(v161), abs(v162)
    v_max3_f32 v36, v36, abs(v163), abs(v164)
    v_max3_f32 v36, v36, abs(v165), abs(v166)
    v_mfma_f32_16x16x32_bf16 a[44:47], a[228:231], v[244:247], a[44:47]
    ds_read_b64_tr_b16 a[198:199], v10 offset:45056
    v_cmp_gt_f32 vcc, s3, v36
    v_mul_f32 v160, v160, v54
    v_mul_f32 v161, v161, v54
    v_mul_f32 v162, v162, v54
    v_mfma_f32_16x16x32_bf16 a[44:47], a[224:227], v[240:243], a[44:47]
    s_waitcnt lgkmcnt(4)
    v_mul_f32 v163, v163, v54
    v_mul_f32 v164, v164, v54
    v_mul_f32 v165, v165, v54
    v_mfma_f32_16x16x32_bf16 a[60:63], a[240:243], v[240:243], a[60:63]
    ds_read_b64_tr_b16 a[200:201], v10 offset:49152
    v_mul_f32 v166, v166, v54
    v_mul_f32 v167, v167, v54
    s_or_b64 s[4:5], s[4:5], vcc
    v_cvt_pk_bf16_f32 v168, v160, v161
    v_mfma_f32_16x16x32_bf16 a[60:63], a[244:247], v[244:247], a[60:63]
    v_cvt_pk_bf16_f32 v169, v162, v163
    v_cvt_pk_bf16_f32 v170, v164, v165
    v_cvt_pk_bf16_f32 v171, v166, v167
    v_mfma_f32_16x16x32_bf16 a[60:63], a[248:251], v[248:251], a[60:63]
    ds_read_b64_tr_b16 a[202:203], v10 offset:53248
    buffer_store_dwordx4 v[168:171], v33, s[16:19], 0 offen sc1
    v_accvgpr_read_b32 v176, a0
    v_accvgpr_read_b32 v177, a1
    v_accvgpr_read_b32 v178, a2
    v_mfma_f32_16x16x32_bf16 a[60:63], a[252:255], v[252:255], a[60:63]
    v_accvgpr_read_b32 v179, a3
    v_accvgpr_read_b32 v180, a16
    v_accvgpr_read_b32 v181, a17
    v_mfma_f32_16x16x32_bf16 a[56:59], a[252:255], v[236:239], a[56:59]
    ds_read_b64_tr_b16 a[204:205], v10 offset:57344
    v_accvgpr_read_b32 v182, a18
    v_accvgpr_read_b32 v183, a19
    v_max3_f32 v36, abs(v176), abs(v177), abs(v178)
    v_max3_f32 v36, v36, abs(v179), abs(v180)
    v_mfma_f32_16x16x32_bf16 a[56:59], a[248:251], v[232:235], a[56:59]
    v_max3_f32 v36, v36, abs(v181), abs(v182)
    v_cmp_gt_f32 vcc, s3, v36
    v_mul_f32 v176, v176, v50
    v_mfma_f32_16x16x32_bf16 a[56:59], a[244:247], v[228:231], a[56:59]
    ds_read_b64_tr_b16 a[206:207], v10 offset:61440
    v_mul_f32 v177, v177, v50
    v_mul_f32 v178, v178, v50
    v_mul_f32 v179, v179, v50
    v_mul_f32 v180, v180, v50
    v_mfma_f32_16x16x32_bf16 a[56:59], a[240:243], v[224:227], a[56:59]
    v_mul_f32 v181, v181, v50
    v_mul_f32 v182, v182, v50
    v_mul_f32 v183, v183, v50
    v_mfma_f32_16x16x32_bf16 a[52:55], a[240:243], v[208:211], a[52:55]
    ds_read_b64_tr_b16 a[208:209], v11 offset:32768
    s_or_b64 s[4:5], s[4:5], vcc
    v_cvt_pk_bf16_f32 v184, v176, v177
    v_cvt_pk_bf16_f32 v185, v178, v179
    v_cvt_pk_bf16_f32 v186, v180, v181
    v_mfma_f32_16x16x32_bf16 a[52:55], a[244:247], v[212:215], a[52:55]
    v_cvt_pk_bf16_f32 v187, v182, v183
    buffer_store_dwordx4 v[184:187], v32, s[16:19], 0 offen sc1
    s_cmp_lg_u64 s[4:5], 0
    v_mfma_f32_16x16x32_bf16 a[52:55], a[248:251], v[216:219], a[52:55]
    ds_read_b64_tr_b16 a[210:211], v11 offset:36864
    s_cselect_b32 s3, 1, 0
    s_lshl_b32 s4, s45, 2
    s_add_u32 s4, s4, 57344
    v_mov_b32 v39, s3
    v_mfma_f32_16x16x32_bf16 a[52:55], a[252:255], v[220:223], a[52:55]
    v_mov_b32 v38, s4
    ds_write_b32 v38, v39
    v_mov_b32 v36, 57344
    v_mfma_f32_16x16x32_bf16 a[48:51], a[252:255], v[204:207], a[48:51]
    ds_read_b64_tr_b16 a[212:213], v11 offset:40960
    v_accvgpr_read_b32 v128, a44
    v_accvgpr_read_b32 v129, a45
    v_accvgpr_read_b32 v130, a46
    v_mfma_f32_16x16x32_bf16 a[48:51], a[248:251], v[200:203], a[48:51]
    v_accvgpr_read_b32 v131, a47
    v_accvgpr_read_b32 v132, a60
    v_accvgpr_read_b32 v133, a61
    v_mfma_f32_16x16x32_bf16 a[48:51], a[244:247], v[196:199], a[48:51]
    ds_read_b64_tr_b16 a[214:215], v11 offset:45056
    v_accvgpr_read_b32 v134, a62
    v_accvgpr_read_b32 v135, a63
    v_mul_f32 v128, v128, v62
    v_mfma_f32_16x16x32_bf16 a[48:51], a[240:243], v[192:195], a[48:51]
    s_waitcnt lgkmcnt(5)
    v_mul_f32 v129, v129, v62
    v_mul_f32 v130, v130, v62
    v_mfma_f32_16x16x32_bf16 a[64:67], a[192:195], v[192:195], a[64:67]
    ds_read_b64_tr_b16 a[216:217], v11 offset:49152
    v_mul_f32 v131, v131, v62
    v_mul_f32 v132, v132, v62
    v_mul_f32 v133, v133, v62
    s_waitcnt lgkmcnt(3)
    s_barrier
    ds_read_b128 v[40:43], v36
    v_mfma_f32_16x16x32_bf16 a[64:67], a[196:199], v[196:199], a[64:67]
    v_xor_b32 v35, 1024, v35
    v_mul_f32 v134, v134, v62
    v_mul_f32 v135, v135, v62
    v_mfma_f32_16x16x32_bf16 a[64:67], a[200:203], v[200:203], a[64:67]
    ds_read_b64_tr_b16 a[218:219], v11 offset:53248
    v_cvt_pk_bf16_f32 v136, v128, v129
    v_cvt_pk_bf16_f32 v137, v130, v131
    v_cvt_pk_bf16_f32 v138, v132, v133
    v_mfma_f32_16x16x32_bf16 a[64:67], a[204:207], v[204:207], a[64:67]
    v_cvt_pk_bf16_f32 v139, v134, v135
    v_mfma_f32_16x16x32_bf16 a[68:71], a[204:207], v[220:223], a[68:71]
    buffer_store_dwordx4 v[136:139], v35, s[16:19], 0 offen sc1
    ds_read_b64_tr_b16 a[220:221], v11 offset:57344
    v_accvgpr_read_b32 v144, a40
    v_accvgpr_read_b32 v145, a41
    v_accvgpr_read_b32 v146, a42
    s_waitcnt lgkmcnt(2)
    v_or3_b32 v40, v40, v41, v42
    v_or_b32 v40, v40, v43
    s_nop 0
    v_readfirstlane_b32 s3, v40
    s_nop 1
    s_andn2_b32 s3, s3, s46
    s_cbranch_scc1 L1_fallback
    v_mfma_f32_16x16x32_bf16 a[68:71], a[200:203], v[216:219], a[68:71]
    v_accvgpr_read_b32 v147, a43
    v_accvgpr_read_b32 v148, a56
    v_accvgpr_read_b32 v149, a57
    v_mfma_f32_16x16x32_bf16 a[68:71], a[196:199], v[212:215], a[68:71]
    ds_read_b64_tr_b16 a[222:223], v11 offset:61440
    v_accvgpr_read_b32 v150, a58
    v_accvgpr_read_b32 v151, a59
    v_mul_f32 v144, v144, v58
    v_mfma_f32_16x16x32_bf16 a[68:71], a[192:195], v[208:211], a[68:71]
    v_mul_f32 v145, v145, v58
    v_mul_f32 v146, v146, v58
    v_mfma_f32_16x16x32_bf16 a[72:75], a[192:195], v[224:227], a[72:75]
    ds_read_b64_tr_b16 a[224:225], v12 offset:32768
    v_mul_f32 v147, v147, v58
    v_mul_f32 v148, v148, v58
    v_mul_f32 v149, v149, v58
    v_mfma_f32_16x16x32_bf16 a[72:75], a[196:199], v[228:231], a[72:75]
    v_xor_b32 v34, 1024, v34
    v_mul_f32 v150, v150, v58
    v_mul_f32 v151, v151, v58
    v_mfma_f32_16x16x32_bf16 a[72:75], a[200:203], v[232:235], a[72:75]
    ds_read_b64_tr_b16 a[226:227], v12 offset:36864
    v_cvt_pk_bf16_f32 v152, v144, v145
    v_cvt_pk_bf16_f32 v153, v146, v147
    v_cvt_pk_bf16_f32 v154, v148, v149
    v_mfma_f32_16x16x32_bf16 a[72:75], a[204:207], v[236:239], a[72:75]
    v_cvt_pk_bf16_f32 v155, v150, v151
    v_mfma_f32_16x16x32_bf16 a[76:79], a[204:207], v[252:255], a[76:79]
    buffer_store_dwordx4 v[152:155], v34, s[16:19], 0 offen sc1
    ds_read_b64_tr_b16 a[228:229], v12 offset:40960
    v_accvgpr_read_b32 v160, a36
    v_accvgpr_read_b32 v161, a37
    v_accvgpr_read_b32 v162, a38
    v_mfma_f32_16x16x32_bf16 a[76:79], a[200:203], v[248:251], a[76:79]
    v_accvgpr_read_b32 v163, a39
    v_accvgpr_read_b32 v164, a52
    v_accvgpr_read_b32 v165, a53
    v_mfma_f32_16x16x32_bf16 a[76:79], a[196:199], v[244:247], a[76:79]
    ds_read_b64_tr_b16 a[230:231], v12 offset:45056
    v_accvgpr_read_b32 v166, a54
    v_accvgpr_read_b32 v167, a55
    v_mul_f32 v160, v160, v54
    v_mfma_f32_16x16x32_bf16 a[76:79], a[192:195], v[240:243], a[76:79]
    s_waitcnt lgkmcnt(4)
    v_mul_f32 v161, v161, v54
    v_mul_f32 v162, v162, v54
    v_mfma_f32_16x16x32_bf16 a[92:95], a[208:211], v[240:243], a[92:95]
    ds_read_b64_tr_b16 a[232:233], v12 offset:49152
    v_mul_f32 v163, v163, v54
    v_mul_f32 v164, v164, v54
    v_mul_f32 v165, v165, v54
    v_mfma_f32_16x16x32_bf16 a[92:95], a[212:215], v[244:247], a[92:95]
    v_xor_b32 v33, 1024, v33
    v_mul_f32 v166, v166, v54
    v_mul_f32 v167, v167, v54
    v_mfma_f32_16x16x32_bf16 a[92:95], a[216:219], v[248:251], a[92:95]
    ds_read_b64_tr_b16 a[234:235], v12 offset:53248
    v_cvt_pk_bf16_f32 v168, v160, v161
    v_cvt_pk_bf16_f32 v169, v162, v163
    v_cvt_pk_bf16_f32 v170, v164, v165
    v_mfma_f32_16x16x32_bf16 a[92:95], a[220:223], v[252:255], a[92:95]
    v_cvt_pk_bf16_f32 v171, v166, v167
    v_mfma_f32_16x16x32_bf16 a[88:91], a[220:223], v[236:239], a[88:91]
    buffer_store_dwordx4 v[168:171], v33, s[16:19], 0 offen sc1
    ds_read_b64_tr_b16 a[236:237], v12 offset:57344
    v_accvgpr_read_b32 v176, a32
    v_accvgpr_read_b32 v177, a33
    v_accvgpr_read_b32 v178, a34
    v_mfma_f32_16x16x32_bf16 a[88:91], a[216:219], v[232:235], a[88:91]
    v_accvgpr_read_b32 v179, a35
    v_accvgpr_read_b32 v180, a48
    v_accvgpr_read_b32 v181, a49
    v_mfma_f32_16x16x32_bf16 a[88:91], a[212:215], v[228:231], a[88:91]
    ds_read_b64_tr_b16 a[238:239], v12 offset:61440
    v_accvgpr_read_b32 v182, a50
    v_accvgpr_read_b32 v183, a51
    v_mul_f32 v176, v176, v50
    v_mfma_f32_16x16x32_bf16 a[88:91], a[208:211], v[224:227], a[88:91]
    v_mul_f32 v177, v177, v50
    v_mul_f32 v178, v178, v50
    v_mfma_f32_16x16x32_bf16 a[84:87], a[208:211], v[208:211], a[84:87]
    ds_read_b64_tr_b16 a[240:241], v13 offset:32768
    v_mul_f32 v179, v179, v50
    v_mul_f32 v180, v180, v50
    v_mul_f32 v181, v181, v50
    v_mfma_f32_16x16x32_bf16 a[84:87], a[212:215], v[212:215], a[84:87]
    v_xor_b32 v32, 1024, v32
    v_mul_f32 v182, v182, v50
    v_mul_f32 v183, v183, v50
    v_mfma_f32_16x16x32_bf16 a[84:87], a[216:219], v[216:219], a[84:87]
    ds_read_b64_tr_b16 a[242:243], v13 offset:36864
    v_cvt_pk_bf16_f32 v184, v176, v177
    v_cvt_pk_bf16_f32 v185, v178, v179
    v_cvt_pk_bf16_f32 v186, v180, v181
    v_mfma_f32_16x16x32_bf16 a[84:87], a[220:223], v[220:223], a[84:87]
    v_cvt_pk_bf16_f32 v187, v182, v183
    v_mfma_f32_16x16x32_bf16 a[80:83], a[220:223], v[204:207], a[80:83]
    buffer_store_dwordx4 v[184:187], v32, s[16:19], 0 offen sc1
    ds_read_b64_tr_b16 a[244:245], v13 offset:40960
    v_accvgpr_read_b32 v128, a76
    v_accvgpr_read_b32 v129, a77
    v_accvgpr_read_b32 v130, a78
    v_mfma_f32_16x16x32_bf16 a[80:83], a[216:219], v[200:203], a[80:83]
    v_accvgpr_read_b32 v131, a79
    v_accvgpr_read_b32 v132, a92
    v_accvgpr_read_b32 v133, a93
    v_mfma_f32_16x16x32_bf16 a[80:83], a[212:215], v[196:199], a[80:83]
    ds_read_b64_tr_b16 a[246:247], v13 offset:45056
    v_accvgpr_read_b32 v134, a94
    v_accvgpr_read_b32 v135, a95
    v_mul_f32 v128, v128, v62
    v_mfma_f32_16x16x32_bf16 a[80:83], a[208:211], v[192:195], a[80:83]
    s_waitcnt lgkmcnt(4)
    v_mul_f32 v129, v129, v62
    v_mul_f32 v130, v130, v62
    v_mfma_f32_16x16x32_bf16 a[96:99], a[224:227], v[192:195], a[96:99]
    ds_read_b64_tr_b16 a[248:249], v13 offset:49152
    v_mul_f32 v131, v131, v62
    v_mul_f32 v132, v132, v62
    v_mul_f32 v133, v133, v62
    v_mfma_f32_16x16x32_bf16 a[96:99], a[228:231], v[196:199], a[96:99]
    v_xor_b32 v35, 3072, v35
    v_mul_f32 v134, v134, v62
    v_mul_f32 v135, v135, v62
    v_mfma_f32_16x16x32_bf16 a[96:99], a[232:235], v[200:203], a[96:99]
    ds_read_b64_tr_b16 a[250:251], v13 offset:53248
    v_cvt_pk_bf16_f32 v136, v128, v129
    v_cvt_pk_bf16_f32 v137, v130, v131
    v_cvt_pk_bf16_f32 v138, v132, v133
    v_mfma_f32_16x16x32_bf16 a[96:99], a[236:239], v[204:207], a[96:99]
    v_cvt_pk_bf16_f32 v139, v134, v135
    v_mfma_f32_16x16x32_bf16 a[100:103], a[236:239], v[220:223], a[100:103]
    buffer_store_dwordx4 v[136:139], v35, s[16:19], 0 offen sc1
    ds_read_b64_tr_b16 a[252:253], v13 offset:57344
    v_accvgpr_read_b32 v144, a72
    v_accvgpr_read_b32 v145, a73
    v_accvgpr_read_b32 v146, a74
    v_mfma_f32_16x16x32_bf16 a[100:103], a[232:235], v[216:219], a[100:103]
    v_accvgpr_read_b32 v147, a75
    v_accvgpr_read_b32 v148, a88
    v_accvgpr_read_b32 v149, a89
    v_mfma_f32_16x16x32_bf16 a[100:103], a[228:231], v[212:215], a[100:103]
    ds_read_b64_tr_b16 a[254:255], v13 offset:61440
    v_accvgpr_read_b32 v150, a90
    v_accvgpr_read_b32 v151, a91
    v_mul_f32 v144, v144, v58
    v_mfma_f32_16x16x32_bf16 a[100:103], a[224:227], v[208:211], a[100:103]
    v_mul_f32 v145, v145, v58
    v_mul_f32 v146, v146, v58
    v_mfma_f32_16x16x32_bf16 a[104:107], a[224:227], v[224:227], a[104:107]
    v_mul_f32 v147, v147, v58
    v_mul_f32 v148, v148, v58
    v_mul_f32 v149, v149, v58
    v_mfma_f32_16x16x32_bf16 a[104:107], a[228:231], v[228:231], a[104:107]
    v_xor_b32 v34, 3072, v34
    v_mul_f32 v150, v150, v58
    v_mul_f32 v151, v151, v58
    v_mfma_f32_16x16x32_bf16 a[104:107], a[232:235], v[232:235], a[104:107]
    v_cvt_pk_bf16_f32 v152, v144, v145
    v_cvt_pk_bf16_f32 v153, v146, v147
    v_cvt_pk_bf16_f32 v154, v148, v149
L1_pc7:
    s_cbranch_execz L1_pc11
    v_mfma_f32_16x16x32_bf16 a[104:107], a[236:239], v[236:239], a[104:107]
    v_cvt_pk_bf16_f32 v155, v150, v151
    v_mfma_f32_16x16x32_bf16 a[108:111], a[236:239], v[252:255], a[108:111]
    buffer_store_dwordx4 v[152:155], v34, s[16:19], 0 offen sc1
    v_accvgpr_read_b32 v160, a68
    v_accvgpr_read_b32 v161, a69
    v_accvgpr_read_b32 v162, a70
    v_mfma_f32_16x16x32_bf16 a[108:111], a[232:235], v[248:251], a[108:111]
    v_accvgpr_read_b32 v163, a71
    v_accvgpr_read_b32 v164, a84
    v_accvgpr_read_b32 v165, a85
    v_mfma_f32_16x16x32_bf16 a[108:111], a[228:231], v[244:247], a[108:111]
    v_accvgpr_read_b32 v166, a86
    v_accvgpr_read_b32 v167, a87
    v_mul_f32 v160, v160, v54
    v_mfma_f32_16x16x32_bf16 a[108:111], a[224:227], v[240:243], a[108:111]
    s_waitcnt lgkmcnt(0)
    v_mul_f32 v161, v161, v54
    v_mul_f32 v162, v162, v54
    v_mfma_f32_16x16x32_bf16 a[124:127], a[240:243], v[240:243], a[124:127]
    v_mul_f32 v163, v163, v54
    v_mul_f32 v164, v164, v54
    v_mul_f32 v165, v165, v54
    v_mfma_f32_16x16x32_bf16 a[124:127], a[244:247], v[244:247], a[124:127]
    v_xor_b32 v33, 3072, v33
    v_mul_f32 v166, v166, v54
    v_mul_f32 v167, v167, v54
    v_mfma_f32_16x16x32_bf16 a[124:127], a[248:251], v[248:251], a[124:127]
    v_cvt_pk_bf16_f32 v168, v160, v161
    v_cvt_pk_bf16_f32 v169, v162, v163
    v_cvt_pk_bf16_f32 v170, v164, v165
    v_mfma_f32_16x16x32_bf16 a[124:127], a[252:255], v[252:255], a[124:127]
    v_cvt_pk_bf16_f32 v171, v166, v167
    v_mfma_f32_16x16x32_bf16 a[120:123], a[252:255], v[236:239], a[120:123]
    buffer_store_dwordx4 v[168:171], v33, s[16:19], 0 offen sc1
    ds_read_b64_tr_b16 a[192:193], v96 offset:0
    v_accvgpr_read_b32 v176, a64
    v_accvgpr_read_b32 v177, a65
    v_accvgpr_read_b32 v178, a66
    v_mfma_f32_16x16x32_bf16 a[120:123], a[248:251], v[232:235], a[120:123]
    ds_read_b64_tr_b16 a[194:195], v96 offset:4096
    v_accvgpr_read_b32 v179, a67
    v_accvgpr_read_b32 v180, a80
    v_accvgpr_read_b32 v181, a81
    v_mfma_f32_16x16x32_bf16 a[120:123], a[244:247], v[228:231], a[120:123]
    ds_read_b64_tr_b16 a[196:197], v96 offset:8192
    v_accvgpr_read_b32 v182, a82
    v_accvgpr_read_b32 v183, a83
    v_mul_f32 v176, v176, v50
    v_mfma_f32_16x16x32_bf16 a[120:123], a[240:243], v[224:227], a[120:123]
    ds_read_b64_tr_b16 a[198:199], v96 offset:12288
    v_mul_f32 v177, v177, v50
    v_mul_f32 v178, v178, v50
    v_mfma_f32_16x16x32_bf16 a[116:119], a[240:243], v[208:211], a[116:119]
    ds_read_b64_tr_b16 a[200:201], v97 offset:0
    v_mul_f32 v179, v179, v50
    v_mul_f32 v180, v180, v50
    v_mul_f32 v181, v181, v50
    v_mfma_f32_16x16x32_bf16 a[116:119], a[244:247], v[212:215], a[116:119]
    ds_read_b64_tr_b16 a[202:203], v97 offset:4096
    v_xor_b32 v32, 3072, v32
    v_mul_f32 v182, v182, v50
    v_mul_f32 v183, v183, v50
    v_mfma_f32_16x16x32_bf16 a[116:119], a[248:251], v[216:219], a[116:119]
    ds_read_b64_tr_b16 a[204:205], v97 offset:8192
    v_cvt_pk_bf16_f32 v184, v176, v177
    v_cvt_pk_bf16_f32 v185, v178, v179
    v_cvt_pk_bf16_f32 v186, v180, v181
    v_mfma_f32_16x16x32_bf16 a[116:119], a[252:255], v[220:223], a[116:119]
    ds_read_b64_tr_b16 a[206:207], v97 offset:12288
    v_cvt_pk_bf16_f32 v187, v182, v183
    v_mfma_f32_16x16x32_bf16 a[112:115], a[252:255], v[204:207], a[112:115]
    buffer_store_dwordx4 v[184:187], v32, s[16:19], 0 offen sc1
    ds_read_b64_tr_b16 a[208:209], v98 offset:0
    v_mfma_f32_16x16x32_bf16 a[112:115], a[248:251], v[200:203], a[112:115]
    ds_read_b64_tr_b16 a[210:211], v98 offset:4096
    v_mfma_f32_16x16x32_bf16 a[112:115], a[244:247], v[196:199], a[112:115]
    ds_read_b64_tr_b16 a[212:213], v98 offset:8192
    v_mfma_f32_16x16x32_bf16 a[112:115], a[240:243], v[192:195], a[112:115]
    ds_read_b64_tr_b16 a[214:215], v98 offset:12288
    s_waitcnt lgkmcnt(4)
    s_waitcnt vmcnt(26)
    v_mfma_f32_16x16x32_bf16 v[128:131], a[192:195], a[128:131], 0
    ds_read_b64_tr_b16 a[216:217], v99 offset:0
    v_accvgpr_read_b32 v192, a108
    v_accvgpr_read_b32 v193, a109
    v_accvgpr_read_b32 v194, a110
    v_mfma_f32_16x16x32_bf16 v[128:131], a[196:199], a[132:135], v[128:131]
    ds_read_b64_tr_b16 a[218:219], v99 offset:4096
    v_accvgpr_read_b32 v195, a111
    v_accvgpr_read_b32 v196, a124
    v_accvgpr_read_b32 v197, a125
    v_mfma_f32_16x16x32_bf16 v[132:135], a[196:199], a[140:143], 0
    ds_read_b64_tr_b16 a[220:221], v99 offset:8192
    v_accvgpr_read_b32 v198, a126
    v_accvgpr_read_b32 v199, a127
    v_mul_f32 v192, v192, v62
    v_mfma_f32_16x16x32_bf16 v[132:135], a[192:195], a[136:139], v[132:135]
    ds_read_b64_tr_b16 a[222:223], v99 offset:12288
    v_mul_f32 v193, v193, v62
    v_mul_f32 v194, v194, v62
    v_mfma_f32_16x16x32_bf16 v[140:143], a[200:203], a[136:139], 0
    ds_read_b64_tr_b16 a[224:225], v100 offset:0
    v_mul_f32 v195, v195, v62
    v_mul_f32 v196, v196, v62
    v_mul_f32 v197, v197, v62
    v_mfma_f32_16x16x32_bf16 v[140:143], a[204:207], a[140:143], v[140:143]
    ds_read_b64_tr_b16 a[226:227], v100 offset:4096
    v_xor_b32 v35, 1024, v35
    v_mul_f32 v198, v198, v62
    v_mul_f32 v199, v199, v62
    v_mfma_f32_16x16x32_bf16 v[136:139], a[204:207], a[132:135], 0
    ds_read_b64_tr_b16 a[228:229], v100 offset:8192
    v_cvt_pk_bf16_f32 v200, v192, v193
    v_cvt_pk_bf16_f32 v201, v194, v195
    v_cvt_pk_bf16_f32 v202, v196, v197
    v_mfma_f32_16x16x32_bf16 v[136:139], a[200:203], a[128:131], v[136:139]
    ds_read_b64_tr_b16 a[230:231], v100 offset:12288
    s_waitcnt lgkmcnt(4)
    v_cvt_pk_bf16_f32 v203, v198, v199
    v_mfma_f32_16x16x32_bf16 v[144:147], a[208:211], a[128:131], 0
    buffer_store_dwordx4 v[200:203], v35, s[16:19], 0 offen sc1
    ds_read_b64_tr_b16 a[232:233], v101 offset:0
    v_accvgpr_read_b32 v208, a104
    v_accvgpr_read_b32 v209, a105
    v_accvgpr_read_b32 v210, a106
    v_mfma_f32_16x16x32_bf16 v[144:147], a[212:215], a[132:135], v[144:147]
    ds_read_b64_tr_b16 a[234:235], v101 offset:4096
    v_accvgpr_read_b32 v211, a107
    v_accvgpr_read_b32 v212, a120
    v_accvgpr_read_b32 v213, a121
    v_mfma_f32_16x16x32_bf16 v[148:151], a[212:215], a[140:143], 0
    ds_read_b64_tr_b16 a[236:237], v101 offset:8192
    v_accvgpr_read_b32 v214, a122
    v_accvgpr_read_b32 v215, a123
    v_mul_f32 v208, v208, v58
    s_waitcnt vmcnt(5)
    s_mov_b64 exec, 0xff
    buffer_store_dwordx4 v[24:27], v1, s[84:87], s70 offen offset:0 sc1
    s_mov_b64 exec, -1
    v_mfma_f32_16x16x32_bf16 v[148:151], a[208:211], a[136:139], v[148:151]
    ds_read_b64_tr_b16 a[238:239], v101 offset:12288
    v_mul_f32 v209, v209, v58
    v_mul_f32 v210, v210, v58
    v_mfma_f32_16x16x32_bf16 v[156:159], a[216:219], a[136:139], 0
    ds_read_b64_tr_b16 a[240:241], v102 offset:0
    v_mul_f32 v211, v211, v58
    v_mul_f32 v212, v212, v58
    v_mul_f32 v213, v213, v58
    v_mfma_f32_16x16x32_bf16 v[156:159], a[220:223], a[140:143], v[156:159]
    ds_read_b64_tr_b16 a[242:243], v102 offset:4096
    v_xor_b32 v34, 1024, v34
    v_mul_f32 v214, v214, v58
    v_mul_f32 v215, v215, v58
    v_mfma_f32_16x16x32_bf16 v[152:155], a[220:223], a[132:135], 0
    ds_read_b64_tr_b16 a[244:245], v102 offset:8192
    v_cvt_pk_bf16_f32 v216, v208, v209
    v_cvt_pk_bf16_f32 v217, v210, v211
    v_cvt_pk_bf16_f32 v218, v212, v213
    v_mfma_f32_16x16x32_bf16 v[152:155], a[216:219], a[128:131], v[152:155]
    ds_read_b64_tr_b16 a[246:247], v102 offset:12288
    s_waitcnt lgkmcnt(4)
    v_cvt_pk_bf16_f32 v219, v214, v215
    v_mfma_f32_16x16x32_bf16 v[160:163], a[224:227], a[128:131], 0
    buffer_store_dwordx4 v[216:219], v34, s[16:19], 0 offen sc1
    ds_read_b64_tr_b16 a[248:249], v103 offset:0
    v_accvgpr_read_b32 v224, a100
    v_accvgpr_read_b32 v225, a101
    v_accvgpr_read_b32 v226, a102
    v_mfma_f32_16x16x32_bf16 v[160:163], a[228:231], a[132:135], v[160:163]
    ds_read_b64_tr_b16 a[250:251], v103 offset:4096
    v_accvgpr_read_b32 v227, a103
    v_accvgpr_read_b32 v228, a116
    v_accvgpr_read_b32 v229, a117
    v_mfma_f32_16x16x32_bf16 v[164:167], a[228:231], a[140:143], 0
    ds_read_b64_tr_b16 a[252:253], v103 offset:8192
    v_accvgpr_read_b32 v230, a118
    v_accvgpr_read_b32 v231, a119
    v_mul_f32 v224, v224, v54
    v_mfma_f32_16x16x32_bf16 v[164:167], a[224:227], a[136:139], v[164:167]
    ds_read_b64_tr_b16 a[254:255], v103 offset:12288
    v_mul_f32 v225, v225, v54
    v_mul_f32 v226, v226, v54
    s_barrier
    v_mfma_f32_16x16x32_bf16 v[172:175], a[232:235], a[136:139], 0
    ds_read_b64_tr_b16 a[192:193], v96 offset:16384
    v_mul_f32 v227, v227, v54
    v_mul_f32 v228, v228, v54
    v_mul_f32 v229, v229, v54
    v_xor_b32 v104, 0, v31
    v_mfma_f32_16x16x32_bf16 v[172:175], a[236:239], a[140:143], v[172:175]
    ds_read_b64_tr_b16 a[194:195], v96 offset:20480
    v_xor_b32 v33, 1024, v33
    v_mul_f32 v230, v230, v54
    v_mul_f32 v231, v231, v54
    v_mfma_f32_16x16x32_bf16 v[168:171], a[236:239], a[132:135], 0
    ds_read_b64_tr_b16 a[196:197], v96 offset:24576
    v_cvt_pk_bf16_f32 v232, v224, v225
    v_cvt_pk_bf16_f32 v233, v226, v227
    v_cvt_pk_bf16_f32 v234, v228, v229
    v_mfma_f32_16x16x32_bf16 v[168:171], a[232:235], a[128:131], v[168:171]
    ds_read_b64_tr_b16 a[198:199], v96 offset:28672
    s_waitcnt lgkmcnt(4)
    v_cvt_pk_bf16_f32 v235, v230, v231
    buffer_store_dwordx4 v[232:235], v33, s[16:19], 0 offen sc1
    v_xor_b32 v105, 32, v31
    v_mfma_f32_16x16x32_bf16 v[176:179], a[240:243], a[128:131], 0
    ds_read_b64_tr_b16 a[200:201], v97 offset:16384
    v_accvgpr_read_b32 v240, a96
    v_accvgpr_read_b32 v241, a97
    v_accvgpr_read_b32 v242, a98
    v_mfma_f32_16x16x32_bf16 v[176:179], a[244:247], a[132:135], v[176:179]
    ds_read_b64_tr_b16 a[202:203], v97 offset:20480
    v_accvgpr_read_b32 v243, a99
    v_accvgpr_read_b32 v244, a112
    v_accvgpr_read_b32 v245, a113
    v_mfma_f32_16x16x32_bf16 v[180:183], a[244:247], a[140:143], 0
    ds_read_b64_tr_b16 a[204:205], v97 offset:24576
    v_accvgpr_read_b32 v246, a114
    v_accvgpr_read_b32 v247, a115
    v_mul_f32 v240, v240, v50
    v_mfma_f32_16x16x32_bf16 v[180:183], a[240:243], a[136:139], v[180:183]
    ds_read_b64_tr_b16 a[206:207], v97 offset:28672
    v_mul_f32 v241, v241, v50
    v_mul_f32 v242, v242, v50
    v_xor_b32 v106, 64, v31
    v_mfma_f32_16x16x32_bf16 v[188:191], a[248:251], a[136:139], 0
    ds_read_b64_tr_b16 a[208:209], v98 offset:16384
    v_mul_f32 v243, v243, v50
    v_mul_f32 v244, v244, v50
    v_mul_f32 v245, v245, v50
    v_mfma_f32_16x16x32_bf16 v[188:191], a[252:255], a[140:143], v[188:191]
    ds_read_b64_tr_b16 a[210:211], v98 offset:20480
    v_xor_b32 v32, 1024, v32
    v_mul_f32 v246, v246, v50
    v_mul_f32 v247, v247, v50
    v_mfma_f32_16x16x32_bf16 v[184:187], a[252:255], a[132:135], 0
    ds_read_b64_tr_b16 a[212:213], v98 offset:24576
    v_cvt_pk_bf16_f32 v248, v240, v241
    v_cvt_pk_bf16_f32 v249, v242, v243
    v_cvt_pk_bf16_f32 v250, v244, v245
    v_xor_b32 v107, 96, v31
    v_mfma_f32_16x16x32_bf16 v[184:187], a[248:251], a[128:131], v[184:187]
    ds_read_b64_tr_b16 a[214:215], v98 offset:28672
    s_waitcnt lgkmcnt(4)
    v_cvt_pk_bf16_f32 v251, v246, v247
    v_mfma_f32_16x16x32_bf16 v[128:131], a[192:195], a[144:147], v[128:131]
    buffer_store_dwordx4 v[248:251], v32, s[16:19], 0 offen sc1
    ds_read_b64_tr_b16 a[216:217], v99 offset:16384
    v_mfma_f32_16x16x32_bf16 v[128:131], a[196:199], a[148:151], v[128:131]
    ds_read_b64_tr_b16 a[218:219], v99 offset:20480
    s_add_u32 m0, s41, 98304
    s_xor_b32 s80, s71, 262144
    v_mfma_f32_16x16x32_bf16 v[132:135], a[196:199], a[156:159], v[132:135]
    buffer_load_dwordx4 v14, s[24:27], s80 offen offset:0 lds
    ds_read_b64_tr_b16 a[220:221], v99 offset:24576
    v_xor_b32 v108, 128, v31
    v_mfma_f32_16x16x32_bf16 v[132:135], a[192:195], a[152:155], v[132:135]
    ds_read_b64_tr_b16 a[222:223], v99 offset:28672
    v_mfma_f32_16x16x32_bf16 v[140:143], a[200:203], a[152:155], v[140:143]
    buffer_load_dwordx4 v15, s[24:27], s80 offen offset:1024 lds
    ds_read_b64_tr_b16 a[224:225], v100 offset:16384
    v_mfma_f32_16x16x32_bf16 v[140:143], a[204:207], a[156:159], v[140:143]
    ds_read_b64_tr_b16 a[226:227], v100 offset:20480
    v_xor_b32 v109, 160, v31
    v_mfma_f32_16x16x32_bf16 v[136:139], a[204:207], a[148:151], v[136:139]
    ds_read_b64_tr_b16 a[228:229], v100 offset:24576
    v_mfma_f32_16x16x32_bf16 v[136:139], a[200:203], a[144:147], v[136:139]
    ds_read_b64_tr_b16 a[230:231], v100 offset:28672
    s_waitcnt lgkmcnt(4)
    v_mfma_f32_16x16x32_bf16 v[144:147], a[208:211], a[144:147], v[144:147]
    buffer_load_dwordx4 v16, s[24:27], s80 offen offset:2048 lds
    ds_read_b64_tr_b16 a[232:233], v101 offset:16384
    v_mfma_f32_16x16x32_bf16 v[144:147], a[212:215], a[148:151], v[144:147]
    ds_read_b64_tr_b16 a[234:235], v101 offset:20480
    v_xor_b32 v110, 192, v31
    v_mfma_f32_16x16x32_bf16 v[148:151], a[212:215], a[156:159], v[148:151]
    buffer_load_dwordx4 v17, s[24:27], s80 offen offset:3072 lds
    ds_read_b64_tr_b16 a[236:237], v101 offset:24576
    v_mfma_f32_16x16x32_bf16 v[148:151], a[208:211], a[152:155], v[148:151]
    ds_read_b64_tr_b16 a[238:239], v101 offset:28672
    v_mfma_f32_16x16x32_bf16 v[156:159], a[216:219], a[152:155], v[156:159]
    ds_read_b64_tr_b16 a[240:241], v102 offset:16384
    v_xor_b32 v111, 224, v31
    v_mfma_f32_16x16x32_bf16 v[156:159], a[220:223], a[156:159], v[156:159]
    ds_read_b64_tr_b16 a[242:243], v102 offset:20480
    s_add_u32 m0, s41, 114688
    s_xor_b32 s80, s71, 393216
    v_mfma_f32_16x16x32_bf16 v[152:155], a[220:223], a[148:151], v[152:155]
    buffer_load_dwordx4 v14, s[24:27], s80 offen offset:0 lds
    ds_read_b64_tr_b16 a[244:245], v102 offset:24576
    v_mfma_f32_16x16x32_bf16 v[152:155], a[216:219], a[144:147], v[152:155]
    ds_read_b64_tr_b16 a[246:247], v102 offset:28672
    s_waitcnt lgkmcnt(4)
    v_mfma_f32_16x16x32_bf16 v[160:163], a[224:227], a[144:147], v[160:163]
    buffer_load_dwordx4 v15, s[24:27], s80 offen offset:1024 lds
    ds_read_b64_tr_b16 a[248:249], v103 offset:16384
    v_mfma_f32_16x16x32_bf16 v[160:163], a[228:231], a[148:151], v[160:163]
    ds_read_b64_tr_b16 a[250:251], v103 offset:20480
    v_mfma_f32_16x16x32_bf16 v[164:167], a[228:231], a[156:159], v[164:167]
    ds_read_b64_tr_b16 a[252:253], v103 offset:24576
    v_mfma_f32_16x16x32_bf16 v[164:167], a[224:227], a[152:155], v[164:167]
    ds_read_b64_tr_b16 a[254:255], v103 offset:28672
    s_barrier
    v_mfma_f32_16x16x32_bf16 v[172:175], a[232:235], a[152:155], v[172:175]
    buffer_load_dwordx4 v16, s[24:27], s80 offen offset:2048 lds
    ds_read_b64_tr_b16 a[192:193], v104 offset:0
    v_mfma_f32_16x16x32_bf16 v[172:175], a[236:239], a[156:159], v[172:175]
    ds_read_b64_tr_b16 a[194:195], v104 offset:4096
    v_mfma_f32_16x16x32_bf16 v[168:171], a[236:239], a[148:151], v[168:171]
    buffer_load_dwordx4 v17, s[24:27], s80 offen offset:3072 lds
    ds_read_b64_tr_b16 a[196:197], v104 offset:8192
    v_mfma_f32_16x16x32_bf16 v[168:171], a[232:235], a[144:147], v[168:171]
    ds_read_b64_tr_b16 a[198:199], v104 offset:12288
    s_waitcnt lgkmcnt(4)
    v_mfma_f32_16x16x32_bf16 v[176:179], a[240:243], a[144:147], v[176:179]
    ds_read_b64_tr_b16 a[200:201], v105 offset:0
    v_mfma_f32_16x16x32_bf16 v[176:179], a[244:247], a[148:151], v[176:179]
    ds_read_b64_tr_b16 a[202:203], v105 offset:4096
    v_mfma_f32_16x16x32_bf16 v[180:183], a[244:247], a[156:159], v[180:183]
    ds_read_b64_tr_b16 a[204:205], v105 offset:8192
    v_mfma_f32_16x16x32_bf16 v[180:183], a[240:243], a[152:155], v[180:183]
    ds_read_b64_tr_b16 a[206:207], v105 offset:12288
    v_mfma_f32_16x16x32_bf16 v[188:191], a[248:251], a[152:155], v[188:191]
    ds_read_b64_tr_b16 a[208:209], v106 offset:0
    v_mfma_f32_16x16x32_bf16 v[188:191], a[252:255], a[156:159], v[188:191]
    ds_read_b64_tr_b16 a[210:211], v106 offset:4096
    v_mfma_f32_16x16x32_bf16 v[184:187], a[252:255], a[148:151], v[184:187]
    ds_read_b64_tr_b16 a[212:213], v106 offset:8192
    v_mfma_f32_16x16x32_bf16 v[184:187], a[248:251], a[144:147], v[184:187]
    ds_read_b64_tr_b16 a[214:215], v106 offset:12288
    s_waitcnt lgkmcnt(4)
    v_mfma_f32_16x16x32_bf16 v[128:131], a[192:195], a[160:163], v[128:131]
    ds_read_b64_tr_b16 a[216:217], v107 offset:0
    s_add_u32 m0, s41, 131072
    v_mfma_f32_16x16x32_bf16 v[128:131], a[196:199], a[164:167], v[128:131]
    ds_read_b64_tr_b16 a[218:219], v107 offset:4096
    s_xor_b32 s80, s71, 524288
    v_mfma_f32_16x16x32_bf16 v[132:135], a[196:199], a[172:175], v[132:135]
    buffer_load_dwordx4 v14, s[24:27], s80 offen offset:0 lds
    ds_read_b64_tr_b16 a[220:221], v107 offset:8192
    v_mfma_f32_16x16x32_bf16 v[132:135], a[192:195], a[168:171], v[132:135]
    ds_read_b64_tr_b16 a[222:223], v107 offset:12288
    v_mfma_f32_16x16x32_bf16 v[140:143], a[200:203], a[168:171], v[140:143]
    ds_read_b64_tr_b16 a[224:225], v108 offset:0
    v_mfma_f32_16x16x32_bf16 v[140:143], a[204:207], a[172:175], v[140:143]
    ds_read_b64_tr_b16 a[226:227], v108 offset:4096
    v_mfma_f32_16x16x32_bf16 v[136:139], a[204:207], a[164:167], v[136:139]
    ds_read_b64_tr_b16 a[228:229], v108 offset:8192
    s_mov_b64 exec, 255
    buffer_load_dword v22, v29, s[84:87], 0 offen offset:0 sc1
    s_mov_b64 exec, -1
    v_mfma_f32_16x16x32_bf16 v[136:139], a[200:203], a[160:163], v[136:139]
    ds_read_b64_tr_b16 a[230:231], v108 offset:12288
    s_waitcnt lgkmcnt(4)
    v_mfma_f32_16x16x32_bf16 v[144:147], a[208:211], a[160:163], v[144:147]
    buffer_load_dwordx4 v15, s[24:27], s80 offen offset:1024 lds
    ds_read_b64_tr_b16 a[232:233], v109 offset:0
    v_mfma_f32_16x16x32_bf16 v[144:147], a[212:215], a[164:167], v[144:147]
    ds_read_b64_tr_b16 a[234:235], v109 offset:4096
    v_mfma_f32_16x16x32_bf16 v[148:151], a[212:215], a[172:175], v[148:151]
    ds_read_b64_tr_b16 a[236:237], v109 offset:8192
    v_mfma_f32_16x16x32_bf16 v[148:151], a[208:211], a[168:171], v[148:151]
    ds_read_b64_tr_b16 a[238:239], v109 offset:12288
    v_mfma_f32_16x16x32_bf16 v[156:159], a[216:219], a[168:171], v[156:159]
    ds_read_b64_tr_b16 a[240:241], v110 offset:0
    v_mfma_f32_16x16x32_bf16 v[156:159], a[220:223], a[172:175], v[156:159]
    ds_read_b64_tr_b16 a[242:243], v110 offset:4096
    v_mfma_f32_16x16x32_bf16 v[152:155], a[220:223], a[164:167], v[152:155]
    ds_read_b64_tr_b16 a[244:245], v110 offset:8192
    v_mfma_f32_16x16x32_bf16 v[152:155], a[216:219], a[160:163], v[152:155]
    ds_read_b64_tr_b16 a[246:247], v110 offset:12288
    s_waitcnt lgkmcnt(4)
    v_mfma_f32_16x16x32_bf16 v[160:163], a[224:227], a[160:163], v[160:163]
    buffer_load_dwordx4 v16, s[24:27], s80 offen offset:2048 lds
    ds_read_b64_tr_b16 a[248:249], v111 offset:0
    v_mfma_f32_16x16x32_bf16 v[160:163], a[228:231], a[164:167], v[160:163]
    ds_read_b64_tr_b16 a[250:251], v111 offset:4096
    v_mfma_f32_16x16x32_bf16 v[164:167], a[228:231], a[172:175], v[164:167]
    ds_read_b64_tr_b16 a[252:253], v111 offset:8192
    v_mfma_f32_16x16x32_bf16 v[164:167], a[224:227], a[168:171], v[164:167]
    ds_read_b64_tr_b16 a[254:255], v111 offset:12288
    s_barrier
    v_mfma_f32_16x16x32_bf16 v[172:175], a[232:235], a[168:171], v[172:175]
    ds_read_b64_tr_b16 a[192:193], v104 offset:16384
    v_mfma_f32_16x16x32_bf16 v[172:175], a[236:239], a[172:175], v[172:175]
    ds_read_b64_tr_b16 a[194:195], v104 offset:20480
    v_mfma_f32_16x16x32_bf16 v[168:171], a[236:239], a[164:167], v[168:171]
    buffer_load_dwordx4 v17, s[24:27], s80 offen offset:3072 lds
    ds_read_b64_tr_b16 a[196:197], v104 offset:24576
    v_mfma_f32_16x16x32_bf16 v[168:171], a[232:235], a[160:163], v[168:171]
    ds_read_b64_tr_b16 a[198:199], v104 offset:28672
    s_waitcnt lgkmcnt(4)
    v_mfma_f32_16x16x32_bf16 v[176:179], a[240:243], a[160:163], v[176:179]
    ds_read_b64_tr_b16 a[200:201], v105 offset:16384
    v_mfma_f32_16x16x32_bf16 v[176:179], a[244:247], a[164:167], v[176:179]
    ds_read_b64_tr_b16 a[202:203], v105 offset:20480
    v_mfma_f32_16x16x32_bf16 v[180:183], a[244:247], a[172:175], v[180:183]
    ds_read_b64_tr_b16 a[204:205], v105 offset:24576
    v_mfma_f32_16x16x32_bf16 v[180:183], a[240:243], a[168:171], v[180:183]
    ds_read_b64_tr_b16 a[206:207], v105 offset:28672
    v_mfma_f32_16x16x32_bf16 v[188:191], a[248:251], a[168:171], v[188:191]
    ds_read_b64_tr_b16 a[208:209], v106 offset:16384
    v_mfma_f32_16x16x32_bf16 v[188:191], a[252:255], a[172:175], v[188:191]
    ds_read_b64_tr_b16 a[210:211], v106 offset:20480
    v_mfma_f32_16x16x32_bf16 v[184:187], a[252:255], a[164:167], v[184:187]
    ds_read_b64_tr_b16 a[212:213], v106 offset:24576
    v_mfma_f32_16x16x32_bf16 v[184:187], a[248:251], a[160:163], v[184:187]
    ds_read_b64_tr_b16 a[214:215], v106 offset:28672
    s_waitcnt lgkmcnt(4)
    v_mfma_f32_16x16x32_bf16 v[128:131], a[192:195], a[176:179], v[128:131]
    ds_read_b64_tr_b16 a[216:217], v107 offset:16384
    s_waitcnt vmcnt(3)
    v_mfma_f32_16x16x32_bf16 v[128:131], a[196:199], a[180:183], v[128:131]
    ds_read_b64_tr_b16 a[218:219], v107 offset:20480
    v_cmp_ne_u32 vcc, 0x3f803f80, v22
    s_nop 0
    s_and_b32 s3, vcc_lo, 255
    s_cbranch_scc1 L1_pa_spin
L1_pa_ok:
    s_xor_b32 s81, s58, 0
    v_mfma_f32_16x16x32_bf16 v[132:135], a[196:199], a[188:191], v[132:135]
    buffer_load_dwordx4 a[0:3], v1, s[16:19], s81 offen offset:0 sc1
    ds_read_b64_tr_b16 a[220:221], v107 offset:24576
    v_mfma_f32_16x16x32_bf16 v[132:135], a[192:195], a[184:187], v[132:135]
    ds_read_b64_tr_b16 a[222:223], v107 offset:28672
    v_mfma_f32_16x16x32_bf16 v[140:143], a[200:203], a[184:187], v[140:143]
    ds_read_b64_tr_b16 a[224:225], v108 offset:16384
    v_xor_b32 v112, 65536, v31
    v_mfma_f32_16x16x32_bf16 v[140:143], a[204:207], a[188:191], v[140:143]
    buffer_load_dwordx4 a[4:7], v1, s[16:19], s81 offen offset:1024 sc1
    ds_read_b64_tr_b16 a[226:227], v108 offset:20480
    v_xor_b32 v113, 65568, v31
    v_mfma_f32_16x16x32_bf16 v[136:139], a[204:207], a[180:183], v[136:139]
    ds_read_b64_tr_b16 a[228:229], v108 offset:24576
    v_xor_b32 v114, 65600, v31
    v_mfma_f32_16x16x32_bf16 v[136:139], a[200:203], a[176:179], v[136:139]
    ds_read_b64_tr_b16 a[230:231], v108 offset:28672
    s_waitcnt lgkmcnt(4)
    v_mfma_f32_16x16x32_bf16 v[144:147], a[208:211], a[176:179], v[144:147]
    buffer_load_dwordx4 a[8:11], v28, s[16:19], s81 offen offset:0 sc1
    ds_read_b64_tr_b16 a[232:233], v109 offset:16384
    v_xor_b32 v115, 65632, v31
    v_mfma_f32_16x16x32_bf16 v[144:147], a[212:215], a[180:183], v[144:147]
    ds_read_b64_tr_b16 a[234:235], v109 offset:20480
    v_xor_b32 v116, 65664, v31
    v_mfma_f32_16x16x32_bf16 v[148:151], a[212:215], a[188:191], v[148:151]
    ds_read_b64_tr_b16 a[236:237], v109 offset:24576
    v_xor_b32 v117, 65696, v31
    v_mfma_f32_16x16x32_bf16 v[148:151], a[208:211], a[184:187], v[148:151]
    buffer_load_dwordx4 a[12:15], v28, s[16:19], s81 offen offset:1024 sc1
    ds_read_b64_tr_b16 a[238:239], v109 offset:28672
    v_xor_b32 v118, 65728, v31
    v_mfma_f32_16x16x32_bf16 v[156:159], a[216:219], a[184:187], v[156:159]
    ds_read_b64_tr_b16 a[240:241], v110 offset:16384
    v_xor_b32 v119, 65760, v31
    v_mfma_f32_16x16x32_bf16 v[156:159], a[220:223], a[188:191], v[156:159]
    ds_read_b64_tr_b16 a[242:243], v110 offset:20480
    s_add_u32 m0, s41, 147456
    s_xor_b32 s80, s71, 655360
    v_mfma_f32_16x16x32_bf16 v[152:155], a[220:223], a[180:183], v[152:155]
    buffer_load_dwordx4 v14, s[24:27], s80 offen offset:0 lds
    ds_read_b64_tr_b16 a[244:245], v110 offset:24576
    v_mfma_f32_16x16x32_bf16 v[152:155], a[216:219], a[176:179], v[152:155]
    ds_read_b64_tr_b16 a[246:247], v110 offset:28672
    s_waitcnt lgkmcnt(4)
    v_mfma_f32_16x16x32_bf16 v[160:163], a[224:227], a[176:179], v[160:163]
    buffer_load_dwordx4 v15, s[24:27], s80 offen offset:1024 lds
    ds_read_b64_tr_b16 a[248:249], v111 offset:16384
    v_mfma_f32_16x16x32_bf16 v[160:163], a[228:231], a[180:183], v[160:163]
    ds_read_b64_tr_b16 a[250:251], v111 offset:20480
    v_mfma_f32_16x16x32_bf16 v[164:167], a[228:231], a[188:191], v[164:167]
    ds_read_b64_tr_b16 a[252:253], v111 offset:24576
    v_mfma_f32_16x16x32_bf16 v[164:167], a[224:227], a[184:187], v[164:167]
    ds_read_b64_tr_b16 a[254:255], v111 offset:28672
    s_barrier
    v_mfma_f32_16x16x32_bf16 v[172:175], a[232:235], a[184:187], v[172:175]
    buffer_load_dwordx4 v16, s[24:27], s80 offen offset:2048 lds
    ds_read_b64_tr_b16 a[192:193], v104 offset:32768
    v_mfma_f32_16x16x32_bf16 v[172:175], a[236:239], a[188:191], v[172:175]
    ds_read_b64_tr_b16 a[194:195], v104 offset:36864
    v_mfma_f32_16x16x32_bf16 v[168:171], a[236:239], a[180:183], v[168:171]
    buffer_load_dwordx4 v17, s[24:27], s80 offen offset:3072 lds
    ds_read_b64_tr_b16 a[196:197], v104 offset:40960
    v_mfma_f32_16x16x32_bf16 v[168:171], a[232:235], a[176:179], v[168:171]
    ds_read_b64_tr_b16 a[198:199], v104 offset:45056
    s_waitcnt lgkmcnt(4)
    v_mfma_f32_16x16x32_bf16 v[176:179], a[240:243], a[176:179], v[176:179]
    ds_read_b64_tr_b16 a[200:201], v105 offset:32768
    v_mfma_f32_16x16x32_bf16 v[176:179], a[244:247], a[180:183], v[176:179]
    ds_read_b64_tr_b16 a[202:203], v105 offset:36864
    v_mfma_f32_16x16x32_bf16 v[180:183], a[244:247], a[188:191], v[180:183]
    ds_read_b64_tr_b16 a[204:205], v105 offset:40960
    v_mfma_f32_16x16x32_bf16 v[180:183], a[240:243], a[184:187], v[180:183]
    ds_read_b64_tr_b16 a[206:207], v105 offset:45056
    v_mfma_f32_16x16x32_bf16 v[188:191], a[248:251], a[184:187], v[188:191]
    ds_read_b64_tr_b16 a[208:209], v106 offset:32768
    v_mfma_f32_16x16x32_bf16 v[188:191], a[252:255], a[188:191], v[188:191]
    ds_read_b64_tr_b16 a[210:211], v106 offset:36864
    s_waitcnt vmcnt(21)
    v_mfma_f32_16x16x32_bf16 v[184:187], a[252:255], a[180:183], v[184:187]
    ds_read_b64_tr_b16 a[212:213], v106 offset:40960
    s_mov_b64 exec, 0xff
    buffer_store_dwordx4 v[24:27], v1, s[84:87], s70 offen offset:128 sc1
    s_mov_b64 exec, -1
    v_mfma_f32_16x16x32_bf16 v[184:187], a[248:251], a[176:179], v[184:187]
    ds_read_b64_tr_b16 a[214:215], v106 offset:45056
    s_waitcnt lgkmcnt(4)
    v_mfma_f32_16x16x32_bf16 v[128:131], a[192:195], v[64:67], v[128:131]
    ds_read_b64_tr_b16 a[216:217], v107 offset:32768
    v_mfma_f32_16x16x32_bf16 v[128:131], a[196:199], v[68:71], v[128:131]
    ds_read_b64_tr_b16 a[218:219], v107 offset:36864
    s_xor_b32 s81, s58, 4096
    v_mfma_f32_16x16x32_bf16 v[132:135], a[196:199], v[76:79], v[132:135]
    buffer_load_dwordx4 a[16:19], v1, s[16:19], s81 offen offset:0 sc1
    ds_read_b64_tr_b16 a[220:221], v107 offset:40960
    v_mfma_f32_16x16x32_bf16 v[132:135], a[192:195], v[72:75], v[132:135]
    ds_read_b64_tr_b16 a[222:223], v107 offset:45056
    v_mfma_f32_16x16x32_bf16 v[140:143], a[200:203], v[72:75], v[140:143]
    buffer_load_dwordx4 a[20:23], v1, s[16:19], s81 offen offset:1024 sc1
    ds_read_b64_tr_b16 a[224:225], v108 offset:32768
    v_mfma_f32_16x16x32_bf16 v[140:143], a[204:207], v[76:79], v[140:143]
    ds_read_b64_tr_b16 a[226:227], v108 offset:36864
    v_mfma_f32_16x16x32_bf16 v[136:139], a[204:207], v[68:71], v[136:139]
    ds_read_b64_tr_b16 a[228:229], v108 offset:40960
    v_mfma_f32_16x16x32_bf16 v[136:139], a[200:203], v[64:67], v[136:139]
    ds_read_b64_tr_b16 a[230:231], v108 offset:45056
    s_waitcnt lgkmcnt(4)
    v_mfma_f32_16x16x32_bf16 v[144:147], a[208:211], v[64:67], v[144:147]
    buffer_load_dwordx4 a[24:27], v28, s[16:19], s81 offen offset:0 sc1
    ds_read_b64_tr_b16 a[232:233], v109 offset:32768
    v_mfma_f32_16x16x32_bf16 v[144:147], a[212:215], v[68:71], v[144:147]
    ds_read_b64_tr_b16 a[234:235], v109 offset:36864
    v_mfma_f32_16x16x32_bf16 v[148:151], a[212:215], v[76:79], v[148:151]
    buffer_load_dwordx4 a[28:31], v28, s[16:19], s81 offen offset:1024 sc1
    ds_read_b64_tr_b16 a[236:237], v109 offset:40960
    v_mfma_f32_16x16x32_bf16 v[148:151], a[208:211], v[72:75], v[148:151]
    ds_read_b64_tr_b16 a[238:239], v109 offset:45056
    v_mfma_f32_16x16x32_bf16 v[156:159], a[216:219], v[72:75], v[156:159]
    ds_read_b64_tr_b16 a[240:241], v110 offset:32768
    s_add_u32 m0, s41, 0
    v_mfma_f32_16x16x32_bf16 v[156:159], a[220:223], v[76:79], v[156:159]
    ds_read_b64_tr_b16 a[242:243], v110 offset:36864
    s_xor_b32 s80, s71, 786432
    v_mfma_f32_16x16x32_bf16 v[152:155], a[220:223], v[68:71], v[152:155]
    buffer_load_dwordx4 v14, s[24:27], s80 offen offset:0 lds
    ds_read_b64_tr_b16 a[244:245], v110 offset:40960
    v_mfma_f32_16x16x32_bf16 v[152:155], a[216:219], v[64:67], v[152:155]
    ds_read_b64_tr_b16 a[246:247], v110 offset:45056
    s_waitcnt lgkmcnt(4)
    v_mfma_f32_16x16x32_bf16 v[160:163], a[224:227], v[64:67], v[160:163]
    buffer_load_dwordx4 v15, s[24:27], s80 offen offset:1024 lds
    ds_read_b64_tr_b16 a[248:249], v111 offset:32768
    v_mfma_f32_16x16x32_bf16 v[160:163], a[228:231], v[68:71], v[160:163]
    ds_read_b64_tr_b16 a[250:251], v111 offset:36864
    v_mfma_f32_16x16x32_bf16 v[164:167], a[228:231], v[76:79], v[164:167]
L1_pc8:
    s_cbranch_execz L1_pgret
    ds_read_b64_tr_b16 a[252:253], v111 offset:40960
    v_mfma_f32_16x16x32_bf16 v[164:167], a[224:227], v[72:75], v[164:167]
    ds_read_b64_tr_b16 a[254:255], v111 offset:45056
    s_barrier
    v_mfma_f32_16x16x32_bf16 v[172:175], a[232:235], v[72:75], v[172:175]
    buffer_load_dwordx4 v16, s[24:27], s80 offen offset:2048 lds
    ds_read_b64_tr_b16 a[192:193], v104 offset:49152
    v_mfma_f32_16x16x32_bf16 v[172:175], a[236:239], v[76:79], v[172:175]
    ds_read_b64_tr_b16 a[194:195], v104 offset:53248
    v_mfma_f32_16x16x32_bf16 v[168:171], a[236:239], v[68:71], v[168:171]
    buffer_load_dwordx4 v17, s[24:27], s80 offen offset:3072 lds
    ds_read_b64_tr_b16 a[200:201], v105 offset:49152
    v_mfma_f32_16x16x32_bf16 v[168:171], a[232:235], v[64:67], v[168:171]
    ds_read_b64_tr_b16 a[202:203], v105 offset:53248
    s_waitcnt lgkmcnt(4)
    v_mfma_f32_16x16x32_bf16 v[176:179], a[240:243], v[64:67], v[176:179]
    ds_read_b64_tr_b16 a[208:209], v106 offset:49152
    v_mfma_f32_16x16x32_bf16 v[176:179], a[244:247], v[68:71], v[176:179]
    ds_read_b64_tr_b16 a[210:211], v106 offset:53248
    v_mfma_f32_16x16x32_bf16 v[180:183], a[244:247], v[76:79], v[180:183]
    ds_read_b64_tr_b16 a[216:217], v107 offset:49152
    v_mfma_f32_16x16x32_bf16 v[180:183], a[240:243], v[72:75], v[180:183]
    ds_read_b64_tr_b16 a[218:219], v107 offset:53248
    v_mfma_f32_16x16x32_bf16 v[188:191], a[248:251], v[72:75], v[188:191]
    ds_read_b64_tr_b16 a[224:225], v108 offset:49152
    v_mfma_f32_16x16x32_bf16 v[188:191], a[252:255], v[76:79], v[188:191]
    ds_read_b64_tr_b16 a[226:227], v108 offset:53248
    v_mfma_f32_16x16x32_bf16 v[184:187], a[252:255], v[68:71], v[184:187]
    ds_read_b64_tr_b16 a[232:233], v109 offset:49152
    v_mfma_f32_16x16x32_bf16 v[184:187], a[248:251], v[64:67], v[184:187]
    ds_read_b64_tr_b16 a[234:235], v109 offset:53248
    s_waitcnt lgkmcnt(8)
    v_mfma_f32_16x16x32_bf16 v[128:131], a[192:195], v[80:83], v[128:131]
    ds_read_b64_tr_b16 a[240:241], v110 offset:49152
    s_xor_b32 s81, s58, 8192
    v_mfma_f32_16x16x32_bf16 v[132:135], a[192:195], v[84:87], v[132:135]
    ds_read_b64_tr_b16 a[242:243], v110 offset:53248
    buffer_load_dwordx4 a[32:35], v1, s[16:19], s81 offen offset:0 sc1
    v_mfma_f32_16x16x32_bf16 v[140:143], a[200:203], v[84:87], v[140:143]
    buffer_load_dwordx4 a[36:39], v1, s[16:19], s81 offen offset:1024 sc1
    ds_read_b64_tr_b16 a[248:249], v111 offset:49152
    v_mfma_f32_16x16x32_bf16 v[136:139], a[200:203], v[80:83], v[136:139]
    ds_read_b64_tr_b16 a[250:251], v111 offset:53248
    s_waitcnt lgkmcnt(8)
    s_waitcnt vmcnt(53)
    s_barrier
    buffer_load_dwordx4 a[40:43], v28, s[16:19], s81 offen offset:0 sc1
    v_mfma_f32_16x16x32_bf16 v[144:147], a[208:211], v[80:83], v[144:147]
    buffer_load_dwordx4 a[44:47], v28, s[16:19], s81 offen offset:1024 sc1
    ds_read_b64_tr_b16 a[192:193], v112 offset:0
    v_mfma_f32_16x16x32_bf16 v[148:151], a[208:211], v[84:87], v[148:151]
    ds_read_b64_tr_b16 a[194:195], v112 offset:4096
    s_xor_b32 s81, s58, 12288
    buffer_load_dwordx4 a[48:51], v1, s[16:19], s81 offen offset:0 sc1
    v_mfma_f32_16x16x32_bf16 v[156:159], a[216:219], v[84:87], v[156:159]
    buffer_load_dwordx4 a[52:55], v1, s[16:19], s81 offen offset:1024 sc1
    ds_read_b64_tr_b16 a[196:197], v112 offset:8192
    v_mfma_f32_16x16x32_bf16 v[152:155], a[216:219], v[80:83], v[152:155]
    ds_read_b64_tr_b16 a[198:199], v112 offset:12288
    s_waitcnt lgkmcnt(8)
    buffer_load_dwordx4 a[56:59], v28, s[16:19], s81 offen offset:0 sc1
    v_mfma_f32_16x16x32_bf16 v[160:163], a[224:227], v[80:83], v[160:163]
    buffer_load_dwordx4 a[60:63], v28, s[16:19], s81 offen offset:1024 sc1
    ds_read_b64_tr_b16 a[200:201], v113 offset:0
    v_mfma_f32_16x16x32_bf16 v[164:167], a[224:227], v[84:87], v[164:167]
    ds_read_b64_tr_b16 a[202:203], v113 offset:4096
    v_mfma_f32_16x16x32_bf16 v[172:175], a[232:235], v[84:87], v[172:175]
    ds_read_b64_tr_b16 a[204:205], v113 offset:8192
    v_mfma_f32_16x16x32_bf16 v[168:171], a[232:235], v[80:83], v[168:171]
    ds_read_b64_tr_b16 a[206:207], v113 offset:12288
    s_waitcnt lgkmcnt(8)
    v_mfma_f32_16x16x32_bf16 v[176:179], a[240:243], v[80:83], v[176:179]
    ds_read_b64_tr_b16 a[208:209], v114 offset:0
    v_mfma_f32_16x16x32_bf16 v[180:183], a[240:243], v[84:87], v[180:183]
    ds_read_b64_tr_b16 a[210:211], v114 offset:4096
    v_mfma_f32_16x16x32_bf16 v[188:191], a[248:251], v[84:87], v[188:191]
    ds_read_b64_tr_b16 a[212:213], v114 offset:8192
    v_mfma_f32_16x16x32_bf16 v[184:187], a[248:251], v[80:83], v[184:187]
    ds_read_b64_tr_b16 a[214:215], v114 offset:12288
    s_waitcnt lgkmcnt(4)
    s_waitcnt vmcnt(21)
    v_mfma_f32_16x16x32_bf16 v[192:195], a[192:195], a[0:3], 0
    ds_read_b64_tr_b16 a[216:217], v115 offset:0
    v_mfma_f32_16x16x32_bf16 v[192:195], a[196:199], a[4:7], v[192:195]
    ds_read_b64_tr_b16 a[218:219], v115 offset:4096
    s_xor_b32 s81, s58, 16384
    v_mfma_f32_16x16x32_bf16 v[196:199], a[196:199], a[12:15], 0
    buffer_load_dwordx4 a[64:67], v1, s[16:19], s81 offen offset:0 sc1
    ds_read_b64_tr_b16 a[220:221], v115 offset:8192
    v_mfma_f32_16x16x32_bf16 v[196:199], a[192:195], a[8:11], v[196:199]
    ds_read_b64_tr_b16 a[222:223], v115 offset:12288
    v_mfma_f32_16x16x32_bf16 v[204:207], a[200:203], a[8:11], 0
    ds_read_b64_tr_b16 a[224:225], v116 offset:0
    v_mfma_f32_16x16x32_bf16 v[204:207], a[204:207], a[12:15], v[204:207]
    ds_read_b64_tr_b16 a[226:227], v116 offset:4096
    v_mfma_f32_16x16x32_bf16 v[200:203], a[204:207], a[4:7], 0
    ds_read_b64_tr_b16 a[228:229], v116 offset:8192
    v_mfma_f32_16x16x32_bf16 v[200:203], a[200:203], a[0:3], v[200:203]
    ds_read_b64_tr_b16 a[230:231], v116 offset:12288
    s_waitcnt lgkmcnt(4)
    v_mfma_f32_16x16x32_bf16 v[208:211], a[208:211], a[0:3], 0
    buffer_load_dwordx4 a[68:71], v1, s[16:19], s81 offen offset:1024 sc1
    ds_read_b64_tr_b16 a[232:233], v117 offset:0
    v_mfma_f32_16x16x32_bf16 v[208:211], a[212:215], a[4:7], v[208:211]
    ds_read_b64_tr_b16 a[234:235], v117 offset:4096
    v_mfma_f32_16x16x32_bf16 v[212:215], a[212:215], a[12:15], 0
    ds_read_b64_tr_b16 a[236:237], v117 offset:8192
    v_mfma_f32_16x16x32_bf16 v[212:215], a[208:211], a[8:11], v[212:215]
    ds_read_b64_tr_b16 a[238:239], v117 offset:12288
    v_mfma_f32_16x16x32_bf16 v[220:223], a[216:219], a[8:11], 0
    ds_read_b64_tr_b16 a[240:241], v118 offset:0
    v_mfma_f32_16x16x32_bf16 v[220:223], a[220:223], a[12:15], v[220:223]
    ds_read_b64_tr_b16 a[242:243], v118 offset:4096
    v_mfma_f32_16x16x32_bf16 v[216:219], a[220:223], a[4:7], 0
    ds_read_b64_tr_b16 a[244:245], v118 offset:8192
    v_mfma_f32_16x16x32_bf16 v[216:219], a[216:219], a[0:3], v[216:219]
    ds_read_b64_tr_b16 a[246:247], v118 offset:12288
    s_waitcnt lgkmcnt(4)
    v_mfma_f32_16x16x32_bf16 v[224:227], a[224:227], a[0:3], 0
    buffer_load_dwordx4 a[72:75], v28, s[16:19], s81 offen offset:0 sc1
    ds_read_b64_tr_b16 a[248:249], v119 offset:0
    v_mfma_f32_16x16x32_bf16 v[224:227], a[228:231], a[4:7], v[224:227]
    ds_read_b64_tr_b16 a[250:251], v119 offset:4096
    v_mfma_f32_16x16x32_bf16 v[228:231], a[228:231], a[12:15], 0
    ds_read_b64_tr_b16 a[252:253], v119 offset:8192
    s_waitcnt vmcnt(58)
    v_mfma_f32_16x16x32_bf16 v[228:231], a[224:227], a[8:11], v[228:231]
    ds_read_b64_tr_b16 a[254:255], v119 offset:12288
    s_barrier
    v_mfma_f32_16x16x32_bf16 v[236:239], a[232:235], a[8:11], 0
    ds_read_b64_tr_b16 a[192:193], v112 offset:16384
    v_mfma_f32_16x16x32_bf16 v[236:239], a[236:239], a[12:15], v[236:239]
    ds_read_b64_tr_b16 a[194:195], v112 offset:20480
    v_mfma_f32_16x16x32_bf16 v[232:235], a[236:239], a[4:7], 0
    buffer_load_dwordx4 a[76:79], v28, s[16:19], s81 offen offset:1024 sc1
    ds_read_b64_tr_b16 a[196:197], v112 offset:24576
    v_mfma_f32_16x16x32_bf16 v[232:235], a[232:235], a[0:3], v[232:235]
    ds_read_b64_tr_b16 a[198:199], v112 offset:28672
    s_waitcnt lgkmcnt(4)
    v_mfma_f32_16x16x32_bf16 v[240:243], a[240:243], a[0:3], 0
    ds_read_b64_tr_b16 a[200:201], v113 offset:16384
    v_mfma_f32_16x16x32_bf16 v[240:243], a[244:247], a[4:7], v[240:243]
    ds_read_b64_tr_b16 a[202:203], v113 offset:20480
    v_mfma_f32_16x16x32_bf16 v[244:247], a[244:247], a[12:15], 0
    ds_read_b64_tr_b16 a[204:205], v113 offset:24576
    v_mfma_f32_16x16x32_bf16 v[244:247], a[240:243], a[8:11], v[244:247]
    ds_read_b64_tr_b16 a[206:207], v113 offset:28672
    v_mfma_f32_16x16x32_bf16 v[252:255], a[248:251], a[8:11], 0
    ds_read_b64_tr_b16 a[208:209], v114 offset:16384
    v_mfma_f32_16x16x32_bf16 v[252:255], a[252:255], a[12:15], v[252:255]
    ds_read_b64_tr_b16 a[210:211], v114 offset:20480
    v_mfma_f32_16x16x32_bf16 v[248:251], a[252:255], a[4:7], 0
    ds_read_b64_tr_b16 a[212:213], v114 offset:24576
    v_mfma_f32_16x16x32_bf16 v[248:251], a[248:251], a[0:3], v[248:251]
    ds_read_b64_tr_b16 a[214:215], v114 offset:28672
    s_waitcnt lgkmcnt(4)
    s_waitcnt vmcnt(16)
    v_mfma_f32_16x16x32_bf16 v[192:195], a[192:195], a[16:19], v[192:195]
    ds_read_b64_tr_b16 a[216:217], v115 offset:16384
    v_mfma_f32_16x16x32_bf16 v[192:195], a[196:199], a[20:23], v[192:195]
    ds_read_b64_tr_b16 a[218:219], v115 offset:20480
    s_xor_b32 s81, s58, 20480
    v_mfma_f32_16x16x32_bf16 v[196:199], a[196:199], a[28:31], v[196:199]
    buffer_load_dwordx4 a[80:83], v1, s[16:19], s81 offen offset:0 sc1
    ds_read_b64_tr_b16 a[220:221], v115 offset:24576
    v_mfma_f32_16x16x32_bf16 v[196:199], a[192:195], a[24:27], v[196:199]
    ds_read_b64_tr_b16 a[222:223], v115 offset:28672
    v_mfma_f32_16x16x32_bf16 v[204:207], a[200:203], a[24:27], v[204:207]
    ds_read_b64_tr_b16 a[224:225], v116 offset:16384
    v_cvt_pk_bf16_f32 v128, v128, v129
    v_mfma_f32_16x16x32_bf16 v[204:207], a[204:207], a[28:31], v[204:207]
    ds_read_b64_tr_b16 a[226:227], v116 offset:20480
    v_cvt_pk_bf16_f32 v129, v130, v131
    v_mfma_f32_16x16x32_bf16 v[200:203], a[204:207], a[20:23], v[200:203]
    buffer_load_dwordx4 a[84:87], v1, s[16:19], s81 offen offset:1024 sc1
    ds_read_b64_tr_b16 a[228:229], v116 offset:24576
    v_mfma_f32_16x16x32_bf16 v[200:203], a[200:203], a[16:19], v[200:203]
    ds_read_b64_tr_b16 a[230:231], v116 offset:28672
    s_waitcnt lgkmcnt(4)
    v_mfma_f32_16x16x32_bf16 v[208:211], a[208:211], a[16:19], v[208:211]
    ds_read_b64_tr_b16 a[232:233], v117 offset:16384
    v_cvt_pk_bf16_f32 v130, v136, v137
    v_mfma_f32_16x16x32_bf16 v[208:211], a[212:215], a[20:23], v[208:211]
    ds_read_b64_tr_b16 a[234:235], v117 offset:20480
    v_cvt_pk_bf16_f32 v131, v138, v139
    v_mfma_f32_16x16x32_bf16 v[212:215], a[212:215], a[28:31], v[212:215]
    buffer_store_dwordx4 v[128:131], v1, s[84:87], s88 offen offset:0 sc1
    ds_read_b64_tr_b16 a[236:237], v117 offset:24576
    v_mfma_f32_16x16x32_bf16 v[212:215], a[208:211], a[24:27], v[212:215]
    buffer_load_dwordx4 a[88:91], v28, s[16:19], s81 offen offset:0 sc1
    ds_read_b64_tr_b16 a[238:239], v117 offset:28672
    v_mfma_f32_16x16x32_bf16 v[220:223], a[216:219], a[24:27], v[220:223]
    ds_read_b64_tr_b16 a[240:241], v118 offset:16384
    v_mfma_f32_16x16x32_bf16 v[220:223], a[220:223], a[28:31], v[220:223]
    ds_read_b64_tr_b16 a[242:243], v118 offset:20480
    v_mfma_f32_16x16x32_bf16 v[216:219], a[220:223], a[20:23], v[216:219]
    ds_read_b64_tr_b16 a[244:245], v118 offset:24576
    v_mfma_f32_16x16x32_bf16 v[216:219], a[216:219], a[16:19], v[216:219]
    ds_read_b64_tr_b16 a[246:247], v118 offset:28672
    s_waitcnt lgkmcnt(4)
    v_mfma_f32_16x16x32_bf16 v[224:227], a[224:227], a[16:19], v[224:227]
    buffer_load_dwordx4 a[92:95], v28, s[16:19], s81 offen offset:1024 sc1
    ds_read_b64_tr_b16 a[248:249], v119 offset:16384
    v_mfma_f32_16x16x32_bf16 v[224:227], a[228:231], a[20:23], v[224:227]
    ds_read_b64_tr_b16 a[250:251], v119 offset:20480
    v_mfma_f32_16x16x32_bf16 v[228:231], a[228:231], a[28:31], v[228:231]
    ds_read_b64_tr_b16 a[252:253], v119 offset:24576
    s_waitcnt vmcnt(43)
    v_mfma_f32_16x16x32_bf16 v[228:231], a[224:227], a[24:27], v[228:231]
    ds_read_b64_tr_b16 a[254:255], v119 offset:28672
    s_barrier
    v_mfma_f32_16x16x32_bf16 v[236:239], a[232:235], a[24:27], v[236:239]
    ds_read_b64_tr_b16 a[192:193], v112 offset:32768
    v_cvt_pk_bf16_f32 v132, v132, v133
    v_mfma_f32_16x16x32_bf16 v[236:239], a[236:239], a[28:31], v[236:239]
    ds_read_b64_tr_b16 a[194:195], v112 offset:36864
    s_mov_b64 exec, 255
    buffer_load_dword v22, v29, s[84:87], 0 offen offset:128 sc1
    s_mov_b64 exec, -1
    v_mfma_f32_16x16x32_bf16 v[232:235], a[236:239], a[20:23], v[232:235]
    ds_read_b64_tr_b16 a[196:197], v112 offset:40960
    v_cvt_pk_bf16_f32 v133, v134, v135
    v_mfma_f32_16x16x32_bf16 v[232:235], a[232:235], a[16:19], v[232:235]
    ds_read_b64_tr_b16 a[198:199], v112 offset:45056
    s_waitcnt lgkmcnt(4)
    v_mfma_f32_16x16x32_bf16 v[240:243], a[240:243], a[16:19], v[240:243]
    ds_read_b64_tr_b16 a[200:201], v113 offset:32768
    v_cvt_pk_bf16_f32 v134, v140, v141
    v_mfma_f32_16x16x32_bf16 v[240:243], a[244:247], a[20:23], v[240:243]
    ds_read_b64_tr_b16 a[202:203], v113 offset:36864
    v_cvt_pk_bf16_f32 v135, v142, v143
    v_mfma_f32_16x16x32_bf16 v[244:247], a[244:247], a[28:31], v[244:247]
    buffer_store_dwordx4 v[132:135], v1, s[84:87], s88 offen offset:1024 sc1
    ds_read_b64_tr_b16 a[204:205], v113 offset:40960
    v_mfma_f32_16x16x32_bf16 v[244:247], a[240:243], a[24:27], v[244:247]
    ds_read_b64_tr_b16 a[206:207], v113 offset:45056
    v_mfma_f32_16x16x32_bf16 v[252:255], a[248:251], a[24:27], v[252:255]
    ds_read_b64_tr_b16 a[208:209], v114 offset:32768
    v_mfma_f32_16x16x32_bf16 v[252:255], a[252:255], a[28:31], v[252:255]
    ds_read_b64_tr_b16 a[210:211], v114 offset:36864
    v_mfma_f32_16x16x32_bf16 v[248:251], a[252:255], a[20:23], v[248:251]
    ds_read_b64_tr_b16 a[212:213], v114 offset:40960
    v_mfma_f32_16x16x32_bf16 v[248:251], a[248:251], a[16:19], v[248:251]
    ds_read_b64_tr_b16 a[214:215], v114 offset:45056
    s_waitcnt lgkmcnt(4)
    s_waitcnt vmcnt(15)
    v_mfma_f32_16x16x32_bf16 v[192:195], a[192:195], a[32:35], v[192:195]
    ds_read_b64_tr_b16 a[216:217], v115 offset:32768
    v_mfma_f32_16x16x32_bf16 v[192:195], a[196:199], a[36:39], v[192:195]
    ds_read_b64_tr_b16 a[218:219], v115 offset:36864
    s_xor_b32 s81, s58, 24576
    v_mfma_f32_16x16x32_bf16 v[196:199], a[196:199], a[44:47], v[196:199]
    buffer_load_dwordx4 a[96:99], v1, s[16:19], s81 offen offset:0 sc1
    ds_read_b64_tr_b16 a[220:221], v115 offset:40960
    v_mfma_f32_16x16x32_bf16 v[196:199], a[192:195], a[40:43], v[196:199]
    ds_read_b64_tr_b16 a[222:223], v115 offset:45056
    v_mfma_f32_16x16x32_bf16 v[204:207], a[200:203], a[40:43], v[204:207]
    ds_read_b64_tr_b16 a[224:225], v116 offset:32768
    v_cvt_pk_bf16_f32 v144, v144, v145
    v_mfma_f32_16x16x32_bf16 v[204:207], a[204:207], a[44:47], v[204:207]
    ds_read_b64_tr_b16 a[226:227], v116 offset:36864
    v_cvt_pk_bf16_f32 v145, v146, v147
    v_mfma_f32_16x16x32_bf16 v[200:203], a[204:207], a[36:39], v[200:203]
    ds_read_b64_tr_b16 a[228:229], v116 offset:40960
    v_cvt_pk_bf16_f32 v146, v152, v153
    v_mfma_f32_16x16x32_bf16 v[200:203], a[200:203], a[32:35], v[200:203]
    ds_read_b64_tr_b16 a[230:231], v116 offset:45056
    s_waitcnt lgkmcnt(4)
    v_mfma_f32_16x16x32_bf16 v[208:211], a[208:211], a[32:35], v[208:211]
    ds_read_b64_tr_b16 a[232:233], v117 offset:32768
    v_cvt_pk_bf16_f32 v147, v154, v155
    buffer_store_dwordx4 v[144:147], v1, s[84:87], s89 offen offset:0 sc1
    v_mfma_f32_16x16x32_bf16 v[208:211], a[212:215], a[36:39], v[208:211]
    buffer_load_dwordx4 a[100:103], v1, s[16:19], s81 offen offset:1024 sc1
    ds_read_b64_tr_b16 a[234:235], v117 offset:36864
    v_mfma_f32_16x16x32_bf16 v[212:215], a[212:215], a[44:47], v[212:215]
    ds_read_b64_tr_b16 a[236:237], v117 offset:40960
    v_mfma_f32_16x16x32_bf16 v[212:215], a[208:211], a[40:43], v[212:215]
    ds_read_b64_tr_b16 a[238:239], v117 offset:45056
    v_mfma_f32_16x16x32_bf16 v[220:223], a[216:219], a[40:43], v[220:223]
    ds_read_b64_tr_b16 a[240:241], v118 offset:32768
    v_mfma_f32_16x16x32_bf16 v[220:223], a[220:223], a[44:47], v[220:223]
    ds_read_b64_tr_b16 a[242:243], v118 offset:36864
    v_mfma_f32_16x16x32_bf16 v[216:219], a[220:223], a[36:39], v[216:219]
    ds_read_b64_tr_b16 a[244:245], v118 offset:40960
    v_mfma_f32_16x16x32_bf16 v[216:219], a[216:219], a[32:35], v[216:219]
    ds_read_b64_tr_b16 a[246:247], v118 offset:45056
    s_waitcnt lgkmcnt(4)
    v_mfma_f32_16x16x32_bf16 v[224:227], a[224:227], a[32:35], v[224:227]
    buffer_load_dwordx4 a[104:107], v28, s[16:19], s81 offen offset:0 sc1
    ds_read_b64_tr_b16 a[248:249], v119 offset:32768
    v_mfma_f32_16x16x32_bf16 v[224:227], a[228:231], a[36:39], v[224:227]
    ds_read_b64_tr_b16 a[250:251], v119 offset:36864
    v_mfma_f32_16x16x32_bf16 v[228:231], a[228:231], a[44:47], v[228:231]
    ds_read_b64_tr_b16 a[252:253], v119 offset:40960
    s_waitcnt vmcnt(45)
    v_mfma_f32_16x16x32_bf16 v[228:231], a[224:227], a[40:43], v[228:231]
    ds_read_b64_tr_b16 a[254:255], v119 offset:45056
    v_cvt_pk_bf16_f32 v148, v148, v149
    s_barrier
    v_mfma_f32_16x16x32_bf16 v[236:239], a[232:235], a[40:43], v[236:239]
    ds_read_b64_tr_b16 a[192:193], v112 offset:49152
    v_cvt_pk_bf16_f32 v149, v150, v151
    v_mfma_f32_16x16x32_bf16 v[236:239], a[236:239], a[44:47], v[236:239]
    ds_read_b64_tr_b16 a[194:195], v112 offset:53248
    v_cvt_pk_bf16_f32 v150, v156, v157
    v_mfma_f32_16x16x32_bf16 v[232:235], a[236:239], a[36:39], v[232:235]
    ds_read_b64_tr_b16 a[196:197], v112 offset:57344
    v_cvt_pk_bf16_f32 v151, v158, v159
    buffer_store_dwordx4 v[148:151], v1, s[84:87], s89 offen offset:1024 sc1
    v_mfma_f32_16x16x32_bf16 v[232:235], a[232:235], a[32:35], v[232:235]
    buffer_load_dwordx4 a[108:111], v28, s[16:19], s81 offen offset:1024 sc1
    ds_read_b64_tr_b16 a[198:199], v112 offset:61440
    s_waitcnt lgkmcnt(4)
    v_mfma_f32_16x16x32_bf16 v[240:243], a[240:243], a[32:35], v[240:243]
    ds_read_b64_tr_b16 a[200:201], v113 offset:49152
    v_mfma_f32_16x16x32_bf16 v[240:243], a[244:247], a[36:39], v[240:243]
    ds_read_b64_tr_b16 a[202:203], v113 offset:53248
    v_mfma_f32_16x16x32_bf16 v[244:247], a[244:247], a[44:47], v[244:247]
    ds_read_b64_tr_b16 a[204:205], v113 offset:57344
    v_mfma_f32_16x16x32_bf16 v[244:247], a[240:243], a[40:43], v[244:247]
    ds_read_b64_tr_b16 a[206:207], v113 offset:61440
    v_mfma_f32_16x16x32_bf16 v[252:255], a[248:251], a[40:43], v[252:255]
    ds_read_b64_tr_b16 a[208:209], v114 offset:49152
    v_mfma_f32_16x16x32_bf16 v[252:255], a[252:255], a[44:47], v[252:255]
    ds_read_b64_tr_b16 a[210:211], v114 offset:53248
    v_mfma_f32_16x16x32_bf16 v[248:251], a[252:255], a[36:39], v[248:251]
    ds_read_b64_tr_b16 a[212:213], v114 offset:57344
    v_mfma_f32_16x16x32_bf16 v[248:251], a[248:251], a[32:35], v[248:251]
    ds_read_b64_tr_b16 a[214:215], v114 offset:61440
    s_waitcnt lgkmcnt(4)
    s_waitcnt vmcnt(17)
    v_mfma_f32_16x16x32_bf16 v[192:195], a[192:195], a[48:51], v[192:195]
    ds_read_b64_tr_b16 a[216:217], v115 offset:49152
    s_xor_b32 s81, s58, 28672
    v_mfma_f32_16x16x32_bf16 v[192:195], a[196:199], a[52:55], v[192:195]
    ds_read_b64_tr_b16 a[218:219], v115 offset:53248
    v_cvt_pk_bf16_f32 v160, v160, v161
    v_mfma_f32_16x16x32_bf16 v[196:199], a[196:199], a[60:63], v[196:199]
    buffer_load_dwordx4 a[112:115], v1, s[16:19], s81 offen offset:0 sc1
    ds_read_b64_tr_b16 a[220:221], v115 offset:57344
    v_cvt_pk_bf16_f32 v161, v162, v163
    v_mfma_f32_16x16x32_bf16 v[196:199], a[192:195], a[56:59], v[196:199]
    ds_read_b64_tr_b16 a[222:223], v115 offset:61440
    v_cvt_pk_bf16_f32 v162, v168, v169
    v_mfma_f32_16x16x32_bf16 v[204:207], a[200:203], a[56:59], v[204:207]
    ds_read_b64_tr_b16 a[224:225], v116 offset:49152
    v_cvt_pk_bf16_f32 v163, v170, v171
    v_mfma_f32_16x16x32_bf16 v[204:207], a[204:207], a[60:63], v[204:207]
    buffer_store_dwordx4 v[160:163], v1, s[84:87], s90 offen offset:0 sc1
    ds_read_b64_tr_b16 a[226:227], v116 offset:53248
    v_mfma_f32_16x16x32_bf16 v[200:203], a[204:207], a[52:55], v[200:203]
    ds_read_b64_tr_b16 a[228:229], v116 offset:57344
    v_mfma_f32_16x16x32_bf16 v[200:203], a[200:203], a[48:51], v[200:203]
    ds_read_b64_tr_b16 a[230:231], v116 offset:61440
    s_waitcnt lgkmcnt(4)
    v_mfma_f32_16x16x32_bf16 v[208:211], a[208:211], a[48:51], v[208:211]
    buffer_load_dwordx4 a[116:119], v1, s[16:19], s81 offen offset:1024 sc1
    ds_read_b64_tr_b16 a[232:233], v117 offset:49152
    v_mfma_f32_16x16x32_bf16 v[208:211], a[212:215], a[52:55], v[208:211]
    ds_read_b64_tr_b16 a[234:235], v117 offset:53248
    v_mfma_f32_16x16x32_bf16 v[212:215], a[212:215], a[60:63], v[212:215]
    ds_read_b64_tr_b16 a[236:237], v117 offset:57344
    v_mfma_f32_16x16x32_bf16 v[212:215], a[208:211], a[56:59], v[212:215]
    ds_read_b64_tr_b16 a[238:239], v117 offset:61440
    v_mfma_f32_16x16x32_bf16 v[220:223], a[216:219], a[56:59], v[220:223]
    ds_read_b64_tr_b16 a[240:241], v118 offset:49152
    v_mfma_f32_16x16x32_bf16 v[220:223], a[220:223], a[60:63], v[220:223]
    ds_read_b64_tr_b16 a[242:243], v118 offset:53248
    v_mfma_f32_16x16x32_bf16 v[216:219], a[220:223], a[52:55], v[216:219]
    ds_read_b64_tr_b16 a[244:245], v118 offset:57344
    v_mfma_f32_16x16x32_bf16 v[216:219], a[216:219], a[48:51], v[216:219]
    ds_read_b64_tr_b16 a[246:247], v118 offset:61440
    s_waitcnt lgkmcnt(4)
    v_mfma_f32_16x16x32_bf16 v[224:227], a[224:227], a[48:51], v[224:227]
    buffer_load_dwordx4 a[120:123], v28, s[16:19], s81 offen offset:0 sc1
    ds_read_b64_tr_b16 a[248:249], v119 offset:49152
    v_cvt_pk_bf16_f32 v164, v164, v165
    v_mfma_f32_16x16x32_bf16 v[224:227], a[228:231], a[52:55], v[224:227]
    ds_read_b64_tr_b16 a[250:251], v119 offset:53248
    v_cvt_pk_bf16_f32 v165, v166, v167
    v_mfma_f32_16x16x32_bf16 v[228:231], a[228:231], a[60:63], v[228:231]
    ds_read_b64_tr_b16 a[252:253], v119 offset:57344
    v_cvt_pk_bf16_f32 v166, v172, v173
    v_mfma_f32_16x16x32_bf16 v[228:231], a[224:227], a[56:59], v[228:231]
    ds_read_b64_tr_b16 a[254:255], v119 offset:61440
    v_cvt_pk_bf16_f32 v167, v174, v175
    buffer_store_dwordx4 v[164:167], v1, s[84:87], s90 offen offset:1024 sc1
    s_waitcnt vmcnt(47)
    s_barrier
    v_mfma_f32_16x16x32_bf16 v[236:239], a[232:235], a[56:59], v[236:239]
    ds_read_b64_tr_b16 a[192:193], v96 offset:0
    v_mfma_f32_16x16x32_bf16 v[236:239], a[236:239], a[60:63], v[236:239]
    ds_read_b64_tr_b16 a[194:195], v96 offset:4096
    v_mfma_f32_16x16x32_bf16 v[232:235], a[236:239], a[52:55], v[232:235]
    buffer_load_dwordx4 a[124:127], v28, s[16:19], s81 offen offset:1024 sc1
    ds_read_b64_tr_b16 a[196:197], v96 offset:8192
    v_mfma_f32_16x16x32_bf16 v[232:235], a[232:235], a[48:51], v[232:235]
    ds_read_b64_tr_b16 a[198:199], v96 offset:12288
    s_waitcnt lgkmcnt(4)
    v_mfma_f32_16x16x32_bf16 v[240:243], a[240:243], a[48:51], v[240:243]
    ds_read_b64_tr_b16 a[200:201], v97 offset:0
    v_mfma_f32_16x16x32_bf16 v[240:243], a[244:247], a[52:55], v[240:243]
    ds_read_b64_tr_b16 a[202:203], v97 offset:4096
    v_mfma_f32_16x16x32_bf16 v[244:247], a[244:247], a[60:63], v[244:247]
    ds_read_b64_tr_b16 a[204:205], v97 offset:8192
    v_mfma_f32_16x16x32_bf16 v[244:247], a[240:243], a[56:59], v[244:247]
    ds_read_b64_tr_b16 a[206:207], v97 offset:12288
    v_mfma_f32_16x16x32_bf16 v[252:255], a[248:251], a[56:59], v[252:255]
    ds_read_b64_tr_b16 a[208:209], v98 offset:0
    v_mfma_f32_16x16x32_bf16 v[252:255], a[252:255], a[60:63], v[252:255]
    ds_read_b64_tr_b16 a[210:211], v98 offset:4096
    v_mfma_f32_16x16x32_bf16 v[248:251], a[252:255], a[52:55], v[248:251]
    ds_read_b64_tr_b16 a[212:213], v98 offset:8192
    s_add_u32 s88, s88, 24576
    v_mfma_f32_16x16x32_bf16 v[248:251], a[248:251], a[48:51], v[248:251]
    ds_read_b64_tr_b16 a[214:215], v98 offset:12288
    s_waitcnt lgkmcnt(4)
    s_waitcnt vmcnt(19)
    v_mfma_f32_16x16x32_bf16 v[192:195], a[192:195], a[64:67], v[192:195]
    ds_read_b64_tr_b16 a[216:217], v99 offset:0
    s_add_u32 s89, s89, 24576
    v_mfma_f32_16x16x32_bf16 v[192:195], a[196:199], a[68:71], v[192:195]
    ds_read_b64_tr_b16 a[218:219], v99 offset:4096
    s_add_u32 s90, s90, 24576
    s_add_u32 m0, s41, 16384
    s_xor_b32 s80, s71, 917504
    v_mfma_f32_16x16x32_bf16 v[196:199], a[196:199], a[76:79], v[196:199]
    buffer_load_dwordx4 v14, s[24:27], s80 offen offset:0 lds
    ds_read_b64_tr_b16 a[220:221], v99 offset:8192
    v_mfma_f32_16x16x32_bf16 v[196:199], a[192:195], a[72:75], v[196:199]
    ds_read_b64_tr_b16 a[222:223], v99 offset:12288
    v_mfma_f32_16x16x32_bf16 v[204:207], a[200:203], a[72:75], v[204:207]
    buffer_load_dwordx4 v15, s[24:27], s80 offen offset:1024 lds
    ds_read_b64_tr_b16 a[224:225], v100 offset:0
    v_mfma_f32_16x16x32_bf16 v[204:207], a[204:207], a[76:79], v[204:207]
    ds_read_b64_tr_b16 a[226:227], v100 offset:4096
    v_mfma_f32_16x16x32_bf16 v[200:203], a[204:207], a[68:71], v[200:203]
    ds_read_b64_tr_b16 a[228:229], v100 offset:8192
    v_mfma_f32_16x16x32_bf16 v[200:203], a[200:203], a[64:67], v[200:203]
    ds_read_b64_tr_b16 a[230:231], v100 offset:12288
    s_waitcnt lgkmcnt(4)
    v_mfma_f32_16x16x32_bf16 v[208:211], a[208:211], a[64:67], v[208:211]
    buffer_load_dwordx4 v16, s[24:27], s80 offen offset:2048 lds
    ds_read_b64_tr_b16 a[232:233], v101 offset:0
    v_mfma_f32_16x16x32_bf16 v[208:211], a[212:215], a[68:71], v[208:211]
    ds_read_b64_tr_b16 a[234:235], v101 offset:4096
    v_mfma_f32_16x16x32_bf16 v[212:215], a[212:215], a[76:79], v[212:215]
    buffer_load_dwordx4 v17, s[24:27], s80 offen offset:3072 lds
    ds_read_b64_tr_b16 a[236:237], v101 offset:8192
    v_mfma_f32_16x16x32_bf16 v[212:215], a[208:211], a[72:75], v[212:215]
    ds_read_b64_tr_b16 a[238:239], v101 offset:12288
    v_mfma_f32_16x16x32_bf16 v[220:223], a[216:219], a[72:75], v[220:223]
    ds_read_b64_tr_b16 a[240:241], v102 offset:0
    s_add_u32 m0, s41, 32768
    v_mfma_f32_16x16x32_bf16 v[220:223], a[220:223], a[76:79], v[220:223]
    ds_read_b64_tr_b16 a[242:243], v102 offset:4096
    s_xor_b32 s80, s71, 65536
    v_mfma_f32_16x16x32_bf16 v[216:219], a[220:223], a[68:71], v[216:219]
    buffer_load_dwordx4 v14, s[24:27], s80 offen offset:0 lds
    ds_read_b64_tr_b16 a[244:245], v102 offset:8192
    v_mfma_f32_16x16x32_bf16 v[216:219], a[216:219], a[64:67], v[216:219]
    ds_read_b64_tr_b16 a[246:247], v102 offset:12288
    s_waitcnt lgkmcnt(4)
    v_mfma_f32_16x16x32_bf16 v[224:227], a[224:227], a[64:67], v[224:227]
    buffer_load_dwordx4 v15, s[24:27], s80 offen offset:1024 lds
    ds_read_b64_tr_b16 a[248:249], v103 offset:0
    v_mfma_f32_16x16x32_bf16 v[224:227], a[228:231], a[68:71], v[224:227]
    ds_read_b64_tr_b16 a[250:251], v103 offset:4096
    v_mfma_f32_16x16x32_bf16 v[228:231], a[228:231], a[76:79], v[228:231]
    ds_read_b64_tr_b16 a[252:253], v103 offset:8192
    s_waitcnt vmcnt(46)
    v_mfma_f32_16x16x32_bf16 v[228:231], a[224:227], a[72:75], v[228:231]
    ds_read_b64_tr_b16 a[254:255], v103 offset:12288
    s_barrier
    v_mfma_f32_16x16x32_bf16 v[236:239], a[232:235], a[72:75], v[236:239]
    buffer_load_dwordx4 v16, s[24:27], s80 offen offset:2048 lds
    ds_read_b64_tr_b16 a[192:193], v96 offset:16384
    v_mfma_f32_16x16x32_bf16 v[236:239], a[236:239], a[76:79], v[236:239]
    ds_read_b64_tr_b16 a[194:195], v96 offset:20480
    v_mfma_f32_16x16x32_bf16 v[232:235], a[236:239], a[68:71], v[232:235]
    buffer_load_dwordx4 v17, s[24:27], s80 offen offset:3072 lds
    ds_read_b64_tr_b16 a[196:197], v96 offset:24576
    v_mfma_f32_16x16x32_bf16 v[232:235], a[232:235], a[64:67], v[232:235]
    ds_read_b64_tr_b16 a[198:199], v96 offset:28672
    s_waitcnt lgkmcnt(4)
    v_mfma_f32_16x16x32_bf16 v[240:243], a[240:243], a[64:67], v[240:243]
    ds_read_b64_tr_b16 a[200:201], v97 offset:16384
    v_mfma_f32_16x16x32_bf16 v[240:243], a[244:247], a[68:71], v[240:243]
    ds_read_b64_tr_b16 a[202:203], v97 offset:20480
    v_mfma_f32_16x16x32_bf16 v[244:247], a[244:247], a[76:79], v[244:247]
    ds_read_b64_tr_b16 a[204:205], v97 offset:24576
    v_mfma_f32_16x16x32_bf16 v[244:247], a[240:243], a[72:75], v[244:247]
    ds_read_b64_tr_b16 a[206:207], v97 offset:28672
    v_mfma_f32_16x16x32_bf16 v[252:255], a[248:251], a[72:75], v[252:255]
    ds_read_b64_tr_b16 a[208:209], v98 offset:16384
    v_mfma_f32_16x16x32_bf16 v[252:255], a[252:255], a[76:79], v[252:255]
    ds_read_b64_tr_b16 a[210:211], v98 offset:20480
    v_mfma_f32_16x16x32_bf16 v[248:251], a[252:255], a[68:71], v[248:251]
    ds_read_b64_tr_b16 a[212:213], v98 offset:24576
    v_mfma_f32_16x16x32_bf16 v[248:251], a[248:251], a[64:67], v[248:251]
    ds_read_b64_tr_b16 a[214:215], v98 offset:28672
    s_waitcnt lgkmcnt(4)
    s_waitcnt vmcnt(22)
    v_mfma_f32_16x16x32_bf16 v[192:195], a[192:195], a[80:83], v[192:195]
    ds_read_b64_tr_b16 a[216:217], v99 offset:16384
    s_waitcnt vmcnt(21)
    v_mfma_f32_16x16x32_bf16 v[192:195], a[196:199], a[84:87], v[192:195]
    ds_read_b64_tr_b16 a[218:219], v99 offset:20480
    v_cmp_ne_u32 vcc, 0x3f803f80, v22
    s_nop 0
    s_and_b32 s3, vcc_lo, 255
    s_cbranch_scc1 L1_pb_spin
L1_pb_ok:
    s_xor_b32 s81, s58, 2048
    v_mfma_f32_16x16x32_bf16 v[196:199], a[196:199], a[92:95], v[196:199]
    buffer_load_dwordx4 a[128:131], v1, s[16:19], s81 offen offset:0 sc1
    ds_read_b64_tr_b16 a[220:221], v99 offset:24576
    v_mfma_f32_16x16x32_bf16 v[196:199], a[192:195], a[88:91], v[196:199]
    ds_read_b64_tr_b16 a[222:223], v99 offset:28672
    v_mfma_f32_16x16x32_bf16 v[204:207], a[200:203], a[88:91], v[204:207]
    buffer_load_dwordx4 a[132:135], v1, s[16:19], s81 offen offset:1024 sc1
    ds_read_b64_tr_b16 a[224:225], v100 offset:16384
    v_mfma_f32_16x16x32_bf16 v[204:207], a[204:207], a[92:95], v[204:207]
    ds_read_b64_tr_b16 a[226:227], v100 offset:20480
    v_mfma_f32_16x16x32_bf16 v[200:203], a[204:207], a[84:87], v[200:203]
    ds_read_b64_tr_b16 a[228:229], v100 offset:24576
    v_mfma_f32_16x16x32_bf16 v[200:203], a[200:203], a[80:83], v[200:203]
    ds_read_b64_tr_b16 a[230:231], v100 offset:28672
    s_waitcnt lgkmcnt(4)
    v_mfma_f32_16x16x32_bf16 v[208:211], a[208:211], a[80:83], v[208:211]
    buffer_load_dwordx4 a[136:139], v28, s[16:19], s81 offen offset:0 sc1
    ds_read_b64_tr_b16 a[232:233], v101 offset:16384
    v_mfma_f32_16x16x32_bf16 v[208:211], a[212:215], a[84:87], v[208:211]
    ds_read_b64_tr_b16 a[234:235], v101 offset:20480
    v_mfma_f32_16x16x32_bf16 v[212:215], a[212:215], a[92:95], v[212:215]
    buffer_load_dwordx4 a[140:143], v28, s[16:19], s81 offen offset:1024 sc1
L1_pc9:
    s_cbranch_execz L1_pgret
    ds_read_b64_tr_b16 a[236:237], v101 offset:24576
    v_mfma_f32_16x16x32_bf16 v[212:215], a[208:211], a[88:91], v[212:215]
    ds_read_b64_tr_b16 a[238:239], v101 offset:28672
    v_mfma_f32_16x16x32_bf16 v[220:223], a[216:219], a[88:91], v[220:223]
    ds_read_b64_tr_b16 a[240:241], v102 offset:16384
    v_mfma_f32_16x16x32_bf16 v[220:223], a[220:223], a[92:95], v[220:223]
    ds_read_b64_tr_b16 a[242:243], v102 offset:20480
    s_xor_b32 s81, s58, 6144
    v_mfma_f32_16x16x32_bf16 v[216:219], a[220:223], a[84:87], v[216:219]
    buffer_load_dwordx4 a[144:147], v1, s[16:19], s81 offen offset:0 sc1
    ds_read_b64_tr_b16 a[244:245], v102 offset:24576
    v_mfma_f32_16x16x32_bf16 v[216:219], a[216:219], a[80:83], v[216:219]
    ds_read_b64_tr_b16 a[246:247], v102 offset:28672
    s_waitcnt lgkmcnt(4)
    v_mfma_f32_16x16x32_bf16 v[224:227], a[224:227], a[80:83], v[224:227]
    buffer_load_dwordx4 a[148:151], v1, s[16:19], s81 offen offset:1024 sc1
    ds_read_b64_tr_b16 a[248:249], v103 offset:16384
    v_mfma_f32_16x16x32_bf16 v[224:227], a[228:231], a[84:87], v[224:227]
    ds_read_b64_tr_b16 a[250:251], v103 offset:20480
    v_mfma_f32_16x16x32_bf16 v[228:231], a[228:231], a[92:95], v[228:231]
    ds_read_b64_tr_b16 a[252:253], v103 offset:24576
    s_waitcnt vmcnt(45)
    v_mfma_f32_16x16x32_bf16 v[228:231], a[224:227], a[88:91], v[228:231]
    ds_read_b64_tr_b16 a[254:255], v103 offset:28672
    s_barrier
    v_mfma_f32_16x16x32_bf16 v[236:239], a[232:235], a[88:91], v[236:239]
    buffer_load_dwordx4 a[152:155], v28, s[16:19], s81 offen offset:0 sc1
    ds_read_b64_tr_b16 a[192:193], v104 offset:0
    v_mfma_f32_16x16x32_bf16 v[236:239], a[236:239], a[92:95], v[236:239]
    ds_read_b64_tr_b16 a[194:195], v104 offset:4096
    v_mfma_f32_16x16x32_bf16 v[232:235], a[236:239], a[84:87], v[232:235]
    buffer_load_dwordx4 a[156:159], v28, s[16:19], s81 offen offset:1024 sc1
    ds_read_b64_tr_b16 a[196:197], v104 offset:8192
    v_mfma_f32_16x16x32_bf16 v[232:235], a[232:235], a[80:83], v[232:235]
    ds_read_b64_tr_b16 a[198:199], v104 offset:12288
    s_waitcnt lgkmcnt(4)
    v_mfma_f32_16x16x32_bf16 v[240:243], a[240:243], a[80:83], v[240:243]
    ds_read_b64_tr_b16 a[200:201], v105 offset:0
    v_mfma_f32_16x16x32_bf16 v[240:243], a[244:247], a[84:87], v[240:243]
    ds_read_b64_tr_b16 a[202:203], v105 offset:4096
    v_mfma_f32_16x16x32_bf16 v[244:247], a[244:247], a[92:95], v[244:247]
    ds_read_b64_tr_b16 a[204:205], v105 offset:8192
    v_mfma_f32_16x16x32_bf16 v[244:247], a[240:243], a[88:91], v[244:247]
    ds_read_b64_tr_b16 a[206:207], v105 offset:12288
    v_mfma_f32_16x16x32_bf16 v[252:255], a[248:251], a[88:91], v[252:255]
    ds_read_b64_tr_b16 a[208:209], v106 offset:0
    v_mfma_f32_16x16x32_bf16 v[252:255], a[252:255], a[92:95], v[252:255]
    ds_read_b64_tr_b16 a[210:211], v106 offset:4096
    v_mfma_f32_16x16x32_bf16 v[248:251], a[252:255], a[84:87], v[248:251]
    ds_read_b64_tr_b16 a[212:213], v106 offset:8192
    v_mfma_f32_16x16x32_bf16 v[248:251], a[248:251], a[80:83], v[248:251]
    ds_read_b64_tr_b16 a[214:215], v106 offset:12288
    s_waitcnt lgkmcnt(4)
    s_waitcnt vmcnt(22)
    v_mfma_f32_16x16x32_bf16 v[192:195], a[192:195], a[96:99], v[192:195]
    ds_read_b64_tr_b16 a[216:217], v107 offset:0
    s_waitcnt vmcnt(17)
    v_mfma_f32_16x16x32_bf16 v[192:195], a[196:199], a[100:103], v[192:195]
    ds_read_b64_tr_b16 a[218:219], v107 offset:4096
    s_mov_b64 exec, 0xff
    buffer_store_dwordx4 v[24:27], v1, s[84:87], s70 offen offset:256 sc1
    s_mov_b64 exec, -1
    v_mfma_f32_16x16x32_bf16 v[196:199], a[196:199], a[108:111], v[196:199]
    ds_read_b64_tr_b16 a[220:221], v107 offset:8192
    v_mfma_f32_16x16x32_bf16 v[196:199], a[192:195], a[104:107], v[196:199]
    ds_read_b64_tr_b16 a[222:223], v107 offset:12288
    s_add_u32 m0, s41, 49152
    v_mfma_f32_16x16x32_bf16 v[204:207], a[200:203], a[104:107], v[204:207]
    ds_read_b64_tr_b16 a[224:225], v108 offset:0
    s_xor_b32 s80, s71, 196608
    v_mfma_f32_16x16x32_bf16 v[204:207], a[204:207], a[108:111], v[204:207]
    buffer_load_dwordx4 v14, s[24:27], s80 offen offset:0 lds
    ds_read_b64_tr_b16 a[226:227], v108 offset:4096
    v_mfma_f32_16x16x32_bf16 v[200:203], a[204:207], a[100:103], v[200:203]
    ds_read_b64_tr_b16 a[228:229], v108 offset:8192
    v_mfma_f32_16x16x32_bf16 v[200:203], a[200:203], a[96:99], v[200:203]
    ds_read_b64_tr_b16 a[230:231], v108 offset:12288
    s_waitcnt lgkmcnt(4)
    v_mfma_f32_16x16x32_bf16 v[208:211], a[208:211], a[96:99], v[208:211]
    buffer_load_dwordx4 v15, s[24:27], s80 offen offset:1024 lds
    ds_read_b64_tr_b16 a[232:233], v109 offset:0
    v_mfma_f32_16x16x32_bf16 v[208:211], a[212:215], a[100:103], v[208:211]
    ds_read_b64_tr_b16 a[234:235], v109 offset:4096
    v_mfma_f32_16x16x32_bf16 v[212:215], a[212:215], a[108:111], v[212:215]
    buffer_load_dwordx4 v16, s[24:27], s80 offen offset:2048 lds
    ds_read_b64_tr_b16 a[236:237], v109 offset:8192
    v_mfma_f32_16x16x32_bf16 v[212:215], a[208:211], a[104:107], v[212:215]
    ds_read_b64_tr_b16 a[238:239], v109 offset:12288
    v_mfma_f32_16x16x32_bf16 v[220:223], a[216:219], a[104:107], v[220:223]
    ds_read_b64_tr_b16 a[240:241], v110 offset:0
    v_mfma_f32_16x16x32_bf16 v[220:223], a[220:223], a[108:111], v[220:223]
    buffer_load_dwordx4 v17, s[24:27], s80 offen offset:3072 lds
    ds_read_b64_tr_b16 a[242:243], v110 offset:4096
    v_mfma_f32_16x16x32_bf16 v[216:219], a[220:223], a[100:103], v[216:219]
    ds_read_b64_tr_b16 a[244:245], v110 offset:8192
    s_add_u32 m0, s41, 65536
    v_mfma_f32_16x16x32_bf16 v[216:219], a[216:219], a[96:99], v[216:219]
    ds_read_b64_tr_b16 a[246:247], v110 offset:12288
    s_waitcnt lgkmcnt(4)
    v_mfma_f32_16x16x32_bf16 v[224:227], a[224:227], a[96:99], v[224:227]
    ds_read_b64_tr_b16 a[248:249], v111 offset:0
    s_xor_b32 s80, s71, 327680
    v_mfma_f32_16x16x32_bf16 v[224:227], a[228:231], a[100:103], v[224:227]
    buffer_load_dwordx4 v14, s[24:27], s80 offen offset:0 lds
    ds_read_b64_tr_b16 a[250:251], v111 offset:4096
    v_mfma_f32_16x16x32_bf16 v[228:231], a[228:231], a[108:111], v[228:231]
    ds_read_b64_tr_b16 a[252:253], v111 offset:8192
    s_waitcnt vmcnt(18)
    v_mfma_f32_16x16x32_bf16 v[228:231], a[224:227], a[104:107], v[228:231]
    ds_read_b64_tr_b16 a[254:255], v111 offset:12288
    s_barrier
    v_mfma_f32_16x16x32_bf16 v[236:239], a[232:235], a[104:107], v[236:239]
    buffer_load_dwordx4 v15, s[24:27], s80 offen offset:1024 lds
    ds_read_b64_tr_b16 a[192:193], v104 offset:16384
    v_mfma_f32_16x16x32_bf16 v[236:239], a[236:239], a[108:111], v[236:239]
    ds_read_b64_tr_b16 a[194:195], v104 offset:20480
    v_mfma_f32_16x16x32_bf16 v[232:235], a[236:239], a[100:103], v[232:235]
    buffer_load_dwordx4 v16, s[24:27], s80 offen offset:2048 lds
    ds_read_b64_tr_b16 a[196:197], v104 offset:24576
    v_mfma_f32_16x16x32_bf16 v[232:235], a[232:235], a[96:99], v[232:235]
    ds_read_b64_tr_b16 a[198:199], v104 offset:28672
    s_waitcnt lgkmcnt(4)
    v_mfma_f32_16x16x32_bf16 v[240:243], a[240:243], a[96:99], v[240:243]
    ds_read_b64_tr_b16 a[200:201], v105 offset:16384
    v_mfma_f32_16x16x32_bf16 v[240:243], a[244:247], a[100:103], v[240:243]
    buffer_load_dwordx4 v17, s[24:27], s80 offen offset:3072 lds
    ds_read_b64_tr_b16 a[202:203], v105 offset:20480
    v_mfma_f32_16x16x32_bf16 v[244:247], a[244:247], a[108:111], v[244:247]
    ds_read_b64_tr_b16 a[204:205], v105 offset:24576
    v_mfma_f32_16x16x32_bf16 v[244:247], a[240:243], a[104:107], v[244:247]
    ds_read_b64_tr_b16 a[206:207], v105 offset:28672
    v_mfma_f32_16x16x32_bf16 v[252:255], a[248:251], a[104:107], v[252:255]
    ds_read_b64_tr_b16 a[208:209], v106 offset:16384
    v_mfma_f32_16x16x32_bf16 v[252:255], a[252:255], a[108:111], v[252:255]
    ds_read_b64_tr_b16 a[210:211], v106 offset:20480
    v_mfma_f32_16x16x32_bf16 v[248:251], a[252:255], a[100:103], v[248:251]
    ds_read_b64_tr_b16 a[212:213], v106 offset:24576
    v_mfma_f32_16x16x32_bf16 v[248:251], a[248:251], a[96:99], v[248:251]
    ds_read_b64_tr_b16 a[214:215], v106 offset:28672
    s_waitcnt lgkmcnt(4)
    s_waitcnt vmcnt(25)
    v_mfma_f32_16x16x32_bf16 v[192:195], a[192:195], a[112:115], v[192:195]
    ds_read_b64_tr_b16 a[216:217], v107 offset:16384
    v_mfma_f32_16x16x32_bf16 v[192:195], a[196:199], a[116:119], v[192:195]
    ds_read_b64_tr_b16 a[218:219], v107 offset:20480
    s_xor_b32 s81, s58, 10240
    v_mfma_f32_16x16x32_bf16 v[196:199], a[196:199], a[124:127], v[196:199]
    buffer_load_dwordx4 a[160:163], v1, s[16:19], s81 offen offset:0 sc1
    ds_read_b64_tr_b16 a[220:221], v107 offset:24576
    v_mfma_f32_16x16x32_bf16 v[196:199], a[192:195], a[120:123], v[196:199]
    ds_read_b64_tr_b16 a[222:223], v107 offset:28672
    v_mfma_f32_16x16x32_bf16 v[204:207], a[200:203], a[120:123], v[204:207]
    buffer_load_dwordx4 a[164:167], v1, s[16:19], s81 offen offset:1024 sc1
    ds_read_b64_tr_b16 a[224:225], v108 offset:16384
    v_mfma_f32_16x16x32_bf16 v[204:207], a[204:207], a[124:127], v[204:207]
    ds_read_b64_tr_b16 a[226:227], v108 offset:20480
    v_mfma_f32_16x16x32_bf16 v[200:203], a[204:207], a[116:119], v[200:203]
    ds_read_b64_tr_b16 a[228:229], v108 offset:24576
    v_mfma_f32_16x16x32_bf16 v[200:203], a[200:203], a[112:115], v[200:203]
    ds_read_b64_tr_b16 a[230:231], v108 offset:28672
    s_waitcnt lgkmcnt(4)
    v_mfma_f32_16x16x32_bf16 v[208:211], a[208:211], a[112:115], v[208:211]
    buffer_load_dwordx4 a[168:171], v28, s[16:19], s81 offen offset:0 sc1
    ds_read_b64_tr_b16 a[232:233], v109 offset:16384
    v_mfma_f32_16x16x32_bf16 v[208:211], a[212:215], a[116:119], v[208:211]
    ds_read_b64_tr_b16 a[234:235], v109 offset:20480
    v_mfma_f32_16x16x32_bf16 v[212:215], a[212:215], a[124:127], v[212:215]
    buffer_load_dwordx4 a[172:175], v28, s[16:19], s81 offen offset:1024 sc1
    ds_read_b64_tr_b16 a[236:237], v109 offset:24576
    v_mfma_f32_16x16x32_bf16 v[212:215], a[208:211], a[120:123], v[212:215]
    ds_read_b64_tr_b16 a[238:239], v109 offset:28672
    v_mfma_f32_16x16x32_bf16 v[220:223], a[216:219], a[120:123], v[220:223]
    ds_read_b64_tr_b16 a[240:241], v110 offset:16384
    v_mfma_f32_16x16x32_bf16 v[220:223], a[220:223], a[124:127], v[220:223]
    ds_read_b64_tr_b16 a[242:243], v110 offset:20480
    s_xor_b32 s81, s58, 14336
    v_mfma_f32_16x16x32_bf16 v[216:219], a[220:223], a[116:119], v[216:219]
    buffer_load_dwordx4 a[176:179], v1, s[16:19], s81 offen offset:0 sc1
    ds_read_b64_tr_b16 a[244:245], v110 offset:24576
    v_mfma_f32_16x16x32_bf16 v[216:219], a[216:219], a[112:115], v[216:219]
    ds_read_b64_tr_b16 a[246:247], v110 offset:28672
    s_waitcnt lgkmcnt(4)
    v_mfma_f32_16x16x32_bf16 v[224:227], a[224:227], a[112:115], v[224:227]
    buffer_load_dwordx4 a[180:183], v1, s[16:19], s81 offen offset:1024 sc1
    ds_read_b64_tr_b16 a[248:249], v111 offset:16384
    v_mfma_f32_16x16x32_bf16 v[224:227], a[228:231], a[116:119], v[224:227]
    ds_read_b64_tr_b16 a[250:251], v111 offset:20480
    v_mfma_f32_16x16x32_bf16 v[228:231], a[228:231], a[124:127], v[228:231]
    ds_read_b64_tr_b16 a[252:253], v111 offset:24576
    s_waitcnt vmcnt(23)
    v_mfma_f32_16x16x32_bf16 v[228:231], a[224:227], a[120:123], v[228:231]
    ds_read_b64_tr_b16 a[254:255], v111 offset:28672
    s_barrier
    v_mfma_f32_16x16x32_bf16 v[236:239], a[232:235], a[120:123], v[236:239]
    buffer_load_dwordx4 a[184:187], v28, s[16:19], s81 offen offset:0 sc1
    ds_read_b64_tr_b16 a[192:193], v104 offset:32768
    v_mfma_f32_16x16x32_bf16 v[236:239], a[236:239], a[124:127], v[236:239]
    ds_read_b64_tr_b16 a[194:195], v104 offset:36864
    v_mfma_f32_16x16x32_bf16 v[232:235], a[236:239], a[116:119], v[232:235]
    buffer_load_dwordx4 a[188:191], v28, s[16:19], s81 offen offset:1024 sc1
    ds_read_b64_tr_b16 a[196:197], v104 offset:40960
    v_mfma_f32_16x16x32_bf16 v[232:235], a[232:235], a[112:115], v[232:235]
    ds_read_b64_tr_b16 a[198:199], v104 offset:45056
    s_waitcnt lgkmcnt(4)
    v_mfma_f32_16x16x32_bf16 v[240:243], a[240:243], a[112:115], v[240:243]
    ds_read_b64_tr_b16 a[200:201], v105 offset:32768
    v_mfma_f32_16x16x32_bf16 v[240:243], a[244:247], a[116:119], v[240:243]
    ds_read_b64_tr_b16 a[202:203], v105 offset:36864
    v_mfma_f32_16x16x32_bf16 v[244:247], a[244:247], a[124:127], v[244:247]
    ds_read_b64_tr_b16 a[204:205], v105 offset:40960
    v_mfma_f32_16x16x32_bf16 v[244:247], a[240:243], a[120:123], v[244:247]
    ds_read_b64_tr_b16 a[206:207], v105 offset:45056
    v_mfma_f32_16x16x32_bf16 v[252:255], a[248:251], a[120:123], v[252:255]
    ds_read_b64_tr_b16 a[208:209], v106 offset:32768
    v_mfma_f32_16x16x32_bf16 v[252:255], a[252:255], a[124:127], v[252:255]
    ds_read_b64_tr_b16 a[210:211], v106 offset:36864
    v_mfma_f32_16x16x32_bf16 v[248:251], a[252:255], a[116:119], v[248:251]
    ds_read_b64_tr_b16 a[212:213], v106 offset:40960
    v_mfma_f32_16x16x32_bf16 v[248:251], a[248:251], a[112:115], v[248:251]
    ds_read_b64_tr_b16 a[214:215], v106 offset:45056
    s_waitcnt lgkmcnt(4)
    s_waitcnt vmcnt(21)
    v_mfma_f32_16x16x32_bf16 v[192:195], a[192:195], a[128:131], v[192:195]
    ds_read_b64_tr_b16 a[216:217], v107 offset:32768
    s_add_u32 m0, s41, 81920
    v_mfma_f32_16x16x32_bf16 v[192:195], a[196:199], a[132:135], v[192:195]
    ds_read_b64_tr_b16 a[218:219], v107 offset:36864
    s_xor_b32 s80, s71, 458752
    v_mfma_f32_16x16x32_bf16 v[196:199], a[196:199], a[140:143], v[196:199]
    buffer_load_dwordx4 v14, s[24:27], s80 offen offset:0 lds
    ds_read_b64_tr_b16 a[220:221], v107 offset:40960
    v_mfma_f32_16x16x32_bf16 v[196:199], a[192:195], a[136:139], v[196:199]
    buffer_load_dwordx4 v15, s[24:27], s80 offen offset:1024 lds
    ds_read_b64_tr_b16 a[222:223], v107 offset:45056
    v_mfma_f32_16x16x32_bf16 v[204:207], a[200:203], a[136:139], v[204:207]
    ds_read_b64_tr_b16 a[224:225], v108 offset:32768
    v_mfma_f32_16x16x32_bf16 v[204:207], a[204:207], a[140:143], v[204:207]
    buffer_load_dwordx4 v16, s[24:27], s80 offen offset:2048 lds
    ds_read_b64_tr_b16 a[226:227], v108 offset:36864
    v_mfma_f32_16x16x32_bf16 v[200:203], a[204:207], a[132:135], v[200:203]
    ds_read_b64_tr_b16 a[228:229], v108 offset:40960
    v_mfma_f32_16x16x32_bf16 v[200:203], a[200:203], a[128:131], v[200:203]
    ds_read_b64_tr_b16 a[230:231], v108 offset:45056
    s_waitcnt lgkmcnt(4)
    v_mfma_f32_16x16x32_bf16 v[208:211], a[208:211], a[128:131], v[208:211]
    buffer_load_dwordx4 v17, s[24:27], s80 offen offset:3072 lds
    ds_read_b64_tr_b16 a[232:233], v109 offset:32768
    v_mfma_f32_16x16x32_bf16 v[208:211], a[212:215], a[132:135], v[208:211]
    ds_read_b64_tr_b16 a[234:235], v109 offset:36864
    s_add_u32 m0, s41, 98304
    s_xor_b32 s80, s71, 589824
    v_mfma_f32_16x16x32_bf16 v[212:215], a[212:215], a[140:143], v[212:215]
    buffer_load_dwordx4 v14, s[24:27], s80 offen offset:0 lds
    ds_read_b64_tr_b16 a[236:237], v109 offset:40960
    v_mfma_f32_16x16x32_bf16 v[212:215], a[208:211], a[136:139], v[212:215]
    ds_read_b64_tr_b16 a[238:239], v109 offset:45056
    s_waitcnt vmcnt(17)
    s_barrier
    v_mfma_f32_16x16x32_bf16 v[220:223], a[216:219], a[136:139], v[220:223]
    buffer_load_dwordx4 v15, s[24:27], s80 offen offset:1024 lds
    ds_read_b64_tr_b16 a[240:241], v104 offset:49152
    v_mfma_f32_16x16x32_bf16 v[220:223], a[220:223], a[140:143], v[220:223]
    buffer_load_dwordx4 v16, s[24:27], s80 offen offset:2048 lds
    ds_read_b64_tr_b16 a[242:243], v104 offset:53248
    v_mfma_f32_16x16x32_bf16 v[216:219], a[220:223], a[132:135], v[216:219]
    ds_read_b64_tr_b16 a[244:245], v104 offset:57344
    v_mfma_f32_16x16x32_bf16 v[216:219], a[216:219], a[128:131], v[216:219]
    ds_read_b64_tr_b16 a[246:247], v104 offset:61440
    s_waitcnt lgkmcnt(4)
    v_mfma_f32_16x16x32_bf16 v[224:227], a[224:227], a[128:131], v[224:227]
    buffer_load_dwordx4 v17, s[24:27], s80 offen offset:3072 lds
    ds_read_b64_tr_b16 a[248:249], v105 offset:49152
    v_mfma_f32_16x16x32_bf16 v[224:227], a[228:231], a[132:135], v[224:227]
    ds_read_b64_tr_b16 a[250:251], v105 offset:53248
    v_mfma_f32_16x16x32_bf16 v[228:231], a[228:231], a[140:143], v[228:231]
    ds_read_b64_tr_b16 a[252:253], v105 offset:57344
    v_mfma_f32_16x16x32_bf16 v[228:231], a[224:227], a[136:139], v[228:231]
    ds_read_b64_tr_b16 a[254:255], v105 offset:61440
    v_mfma_f32_16x16x32_bf16 v[236:239], a[232:235], a[136:139], v[236:239]
    ds_read_b64_tr_b16 a[192:193], v106 offset:49152
    v_mfma_f32_16x16x32_bf16 v[236:239], a[236:239], a[140:143], v[236:239]
    ds_read_b64_tr_b16 a[194:195], v106 offset:53248
    v_mfma_f32_16x16x32_bf16 v[232:235], a[236:239], a[132:135], v[232:235]
    ds_read_b64_tr_b16 a[196:197], v106 offset:57344
    v_mfma_f32_16x16x32_bf16 v[232:235], a[232:235], a[128:131], v[232:235]
    ds_read_b64_tr_b16 a[198:199], v106 offset:61440
    s_waitcnt lgkmcnt(4)
    s_waitcnt vmcnt(25)
    v_mfma_f32_16x16x32_bf16 v[192:195], a[240:243], a[144:147], v[192:195]
    ds_read_b64_tr_b16 a[200:201], v107 offset:49152
    v_mfma_f32_16x16x32_bf16 v[192:195], a[244:247], a[148:151], v[192:195]
    ds_read_b64_tr_b16 a[202:203], v107 offset:53248
    s_xor_b32 s81, s58, 18432
    v_mfma_f32_16x16x32_bf16 v[196:199], a[244:247], a[156:159], v[196:199]
    buffer_load_dwordx4 a[0:3], v1, s[16:19], s81 offen offset:0 sc1
    ds_read_b64_tr_b16 a[204:205], v107 offset:57344
    v_mfma_f32_16x16x32_bf16 v[196:199], a[240:243], a[152:155], v[196:199]
    buffer_load_dwordx4 a[4:7], v1, s[16:19], s81 offen offset:1024 sc1
    ds_read_b64_tr_b16 a[206:207], v107 offset:61440
    v_mfma_f32_16x16x32_bf16 v[204:207], a[248:251], a[152:155], v[204:207]
    ds_read_b64_tr_b16 a[208:209], v108 offset:49152
    v_mfma_f32_16x16x32_bf16 v[204:207], a[252:255], a[156:159], v[204:207]
    buffer_load_dwordx4 a[8:11], v28, s[16:19], s81 offen offset:0 sc1
    ds_read_b64_tr_b16 a[210:211], v108 offset:53248
    v_mfma_f32_16x16x32_bf16 v[200:203], a[252:255], a[148:151], v[200:203]
    ds_read_b64_tr_b16 a[212:213], v108 offset:57344
    v_mfma_f32_16x16x32_bf16 v[200:203], a[248:251], a[144:147], v[200:203]
    ds_read_b64_tr_b16 a[214:215], v108 offset:61440
    s_waitcnt lgkmcnt(4)
    v_mfma_f32_16x16x32_bf16 v[208:211], a[192:195], a[144:147], v[208:211]
    buffer_load_dwordx4 a[12:15], v28, s[16:19], s81 offen offset:1024 sc1
    ds_read_b64_tr_b16 a[216:217], v109 offset:49152
    v_mfma_f32_16x16x32_bf16 v[208:211], a[196:199], a[148:151], v[208:211]
    ds_read_b64_tr_b16 a[218:219], v109 offset:53248
    s_xor_b32 s81, s58, 22528
    v_mfma_f32_16x16x32_bf16 v[212:215], a[196:199], a[156:159], v[212:215]
    buffer_load_dwordx4 a[16:19], v1, s[16:19], s81 offen offset:0 sc1
    ds_read_b64_tr_b16 a[220:221], v109 offset:57344
    v_mfma_f32_16x16x32_bf16 v[212:215], a[192:195], a[152:155], v[212:215]
    ds_read_b64_tr_b16 a[222:223], v109 offset:61440
    s_waitcnt vmcnt(21)
    s_barrier
    v_mfma_f32_16x16x32_bf16 v[220:223], a[200:203], a[152:155], v[220:223]
    buffer_load_dwordx4 a[20:23], v1, s[16:19], s81 offen offset:1024 sc1
    ds_read_b64_tr_b16 a[224:225], v112 offset:0
    v_mfma_f32_16x16x32_bf16 v[220:223], a[204:207], a[156:159], v[220:223]
    buffer_load_dwordx4 a[24:27], v28, s[16:19], s81 offen offset:0 sc1
    ds_read_b64_tr_b16 a[226:227], v112 offset:4096
    v_mfma_f32_16x16x32_bf16 v[216:219], a[204:207], a[148:151], v[216:219]
    ds_read_b64_tr_b16 a[228:229], v112 offset:8192
    v_mfma_f32_16x16x32_bf16 v[216:219], a[200:203], a[144:147], v[216:219]
    ds_read_b64_tr_b16 a[230:231], v112 offset:12288
    s_waitcnt lgkmcnt(4)
    v_mfma_f32_16x16x32_bf16 v[224:227], a[208:211], a[144:147], v[224:227]
    buffer_load_dwordx4 a[28:31], v28, s[16:19], s81 offen offset:1024 sc1
    ds_read_b64_tr_b16 a[232:233], v113 offset:0
    v_mfma_f32_16x16x32_bf16 v[224:227], a[212:215], a[148:151], v[224:227]
    ds_read_b64_tr_b16 a[234:235], v113 offset:4096
    v_mfma_f32_16x16x32_bf16 v[228:231], a[212:215], a[156:159], v[228:231]
    ds_read_b64_tr_b16 a[236:237], v113 offset:8192
    v_mfma_f32_16x16x32_bf16 v[228:231], a[208:211], a[152:155], v[228:231]
    ds_read_b64_tr_b16 a[238:239], v113 offset:12288
    v_mfma_f32_16x16x32_bf16 v[236:239], a[216:219], a[152:155], v[236:239]
    ds_read_b64_tr_b16 a[240:241], v114 offset:0
    v_mfma_f32_16x16x32_bf16 v[236:239], a[220:223], a[156:159], v[236:239]
    ds_read_b64_tr_b16 a[242:243], v114 offset:4096
    v_mfma_f32_16x16x32_bf16 v[232:235], a[220:223], a[148:151], v[232:235]
    ds_read_b64_tr_b16 a[244:245], v114 offset:8192
    v_mfma_f32_16x16x32_bf16 v[232:235], a[216:219], a[144:147], v[232:235]
    ds_read_b64_tr_b16 a[246:247], v114 offset:12288
    s_waitcnt lgkmcnt(4)
    s_waitcnt vmcnt(20)
    v_mfma_f32_16x16x32_bf16 v[192:195], a[224:227], a[160:163], v[192:195]
    ds_read_b64_tr_b16 a[248:249], v115 offset:0
    v_mfma_f32_16x16x32_bf16 v[192:195], a[228:231], a[164:167], v[192:195]
    ds_read_b64_tr_b16 a[250:251], v115 offset:4096
    s_mov_b64 exec, 7
    buffer_load_dword v22, v30, s[84:87], 0 offen offset:256 sc1
    s_mov_b64 exec, -1
    v_mfma_f32_16x16x32_bf16 v[196:199], a[228:231], a[172:175], v[196:199]
    ds_read_b64_tr_b16 a[252:253], v115 offset:8192
    s_add_u32 m0, s41, 114688
    v_mfma_f32_16x16x32_bf16 v[196:199], a[224:227], a[168:171], v[196:199]
    ds_read_b64_tr_b16 a[254:255], v115 offset:12288
    s_xor_b32 s80, s71, 720896
    v_mfma_f32_16x16x32_bf16 v[204:207], a[232:235], a[168:171], v[204:207]
    buffer_load_dwordx4 v14, s[24:27], s80 offen offset:0 lds
    ds_read_b64_tr_b16 a[192:193], v116 offset:0
    v_mfma_f32_16x16x32_bf16 v[204:207], a[236:239], a[172:175], v[204:207]
    buffer_load_dwordx4 v15, s[24:27], s80 offen offset:1024 lds
    ds_read_b64_tr_b16 a[194:195], v116 offset:4096
    v_mfma_f32_16x16x32_bf16 v[200:203], a[236:239], a[164:167], v[200:203]
    ds_read_b64_tr_b16 a[196:197], v116 offset:8192
    v_mfma_f32_16x16x32_bf16 v[200:203], a[232:235], a[160:163], v[200:203]
    ds_read_b64_tr_b16 a[198:199], v116 offset:12288
    s_waitcnt lgkmcnt(4)
    v_mfma_f32_16x16x32_bf16 v[208:211], a[240:243], a[160:163], v[208:211]
    buffer_load_dwordx4 v16, s[24:27], s80 offen offset:2048 lds
    ds_read_b64_tr_b16 a[200:201], v117 offset:0
    v_mfma_f32_16x16x32_bf16 v[208:211], a[244:247], a[164:167], v[208:211]
    buffer_load_dwordx4 v17, s[24:27], s80 offen offset:3072 lds
    ds_read_b64_tr_b16 a[202:203], v117 offset:4096
    v_mfma_f32_16x16x32_bf16 v[212:215], a[244:247], a[172:175], v[212:215]
    ds_read_b64_tr_b16 a[204:205], v117 offset:8192
    s_waitcnt vmcnt(17)
    v_mfma_f32_16x16x32_bf16 v[212:215], a[240:243], a[168:171], v[212:215]
    ds_read_b64_tr_b16 a[206:207], v117 offset:12288
    s_barrier
    s_add_u32 m0, s41, 131072
    s_xor_b32 s80, s71, 851968
    v_mfma_f32_16x16x32_bf16 v[220:223], a[248:251], a[168:171], v[220:223]
    buffer_load_dwordx4 v14, s[24:27], s80 offen offset:0 lds
    ds_read_b64_tr_b16 a[208:209], v112 offset:16384
    v_mfma_f32_16x16x32_bf16 v[220:223], a[252:255], a[172:175], v[220:223]
    buffer_load_dwordx4 v15, s[24:27], s80 offen offset:1024 lds
    ds_read_b64_tr_b16 a[210:211], v112 offset:20480
    v_mfma_f32_16x16x32_bf16 v[216:219], a[252:255], a[164:167], v[216:219]
    ds_read_b64_tr_b16 a[212:213], v112 offset:24576
    v_mfma_f32_16x16x32_bf16 v[216:219], a[248:251], a[160:163], v[216:219]
    ds_read_b64_tr_b16 a[214:215], v112 offset:28672
    s_waitcnt lgkmcnt(4)
    v_mfma_f32_16x16x32_bf16 v[224:227], a[192:195], a[160:163], v[224:227]
    buffer_load_dwordx4 v16, s[24:27], s80 offen offset:2048 lds
    ds_read_b64_tr_b16 a[216:217], v113 offset:16384
    v_mfma_f32_16x16x32_bf16 v[224:227], a[196:199], a[164:167], v[224:227]
    buffer_load_dwordx4 v17, s[24:27], s80 offen offset:3072 lds
    ds_read_b64_tr_b16 a[218:219], v113 offset:20480
    v_mfma_f32_16x16x32_bf16 v[228:231], a[196:199], a[172:175], v[228:231]
    ds_read_b64_tr_b16 a[220:221], v113 offset:24576
    v_mfma_f32_16x16x32_bf16 v[228:231], a[192:195], a[168:171], v[228:231]
    ds_read_b64_tr_b16 a[222:223], v113 offset:28672
    v_mfma_f32_16x16x32_bf16 v[236:239], a[200:203], a[168:171], v[236:239]
    ds_read_b64_tr_b16 a[224:225], v114 offset:16384
    v_mfma_f32_16x16x32_bf16 v[236:239], a[204:207], a[172:175], v[236:239]
    ds_read_b64_tr_b16 a[226:227], v114 offset:20480
    v_mfma_f32_16x16x32_bf16 v[232:235], a[204:207], a[164:167], v[232:235]
    ds_read_b64_tr_b16 a[228:229], v114 offset:24576
    v_mfma_f32_16x16x32_bf16 v[232:235], a[200:203], a[160:163], v[232:235]
    ds_read_b64_tr_b16 a[230:231], v114 offset:28672
    s_waitcnt lgkmcnt(4)
    s_waitcnt vmcnt(25)
    v_mfma_f32_16x16x32_bf16 v[192:195], a[208:211], a[176:179], v[192:195]
    ds_read_b64_tr_b16 a[232:233], v115 offset:16384
    v_mfma_f32_16x16x32_bf16 v[192:195], a[212:215], a[180:183], v[192:195]
    ds_read_b64_tr_b16 a[234:235], v115 offset:20480
    s_xor_b32 s81, s58, 26624
    v_mfma_f32_16x16x32_bf16 v[196:199], a[212:215], a[188:191], v[196:199]
    buffer_load_dwordx4 a[32:35], v1, s[16:19], s81 offen offset:0 sc1
    ds_read_b64_tr_b16 a[236:237], v115 offset:24576
    v_mfma_f32_16x16x32_bf16 v[196:199], a[208:211], a[184:187], v[196:199]
    buffer_load_dwordx4 a[36:39], v1, s[16:19], s81 offen offset:1024 sc1
    ds_read_b64_tr_b16 a[238:239], v115 offset:28672
    v_mfma_f32_16x16x32_bf16 v[204:207], a[216:219], a[184:187], v[204:207]
    ds_read_b64_tr_b16 a[240:241], v116 offset:16384
    v_mfma_f32_16x16x32_bf16 v[204:207], a[220:223], a[188:191], v[204:207]
    buffer_load_dwordx4 a[40:43], v28, s[16:19], s81 offen offset:0 sc1
    ds_read_b64_tr_b16 a[242:243], v116 offset:20480
    v_mfma_f32_16x16x32_bf16 v[200:203], a[220:223], a[180:183], v[200:203]
    ds_read_b64_tr_b16 a[244:245], v116 offset:24576
    v_mfma_f32_16x16x32_bf16 v[200:203], a[216:219], a[176:179], v[200:203]
    ds_read_b64_tr_b16 a[246:247], v116 offset:28672
    s_waitcnt lgkmcnt(4)
    v_mfma_f32_16x16x32_bf16 v[208:211], a[224:227], a[176:179], v[208:211]
    buffer_load_dwordx4 a[44:47], v28, s[16:19], s81 offen offset:1024 sc1
    ds_read_b64_tr_b16 a[248:249], v117 offset:16384
    v_mfma_f32_16x16x32_bf16 v[208:211], a[228:231], a[180:183], v[208:211]
    ds_read_b64_tr_b16 a[250:251], v117 offset:20480
    s_xor_b32 s81, s58, 30720
    v_mfma_f32_16x16x32_bf16 v[212:215], a[228:231], a[188:191], v[212:215]
    buffer_load_dwordx4 a[48:51], v1, s[16:19], s81 offen offset:0 sc1
    ds_read_b64_tr_b16 a[252:253], v117 offset:24576
    v_mfma_f32_16x16x32_bf16 v[212:215], a[224:227], a[184:187], v[212:215]
    ds_read_b64_tr_b16 a[254:255], v117 offset:28672
    s_waitcnt vmcnt(22)
    s_barrier
    v_mfma_f32_16x16x32_bf16 v[220:223], a[232:235], a[184:187], v[220:223]
    buffer_load_dwordx4 a[52:55], v1, s[16:19], s81 offen offset:1024 sc1
    ds_read_b64_tr_b16 a[192:193], v112 offset:32768
    v_mfma_f32_16x16x32_bf16 v[220:223], a[236:239], a[188:191], v[220:223]
    buffer_load_dwordx4 a[56:59], v28, s[16:19], s81 offen offset:0 sc1
    ds_read_b64_tr_b16 a[194:195], v112 offset:36864
    v_mfma_f32_16x16x32_bf16 v[216:219], a[236:239], a[180:183], v[216:219]
    ds_read_b64_tr_b16 a[196:197], v112 offset:40960
    v_mfma_f32_16x16x32_bf16 v[216:219], a[232:235], a[176:179], v[216:219]
    ds_read_b64_tr_b16 a[198:199], v112 offset:45056
    s_waitcnt lgkmcnt(4)
    v_mfma_f32_16x16x32_bf16 v[224:227], a[240:243], a[176:179], v[224:227]
    buffer_load_dwordx4 a[60:63], v28, s[16:19], s81 offen offset:1024 sc1
    ds_read_b64_tr_b16 a[200:201], v113 offset:32768
    v_mfma_f32_16x16x32_bf16 v[224:227], a[244:247], a[180:183], v[224:227]
    ds_read_b64_tr_b16 a[202:203], v113 offset:36864
    v_mfma_f32_16x16x32_bf16 v[228:231], a[244:247], a[188:191], v[228:231]
    ds_read_b64_tr_b16 a[204:205], v113 offset:40960
    v_mfma_f32_16x16x32_bf16 v[228:231], a[240:243], a[184:187], v[228:231]
    ds_read_b64_tr_b16 a[206:207], v113 offset:45056
    v_mfma_f32_16x16x32_bf16 v[236:239], a[248:251], a[184:187], v[236:239]
    ds_read_b64_tr_b16 a[208:209], v114 offset:32768
    v_mfma_f32_16x16x32_bf16 v[236:239], a[252:255], a[188:191], v[236:239]
    ds_read_b64_tr_b16 a[210:211], v114 offset:36864
    v_mfma_f32_16x16x32_bf16 v[232:235], a[252:255], a[180:183], v[232:235]
    ds_read_b64_tr_b16 a[212:213], v114 offset:40960
    v_mfma_f32_16x16x32_bf16 v[232:235], a[248:251], a[176:179], v[232:235]
    ds_read_b64_tr_b16 a[214:215], v114 offset:45056
    s_waitcnt lgkmcnt(4)
    s_waitcnt vmcnt(21)
    v_mfma_f32_16x16x32_bf16 v[192:195], a[192:195], a[0:3], v[192:195]
    ds_read_b64_tr_b16 a[216:217], v115 offset:32768
    s_add_u32 m0, s41, 147456
    v_mfma_f32_16x16x32_bf16 v[192:195], a[196:199], a[4:7], v[192:195]
    ds_read_b64_tr_b16 a[218:219], v115 offset:36864
    s_xor_b32 s80, s71, 983040
    v_mfma_f32_16x16x32_bf16 v[196:199], a[196:199], a[12:15], v[196:199]
    buffer_load_dwordx4 v14, s[24:27], s80 offen offset:0 lds
    ds_read_b64_tr_b16 a[220:221], v115 offset:40960
    v_mfma_f32_16x16x32_bf16 v[196:199], a[192:195], a[8:11], v[196:199]
    buffer_load_dwordx4 v15, s[24:27], s80 offen offset:1024 lds
    ds_read_b64_tr_b16 a[222:223], v115 offset:45056
    v_mfma_f32_16x16x32_bf16 v[204:207], a[200:203], a[8:11], v[204:207]
    ds_read_b64_tr_b16 a[224:225], v116 offset:32768
    v_mfma_f32_16x16x32_bf16 v[204:207], a[204:207], a[12:15], v[204:207]
    buffer_load_dwordx4 v16, s[24:27], s80 offen offset:2048 lds
    ds_read_b64_tr_b16 a[226:227], v116 offset:36864
    v_mfma_f32_16x16x32_bf16 v[200:203], a[204:207], a[4:7], v[200:203]
    ds_read_b64_tr_b16 a[228:229], v116 offset:40960
    v_mfma_f32_16x16x32_bf16 v[200:203], a[200:203], a[0:3], v[200:203]
    ds_read_b64_tr_b16 a[230:231], v116 offset:45056
    s_waitcnt lgkmcnt(4)
    v_mfma_f32_16x16x32_bf16 v[208:211], a[208:211], a[0:3], v[208:211]
    buffer_load_dwordx4 v17, s[24:27], s80 offen offset:3072 lds
    ds_read_b64_tr_b16 a[232:233], v117 offset:32768
    v_mfma_f32_16x16x32_bf16 v[208:211], a[212:215], a[4:7], v[208:211]
    ds_read_b64_tr_b16 a[234:235], v117 offset:36864
    s_waitcnt vmcnt(20)
    v_cmp_ne_u32 vcc, 0x3f803f80, v22
    s_nop 0
    s_and_b32 s3, vcc_lo, 7
    s_cbranch_scc1 L1_pf_spin
L1_pf_ok:
    s_add_u32 s81, s83, 0
    v_mfma_f32_16x16x32_bf16 v[212:215], a[212:215], a[12:15], v[212:215]
    buffer_load_dwordx4 v[64:67], v1, s[84:87], s81 offen offset:0 sc1
    ds_read_b64_tr_b16 a[236:237], v117 offset:40960
    v_mfma_f32_16x16x32_bf16 v[212:215], a[208:211], a[8:11], v[212:215]
    ds_read_b64_tr_b16 a[238:239], v117 offset:45056
    s_waitcnt vmcnt(17)
    s_barrier
    v_mfma_f32_16x16x32_bf16 v[220:223], a[216:219], a[8:11], v[220:223]
    buffer_load_dwordx4 v[68:71], v1, s[84:87], s81 offen offset:1024 sc1
    ds_read_b64_tr_b16 a[240:241], v112 offset:49152
    v_mfma_f32_16x16x32_bf16 v[220:223], a[220:223], a[12:15], v[220:223]
    ds_read_b64_tr_b16 a[242:243], v112 offset:53248
    s_add_u32 s81, s83, 8192
    v_mfma_f32_16x16x32_bf16 v[216:219], a[220:223], a[4:7], v[216:219]
    buffer_load_dwordx4 v[72:75], v1, s[84:87], s81 offen offset:0 sc1
    ds_read_b64_tr_b16 a[244:245], v112 offset:57344
    v_mfma_f32_16x16x32_bf16 v[216:219], a[216:219], a[0:3], v[216:219]
    ds_read_b64_tr_b16 a[246:247], v112 offset:61440
    s_waitcnt lgkmcnt(4)
    v_mfma_f32_16x16x32_bf16 v[224:227], a[224:227], a[0:3], v[224:227]
    buffer_load_dwordx4 v[76:79], v1, s[84:87], s81 offen offset:1024 sc1
    ds_read_b64_tr_b16 a[248:249], v113 offset:49152
L1_pc10:
    s_cbranch_execz L1_pgret
    v_mfma_f32_16x16x32_bf16 v[224:227], a[228:231], a[4:7], v[224:227]
    ds_read_b64_tr_b16 a[250:251], v113 offset:53248
    s_add_u32 s81, s83, 16384
    v_mfma_f32_16x16x32_bf16 v[228:231], a[228:231], a[12:15], v[228:231]
    buffer_load_dwordx4 v[80:83], v1, s[84:87], s81 offen offset:0 sc1
    ds_read_b64_tr_b16 a[252:253], v113 offset:57344
    v_mfma_f32_16x16x32_bf16 v[228:231], a[224:227], a[8:11], v[228:231]
    buffer_load_dwordx4 v[84:87], v1, s[84:87], s81 offen offset:1024 sc1
    ds_read_b64_tr_b16 a[254:255], v113 offset:61440
    v_mfma_f32_16x16x32_bf16 v[236:239], a[232:235], a[8:11], v[236:239]
    ds_read_b64_tr_b16 a[192:193], v114 offset:49152
    v_mfma_f32_16x16x32_bf16 v[236:239], a[236:239], a[12:15], v[236:239]
    ds_read_b64_tr_b16 a[194:195], v114 offset:53248
    v_mfma_f32_16x16x32_bf16 v[232:235], a[236:239], a[4:7], v[232:235]
    ds_read_b64_tr_b16 a[196:197], v114 offset:57344
    v_mfma_f32_16x16x32_bf16 v[232:235], a[232:235], a[0:3], v[232:235]
    ds_read_b64_tr_b16 a[198:199], v114 offset:61440
    s_waitcnt lgkmcnt(4)
    s_waitcnt vmcnt(27)
    v_mfma_f32_16x16x32_bf16 v[192:195], a[240:243], a[16:19], v[192:195]
    ds_read_b64_tr_b16 a[200:201], v115 offset:49152
    v_mfma_f32_16x16x32_bf16 v[192:195], a[244:247], a[20:23], v[192:195]
    ds_read_b64_tr_b16 a[202:203], v115 offset:53248
    v_mfma_f32_16x16x32_bf16 v[196:199], a[244:247], a[28:31], v[196:199]
    ds_read_b64_tr_b16 a[204:205], v115 offset:57344
    v_mfma_f32_16x16x32_bf16 v[196:199], a[240:243], a[24:27], v[196:199]
    ds_read_b64_tr_b16 a[206:207], v115 offset:61440
    v_mfma_f32_16x16x32_bf16 v[204:207], a[248:251], a[24:27], v[204:207]
    ds_read_b64_tr_b16 a[208:209], v116 offset:49152
    v_mfma_f32_16x16x32_bf16 v[204:207], a[252:255], a[28:31], v[204:207]
    ds_read_b64_tr_b16 a[210:211], v116 offset:53248
    v_mfma_f32_16x16x32_bf16 v[200:203], a[252:255], a[20:23], v[200:203]
    ds_read_b64_tr_b16 a[212:213], v116 offset:57344
    v_mfma_f32_16x16x32_bf16 v[200:203], a[248:251], a[16:19], v[200:203]
    ds_read_b64_tr_b16 a[214:215], v116 offset:61440
    s_waitcnt lgkmcnt(4)
    v_mfma_f32_16x16x32_bf16 v[208:211], a[192:195], a[16:19], v[208:211]
    ds_read_b64_tr_b16 a[216:217], v117 offset:49152
    v_mfma_f32_16x16x32_bf16 v[208:211], a[196:199], a[20:23], v[208:211]
    ds_read_b64_tr_b16 a[218:219], v117 offset:53248
    v_mfma_f32_16x16x32_bf16 v[212:215], a[196:199], a[28:31], v[212:215]
    ds_read_b64_tr_b16 a[220:221], v117 offset:57344
    s_waitcnt vmcnt(18)
    v_mfma_f32_16x16x32_bf16 v[212:215], a[192:195], a[24:27], v[212:215]
    ds_read_b64_tr_b16 a[222:223], v117 offset:61440
    s_barrier
    v_mfma_f32_16x16x32_bf16 v[220:223], a[200:203], a[24:27], v[220:223]
    ds_read_b64_tr_b16 a[224:225], v96 offset:0
    v_mfma_f32_16x16x32_bf16 v[220:223], a[204:207], a[28:31], v[220:223]
    ds_read_b64_tr_b16 a[226:227], v96 offset:4096
    v_mfma_f32_16x16x32_bf16 v[216:219], a[204:207], a[20:23], v[216:219]
    ds_read_b64_tr_b16 a[228:229], v96 offset:8192
    v_mfma_f32_16x16x32_bf16 v[216:219], a[200:203], a[16:19], v[216:219]
    ds_read_b64_tr_b16 a[230:231], v96 offset:12288
    s_waitcnt lgkmcnt(4)
    v_mfma_f32_16x16x32_bf16 v[224:227], a[208:211], a[16:19], v[224:227]
    ds_read_b64_tr_b16 a[232:233], v97 offset:0
    v_mfma_f32_16x16x32_bf16 v[224:227], a[212:215], a[20:23], v[224:227]
    ds_read_b64_tr_b16 a[234:235], v97 offset:4096
    v_mfma_f32_16x16x32_bf16 v[228:231], a[212:215], a[28:31], v[228:231]
    ds_read_b64_tr_b16 a[236:237], v97 offset:8192
    v_mfma_f32_16x16x32_bf16 v[228:231], a[208:211], a[24:27], v[228:231]
    ds_read_b64_tr_b16 a[238:239], v97 offset:12288
    v_mfma_f32_16x16x32_bf16 v[236:239], a[216:219], a[24:27], v[236:239]
    ds_read_b64_tr_b16 a[240:241], v98 offset:0
    v_mfma_f32_16x16x32_bf16 v[236:239], a[220:223], a[28:31], v[236:239]
    ds_read_b64_tr_b16 a[242:243], v98 offset:4096
    v_mfma_f32_16x16x32_bf16 v[232:235], a[220:223], a[20:23], v[232:235]
    ds_read_b64_tr_b16 a[244:245], v98 offset:8192
    v_mfma_f32_16x16x32_bf16 v[232:235], a[216:219], a[16:19], v[232:235]
    ds_read_b64_tr_b16 a[246:247], v98 offset:12288
    s_waitcnt lgkmcnt(4)
    s_waitcnt vmcnt(14)
    v_mfma_f32_16x16x32_bf16 v[192:195], a[224:227], a[32:35], v[192:195]
    ds_read_b64_tr_b16 a[248:249], v99 offset:0
    v_mfma_f32_16x16x32_bf16 v[192:195], a[228:231], a[36:39], v[192:195]
    ds_read_b64_tr_b16 a[250:251], v99 offset:4096
    v_mfma_f32_16x16x32_bf16 v[196:199], a[228:231], a[44:47], v[196:199]
    ds_read_b64_tr_b16 a[252:253], v99 offset:8192
    v_mfma_f32_16x16x32_bf16 v[196:199], a[224:227], a[40:43], v[196:199]
    ds_read_b64_tr_b16 a[254:255], v99 offset:12288
    v_mfma_f32_16x16x32_bf16 v[204:207], a[232:235], a[40:43], v[204:207]
    ds_read_b64_tr_b16 a[192:193], v100 offset:0
    v_mfma_f32_16x16x32_bf16 v[204:207], a[236:239], a[44:47], v[204:207]
    ds_read_b64_tr_b16 a[194:195], v100 offset:4096
    v_mfma_f32_16x16x32_bf16 v[200:203], a[236:239], a[36:39], v[200:203]
    ds_read_b64_tr_b16 a[196:197], v100 offset:8192
    v_mfma_f32_16x16x32_bf16 v[200:203], a[232:235], a[32:35], v[200:203]
    ds_read_b64_tr_b16 a[198:199], v100 offset:12288
    s_waitcnt lgkmcnt(4)
    v_mfma_f32_16x16x32_bf16 v[208:211], a[240:243], a[32:35], v[208:211]
    ds_read_b64_tr_b16 a[200:201], v101 offset:0
    v_mfma_f32_16x16x32_bf16 v[208:211], a[244:247], a[36:39], v[208:211]
    ds_read_b64_tr_b16 a[202:203], v101 offset:4096
    v_mfma_f32_16x16x32_bf16 v[212:215], a[244:247], a[44:47], v[212:215]
    ds_read_b64_tr_b16 a[204:205], v101 offset:8192
    s_waitcnt vmcnt(6)
    v_mfma_f32_16x16x32_bf16 v[212:215], a[240:243], a[40:43], v[212:215]
    ds_read_b64_tr_b16 a[206:207], v101 offset:12288
    s_barrier
    v_mfma_f32_16x16x32_bf16 v[220:223], a[248:251], a[40:43], v[220:223]
    ds_read_b64_tr_b16 a[208:209], v96 offset:16384
    v_mfma_f32_16x16x32_bf16 v[220:223], a[252:255], a[44:47], v[220:223]
    ds_read_b64_tr_b16 a[210:211], v96 offset:20480
    v_mfma_f32_16x16x32_bf16 v[216:219], a[252:255], a[36:39], v[216:219]
    ds_read_b64_tr_b16 a[212:213], v96 offset:24576
    v_mfma_f32_16x16x32_bf16 v[216:219], a[248:251], a[32:35], v[216:219]
    ds_read_b64_tr_b16 a[214:215], v96 offset:28672
    s_waitcnt lgkmcnt(4)
    v_mfma_f32_16x16x32_bf16 v[224:227], a[192:195], a[32:35], v[224:227]
    ds_read_b64_tr_b16 a[216:217], v97 offset:16384
    v_mfma_f32_16x16x32_bf16 v[224:227], a[196:199], a[36:39], v[224:227]
    ds_read_b64_tr_b16 a[218:219], v97 offset:20480
    v_mfma_f32_16x16x32_bf16 v[228:231], a[196:199], a[44:47], v[228:231]
    ds_read_b64_tr_b16 a[220:221], v97 offset:24576
    v_mfma_f32_16x16x32_bf16 v[228:231], a[192:195], a[40:43], v[228:231]
    ds_read_b64_tr_b16 a[222:223], v97 offset:28672
    v_mfma_f32_16x16x32_bf16 v[236:239], a[200:203], a[40:43], v[236:239]
    ds_read_b64_tr_b16 a[224:225], v98 offset:16384
    v_mfma_f32_16x16x32_bf16 v[236:239], a[204:207], a[44:47], v[236:239]
    ds_read_b64_tr_b16 a[226:227], v98 offset:20480
    v_mfma_f32_16x16x32_bf16 v[232:235], a[204:207], a[36:39], v[232:235]
    ds_read_b64_tr_b16 a[228:229], v98 offset:24576
    v_mfma_f32_16x16x32_bf16 v[232:235], a[200:203], a[32:35], v[232:235]
    ds_read_b64_tr_b16 a[230:231], v98 offset:28672
    s_waitcnt lgkmcnt(4)
    s_waitcnt vmcnt(10)
    v_mfma_f32_16x16x32_bf16 v[192:195], a[208:211], a[48:51], v[192:195]
    ds_read_b64_tr_b16 a[232:233], v99 offset:16384
    v_mfma_f32_16x16x32_bf16 v[192:195], a[212:215], a[52:55], v[192:195]
    ds_read_b64_tr_b16 a[234:235], v99 offset:20480
    v_mfma_f32_16x16x32_bf16 v[196:199], a[212:215], a[60:63], v[196:199]
    ds_read_b64_tr_b16 a[236:237], v99 offset:24576
    v_mfma_f32_16x16x32_bf16 v[196:199], a[208:211], a[56:59], v[196:199]
    ds_read_b64_tr_b16 a[238:239], v99 offset:28672
    v_mfma_f32_16x16x32_bf16 v[204:207], a[216:219], a[56:59], v[204:207]
    ds_read_b64_tr_b16 a[240:241], v100 offset:16384
    v_mfma_f32_16x16x32_bf16 v[204:207], a[220:223], a[60:63], v[204:207]
    ds_read_b64_tr_b16 a[242:243], v100 offset:20480
    v_mfma_f32_16x16x32_bf16 v[200:203], a[220:223], a[52:55], v[200:203]
    ds_read_b64_tr_b16 a[244:245], v100 offset:24576
    v_mfma_f32_16x16x32_bf16 v[200:203], a[216:219], a[48:51], v[200:203]
    ds_read_b64_tr_b16 a[246:247], v100 offset:28672
    s_waitcnt lgkmcnt(4)
    v_mfma_f32_16x16x32_bf16 v[208:211], a[224:227], a[48:51], v[208:211]
    ds_read_b64_tr_b16 a[248:249], v101 offset:16384
    v_mfma_f32_16x16x32_bf16 v[208:211], a[228:231], a[52:55], v[208:211]
    ds_read_b64_tr_b16 a[250:251], v101 offset:20480
    v_mfma_f32_16x16x32_bf16 v[212:215], a[228:231], a[60:63], v[212:215]
    ds_read_b64_tr_b16 a[252:253], v101 offset:24576
    v_mfma_f32_16x16x32_bf16 v[212:215], a[224:227], a[56:59], v[212:215]
    ds_read_b64_tr_b16 a[254:255], v101 offset:28672
    v_cvt_pk_bf16_f32 v192, v192, v193
    v_cvt_pk_bf16_f32 v193, v194, v195
    v_mfma_f32_16x16x32_bf16 v[220:223], a[232:235], a[56:59], v[220:223]
    ds_read_b64_tr_b16 a[192:193], v110 offset:32768
    v_cvt_pk_bf16_f32 v194, v200, v201
    v_cvt_pk_bf16_f32 v195, v202, v203
    v_mfma_f32_16x16x32_bf16 v[220:223], a[236:239], a[60:63], v[220:223]
    buffer_store_dwordx4 v[192:195], v1, s[84:87], s88 offen offset:0 sc1
    ds_read_b64_tr_b16 a[194:195], v110 offset:36864
    v_mfma_f32_16x16x32_bf16 v[216:219], a[236:239], a[52:55], v[216:219]
    ds_read_b64_tr_b16 a[196:197], v110 offset:40960
    v_cvt_pk_bf16_f32 v196, v196, v197
    v_cvt_pk_bf16_f32 v197, v198, v199
    v_mfma_f32_16x16x32_bf16 v[216:219], a[232:235], a[48:51], v[216:219]
    ds_read_b64_tr_b16 a[198:199], v110 offset:45056
    s_waitcnt lgkmcnt(4)
    v_cvt_pk_bf16_f32 v198, v204, v205
    v_cvt_pk_bf16_f32 v199, v206, v207
    v_mfma_f32_16x16x32_bf16 v[224:227], a[240:243], a[48:51], v[224:227]
    buffer_store_dwordx4 v[196:199], v1, s[84:87], s88 offen offset:1024 sc1
    ds_read_b64_tr_b16 a[200:201], v111 offset:32768
    v_mfma_f32_16x16x32_bf16 v[224:227], a[244:247], a[52:55], v[224:227]
    ds_read_b64_tr_b16 a[202:203], v111 offset:36864
    v_mfma_f32_16x16x32_bf16 v[228:231], a[244:247], a[60:63], v[228:231]
    ds_read_b64_tr_b16 a[204:205], v111 offset:40960
    v_mfma_f32_16x16x32_bf16 v[228:231], a[240:243], a[56:59], v[228:231]
    ds_read_b64_tr_b16 a[206:207], v111 offset:45056
    v_cvt_pk_bf16_f32 v208, v208, v209
    v_cvt_pk_bf16_f32 v209, v210, v211
    v_mfma_f32_16x16x32_bf16 v[236:239], a[248:251], a[56:59], v[236:239]
    ds_read_b64_tr_b16 a[208:209], v110 offset:49152
    v_cvt_pk_bf16_f32 v210, v216, v217
    v_cvt_pk_bf16_f32 v211, v218, v219
    v_mfma_f32_16x16x32_bf16 v[236:239], a[252:255], a[60:63], v[236:239]
    buffer_store_dwordx4 v[208:211], v1, s[84:87], s89 offen offset:0 sc1
    ds_read_b64_tr_b16 a[210:211], v110 offset:53248
    v_mfma_f32_16x16x32_bf16 v[232:235], a[252:255], a[52:55], v[232:235]
    ds_read_b64_tr_b16 a[212:213], v110 offset:57344
    v_cvt_pk_bf16_f32 v212, v212, v213
    v_cvt_pk_bf16_f32 v213, v214, v215
    v_mfma_f32_16x16x32_bf16 v[232:235], a[248:251], a[48:51], v[232:235]
    ds_read_b64_tr_b16 a[214:215], v110 offset:61440
    s_waitcnt lgkmcnt(4)
    v_cvt_pk_bf16_f32 v214, v220, v221
    v_cvt_pk_bf16_f32 v215, v222, v223
    v_mfma_f32_16x16x32_bf16 v[240:243], a[192:195], a[128:131], v[240:243]
    buffer_store_dwordx4 v[212:215], v1, s[84:87], s89 offen offset:1024 sc1
    ds_read_b64_tr_b16 a[216:217], v111 offset:49152
    v_mfma_f32_16x16x32_bf16 v[240:243], a[196:199], a[132:135], v[240:243]
    ds_read_b64_tr_b16 a[218:219], v111 offset:53248
    v_mfma_f32_16x16x32_bf16 v[244:247], a[196:199], a[140:143], v[244:247]
    ds_read_b64_tr_b16 a[220:221], v111 offset:57344
    v_mfma_f32_16x16x32_bf16 v[244:247], a[192:195], a[136:139], v[244:247]
    ds_read_b64_tr_b16 a[222:223], v111 offset:61440
    v_cvt_pk_bf16_f32 v224, v224, v225
    v_cvt_pk_bf16_f32 v225, v226, v227
    v_mfma_f32_16x16x32_bf16 v[252:255], a[200:203], a[136:139], v[252:255]
    ds_read_b64_tr_b16 a[224:225], v118 offset:0
    v_cvt_pk_bf16_f32 v226, v232, v233
    v_cvt_pk_bf16_f32 v227, v234, v235
    v_mfma_f32_16x16x32_bf16 v[252:255], a[204:207], a[140:143], v[252:255]
    buffer_store_dwordx4 v[224:227], v1, s[84:87], s90 offen offset:0 sc1
    ds_read_b64_tr_b16 a[226:227], v118 offset:4096
    v_mfma_f32_16x16x32_bf16 v[248:251], a[204:207], a[132:135], v[248:251]
    ds_read_b64_tr_b16 a[228:229], v118 offset:8192
    v_cvt_pk_bf16_f32 v228, v228, v229
    v_cvt_pk_bf16_f32 v229, v230, v231
    v_mfma_f32_16x16x32_bf16 v[248:251], a[200:203], a[128:131], v[248:251]
    ds_read_b64_tr_b16 a[230:231], v118 offset:12288
    s_waitcnt lgkmcnt(4)
    v_cvt_pk_bf16_f32 v230, v236, v237
    v_cvt_pk_bf16_f32 v231, v238, v239
    v_mfma_f32_16x16x32_bf16 v[240:243], a[208:211], a[144:147], v[240:243]
    buffer_store_dwordx4 v[228:231], v1, s[84:87], s90 offen offset:1024 sc1
    ds_read_b64_tr_b16 a[232:233], v119 offset:0
    v_mfma_f32_16x16x32_bf16 v[240:243], a[212:215], a[148:151], v[240:243]
    ds_read_b64_tr_b16 a[234:235], v119 offset:4096
    v_mfma_f32_16x16x32_bf16 v[244:247], a[212:215], a[156:159], v[244:247]
    ds_read_b64_tr_b16 a[236:237], v119 offset:8192
    v_mfma_f32_16x16x32_bf16 v[244:247], a[208:211], a[152:155], v[244:247]
    ds_read_b64_tr_b16 a[238:239], v119 offset:12288
    v_mfma_f32_16x16x32_bf16 v[252:255], a[216:219], a[152:155], v[252:255]
    ds_read_b64_tr_b16 a[240:241], v118 offset:16384
    v_mfma_f32_16x16x32_bf16 v[252:255], a[220:223], a[156:159], v[252:255]
    ds_read_b64_tr_b16 a[242:243], v118 offset:20480
    v_mfma_f32_16x16x32_bf16 v[248:251], a[220:223], a[148:151], v[248:251]
    ds_read_b64_tr_b16 a[244:245], v118 offset:24576
    v_mfma_f32_16x16x32_bf16 v[248:251], a[216:219], a[144:147], v[248:251]
    ds_read_b64_tr_b16 a[246:247], v118 offset:28672
    s_waitcnt lgkmcnt(4)
    v_mfma_f32_16x16x32_bf16 v[240:243], a[224:227], a[160:163], v[240:243]
    ds_read_b64_tr_b16 a[248:249], v119 offset:16384
    v_mfma_f32_16x16x32_bf16 v[240:243], a[228:231], a[164:167], v[240:243]
    ds_read_b64_tr_b16 a[250:251], v119 offset:20480
    v_mfma_f32_16x16x32_bf16 v[244:247], a[228:231], a[172:175], v[244:247]
    ds_read_b64_tr_b16 a[252:253], v119 offset:24576
    v_mfma_f32_16x16x32_bf16 v[244:247], a[224:227], a[168:171], v[244:247]
    ds_read_b64_tr_b16 a[254:255], v119 offset:28672
    v_mfma_f32_16x16x32_bf16 v[252:255], a[232:235], a[168:171], v[252:255]
    ds_read_b64_tr_b16 a[192:193], v118 offset:32768
    v_mfma_f32_16x16x32_bf16 v[252:255], a[236:239], a[172:175], v[252:255]
    ds_read_b64_tr_b16 a[194:195], v118 offset:36864
    v_mfma_f32_16x16x32_bf16 v[248:251], a[236:239], a[164:167], v[248:251]
    ds_read_b64_tr_b16 a[196:197], v118 offset:40960
    v_mfma_f32_16x16x32_bf16 v[248:251], a[232:235], a[160:163], v[248:251]
    ds_read_b64_tr_b16 a[198:199], v118 offset:45056
    s_waitcnt lgkmcnt(4)
    v_mfma_f32_16x16x32_bf16 v[240:243], a[240:243], a[176:179], v[240:243]
    ds_read_b64_tr_b16 a[200:201], v119 offset:32768
    v_mfma_f32_16x16x32_bf16 v[240:243], a[244:247], a[180:183], v[240:243]
    ds_read_b64_tr_b16 a[202:203], v119 offset:36864
    v_mfma_f32_16x16x32_bf16 v[244:247], a[244:247], a[188:191], v[244:247]
    ds_read_b64_tr_b16 a[204:205], v119 offset:40960
    v_mfma_f32_16x16x32_bf16 v[244:247], a[240:243], a[184:187], v[244:247]
    ds_read_b64_tr_b16 a[206:207], v119 offset:45056
    v_mfma_f32_16x16x32_bf16 v[252:255], a[248:251], a[184:187], v[252:255]
    ds_read_b64_tr_b16 a[208:209], v118 offset:49152
    v_mfma_f32_16x16x32_bf16 v[252:255], a[252:255], a[188:191], v[252:255]
    ds_read_b64_tr_b16 a[210:211], v118 offset:53248
    v_mfma_f32_16x16x32_bf16 v[248:251], a[252:255], a[180:183], v[248:251]
    ds_read_b64_tr_b16 a[212:213], v118 offset:57344
    v_mfma_f32_16x16x32_bf16 v[248:251], a[248:251], a[176:179], v[248:251]
    ds_read_b64_tr_b16 a[214:215], v118 offset:61440
    s_waitcnt lgkmcnt(4)
    v_mfma_f32_16x16x32_bf16 v[240:243], a[192:195], a[0:3], v[240:243]
    ds_read_b64_tr_b16 a[216:217], v119 offset:49152
    v_mfma_f32_16x16x32_bf16 v[240:243], a[196:199], a[4:7], v[240:243]
    ds_read_b64_tr_b16 a[218:219], v119 offset:53248
    v_mfma_f32_16x16x32_bf16 v[244:247], a[196:199], a[12:15], v[244:247]
    ds_read_b64_tr_b16 a[220:221], v119 offset:57344
    v_mfma_f32_16x16x32_bf16 v[244:247], a[192:195], a[8:11], v[244:247]
    ds_read_b64_tr_b16 a[222:223], v119 offset:61440
    v_mfma_f32_16x16x32_bf16 v[252:255], a[200:203], a[8:11], v[252:255]
    ds_read_b64_tr_b16 a[224:225], v102 offset:0
    v_mfma_f32_16x16x32_bf16 v[252:255], a[204:207], a[12:15], v[252:255]
    ds_read_b64_tr_b16 a[226:227], v102 offset:4096
    v_mfma_f32_16x16x32_bf16 v[248:251], a[204:207], a[4:7], v[248:251]
    ds_read_b64_tr_b16 a[228:229], v102 offset:8192
    v_mfma_f32_16x16x32_bf16 v[248:251], a[200:203], a[0:3], v[248:251]
    ds_read_b64_tr_b16 a[230:231], v102 offset:12288
    s_waitcnt lgkmcnt(4)
    v_mfma_f32_16x16x32_bf16 v[240:243], a[208:211], a[16:19], v[240:243]
    ds_read_b64_tr_b16 a[232:233], v103 offset:0
    v_mfma_f32_16x16x32_bf16 v[240:243], a[212:215], a[20:23], v[240:243]
    ds_read_b64_tr_b16 a[234:235], v103 offset:4096
    v_mfma_f32_16x16x32_bf16 v[244:247], a[212:215], a[28:31], v[244:247]
    ds_read_b64_tr_b16 a[236:237], v103 offset:8192
    v_mfma_f32_16x16x32_bf16 v[244:247], a[208:211], a[24:27], v[244:247]
    ds_read_b64_tr_b16 a[238:239], v103 offset:12288
    v_mfma_f32_16x16x32_bf16 v[252:255], a[216:219], a[24:27], v[252:255]
    ds_read_b64_tr_b16 a[240:241], v102 offset:16384
    v_mfma_f32_16x16x32_bf16 v[252:255], a[220:223], a[28:31], v[252:255]
    ds_read_b64_tr_b16 a[242:243], v102 offset:20480
    v_mfma_f32_16x16x32_bf16 v[248:251], a[220:223], a[20:23], v[248:251]
    ds_read_b64_tr_b16 a[244:245], v102 offset:24576
    v_mfma_f32_16x16x32_bf16 v[248:251], a[216:219], a[16:19], v[248:251]
    ds_read_b64_tr_b16 a[246:247], v102 offset:28672
    s_waitcnt lgkmcnt(4)
    v_mfma_f32_16x16x32_bf16 v[240:243], a[224:227], a[32:35], v[240:243]
    ds_read_b64_tr_b16 a[248:249], v103 offset:16384
    v_mfma_f32_16x16x32_bf16 v[240:243], a[228:231], a[36:39], v[240:243]
    ds_read_b64_tr_b16 a[250:251], v103 offset:20480
    s_waitcnt vmcnt(0)
    v_mfma_f32_16x16x32_bf16 v[244:247], a[228:231], a[44:47], v[244:247]
    ds_read_b64_tr_b16 a[252:253], v103 offset:24576
    s_mov_b64 exec, 0xff
    buffer_store_dwordx4 v[24:27], v1, s[84:87], s70 offen offset:384 sc1
    s_mov_b64 exec, -1
    v_mfma_f32_16x16x32_bf16 v[244:247], a[224:227], a[40:43], v[244:247]
    ds_read_b64_tr_b16 a[254:255], v103 offset:28672
    v_mfma_f32_16x16x32_bf16 v[252:255], a[232:235], a[40:43], v[252:255]
    v_mfma_f32_16x16x32_bf16 v[252:255], a[236:239], a[44:47], v[252:255]
    v_mfma_f32_16x16x32_bf16 v[248:251], a[236:239], a[36:39], v[248:251]
    v_mfma_f32_16x16x32_bf16 v[248:251], a[232:235], a[32:35], v[248:251]
    s_waitcnt lgkmcnt(0)
    v_mfma_f32_16x16x32_bf16 v[240:243], a[240:243], a[48:51], v[240:243]
    v_mfma_f32_16x16x32_bf16 v[240:243], a[244:247], a[52:55], v[240:243]
    v_mfma_f32_16x16x32_bf16 v[244:247], a[244:247], a[60:63], v[244:247]
    v_mfma_f32_16x16x32_bf16 v[244:247], a[240:243], a[56:59], v[244:247]
    v_mfma_f32_16x16x32_bf16 v[252:255], a[248:251], a[56:59], v[252:255]
    v_mfma_f32_16x16x32_bf16 v[252:255], a[252:255], a[60:63], v[252:255]
    v_mfma_f32_16x16x32_bf16 v[248:251], a[252:255], a[52:55], v[248:251]
    v_mfma_f32_16x16x32_bf16 v[248:251], a[248:251], a[48:51], v[248:251]
    s_waitcnt vmcnt(63)
    s_waitcnt vmcnt(7)
    v_lshlrev_b32 v2, 16, v44
    v_and_b32 v3, 0xffff0000, v44
    v_pk_add_f32 v[176:177], v[176:177], v[2:3]
    v_lshlrev_b32 v4, 16, v45
    v_and_b32 v5, 0xffff0000, v45
    v_pk_add_f32 v[178:179], v[178:179], v[4:5]
    v_lshlrev_b32 v2, 16, v46
    v_and_b32 v3, 0xffff0000, v46
    v_pk_add_f32 v[184:185], v[184:185], v[2:3]
    v_lshlrev_b32 v4, 16, v47
    v_and_b32 v5, 0xffff0000, v47
    v_pk_add_f32 v[186:187], v[186:187], v[4:5]
    v_lshlrev_b32 v2, 16, v64
    v_and_b32 v3, 0xffff0000, v64
    v_pk_add_f32 v[176:177], v[176:177], v[2:3]
    v_lshlrev_b32 v4, 16, v65
    v_and_b32 v5, 0xffff0000, v65
    v_pk_add_f32 v[178:179], v[178:179], v[4:5]
    v_lshlrev_b32 v2, 16, v66
    v_and_b32 v3, 0xffff0000, v66
    v_pk_add_f32 v[184:185], v[184:185], v[2:3]
    v_lshlrev_b32 v4, 16, v67
    v_and_b32 v5, 0xffff0000, v67
    v_pk_add_f32 v[186:187], v[186:187], v[4:5]
    v_lshlrev_b32 v2, 16, v72
    v_and_b32 v3, 0xffff0000, v72
    v_pk_add_f32 v[176:177], v[176:177], v[2:3]
    v_lshlrev_b32 v4, 16, v73
    v_and_b32 v5, 0xffff0000, v73
    v_pk_add_f32 v[178:179], v[178:179], v[4:5]
    v_lshlrev_b32 v2, 16, v74
    v_and_b32 v3, 0xffff0000, v74
    v_pk_add_f32 v[184:185], v[184:185], v[2:3]
    v_lshlrev_b32 v4, 16, v75
    v_and_b32 v5, 0xffff0000, v75
    v_pk_add_f32 v[186:187], v[186:187], v[4:5]
    v_lshlrev_b32 v2, 16, v80
    v_and_b32 v3, 0xffff0000, v80
    v_pk_add_f32 v[176:177], v[176:177], v[2:3]
    v_lshlrev_b32 v4, 16, v81
    v_and_b32 v5, 0xffff0000, v81
    v_pk_add_f32 v[178:179], v[178:179], v[4:5]
    v_lshlrev_b32 v2, 16, v82
    v_and_b32 v3, 0xffff0000, v82
    v_pk_add_f32 v[184:185], v[184:185], v[2:3]
    v_lshlrev_b32 v4, 16, v83
    v_and_b32 v5, 0xffff0000, v83
    v_pk_add_f32 v[186:187], v[186:187], v[4:5]
    v_lshlrev_b32 v2, 16, v44
    v_and_b32 v3, 0xffff0000, v44
    v_pk_add_f32 v[180:181], v[180:181], v[2:3]
    v_lshlrev_b32 v4, 16, v45
    v_and_b32 v5, 0xffff0000, v45
    v_pk_add_f32 v[182:183], v[182:183], v[4:5]
    v_lshlrev_b32 v2, 16, v46
    v_and_b32 v3, 0xffff0000, v46
    v_pk_add_f32 v[188:189], v[188:189], v[2:3]
    v_lshlrev_b32 v4, 16, v47
    v_and_b32 v5, 0xffff0000, v47
    v_pk_add_f32 v[190:191], v[190:191], v[4:5]
    v_lshlrev_b32 v2, 16, v68
    v_and_b32 v3, 0xffff0000, v68
    v_pk_add_f32 v[180:181], v[180:181], v[2:3]
    v_lshlrev_b32 v4, 16, v69
    v_and_b32 v5, 0xffff0000, v69
    v_pk_add_f32 v[182:183], v[182:183], v[4:5]
    v_lshlrev_b32 v2, 16, v70
    v_and_b32 v3, 0xffff0000, v70
    v_pk_add_f32 v[188:189], v[188:189], v[2:3]
    v_lshlrev_b32 v4, 16, v71
    s_mov_b64 exec, 7
    buffer_load_dword v22, v30, s[84:87], 0 offen offset:384 sc1
    s_mov_b64 exec, -1
    v_and_b32 v5, 0xffff0000, v71
    v_pk_add_f32 v[190:191], v[190:191], v[4:5]
    v_lshlrev_b32 v2, 16, v76
    v_and_b32 v3, 0xffff0000, v76
    v_pk_add_f32 v[180:181], v[180:181], v[2:3]
    v_lshlrev_b32 v4, 16, v77
    v_and_b32 v5, 0xffff0000, v77
    v_pk_add_f32 v[182:183], v[182:183], v[4:5]
    v_lshlrev_b32 v2, 16, v78
    v_and_b32 v3, 0xffff0000, v78
    v_pk_add_f32 v[188:189], v[188:189], v[2:3]
    v_lshlrev_b32 v4, 16, v79
    v_and_b32 v5, 0xffff0000, v79
    v_pk_add_f32 v[190:191], v[190:191], v[4:5]
    v_lshlrev_b32 v2, 16, v84
    v_and_b32 v3, 0xffff0000, v84
    v_pk_add_f32 v[180:181], v[180:181], v[2:3]
    v_lshlrev_b32 v4, 16, v85
    v_and_b32 v5, 0xffff0000, v85
    v_pk_add_f32 v[182:183], v[182:183], v[4:5]
    v_lshlrev_b32 v2, 16, v86
    v_and_b32 v3, 0xffff0000, v86
    v_pk_add_f32 v[188:189], v[188:189], v[2:3]
    v_lshlrev_b32 v4, 16, v87
    v_and_b32 v5, 0xffff0000, v87
    v_pk_add_f32 v[190:191], v[190:191], v[4:5]
    v_bfe_u32 v2, v1, 8, 1
    v_mul_u32_u24 v2, 24, v2
    v_add_u32 v18, v18, v2
    v_add_u32 v19, v19, v2
    v_mul_f32 v64, 0xbfb8aa3b, v176
    v_mul_f32 v65, 0xbfb8aa3b, v177
    v_mul_f32 v66, 0xbfb8aa3b, v178
    v_mul_f32 v67, 0xbfb8aa3b, v179
    v_mul_f32 v68, 0xbfb8aa3b, v180
    v_mul_f32 v69, 0xbfb8aa3b, v181
    v_mul_f32 v70, 0xbfb8aa3b, v182
    v_mul_f32 v71, 0xbfb8aa3b, v183
    v_mul_f32 v72, 0xbfb8aa3b, v184
    v_mul_f32 v73, 0xbfb8aa3b, v185
    v_mul_f32 v74, 0xbfb8aa3b, v186
    v_mul_f32 v75, 0xbfb8aa3b, v187
    v_mul_f32 v76, 0xbfb8aa3b, v188
    v_mul_f32 v77, 0xbfb8aa3b, v189
    v_mul_f32 v78, 0xbfb8aa3b, v190
    v_mul_f32 v79, 0xbfb8aa3b, v191
    v_exp_f32 v64, v64
    v_exp_f32 v65, v65
    v_exp_f32 v66, v66
    v_exp_f32 v67, v67
    v_exp_f32 v68, v68
    v_exp_f32 v69, v69
    v_exp_f32 v70, v70
    v_exp_f32 v71, v71
    v_exp_f32 v72, v72
    v_exp_f32 v73, v73
    v_exp_f32 v74, v74
    v_exp_f32 v75, v75
    v_exp_f32 v76, v76
    v_exp_f32 v77, v77
    v_exp_f32 v78, v78
    v_exp_f32 v79, v79
    v_pk_add_f32 v[64:65], v[64:65], 1.0 op_sel_hi:[1,0]
    v_pk_add_f32 v[66:67], v[66:67], 1.0 op_sel_hi:[1,0]
    v_pk_add_f32 v[68:69], v[68:69], 1.0 op_sel_hi:[1,0]
    v_pk_add_f32 v[70:71], v[70:71], 1.0 op_sel_hi:[1,0]
    v_pk_add_f32 v[72:73], v[72:73], 1.0 op_sel_hi:[1,0]
    v_pk_add_f32 v[74:75], v[74:75], 1.0 op_sel_hi:[1,0]
    v_pk_add_f32 v[76:77], v[76:77], 1.0 op_sel_hi:[1,0]
    v_pk_add_f32 v[78:79], v[78:79], 1.0 op_sel_hi:[1,0]
    v_rcp_f32 v64, v64
    v_rcp_f32 v65, v65
    v_rcp_f32 v66, v66
    v_rcp_f32 v67, v67
    v_rcp_f32 v68, v68
    v_rcp_f32 v69, v69
    v_rcp_f32 v70, v70
    v_rcp_f32 v71, v71
    v_rcp_f32 v72, v72
    v_rcp_f32 v73, v73
    v_rcp_f32 v74, v74
    v_rcp_f32 v75, v75
    v_rcp_f32 v76, v76
    v_rcp_f32 v77, v77
    v_rcp_f32 v78, v78
    v_rcp_f32 v79, v79
    v_pk_mul_f32 v[176:177], v[176:177], v[64:65]
    v_pk_mul_f32 v[178:179], v[178:179], v[66:67]
    v_pk_mul_f32 v[180:181], v[180:181], v[68:69]
    v_pk_mul_f32 v[182:183], v[182:183], v[70:71]
    v_pk_mul_f32 v[184:185], v[184:185], v[72:73]
    v_pk_mul_f32 v[186:187], v[186:187], v[74:75]
    v_pk_mul_f32 v[188:189], v[188:189], v[76:77]
    v_pk_mul_f32 v[190:191], v[190:191], v[78:79]
    v_lshlrev_b32 v64, 16, v88
    v_and_b32 v65, 0xffff0000, v88
    v_lshlrev_b32 v66, 16, v89
    v_and_b32 v67, 0xffff0000, v89
    v_lshlrev_b32 v68, 16, v90
    v_and_b32 v69, 0xffff0000, v90
    v_lshlrev_b32 v70, 16, v91
    v_and_b32 v71, 0xffff0000, v91
    v_lshlrev_b32 v72, 16, v92
    v_and_b32 v73, 0xffff0000, v92
    v_lshlrev_b32 v74, 16, v93
    v_and_b32 v75, 0xffff0000, v93
    v_lshlrev_b32 v76, 16, v94
    v_and_b32 v77, 0xffff0000, v94
    v_lshlrev_b32 v78, 16, v95
    v_and_b32 v79, 0xffff0000, v95
    v_pk_fma_f32 v[64:65], v[240:241], v[176:177], v[64:65]
    v_pk_fma_f32 v[66:67], v[242:243], v[178:179], v[66:67]
    v_pk_fma_f32 v[68:69], v[248:249], v[184:185], v[68:69]
    v_pk_fma_f32 v[70:71], v[250:251], v[186:187], v[70:71]
    v_pk_fma_f32 v[72:73], v[244:245], v[180:181], v[72:73]
    v_pk_fma_f32 v[74:75], v[246:247], v[182:183], v[74:75]
    v_pk_fma_f32 v[76:77], v[252:253], v[188:189], v[76:77]
    v_pk_fma_f32 v[78:79], v[254:255], v[190:191], v[78:79]
    s_waitcnt vmcnt(0)
    v_cmp_ne_u32 vcc, 0x3f803f80, v22
    s_nop 0
    s_and_b32 s3, vcc_lo, 7
    s_cbranch_scc1 L1_ps_spin
L1_ps_ok:
    s_add_u32 s81, s83, 24576
    buffer_load_dwordx4 v[128:131], v1, s[84:87], s81 offen offset:0 sc1
    buffer_load_dwordx4 v[132:135], v1, s[84:87], s81 offen offset:1024 sc1
    s_add_u32 s81, s83, 32768
    buffer_load_dwordx4 v[136:139], v1, s[84:87], s81 offen offset:0 sc1
    buffer_load_dwordx4 v[140:143], v1, s[84:87], s81 offen offset:1024 sc1
    s_add_u32 s81, s83, 40960
    buffer_load_dwordx4 v[144:147], v1, s[84:87], s81 offen offset:0 sc1
    buffer_load_dwordx4 v[148:151], v1, s[84:87], s81 offen offset:1024 sc1
    s_waitcnt vmcnt(4)
    v_lshlrev_b32 v2, 16, v128
    v_and_b32 v3, 0xffff0000, v128
    v_pk_fma_f32 v[64:65], v[2:3], v[176:177], v[64:65]
    v_lshlrev_b32 v4, 16, v129
    v_and_b32 v5, 0xffff0000, v129
    v_pk_fma_f32 v[66:67], v[4:5], v[178:179], v[66:67]
    v_lshlrev_b32 v2, 16, v130
    v_and_b32 v3, 0xffff0000, v130
    v_pk_fma_f32 v[68:69], v[2:3], v[184:185], v[68:69]
    v_lshlrev_b32 v4, 16, v131
    v_and_b32 v5, 0xffff0000, v131
    v_pk_fma_f32 v[70:71], v[4:5], v[186:187], v[70:71]
    v_lshlrev_b32 v2, 16, v132
    v_and_b32 v3, 0xffff0000, v132
    v_pk_fma_f32 v[72:73], v[2:3], v[180:181], v[72:73]
    v_lshlrev_b32 v4, 16, v133
    v_and_b32 v5, 0xffff0000, v133
    v_pk_fma_f32 v[74:75], v[4:5], v[182:183], v[74:75]
    v_lshlrev_b32 v2, 16, v134
    v_and_b32 v3, 0xffff0000, v134
    v_pk_fma_f32 v[76:77], v[2:3], v[188:189], v[76:77]
    v_lshlrev_b32 v4, 16, v135
    v_and_b32 v5, 0xffff0000, v135
    v_pk_fma_f32 v[78:79], v[4:5], v[190:191], v[78:79]
    s_waitcnt vmcnt(2)
    v_lshlrev_b32 v2, 16, v136
    v_and_b32 v3, 0xffff0000, v136
    v_pk_fma_f32 v[64:65], v[2:3], v[176:177], v[64:65]
    v_lshlrev_b32 v4, 16, v137
L1_pc11:
    s_cbranch_execz L1_pgret
    v_and_b32 v5, 0xffff0000, v137
    v_pk_fma_f32 v[66:67], v[4:5], v[178:179], v[66:67]
    v_lshlrev_b32 v2, 16, v138
    v_and_b32 v3, 0xffff0000, v138
    v_pk_fma_f32 v[68:69], v[2:3], v[184:185], v[68:69]
    v_lshlrev_b32 v4, 16, v139
    v_and_b32 v5, 0xffff0000, v139
    v_pk_fma_f32 v[70:71], v[4:5], v[186:187], v[70:71]
    v_lshlrev_b32 v2, 16, v140
    v_and_b32 v3, 0xffff0000, v140
    v_pk_fma_f32 v[72:73], v[2:3], v[180:181], v[72:73]
    v_lshlrev_b32 v4, 16, v141
    v_and_b32 v5, 0xffff0000, v141
    v_pk_fma_f32 v[74:75], v[4:5], v[182:183], v[74:75]
    v_lshlrev_b32 v2, 16, v142
    v_and_b32 v3, 0xffff0000, v142
    v_pk_fma_f32 v[76:77], v[2:3], v[188:189], v[76:77]
    v_lshlrev_b32 v4, 16, v143
    v_and_b32 v5, 0xffff0000, v143
    v_pk_fma_f32 v[78:79], v[4:5], v[190:191], v[78:79]
    s_waitcnt vmcnt(0)
    v_lshlrev_b32 v2, 16, v144
    v_and_b32 v3, 0xffff0000, v144
    v_pk_fma_f32 v[64:65], v[2:3], v[176:177], v[64:65]
    v_cvt_pk_bf16_f32 v88, v64, v65
    v_lshlrev_b32 v4, 16, v145
    v_and_b32 v5, 0xffff0000, v145
    v_pk_fma_f32 v[66:67], v[4:5], v[178:179], v[66:67]
    v_cvt_pk_bf16_f32 v89, v66, v67
    v_lshlrev_b32 v2, 16, v146
    v_and_b32 v3, 0xffff0000, v146
    v_pk_fma_f32 v[68:69], v[2:3], v[184:185], v[68:69]
    v_cvt_pk_bf16_f32 v90, v68, v69
    v_lshlrev_b32 v4, 16, v147
    v_and_b32 v5, 0xffff0000, v147
    v_pk_fma_f32 v[70:71], v[4:5], v[186:187], v[70:71]
    v_cvt_pk_bf16_f32 v91, v70, v71
    v_permlane16_swap_b32 v88, v90
    s_nop 0
    v_permlane16_swap_b32 v89, v91
    buffer_store_dwordx4 v[88:91], v18, s[48:51], 0 offen sc1
    v_lshlrev_b32 v2, 16, v148
    v_and_b32 v3, 0xffff0000, v148
    v_pk_fma_f32 v[72:73], v[2:3], v[180:181], v[72:73]
    v_cvt_pk_bf16_f32 v92, v72, v73
    v_lshlrev_b32 v4, 16, v149
    v_and_b32 v5, 0xffff0000, v149
    v_pk_fma_f32 v[74:75], v[4:5], v[182:183], v[74:75]
    v_cvt_pk_bf16_f32 v93, v74, v75
    v_lshlrev_b32 v2, 16, v150
    v_and_b32 v3, 0xffff0000, v150
    v_pk_fma_f32 v[76:77], v[2:3], v[188:189], v[76:77]
    v_cvt_pk_bf16_f32 v94, v76, v77
    v_lshlrev_b32 v4, 16, v151
    v_and_b32 v5, 0xffff0000, v151
    v_pk_fma_f32 v[78:79], v[4:5], v[190:191], v[78:79]
    v_cvt_pk_bf16_f32 v95, v78, v79
    v_permlane16_swap_b32 v92, v94
    s_nop 0
    v_permlane16_swap_b32 v93, v95
    buffer_store_dwordx4 v[92:95], v19, s[48:51], 0 offen sc1
L1_last:
    s_endpgm
.section .rodata,"a"
.p2align 6
.amdhsa_kernel recurrent_scan__gqa_block_cached__dense_activation_gelu__prompt_kernel
  .amdhsa_next_free_vgpr 512
  .amdhsa_next_free_sgpr 102
  .amdhsa_accum_offset 256
  .amdhsa_group_segment_fixed_size 0
  .amdhsa_kernarg_size 104
  .amdhsa_user_sgpr_count 2
  .amdhsa_user_sgpr_kernarg_segment_ptr 1
  .amdhsa_system_sgpr_workgroup_id_x 1
  .amdhsa_float_denorm_mode_32 3
.end_amdhsa_kernel
```
